```python
import torch

def _softmax(x, axis=-1):
    return torch.softmax(x, dim=axis)
def _gelu(x):
    return torch.nn.functional.gelu(x, approximate="tanh")
def _silu(x):
    return torch.nn.functional.silu(x)
def _sigmoid(x):
    return torch.sigmoid(x)
def _layernorm(x, axis=-1, eps=1e-5):
    m = x.mean(dim=axis, keepdim=True)
    v = x.var(dim=axis, keepdim=True, unbiased=False)
    return (x - m) / torch.sqrt(v + eps)
def _scatter_add(tgt, idx, src, axis=0):
    return tgt.clone().index_add_(axis, idx, src)
def _segment_sum(src, seg, n):
    out = torch.zeros((n,) + src.shape[1:], dtype=src.dtype)
    return out.index_add_(0, seg, src)
def _pad(x, pw):
    flat = tuple(v for pair in reversed(pw) for v in pair)
    return torch.nn.functional.pad(x, flat)

kernel_name = 'interleave_layers__softmax_full_mha__sliding_local_dilated__prompt'

def setup_inputs():

    _w = (lambda a: (lambda t: t.to(torch.bfloat16) if t.is_floating_point() else t)(torch.as_tensor(a)))
    def _A_setup():
        B, S, D = 1, 2048, 640
        return {
            "x": _w((lambda *s: torch.randn(*s, dtype=torch.bfloat16) * 0.05)(B, S, D)),
            "wqkv": _w((lambda *s: torch.randn(*s, dtype=torch.bfloat16) * 0.05)(D, 3 * D)),
            "wo": _w((lambda *s: torch.randn(*s, dtype=torch.bfloat16) * 0.05)(D, D)),
        }
    _A_in = _A_setup()

    def _B_setup():
        B, S, D = 1, 2048, 640
        return {
            "x": _w((lambda *s: torch.randn(*s, dtype=torch.bfloat16) * 0.05)(B, S, D)),
            "wqkv": _w((lambda *s: torch.randn(*s, dtype=torch.bfloat16) * 0.05)(D, 3 * D)),
            "wo": _w((lambda *s: torch.randn(*s, dtype=torch.bfloat16) * 0.05)(D, D)),
        }
    _B_in = _B_setup()

    return {
        "A_x": _A_in["x"],
        "A_wqkv": _A_in["wqkv"],
        "A_wo": _A_in["wo"],
        "B_x": _B_in["x"],
        "B_wqkv": _B_in["wqkv"],
        "B_wo": _B_in["wo"],
    }

def reference(A_x, A_wqkv, A_wo, B_x, B_wqkv, B_wo):
    def _A_ref(x, wqkv, wo):
        B, S, D = x.shape
        H = 32; Dh = D // H
        qkv = (lambda x, *d: x.permute(*d))((x @ wqkv).reshape(B, S, 3, H, Dh), 2, 0, 3, 1, 4)
        q, k, v = qkv[0], qkv[1], qkv[2]
        scale = Dh ** -0.5
        scores = torch.einsum("bhqd,bhkd->bhqk", q, k) * scale
        p = _softmax(scores, axis=-1)
        o = torch.einsum("bhqk,bhkd->bhqd", p, v)
        return (lambda x, *d: x.permute(*d))(o, 0, 2, 1, 3).reshape(B, S, D) @ wo

    def _B_ref(x, wqkv, wo):
        B, S, D = x.shape
        H = 32; Dh = D // H
        W, dil = 8, 2
        qkv = (lambda x, *d: x.permute(*d))((x @ wqkv).reshape(B, S, 3, H, Dh), 2, 0, 3, 1, 4)
        q, k, v = qkv[0], qkv[1], qkv[2]
        scale = Dh ** -0.5
        pos = torch.arange(S)
        off = torch.arange(W) * dil
        idx = pos[:, None] - off[None, :]
        mask = idx >= 0
        idx_c = torch.where(mask, idx, 0).reshape(-1)
        kg = k[:, :, idx_c, :].reshape(B, H, S, W, Dh)
        vg = v[:, :, idx_c, :].reshape(B, H, S, W, Dh)
        logits = torch.einsum("bhsd,bhswd->bhsw", q, kg) * scale
        logits = torch.where(mask[None, None, :, :], logits, -1e9)
        attn = _softmax(logits, axis=-1)
        o = torch.einsum("bhsw,bhswd->bhsd", attn, vg)
        return (lambda x, *d: x.permute(*d))(o, 0, 2, 1, 3).reshape(B, S, D) @ wo

    x = A_x
    x = x + _A_ref(_layernorm(x, axis=-1), A_wqkv, A_wo)
    x = x + _B_ref(_layernorm(x, axis=-1), B_wqkv, B_wo)
    x = x + _A_ref(_layernorm(x, axis=-1), A_wqkv, A_wo)
    x = x + _B_ref(_layernorm(x, axis=-1), B_wqkv, B_wo)
    return x
```

```asm
; @launch grid=(256,1,1) block=(512,1,1) lds=163840
.amdgcn_target "amdgcn-amd-amdhsa--gfx950"

.text
.globl interleave_layers__softmax_full_mha__sliding_local_dilated__prompt_kernel
.p2align 8
.type interleave_layers__softmax_full_mha__sliding_local_dilated__prompt_kernel,@function
interleave_layers__softmax_full_mha__sliding_local_dilated__prompt_kernel:
    s_cmp_ge_u32 s2, 256
    s_cbranch_scc1 interleave_layers__softmax_full_mha__sliding_local_dilated__prompt_kernel_end
    s_load_dwordx4 s[60:63], s[0:1], 0
    s_load_dwordx2 s[6:7], s[0:1], 64
    s_load_dwordx2 s[4:5], s[0:1], 56
    s_and_b32 s20, s2, 7
    s_lshr_b32 s21, s2, 3
    v_lshrrev_b32 v2, 6, v0
    v_and_b32 v1, 63, v0
    v_readfirstlane_b32 s18, v2
    s_and_b32 s39, s18, 3
    s_lshl_b32 s45, s39, 10
    s_lshl_b32 s22, s20, 1
    s_and_b32 s23, s21, 1
    s_add_u32 s16, s22, s23
    s_lshr_b32 s17, s21, 1
    v_lshlrev_b32 v3, 4, v1
    v_lshlrev_b32 v9, 6, v1
    s_lshl_b32 s22, s2, 2
    s_add_u32 s22, s22, s39
    s_mul_i32 s23, s22, 2400
    s_lshl_b32 s22, s20, 5
    s_add_u32 s22, s22, s21
    s_lshl_b32 s22, s22, 2
    s_add_u32 s22, s22, s39
    s_mul_i32 s22, s22, 2560
    s_cmp_ge_u32 s17, 15
    s_cbranch_scc1 interleave_layers__softmax_full_mha__sliding_local_dilated__prompt_kernel_f_ub
    v_and_b32 v10, 31, v1
    v_lshrrev_b32 v4, 5, v1
    v_and_b32 v5, 15, v1
    v_bfe_u32 v7, v1, 4, 1
    v_lshrrev_b32 v13, 2, v5
    v_and_b32 v6, 3, v1
    v_lshl_add_u32 v14, v4, 3, v13
    v_lshlrev_b32 v14, 8, v14
    v_lshl_add_u32 v14, v7, 5, v14
    v_lshl_add_u32 v14, v6, 3, v14
    v_add_u32 v14, 16384, v14
    s_cmp_ge_u32 s18, 4
    s_cbranch_scc1 interleave_layers__softmax_full_mha__sliding_local_dilated__prompt_kernel_f_ld
    s_waitcnt lgkmcnt(0)
    s_mov_b32 s8, s60
    s_and_b32 s9, s61, 0xffff
    s_mov_b32 s10, 2621440
    s_mov_b32 s11, 0x20000
    s_mov_b32 s28, s62
    s_and_b32 s29, s63, 0xffff
    s_mov_b32 s30, 2457600
    s_mov_b32 s31, 0x20000
    s_mov_b32 s12, s6
    s_and_b32 s13, s7, 0xffff
    s_mov_b32 s14, 29851648
    s_mov_b32 s15, 0x20000
    s_mov_b32 exec_hi, 0xff
    buffer_load_dword v240, v9, s[8:11], s22 offen
    buffer_load_dword v241, v9, s[28:31], s23 offen
    s_mov_b64 exec, -1
    s_getpc_b64 s[34:35]
interleave_layers__softmax_full_mha__sliding_local_dilated__prompt_kernel_f_pcc:
    s_sub_u32 s34, s34, interleave_layers__softmax_full_mha__sliding_local_dilated__prompt_kernel_f_pcc - interleave_layers__softmax_full_mha__sliding_local_dilated__prompt_kernel
    s_subb_u32 s35, s35, 0
    v_lshlrev_b32 v242, 4, v0
    s_lshl_b32 s36, s21, 12
    v_add_u32 v242, s36, v242
    v_and_b32 v242, 0xffffffc0, v242
    v_min_u32 v242, code_end - interleave_layers__softmax_full_mha__sliding_local_dilated__prompt_kernel - 4, v242
    global_load_dword v243, v242, s[34:35]
    s_lshl_b32 s19, s16, 2
    s_add_u32 s19, s19, s18
    v_xor_b32 v15, 0, v13
    v_lshl_add_u32 v216, v15, 6, v14
    v_add_u32 v220, 65536, v216
    v_xor_b32 v15, 1, v13
    v_lshl_add_u32 v217, v15, 6, v14
    v_add_u32 v221, 65536, v217
    v_xor_b32 v15, 2, v13
    v_lshl_add_u32 v218, v15, 6, v14
    v_add_u32 v222, 65536, v218
    v_xor_b32 v15, 3, v13
    v_lshl_add_u32 v219, v15, 6, v14
    v_add_u32 v223, 65536, v219
    v_lshl_add_u32 v15, v2, 5, v10
    v_lshlrev_b32 v15, 7, v15
    v_bfe_u32 v12, v10, 1, 3
    v_xor_b32 v12, v12, v4
    v_xor_b32 v11, 0, v12
    v_lshl_add_u32 v224, v11, 4, v15
    v_add_u32 v228, 65536, v224
    v_xor_b32 v11, 2, v12
    v_lshl_add_u32 v225, v11, 4, v15
    v_add_u32 v229, 65536, v225
    v_xor_b32 v11, 4, v12
    v_lshl_add_u32 v226, v11, 4, v15
    v_add_u32 v230, 65536, v226
    v_xor_b32 v11, 6, v12
    v_lshl_add_u32 v227, v11, 4, v15
    v_add_u32 v231, 65536, v227
    v_mul_u32_u24 v8, 20480, v7
    v_lshl_add_u32 v8, v4, 8, v8
    v_lshl_add_u32 v8, v5, 4, v8
    s_mul_i32 s24, s19, 40960
    s_add_u32 s24, s24, 131072
    v_subrev_u32 v58, 1, v4
    v_not_b32 v59, v58
    s_lshl_b32 s40, s2, 2
    s_add_u32 s40, s40, s39
    s_mul_i32 s40, s40, 8192
    s_add_u32 s40, s40, 2883584
    v_lshlrev_b32 v238, 7, v1
    s_cmp_ge_u32 s17, 10
    s_cbranch_scc1 interleave_layers__softmax_full_mha__sliding_local_dilated__prompt_kernel_f_qv
    s_barrier
    ds_read_b128 v[160:163], v224 offset:0
    ds_read_b128 v[164:167], v225 offset:0
    ds_read_b64_tr_b16 v[128:129], v216 offset:0
    ds_read_b64_tr_b16 v[130:131], v216 offset:1024
    ds_read_b64_tr_b16 v[132:133], v217 offset:0
    ds_read_b64_tr_b16 v[134:135], v217 offset:1024
    ds_read_b64_tr_b16 v[136:137], v218 offset:0
    ds_read_b64_tr_b16 v[138:139], v218 offset:1024
    ds_read_b64_tr_b16 v[140:141], v219 offset:0
    ds_read_b64_tr_b16 v[142:143], v219 offset:1024
    ds_read_b64_tr_b16 v[144:145], v216 offset:4096
    ds_read_b64_tr_b16 v[146:147], v216 offset:5120
    ds_read_b64_tr_b16 v[148:149], v217 offset:4096
    ds_read_b64_tr_b16 v[150:151], v217 offset:5120
    ds_read_b64_tr_b16 v[152:153], v218 offset:4096
    ds_read_b64_tr_b16 v[154:155], v218 offset:5120
    ds_read_b64_tr_b16 v[156:157], v219 offset:4096
    ds_read_b64_tr_b16 v[158:159], v219 offset:5120
    s_waitcnt lgkmcnt(12)
    v_mfma_f32_32x32x16_bf16 v[64:79], v[128:131], v[160:163], 0
    ds_read_b128 v[168:171], v226 offset:0
    ds_read_b128 v[172:175], v227 offset:0
    ds_read_b64_tr_b16 v[128:129], v216 offset:8192
    ds_read_b64_tr_b16 v[130:131], v216 offset:9216
    v_mfma_f32_32x32x16_bf16 v[80:95], v[132:135], v[160:163], 0
    ds_read_b64_tr_b16 v[132:133], v217 offset:8192
    ds_read_b64_tr_b16 v[134:135], v217 offset:9216
    s_waitcnt lgkmcnt(14)
    v_mfma_f32_32x32x16_bf16 v[96:111], v[136:139], v[160:163], 0
    ds_read_b64_tr_b16 v[136:137], v218 offset:8192
    ds_read_b64_tr_b16 v[138:139], v218 offset:9216
    v_mfma_f32_32x32x16_bf16 v[112:127], v[140:143], v[160:163], 0
    ds_read_b64_tr_b16 v[140:141], v219 offset:8192
    ds_read_b64_tr_b16 v[142:143], v219 offset:9216
    s_waitcnt lgkmcnt(14)
    v_mfma_f32_32x32x16_bf16 v[64:79], v[144:147], v[164:167], v[64:79]
    ds_read_b64_tr_b16 v[144:145], v216 offset:12288
    ds_read_b64_tr_b16 v[146:147], v216 offset:13312
    v_mfma_f32_32x32x16_bf16 v[80:95], v[148:151], v[164:167], v[80:95]
    ds_read_b64_tr_b16 v[148:149], v217 offset:12288
    ds_read_b64_tr_b16 v[150:151], v217 offset:13312
    s_waitcnt lgkmcnt(14)
    v_mfma_f32_32x32x16_bf16 v[96:111], v[152:155], v[164:167], v[96:111]
    ds_read_b64_tr_b16 v[152:153], v218 offset:12288
    ds_read_b64_tr_b16 v[154:155], v218 offset:13312
    v_mfma_f32_32x32x16_bf16 v[112:127], v[156:159], v[164:167], v[112:127]
    ds_read_b64_tr_b16 v[156:157], v219 offset:12288
    ds_read_b64_tr_b16 v[158:159], v219 offset:13312
    s_cmp_eq_u32 s17, 0
    s_cbranch_scc0 interleave_layers__softmax_full_mha__sliding_local_dilated__prompt_kernel_f_xq0
    s_add_u32 s32, s24, 0
    buffer_store_dwordx4 v[160:163], v8, s[12:15], s32 offen offset:0 sc1
    buffer_store_dwordx4 v[164:167], v8, s[12:15], s32 offen offset:512 sc1
interleave_layers__softmax_full_mha__sliding_local_dilated__prompt_kernel_f_xq0:
    s_waitcnt lgkmcnt(12)
    v_mfma_f32_32x32x16_bf16 v[64:79], v[128:131], v[168:171], v[64:79]
    s_barrier
    ds_read_b128 v[176:179], v224 offset:32768
    ds_read_b128 v[180:183], v225 offset:32768
    ds_read_b64_tr_b16 v[128:129], v216 offset:32768
    ds_read_b64_tr_b16 v[130:131], v216 offset:33792
    v_mfma_f32_32x32x16_bf16 v[80:95], v[132:135], v[168:171], v[80:95]
    ds_read_b64_tr_b16 v[132:133], v217 offset:32768
    ds_read_b64_tr_b16 v[134:135], v217 offset:33792
    s_waitcnt lgkmcnt(14)
    v_mfma_f32_32x32x16_bf16 v[96:111], v[136:139], v[168:171], v[96:111]
    ds_read_b64_tr_b16 v[136:137], v218 offset:32768
    ds_read_b64_tr_b16 v[138:139], v218 offset:33792
    v_mfma_f32_32x32x16_bf16 v[112:127], v[140:143], v[168:171], v[112:127]
    ds_read_b64_tr_b16 v[140:141], v219 offset:32768
    ds_read_b64_tr_b16 v[142:143], v219 offset:33792
    s_waitcnt lgkmcnt(14)
    v_mfma_f32_32x32x16_bf16 v[64:79], v[144:147], v[172:175], v[64:79]
    ds_read_b64_tr_b16 v[144:145], v216 offset:36864
    ds_read_b64_tr_b16 v[146:147], v216 offset:37888
    v_mfma_f32_32x32x16_bf16 v[80:95], v[148:151], v[172:175], v[80:95]
    ds_read_b64_tr_b16 v[148:149], v217 offset:36864
    ds_read_b64_tr_b16 v[150:151], v217 offset:37888
    s_waitcnt lgkmcnt(14)
    v_mfma_f32_32x32x16_bf16 v[96:111], v[152:155], v[172:175], v[96:111]
    ds_read_b64_tr_b16 v[152:153], v218 offset:36864
    ds_read_b64_tr_b16 v[154:155], v218 offset:37888
    v_mfma_f32_32x32x16_bf16 v[112:127], v[156:159], v[172:175], v[112:127]
    ds_read_b64_tr_b16 v[156:157], v219 offset:36864
    ds_read_b64_tr_b16 v[158:159], v219 offset:37888
    s_cmp_eq_u32 s17, 1
    s_cbranch_scc0 interleave_layers__softmax_full_mha__sliding_local_dilated__prompt_kernel_f_xq1
    s_add_u32 s32, s24, 1024
    buffer_store_dwordx4 v[168:171], v8, s[12:15], s32 offen offset:0 sc1
    buffer_store_dwordx4 v[172:175], v8, s[12:15], s32 offen offset:512 sc1
interleave_layers__softmax_full_mha__sliding_local_dilated__prompt_kernel_f_xq1:
    s_waitcnt lgkmcnt(12)
    v_mfma_f32_32x32x16_bf16 v[64:79], v[128:131], v[176:179], v[64:79]
    ds_read_b128 v[184:187], v226 offset:32768
    ds_read_b128 v[188:191], v227 offset:32768
    ds_read_b64_tr_b16 v[128:129], v216 offset:40960
    ds_read_b64_tr_b16 v[130:131], v216 offset:41984
    v_mfma_f32_32x32x16_bf16 v[80:95], v[132:135], v[176:179], v[80:95]
    ds_read_b64_tr_b16 v[132:133], v217 offset:40960
    ds_read_b64_tr_b16 v[134:135], v217 offset:41984
    s_waitcnt lgkmcnt(14)
    v_mfma_f32_32x32x16_bf16 v[96:111], v[136:139], v[176:179], v[96:111]
    ds_read_b64_tr_b16 v[136:137], v218 offset:40960
    ds_read_b64_tr_b16 v[138:139], v218 offset:41984
    v_mfma_f32_32x32x16_bf16 v[112:127], v[140:143], v[176:179], v[112:127]
    ds_read_b64_tr_b16 v[140:141], v219 offset:40960
    ds_read_b64_tr_b16 v[142:143], v219 offset:41984
    s_waitcnt lgkmcnt(14)
    v_mfma_f32_32x32x16_bf16 v[64:79], v[144:147], v[180:183], v[64:79]
    ds_read_b64_tr_b16 v[144:145], v216 offset:45056
    ds_read_b64_tr_b16 v[146:147], v216 offset:46080
    v_mfma_f32_32x32x16_bf16 v[80:95], v[148:151], v[180:183], v[80:95]
    ds_read_b64_tr_b16 v[148:149], v217 offset:45056
    ds_read_b64_tr_b16 v[150:151], v217 offset:46080
    s_waitcnt lgkmcnt(14)
    v_mfma_f32_32x32x16_bf16 v[96:111], v[152:155], v[180:183], v[96:111]
    ds_read_b64_tr_b16 v[152:153], v218 offset:45056
    ds_read_b64_tr_b16 v[154:155], v218 offset:46080
    v_mfma_f32_32x32x16_bf16 v[112:127], v[156:159], v[180:183], v[112:127]
    ds_read_b64_tr_b16 v[156:157], v219 offset:45056
    ds_read_b64_tr_b16 v[158:159], v219 offset:46080
    s_cmp_eq_u32 s17, 2
    s_cbranch_scc0 interleave_layers__softmax_full_mha__sliding_local_dilated__prompt_kernel_f_xq2
    s_add_u32 s32, s24, 2048
    buffer_store_dwordx4 v[176:179], v8, s[12:15], s32 offen offset:0 sc1
    buffer_store_dwordx4 v[180:183], v8, s[12:15], s32 offen offset:512 sc1
interleave_layers__softmax_full_mha__sliding_local_dilated__prompt_kernel_f_xq2:
    s_waitcnt lgkmcnt(12)
    v_mfma_f32_32x32x16_bf16 v[64:79], v[128:131], v[184:187], v[64:79]
    s_barrier
    ds_read_b128 v[160:163], v228 offset:0
    ds_read_b128 v[164:167], v229 offset:0
    ds_read_b64_tr_b16 v[128:129], v220 offset:0
    ds_read_b64_tr_b16 v[130:131], v220 offset:1024
    v_mfma_f32_32x32x16_bf16 v[80:95], v[132:135], v[184:187], v[80:95]
    ds_read_b64_tr_b16 v[132:133], v221 offset:0
    ds_read_b64_tr_b16 v[134:135], v221 offset:1024
    s_waitcnt lgkmcnt(14)
    v_mfma_f32_32x32x16_bf16 v[96:111], v[136:139], v[184:187], v[96:111]
    ds_read_b64_tr_b16 v[136:137], v222 offset:0
    ds_read_b64_tr_b16 v[138:139], v222 offset:1024
    v_mfma_f32_32x32x16_bf16 v[112:127], v[140:143], v[184:187], v[112:127]
    ds_read_b64_tr_b16 v[140:141], v223 offset:0
    ds_read_b64_tr_b16 v[142:143], v223 offset:1024
    s_waitcnt lgkmcnt(14)
    v_mfma_f32_32x32x16_bf16 v[64:79], v[144:147], v[188:191], v[64:79]
    ds_read_b64_tr_b16 v[144:145], v220 offset:4096
    ds_read_b64_tr_b16 v[146:147], v220 offset:5120
    v_mfma_f32_32x32x16_bf16 v[80:95], v[148:151], v[188:191], v[80:95]
    ds_read_b64_tr_b16 v[148:149], v221 offset:4096
    ds_read_b64_tr_b16 v[150:151], v221 offset:5120
    s_waitcnt lgkmcnt(14)
    v_mfma_f32_32x32x16_bf16 v[96:111], v[152:155], v[188:191], v[96:111]
    ds_read_b64_tr_b16 v[152:153], v222 offset:4096
    ds_read_b64_tr_b16 v[154:155], v222 offset:5120
    v_mfma_f32_32x32x16_bf16 v[112:127], v[156:159], v[188:191], v[112:127]
    ds_read_b64_tr_b16 v[156:157], v223 offset:4096
    ds_read_b64_tr_b16 v[158:159], v223 offset:5120
    s_cmp_eq_u32 s17, 3
    s_cbranch_scc0 interleave_layers__softmax_full_mha__sliding_local_dilated__prompt_kernel_f_xq3
    s_add_u32 s32, s24, 3072
    buffer_store_dwordx4 v[184:187], v8, s[12:15], s32 offen offset:0 sc1
    buffer_store_dwordx4 v[188:191], v8, s[12:15], s32 offen offset:512 sc1
interleave_layers__softmax_full_mha__sliding_local_dilated__prompt_kernel_f_xq3:
    s_waitcnt lgkmcnt(12)
    v_mfma_f32_32x32x16_bf16 v[64:79], v[128:131], v[160:163], v[64:79]
    ds_read_b128 v[168:171], v230 offset:0
    ds_read_b128 v[172:175], v231 offset:0
    ds_read_b64_tr_b16 v[128:129], v220 offset:8192
    ds_read_b64_tr_b16 v[130:131], v220 offset:9216
    s_cmp_ge_u32 s17, 5
    s_cselect_b32 s33, 2621440, 0
    s_cselect_b32 s59, 1.0, 0x3ea52b5c
    s_cselect_b32 s35, 5, 0
    s_cselect_b32 s37, 1, 0
    v_mfma_f32_32x32x16_bf16 v[80:95], v[132:135], v[160:163], v[80:95]
    ds_read_b64_tr_b16 v[132:133], v221 offset:8192
    ds_read_b64_tr_b16 v[134:135], v221 offset:9216
    s_add_u32 s33, s33, 2883584
    s_waitcnt lgkmcnt(14)
    v_mfma_f32_32x32x16_bf16 v[96:111], v[136:139], v[160:163], v[96:111]
    ds_read_b64_tr_b16 v[136:137], v222 offset:8192
    ds_read_b64_tr_b16 v[138:139], v222 offset:9216
    s_sub_u32 s35, s17, s35
    v_mfma_f32_32x32x16_bf16 v[112:127], v[140:143], v[160:163], v[112:127]
    ds_read_b64_tr_b16 v[140:141], v223 offset:8192
    ds_read_b64_tr_b16 v[142:143], v223 offset:9216
    s_and_b32 s36, s19, 31
    s_waitcnt lgkmcnt(14)
    v_mfma_f32_32x32x16_bf16 v[64:79], v[144:147], v[164:167], v[64:79]
    ds_read_b64_tr_b16 v[144:145], v220 offset:12288
    ds_read_b64_tr_b16 v[146:147], v220 offset:13312
    s_lshl_b32 s36, s36, 1
    v_mfma_f32_32x32x16_bf16 v[80:95], v[148:151], v[164:167], v[80:95]
    ds_read_b64_tr_b16 v[148:149], v221 offset:12288
    ds_read_b64_tr_b16 v[150:151], v221 offset:13312
    s_lshr_b32 s34, s19, 5
    s_waitcnt lgkmcnt(14)
    v_mfma_f32_32x32x16_bf16 v[96:111], v[152:155], v[164:167], v[96:111]
    ds_read_b64_tr_b16 v[152:153], v222 offset:12288
    ds_read_b64_tr_b16 v[154:155], v222 offset:13312
    s_add_u32 s36, s36, s34
    v_mfma_f32_32x32x16_bf16 v[112:127], v[156:159], v[164:167], v[112:127]
    ds_read_b64_tr_b16 v[156:157], v223 offset:12288
    ds_read_b64_tr_b16 v[158:159], v223 offset:13312
    s_add_u32 s36, s36, 44
    s_cmp_eq_u32 s17, 4
    s_cbranch_scc0 interleave_layers__softmax_full_mha__sliding_local_dilated__prompt_kernel_f_xq4
    s_add_u32 s32, s24, 4096
    buffer_store_dwordx4 v[160:163], v8, s[12:15], s32 offen offset:0 sc1
    buffer_store_dwordx4 v[164:167], v8, s[12:15], s32 offen offset:512 sc1
interleave_layers__softmax_full_mha__sliding_local_dilated__prompt_kernel_f_xq4:
    s_waitcnt lgkmcnt(12)
    v_mfma_f32_32x32x16_bf16 v[64:79], v[128:131], v[168:171], v[64:79]
    s_barrier
    ds_read_b128 v[176:179], v228 offset:32768
    ds_read_b128 v[180:183], v229 offset:32768
    ds_read_b64_tr_b16 v[128:129], v220 offset:32768
    ds_read_b64_tr_b16 v[130:131], v220 offset:33792
    s_and_b32 s36, s36, 63
    v_mfma_f32_32x32x16_bf16 v[80:95], v[132:135], v[168:171], v[80:95]
    ds_read_b64_tr_b16 v[132:133], v221 offset:32768
    ds_read_b64_tr_b16 v[134:135], v221 offset:33792
    s_cmp_eq_u32 s37, 0
    s_cselect_b32 s36, s19, s36
    s_waitcnt lgkmcnt(14)
    v_mfma_f32_32x32x16_bf16 v[96:111], v[136:139], v[168:171], v[96:111]
    ds_read_b64_tr_b16 v[136:137], v222 offset:32768
    ds_read_b64_tr_b16 v[138:139], v222 offset:33792
    s_mul_i32 s36, s36, 1280
    v_mfma_f32_32x32x16_bf16 v[112:127], v[140:143], v[168:171], v[112:127]
    ds_read_b64_tr_b16 v[140:141], v223 offset:32768
    ds_read_b64_tr_b16 v[142:143], v223 offset:33792
    s_lshl_b32 s36, s36, s37
    s_waitcnt lgkmcnt(14)
    v_mfma_f32_32x32x16_bf16 v[64:79], v[144:147], v[172:175], v[64:79]
    ds_read_b64_tr_b16 v[144:145], v220 offset:36864
    ds_read_b64_tr_b16 v[146:147], v220 offset:37888
    s_add_u32 s33, s33, s36
    v_mfma_f32_32x32x16_bf16 v[80:95], v[148:151], v[172:175], v[80:95]
    ds_read_b64_tr_b16 v[148:149], v221 offset:36864
    ds_read_b64_tr_b16 v[150:151], v221 offset:37888
    s_lshl_b32 s34, 81920, s37
    s_waitcnt lgkmcnt(14)
    v_mfma_f32_32x32x16_bf16 v[96:111], v[152:155], v[172:175], v[96:111]
    ds_read_b64_tr_b16 v[152:153], v222 offset:36864
    ds_read_b64_tr_b16 v[154:155], v222 offset:37888
    v_lshlrev_b32 v16, 4, v10
    v_mfma_f32_32x32x16_bf16 v[112:127], v[156:159], v[172:175], v[112:127]
    ds_read_b64_tr_b16 v[156:157], v223 offset:36864
    ds_read_b64_tr_b16 v[158:159], v223 offset:37888
    v_lshlrev_b32 v17, 3, v10
    s_cmp_eq_u32 s17, 5
    s_cbranch_scc0 interleave_layers__softmax_full_mha__sliding_local_dilated__prompt_kernel_f_xq5
    s_add_u32 s32, s24, 5120
    buffer_store_dwordx4 v[168:171], v8, s[12:15], s32 offen offset:0 sc1
    buffer_store_dwordx4 v[172:175], v8, s[12:15], s32 offen offset:512 sc1
interleave_layers__softmax_full_mha__sliding_local_dilated__prompt_kernel_f_xq5:
    s_waitcnt lgkmcnt(12)
    v_mfma_f32_32x32x16_bf16 v[64:79], v[128:131], v[176:179], v[64:79]
    ds_read_b128 v[184:187], v230 offset:32768
    ds_read_b128 v[188:191], v231 offset:32768
    ds_read_b64_tr_b16 v[128:129], v220 offset:40960
    ds_read_b64_tr_b16 v[130:131], v220 offset:41984
    v_lshl_add_u32 v18, v4, 9, v16
    v_mfma_f32_32x32x16_bf16 v[80:95], v[132:135], v[176:179], v[80:95]
    ds_read_b64_tr_b16 v[132:133], v221 offset:40960
    ds_read_b64_tr_b16 v[134:135], v221 offset:41984
    s_sub_u32 s36, s34, 512
    s_waitcnt lgkmcnt(14)
    v_mfma_f32_32x32x16_bf16 v[96:111], v[136:139], v[176:179], v[96:111]
    ds_read_b64_tr_b16 v[136:137], v222 offset:40960
    ds_read_b64_tr_b16 v[138:139], v222 offset:41984
    v_and_b32 v19, s36, v59
    v_mfma_f32_32x32x16_bf16 v[112:127], v[140:143], v[176:179], v[112:127]
    ds_read_b64_tr_b16 v[140:141], v223 offset:40960
    ds_read_b64_tr_b16 v[142:143], v223 offset:41984
    v_add_u32 v19, v19, v16
    s_waitcnt lgkmcnt(14)
    v_mfma_f32_32x32x16_bf16 v[64:79], v[144:147], v[180:183], v[64:79]
    ds_read_b64_tr_b16 v[144:145], v220 offset:45056
    ds_read_b64_tr_b16 v[146:147], v220 offset:46080
    s_mov_b32 s28, -1
    v_mfma_f32_32x32x16_bf16 v[80:95], v[148:151], v[180:183], v[80:95]
    ds_read_b64_tr_b16 v[148:149], v221 offset:45056
    ds_read_b64_tr_b16 v[150:151], v221 offset:46080
    s_mov_b32 s29, 0
    s_waitcnt lgkmcnt(14)
    v_mfma_f32_32x32x16_bf16 v[96:111], v[152:155], v[180:183], v[96:111]
    ds_read_b64_tr_b16 v[152:153], v222 offset:45056
    ds_read_b64_tr_b16 v[154:155], v222 offset:46080
    s_mov_b32 s30, 0
    v_mfma_f32_32x32x16_bf16 v[112:127], v[156:159], v[180:183], v[112:127]
    ds_read_b64_tr_b16 v[156:157], v223 offset:45056
    ds_read_b64_tr_b16 v[158:159], v223 offset:46080
    s_mov_b32 s31, -1
    s_cmp_eq_u32 s17, 6
    s_cbranch_scc0 interleave_layers__softmax_full_mha__sliding_local_dilated__prompt_kernel_f_xq6
    s_add_u32 s32, s24, 6144
    buffer_store_dwordx4 v[176:179], v8, s[12:15], s32 offen offset:0 sc1
    buffer_store_dwordx4 v[180:183], v8, s[12:15], s32 offen offset:512 sc1
interleave_layers__softmax_full_mha__sliding_local_dilated__prompt_kernel_f_xq6:
    s_waitcnt lgkmcnt(12)
    v_mfma_f32_32x32x16_bf16 v[64:79], v[128:131], v[184:187], v[64:79]
    s_barrier
    ds_read_b128 v[160:163], v224 offset:0
    ds_read_b128 v[164:167], v225 offset:0
    ds_read_b64_tr_b16 v[128:129], v216 offset:0
    ds_read_b64_tr_b16 v[130:131], v216 offset:1024
    v_mfma_f32_32x32x16_bf16 v[80:95], v[132:135], v[184:187], v[80:95]
    ds_read_b64_tr_b16 v[132:133], v217 offset:0
    ds_read_b64_tr_b16 v[134:135], v217 offset:1024
    s_waitcnt lgkmcnt(14)
    v_mfma_f32_32x32x16_bf16 v[96:111], v[136:139], v[184:187], v[96:111]
    ds_read_b64_tr_b16 v[136:137], v218 offset:0
    ds_read_b64_tr_b16 v[138:139], v218 offset:1024
    v_mfma_f32_32x32x16_bf16 v[112:127], v[140:143], v[184:187], v[112:127]
    ds_read_b64_tr_b16 v[140:141], v219 offset:0
    ds_read_b64_tr_b16 v[142:143], v219 offset:1024
    s_waitcnt lgkmcnt(14)
    v_mfma_f32_32x32x16_bf16 v[64:79], v[144:147], v[188:191], v[64:79]
    ds_read_b64_tr_b16 v[144:145], v216 offset:4096
    ds_read_b64_tr_b16 v[146:147], v216 offset:5120
    v_mfma_f32_32x32x16_bf16 v[80:95], v[148:151], v[188:191], v[80:95]
    ds_read_b64_tr_b16 v[148:149], v217 offset:4096
    ds_read_b64_tr_b16 v[150:151], v217 offset:5120
    s_waitcnt lgkmcnt(14)
    v_mfma_f32_32x32x16_bf16 v[96:111], v[152:155], v[188:191], v[96:111]
    ds_read_b64_tr_b16 v[152:153], v218 offset:4096
    ds_read_b64_tr_b16 v[154:155], v218 offset:5120
    v_mfma_f32_32x32x16_bf16 v[112:127], v[156:159], v[188:191], v[112:127]
    ds_read_b64_tr_b16 v[156:157], v219 offset:4096
    ds_read_b64_tr_b16 v[158:159], v219 offset:5120
    s_cmp_eq_u32 s17, 7
    s_cbranch_scc0 interleave_layers__softmax_full_mha__sliding_local_dilated__prompt_kernel_f_xq7
    s_add_u32 s32, s24, 7168
    buffer_store_dwordx4 v[184:187], v8, s[12:15], s32 offen offset:0 sc1
    buffer_store_dwordx4 v[188:191], v8, s[12:15], s32 offen offset:512 sc1
interleave_layers__softmax_full_mha__sliding_local_dilated__prompt_kernel_f_xq7:
    s_waitcnt lgkmcnt(12)
    v_mfma_f32_32x32x16_bf16 v[64:79], v[128:131], v[160:163], v[64:79]
    ds_read_b128 v[168:171], v226 offset:0
    ds_read_b128 v[172:175], v227 offset:0
    ds_read_b64_tr_b16 v[128:129], v216 offset:8192
    ds_read_b64_tr_b16 v[130:131], v216 offset:9216
    v_mfma_f32_32x32x16_bf16 v[80:95], v[132:135], v[160:163], v[80:95]
    ds_read_b64_tr_b16 v[132:133], v217 offset:8192
    ds_read_b64_tr_b16 v[134:135], v217 offset:9216
    s_waitcnt lgkmcnt(14)
    v_mfma_f32_32x32x16_bf16 v[96:111], v[136:139], v[160:163], v[96:111]
    ds_read_b64_tr_b16 v[136:137], v218 offset:8192
    ds_read_b64_tr_b16 v[138:139], v218 offset:9216
    v_mfma_f32_32x32x16_bf16 v[112:127], v[140:143], v[160:163], v[112:127]
    ds_read_b64_tr_b16 v[140:141], v219 offset:8192
    ds_read_b64_tr_b16 v[142:143], v219 offset:9216
    s_waitcnt lgkmcnt(14)
    v_mfma_f32_32x32x16_bf16 v[64:79], v[144:147], v[164:167], v[64:79]
    ds_read_b64_tr_b16 v[144:145], v216 offset:12288
    ds_read_b64_tr_b16 v[146:147], v216 offset:13312
    v_mfma_f32_32x32x16_bf16 v[80:95], v[148:151], v[164:167], v[80:95]
    ds_read_b64_tr_b16 v[148:149], v217 offset:12288
    ds_read_b64_tr_b16 v[150:151], v217 offset:13312
    s_waitcnt lgkmcnt(14)
    v_mfma_f32_32x32x16_bf16 v[96:111], v[152:155], v[164:167], v[96:111]
    ds_read_b64_tr_b16 v[152:153], v218 offset:12288
    ds_read_b64_tr_b16 v[154:155], v218 offset:13312
    v_mfma_f32_32x32x16_bf16 v[112:127], v[156:159], v[164:167], v[112:127]
    ds_read_b64_tr_b16 v[156:157], v219 offset:12288
    ds_read_b64_tr_b16 v[158:159], v219 offset:13312
    s_cmp_eq_u32 s17, 8
    s_cbranch_scc0 interleave_layers__softmax_full_mha__sliding_local_dilated__prompt_kernel_f_xq8
    s_add_u32 s32, s24, 8192
    buffer_store_dwordx4 v[160:163], v8, s[12:15], s32 offen offset:0 sc1
    buffer_store_dwordx4 v[164:167], v8, s[12:15], s32 offen offset:512 sc1
interleave_layers__softmax_full_mha__sliding_local_dilated__prompt_kernel_f_xq8:
    s_waitcnt lgkmcnt(12)
    v_mfma_f32_32x32x16_bf16 v[64:79], v[128:131], v[168:171], v[64:79]
    s_barrier
    ds_read_b128 v[176:179], v224 offset:32768
    ds_read_b128 v[180:183], v225 offset:32768
    ds_read_b64_tr_b16 v[128:129], v216 offset:32768
    ds_read_b64_tr_b16 v[130:131], v216 offset:33792
    v_mfma_f32_32x32x16_bf16 v[80:95], v[132:135], v[168:171], v[80:95]
    ds_read_b64_tr_b16 v[132:133], v217 offset:32768
    ds_read_b64_tr_b16 v[134:135], v217 offset:33792
    s_waitcnt lgkmcnt(14)
    v_mfma_f32_32x32x16_bf16 v[96:111], v[136:139], v[168:171], v[96:111]
    ds_read_b64_tr_b16 v[136:137], v218 offset:32768
    ds_read_b64_tr_b16 v[138:139], v218 offset:33792
    v_mfma_f32_32x32x16_bf16 v[112:127], v[140:143], v[168:171], v[112:127]
    ds_read_b64_tr_b16 v[140:141], v219 offset:32768
    ds_read_b64_tr_b16 v[142:143], v219 offset:33792
    s_waitcnt lgkmcnt(14)
    v_mfma_f32_32x32x16_bf16 v[64:79], v[144:147], v[172:175], v[64:79]
    ds_read_b64_tr_b16 v[144:145], v216 offset:36864
    ds_read_b64_tr_b16 v[146:147], v216 offset:37888
    v_mfma_f32_32x32x16_bf16 v[80:95], v[148:151], v[172:175], v[80:95]
    ds_read_b64_tr_b16 v[148:149], v217 offset:36864
    ds_read_b64_tr_b16 v[150:151], v217 offset:37888
    s_waitcnt lgkmcnt(14)
    v_mfma_f32_32x32x16_bf16 v[96:111], v[152:155], v[172:175], v[96:111]
    ds_read_b64_tr_b16 v[152:153], v218 offset:36864
    ds_read_b64_tr_b16 v[154:155], v218 offset:37888
    v_mfma_f32_32x32x16_bf16 v[112:127], v[156:159], v[172:175], v[112:127]
    ds_read_b64_tr_b16 v[156:157], v219 offset:36864
    ds_read_b64_tr_b16 v[158:159], v219 offset:37888
    s_cmp_eq_u32 s17, 9
    s_cbranch_scc0 interleave_layers__softmax_full_mha__sliding_local_dilated__prompt_kernel_f_xq9
    s_add_u32 s32, s24, 9216
    buffer_store_dwordx4 v[168:171], v8, s[12:15], s32 offen offset:0 sc1
    buffer_store_dwordx4 v[172:175], v8, s[12:15], s32 offen offset:512 sc1
interleave_layers__softmax_full_mha__sliding_local_dilated__prompt_kernel_f_xq9:
    s_waitcnt lgkmcnt(12)
    v_mfma_f32_32x32x16_bf16 v[64:79], v[128:131], v[176:179], v[64:79]
    ds_read_b128 v[184:187], v226 offset:32768
    ds_read_b128 v[188:191], v227 offset:32768
    ds_read_b64_tr_b16 v[128:129], v216 offset:40960
    ds_read_b64_tr_b16 v[130:131], v216 offset:41984
    v_mfma_f32_32x32x16_bf16 v[80:95], v[132:135], v[176:179], v[80:95]
    ds_read_b64_tr_b16 v[132:133], v217 offset:40960
    ds_read_b64_tr_b16 v[134:135], v217 offset:41984
    s_waitcnt lgkmcnt(14)
    v_mfma_f32_32x32x16_bf16 v[96:111], v[136:139], v[176:179], v[96:111]
    ds_read_b64_tr_b16 v[136:137], v218 offset:40960
    ds_read_b64_tr_b16 v[138:139], v218 offset:41984
    v_mfma_f32_32x32x16_bf16 v[112:127], v[140:143], v[176:179], v[112:127]
    ds_read_b64_tr_b16 v[140:141], v219 offset:40960
    ds_read_b64_tr_b16 v[142:143], v219 offset:41984
    s_waitcnt lgkmcnt(14)
    v_mfma_f32_32x32x16_bf16 v[64:79], v[144:147], v[180:183], v[64:79]
    ds_read_b64_tr_b16 v[144:145], v216 offset:45056
    ds_read_b64_tr_b16 v[146:147], v216 offset:46080
    v_mfma_f32_32x32x16_bf16 v[80:95], v[148:151], v[180:183], v[80:95]
    ds_read_b64_tr_b16 v[148:149], v217 offset:45056
    ds_read_b64_tr_b16 v[150:151], v217 offset:46080
    s_waitcnt lgkmcnt(14)
    v_mfma_f32_32x32x16_bf16 v[96:111], v[152:155], v[180:183], v[96:111]
    ds_read_b64_tr_b16 v[152:153], v218 offset:45056
    ds_read_b64_tr_b16 v[154:155], v218 offset:46080
    v_mfma_f32_32x32x16_bf16 v[112:127], v[156:159], v[180:183], v[112:127]
    ds_read_b64_tr_b16 v[156:157], v219 offset:45056
    ds_read_b64_tr_b16 v[158:159], v219 offset:46080
    s_cmp_eq_u32 s17, 10
    s_cbranch_scc0 interleave_layers__softmax_full_mha__sliding_local_dilated__prompt_kernel_f_xq10
    s_add_u32 s32, s24, 10240
    buffer_store_dwordx4 v[176:179], v8, s[12:15], s32 offen offset:0 sc1
    buffer_store_dwordx4 v[180:183], v8, s[12:15], s32 offen offset:512 sc1
interleave_layers__softmax_full_mha__sliding_local_dilated__prompt_kernel_f_xq10:
    s_waitcnt lgkmcnt(12)
    v_mfma_f32_32x32x16_bf16 v[64:79], v[128:131], v[184:187], v[64:79]
    s_barrier
    ds_read_b128 v[160:163], v228 offset:0
    ds_read_b128 v[164:167], v229 offset:0
    ds_read_b64_tr_b16 v[128:129], v220 offset:0
    ds_read_b64_tr_b16 v[130:131], v220 offset:1024
    v_mfma_f32_32x32x16_bf16 v[80:95], v[132:135], v[184:187], v[80:95]
    ds_read_b64_tr_b16 v[132:133], v221 offset:0
    ds_read_b64_tr_b16 v[134:135], v221 offset:1024
    s_waitcnt lgkmcnt(14)
    v_mfma_f32_32x32x16_bf16 v[96:111], v[136:139], v[184:187], v[96:111]
    ds_read_b64_tr_b16 v[136:137], v222 offset:0
    ds_read_b64_tr_b16 v[138:139], v222 offset:1024
    v_mfma_f32_32x32x16_bf16 v[112:127], v[140:143], v[184:187], v[112:127]
    ds_read_b64_tr_b16 v[140:141], v223 offset:0
    ds_read_b64_tr_b16 v[142:143], v223 offset:1024
    s_waitcnt lgkmcnt(14)
    v_mfma_f32_32x32x16_bf16 v[64:79], v[144:147], v[188:191], v[64:79]
    ds_read_b64_tr_b16 v[144:145], v220 offset:4096
    ds_read_b64_tr_b16 v[146:147], v220 offset:5120
    v_mfma_f32_32x32x16_bf16 v[80:95], v[148:151], v[188:191], v[80:95]
    ds_read_b64_tr_b16 v[148:149], v221 offset:4096
    ds_read_b64_tr_b16 v[150:151], v221 offset:5120
    s_waitcnt lgkmcnt(14)
    v_mfma_f32_32x32x16_bf16 v[96:111], v[152:155], v[188:191], v[96:111]
    ds_read_b64_tr_b16 v[152:153], v222 offset:4096
    ds_read_b64_tr_b16 v[154:155], v222 offset:5120
    v_mfma_f32_32x32x16_bf16 v[112:127], v[156:159], v[188:191], v[112:127]
    ds_read_b64_tr_b16 v[156:157], v223 offset:4096
    ds_read_b64_tr_b16 v[158:159], v223 offset:5120
    s_cmp_eq_u32 s17, 11
    s_cbranch_scc0 interleave_layers__softmax_full_mha__sliding_local_dilated__prompt_kernel_f_xq11
    s_add_u32 s32, s24, 11264
    buffer_store_dwordx4 v[184:187], v8, s[12:15], s32 offen offset:0 sc1
    buffer_store_dwordx4 v[188:191], v8, s[12:15], s32 offen offset:512 sc1
interleave_layers__softmax_full_mha__sliding_local_dilated__prompt_kernel_f_xq11:
    s_waitcnt lgkmcnt(12)
    v_mfma_f32_32x32x16_bf16 v[64:79], v[128:131], v[160:163], v[64:79]
    ds_read_b128 v[168:171], v230 offset:0
    ds_read_b128 v[172:175], v231 offset:0
    ds_read_b64_tr_b16 v[128:129], v220 offset:8192
    ds_read_b64_tr_b16 v[130:131], v220 offset:9216
    v_mfma_f32_32x32x16_bf16 v[80:95], v[132:135], v[160:163], v[80:95]
    ds_read_b64_tr_b16 v[132:133], v221 offset:8192
    ds_read_b64_tr_b16 v[134:135], v221 offset:9216
    s_waitcnt lgkmcnt(14)
    v_mfma_f32_32x32x16_bf16 v[96:111], v[136:139], v[160:163], v[96:111]
    ds_read_b64_tr_b16 v[136:137], v222 offset:8192
    ds_read_b64_tr_b16 v[138:139], v222 offset:9216
    v_mfma_f32_32x32x16_bf16 v[112:127], v[140:143], v[160:163], v[112:127]
    ds_read_b64_tr_b16 v[140:141], v223 offset:8192
    ds_read_b64_tr_b16 v[142:143], v223 offset:9216
    s_waitcnt lgkmcnt(14)
    v_mfma_f32_32x32x16_bf16 v[64:79], v[144:147], v[164:167], v[64:79]
    ds_read_b64_tr_b16 v[144:145], v220 offset:12288
    ds_read_b64_tr_b16 v[146:147], v220 offset:13312
    v_mfma_f32_32x32x16_bf16 v[80:95], v[148:151], v[164:167], v[80:95]
    ds_read_b64_tr_b16 v[148:149], v221 offset:12288
    ds_read_b64_tr_b16 v[150:151], v221 offset:13312
    s_waitcnt lgkmcnt(14)
    v_mfma_f32_32x32x16_bf16 v[96:111], v[152:155], v[164:167], v[96:111]
    ds_read_b64_tr_b16 v[152:153], v222 offset:12288
    ds_read_b64_tr_b16 v[154:155], v222 offset:13312
    v_mfma_f32_32x32x16_bf16 v[112:127], v[156:159], v[164:167], v[112:127]
    ds_read_b64_tr_b16 v[156:157], v223 offset:12288
    ds_read_b64_tr_b16 v[158:159], v223 offset:13312
    s_cmp_eq_u32 s17, 12
    s_cbranch_scc0 interleave_layers__softmax_full_mha__sliding_local_dilated__prompt_kernel_f_xq12
    s_add_u32 s32, s24, 12288
    buffer_store_dwordx4 v[160:163], v8, s[12:15], s32 offen offset:0 sc1
    buffer_store_dwordx4 v[164:167], v8, s[12:15], s32 offen offset:512 sc1
interleave_layers__softmax_full_mha__sliding_local_dilated__prompt_kernel_f_xq12:
    s_waitcnt lgkmcnt(12)
    v_mfma_f32_32x32x16_bf16 v[64:79], v[128:131], v[168:171], v[64:79]
    s_barrier
    ds_read_b128 v[176:179], v228 offset:32768
    ds_read_b128 v[180:183], v229 offset:32768
    ds_read_b64_tr_b16 v[128:129], v220 offset:32768
    ds_read_b64_tr_b16 v[130:131], v220 offset:33792
    v_mfma_f32_32x32x16_bf16 v[80:95], v[132:135], v[168:171], v[80:95]
    ds_read_b64_tr_b16 v[132:133], v221 offset:32768
    ds_read_b64_tr_b16 v[134:135], v221 offset:33792
    s_waitcnt lgkmcnt(14)
    v_mfma_f32_32x32x16_bf16 v[96:111], v[136:139], v[168:171], v[96:111]
    ds_read_b64_tr_b16 v[136:137], v222 offset:32768
    ds_read_b64_tr_b16 v[138:139], v222 offset:33792
    v_mfma_f32_32x32x16_bf16 v[112:127], v[140:143], v[168:171], v[112:127]
    ds_read_b64_tr_b16 v[140:141], v223 offset:32768
    ds_read_b64_tr_b16 v[142:143], v223 offset:33792
    s_waitcnt lgkmcnt(14)
    v_mfma_f32_32x32x16_bf16 v[64:79], v[144:147], v[172:175], v[64:79]
    ds_read_b64_tr_b16 v[144:145], v220 offset:36864
    ds_read_b64_tr_b16 v[146:147], v220 offset:37888
    v_mfma_f32_32x32x16_bf16 v[80:95], v[148:151], v[172:175], v[80:95]
    ds_read_b64_tr_b16 v[148:149], v221 offset:36864
    ds_read_b64_tr_b16 v[150:151], v221 offset:37888
    s_waitcnt lgkmcnt(14)
    v_mfma_f32_32x32x16_bf16 v[96:111], v[152:155], v[172:175], v[96:111]
    ds_read_b64_tr_b16 v[152:153], v222 offset:36864
    ds_read_b64_tr_b16 v[154:155], v222 offset:37888
    v_mfma_f32_32x32x16_bf16 v[112:127], v[156:159], v[172:175], v[112:127]
    ds_read_b64_tr_b16 v[156:157], v223 offset:36864
    ds_read_b64_tr_b16 v[158:159], v223 offset:37888
    s_cmp_eq_u32 s17, 13
    s_cbranch_scc0 interleave_layers__softmax_full_mha__sliding_local_dilated__prompt_kernel_f_xq13
    s_add_u32 s32, s24, 13312
    buffer_store_dwordx4 v[168:171], v8, s[12:15], s32 offen offset:0 sc1
    buffer_store_dwordx4 v[172:175], v8, s[12:15], s32 offen offset:512 sc1
interleave_layers__softmax_full_mha__sliding_local_dilated__prompt_kernel_f_xq13:
    s_waitcnt lgkmcnt(12)
    v_mfma_f32_32x32x16_bf16 v[64:79], v[128:131], v[176:179], v[64:79]
    ds_read_b128 v[184:187], v230 offset:32768
    ds_read_b128 v[188:191], v231 offset:32768
    ds_read_b64_tr_b16 v[128:129], v220 offset:40960
    ds_read_b64_tr_b16 v[130:131], v220 offset:41984
    v_mfma_f32_32x32x16_bf16 v[80:95], v[132:135], v[176:179], v[80:95]
    ds_read_b64_tr_b16 v[132:133], v221 offset:40960
    ds_read_b64_tr_b16 v[134:135], v221 offset:41984
    s_waitcnt lgkmcnt(14)
    v_mfma_f32_32x32x16_bf16 v[96:111], v[136:139], v[176:179], v[96:111]
    ds_read_b64_tr_b16 v[136:137], v222 offset:40960
    ds_read_b64_tr_b16 v[138:139], v222 offset:41984
    v_mfma_f32_32x32x16_bf16 v[112:127], v[140:143], v[176:179], v[112:127]
    ds_read_b64_tr_b16 v[140:141], v223 offset:40960
    ds_read_b64_tr_b16 v[142:143], v223 offset:41984
    s_waitcnt lgkmcnt(14)
    v_mfma_f32_32x32x16_bf16 v[64:79], v[144:147], v[180:183], v[64:79]
    ds_read_b64_tr_b16 v[144:145], v220 offset:45056
    ds_read_b64_tr_b16 v[146:147], v220 offset:46080
    v_mfma_f32_32x32x16_bf16 v[80:95], v[148:151], v[180:183], v[80:95]
    ds_read_b64_tr_b16 v[148:149], v221 offset:45056
    ds_read_b64_tr_b16 v[150:151], v221 offset:46080
    s_waitcnt lgkmcnt(14)
    v_mfma_f32_32x32x16_bf16 v[96:111], v[152:155], v[180:183], v[96:111]
    ds_read_b64_tr_b16 v[152:153], v222 offset:45056
    ds_read_b64_tr_b16 v[154:155], v222 offset:46080
    v_mfma_f32_32x32x16_bf16 v[112:127], v[156:159], v[180:183], v[112:127]
    ds_read_b64_tr_b16 v[156:157], v223 offset:45056
    ds_read_b64_tr_b16 v[158:159], v223 offset:46080
    s_cmp_eq_u32 s17, 14
    s_cbranch_scc0 interleave_layers__softmax_full_mha__sliding_local_dilated__prompt_kernel_f_xq14
    s_add_u32 s32, s24, 14336
    buffer_store_dwordx4 v[176:179], v8, s[12:15], s32 offen offset:0 sc1
    buffer_store_dwordx4 v[180:183], v8, s[12:15], s32 offen offset:512 sc1
interleave_layers__softmax_full_mha__sliding_local_dilated__prompt_kernel_f_xq14:
    s_waitcnt lgkmcnt(12)
    v_mfma_f32_32x32x16_bf16 v[64:79], v[128:131], v[184:187], v[64:79]
    s_barrier
    ds_read_b128 v[160:163], v224 offset:0
    ds_read_b128 v[164:167], v225 offset:0
    ds_read_b64_tr_b16 v[128:129], v216 offset:0
    ds_read_b64_tr_b16 v[130:131], v216 offset:1024
    v_mfma_f32_32x32x16_bf16 v[80:95], v[132:135], v[184:187], v[80:95]
    ds_read_b64_tr_b16 v[132:133], v217 offset:0
    ds_read_b64_tr_b16 v[134:135], v217 offset:1024
    s_waitcnt lgkmcnt(14)
    v_mfma_f32_32x32x16_bf16 v[96:111], v[136:139], v[184:187], v[96:111]
    ds_read_b64_tr_b16 v[136:137], v218 offset:0
    ds_read_b64_tr_b16 v[138:139], v218 offset:1024
    v_mfma_f32_32x32x16_bf16 v[112:127], v[140:143], v[184:187], v[112:127]
    ds_read_b64_tr_b16 v[140:141], v219 offset:0
    ds_read_b64_tr_b16 v[142:143], v219 offset:1024
    s_waitcnt lgkmcnt(14)
    v_mfma_f32_32x32x16_bf16 v[64:79], v[144:147], v[188:191], v[64:79]
    ds_read_b64_tr_b16 v[144:145], v216 offset:4096
    ds_read_b64_tr_b16 v[146:147], v216 offset:5120
    v_mfma_f32_32x32x16_bf16 v[80:95], v[148:151], v[188:191], v[80:95]
    ds_read_b64_tr_b16 v[148:149], v217 offset:4096
    ds_read_b64_tr_b16 v[150:151], v217 offset:5120
    s_waitcnt lgkmcnt(14)
    v_mfma_f32_32x32x16_bf16 v[96:111], v[152:155], v[188:191], v[96:111]
    ds_read_b64_tr_b16 v[152:153], v218 offset:4096
    ds_read_b64_tr_b16 v[154:155], v218 offset:5120
    v_mfma_f32_32x32x16_bf16 v[112:127], v[156:159], v[188:191], v[112:127]
    ds_read_b64_tr_b16 v[156:157], v219 offset:4096
    ds_read_b64_tr_b16 v[158:159], v219 offset:5120
    s_cmp_eq_u32 s17, 0
    s_cbranch_scc0 interleave_layers__softmax_full_mha__sliding_local_dilated__prompt_kernel_f_xq15
    s_add_u32 s32, s24, 15360
    buffer_store_dwordx4 v[184:187], v8, s[12:15], s32 offen offset:0 sc1
    buffer_store_dwordx4 v[188:191], v8, s[12:15], s32 offen offset:512 sc1
interleave_layers__softmax_full_mha__sliding_local_dilated__prompt_kernel_f_xq15:
    s_waitcnt lgkmcnt(12)
    v_mfma_f32_32x32x16_bf16 v[64:79], v[128:131], v[160:163], v[64:79]
    ds_read_b128 v[168:171], v226 offset:0
    ds_read_b128 v[172:175], v227 offset:0
    ds_read_b64_tr_b16 v[128:129], v216 offset:8192
    ds_read_b64_tr_b16 v[130:131], v216 offset:9216
    v_mfma_f32_32x32x16_bf16 v[80:95], v[132:135], v[160:163], v[80:95]
    ds_read_b64_tr_b16 v[132:133], v217 offset:8192
    ds_read_b64_tr_b16 v[134:135], v217 offset:9216
    s_waitcnt lgkmcnt(14)
    v_mfma_f32_32x32x16_bf16 v[96:111], v[136:139], v[160:163], v[96:111]
    ds_read_b64_tr_b16 v[136:137], v218 offset:8192
    ds_read_b64_tr_b16 v[138:139], v218 offset:9216
    v_mfma_f32_32x32x16_bf16 v[112:127], v[140:143], v[160:163], v[112:127]
    ds_read_b64_tr_b16 v[140:141], v219 offset:8192
    ds_read_b64_tr_b16 v[142:143], v219 offset:9216
    s_waitcnt lgkmcnt(14)
    v_mfma_f32_32x32x16_bf16 v[64:79], v[144:147], v[164:167], v[64:79]
    ds_read_b64_tr_b16 v[144:145], v216 offset:12288
    ds_read_b64_tr_b16 v[146:147], v216 offset:13312
    v_mfma_f32_32x32x16_bf16 v[80:95], v[148:151], v[164:167], v[80:95]
    ds_read_b64_tr_b16 v[148:149], v217 offset:12288
    ds_read_b64_tr_b16 v[150:151], v217 offset:13312
    s_waitcnt lgkmcnt(14)
    v_mfma_f32_32x32x16_bf16 v[96:111], v[152:155], v[164:167], v[96:111]
    ds_read_b64_tr_b16 v[152:153], v218 offset:12288
    ds_read_b64_tr_b16 v[154:155], v218 offset:13312
    v_mfma_f32_32x32x16_bf16 v[112:127], v[156:159], v[164:167], v[112:127]
    ds_read_b64_tr_b16 v[156:157], v219 offset:12288
    ds_read_b64_tr_b16 v[158:159], v219 offset:13312
    s_cmp_eq_u32 s17, 1
    s_cbranch_scc0 interleave_layers__softmax_full_mha__sliding_local_dilated__prompt_kernel_f_xq16
    s_add_u32 s32, s24, 16384
    buffer_store_dwordx4 v[160:163], v8, s[12:15], s32 offen offset:0 sc1
    buffer_store_dwordx4 v[164:167], v8, s[12:15], s32 offen offset:512 sc1
interleave_layers__softmax_full_mha__sliding_local_dilated__prompt_kernel_f_xq16:
    s_waitcnt lgkmcnt(12)
    v_mfma_f32_32x32x16_bf16 v[64:79], v[128:131], v[168:171], v[64:79]
    s_barrier
    ds_read_b128 v[176:179], v224 offset:32768
    ds_read_b128 v[180:183], v225 offset:32768
    ds_read_b64_tr_b16 v[128:129], v216 offset:32768
    ds_read_b64_tr_b16 v[130:131], v216 offset:33792
    v_mfma_f32_32x32x16_bf16 v[80:95], v[132:135], v[168:171], v[80:95]
    ds_read_b64_tr_b16 v[132:133], v216 offset:36864
    ds_read_b64_tr_b16 v[134:135], v216 offset:37888
    s_waitcnt lgkmcnt(14)
    v_mfma_f32_32x32x16_bf16 v[96:111], v[136:139], v[168:171], v[96:111]
    ds_read_b128 v[184:187], v226 offset:32768
    ds_read_b128 v[188:191], v227 offset:32768
    ds_read_b64_tr_b16 v[136:137], v216 offset:40960
    ds_read_b64_tr_b16 v[138:139], v216 offset:41984
    v_mfma_f32_32x32x16_bf16 v[112:127], v[140:143], v[168:171], v[112:127]
    ds_read_b64_tr_b16 v[140:141], v216 offset:45056
    ds_read_b64_tr_b16 v[142:143], v216 offset:46080
    s_waitcnt lgkmcnt(15)
    v_mfma_f32_32x32x16_bf16 v[64:79], v[144:147], v[172:175], v[64:79]
    ds_read_b64_tr_b16 v[144:145], v217 offset:32768
    ds_read_b64_tr_b16 v[146:147], v217 offset:33792
    v_mfma_f32_32x32x16_bf16 v[80:95], v[148:151], v[172:175], v[80:95]
    ds_read_b64_tr_b16 v[148:149], v217 offset:36864
    ds_read_b64_tr_b16 v[150:151], v217 offset:37888
    s_waitcnt lgkmcnt(15)
    v_mfma_f32_32x32x16_bf16 v[96:111], v[152:155], v[172:175], v[96:111]
    ds_read_b64_tr_b16 v[152:153], v217 offset:40960
    ds_read_b64_tr_b16 v[154:155], v217 offset:41984
    v_mfma_f32_32x32x16_bf16 v[112:127], v[156:159], v[172:175], v[112:127]
    ds_read_b64_tr_b16 v[156:157], v217 offset:45056
    ds_read_b64_tr_b16 v[158:159], v217 offset:46080
    s_cmp_eq_u32 s17, 2
    s_cbranch_scc0 interleave_layers__softmax_full_mha__sliding_local_dilated__prompt_kernel_f_xq17
    s_add_u32 s32, s24, 17408
    buffer_store_dwordx4 v[168:171], v8, s[12:15], s32 offen offset:0 sc1
    buffer_store_dwordx4 v[172:175], v8, s[12:15], s32 offen offset:512 sc1
interleave_layers__softmax_full_mha__sliding_local_dilated__prompt_kernel_f_xq17:
    v_lshlrev_b32 v23, 2, v10
    v_add_u32 v23, 65536, v23
    s_lshl_b32 s32, s18, 8
    v_add_u32 v22, s32, v23
    s_waitcnt lgkmcnt(14)
    v_mfma_f32_32x32x16_bf16 v[64:79], v[128:131], v[176:179], v[64:79]
    ds_read_b64_tr_b16 v[128:129], v218 offset:32768
    ds_read_b64_tr_b16 v[130:131], v218 offset:33792
    v_mfma_f32_32x32x16_bf16 v[64:79], v[132:135], v[180:183], v[64:79]
    ds_read_b64_tr_b16 v[132:133], v218 offset:36864
    ds_read_b64_tr_b16 v[134:135], v218 offset:37888
    s_waitcnt lgkmcnt(12)
    v_mfma_f32_32x32x16_bf16 v[64:79], v[136:139], v[184:187], v[64:79]
    ds_read_b64_tr_b16 v[136:137], v218 offset:40960
    ds_read_b64_tr_b16 v[138:139], v218 offset:41984
    v_mfma_f32_32x32x16_bf16 v[64:79], v[140:143], v[188:191], v[64:79]
    ds_read_b64_tr_b16 v[140:141], v218 offset:45056
    ds_read_b64_tr_b16 v[142:143], v218 offset:46080
    s_cmp_eq_u32 s17, 3
    s_cbranch_scc0 interleave_layers__softmax_full_mha__sliding_local_dilated__prompt_kernel_f_xq18
    s_add_u32 s32, s24, 18432
    buffer_store_dwordx4 v[176:179], v8, s[12:15], s32 offen offset:0 sc1
    buffer_store_dwordx4 v[180:183], v8, s[12:15], s32 offen offset:512 sc1
interleave_layers__softmax_full_mha__sliding_local_dilated__prompt_kernel_f_xq18:
    s_cmp_eq_u32 s17, 4
    s_cbranch_scc0 interleave_layers__softmax_full_mha__sliding_local_dilated__prompt_kernel_f_xq19
    s_add_u32 s32, s24, 19456
    buffer_store_dwordx4 v[184:187], v8, s[12:15], s32 offen offset:0 sc1
    buffer_store_dwordx4 v[188:191], v8, s[12:15], s32 offen offset:512 sc1
interleave_layers__softmax_full_mha__sliding_local_dilated__prompt_kernel_f_xq19:
    s_barrier
    ds_read_b32 v48, v22 offset:1024
    ds_read_b32 v49, v22 offset:1152
    ds_read_b32 v28, v23 offset:0
    ds_read_b32 v29, v23 offset:128
    ds_read_b32 v30, v23 offset:256
    ds_read_b32 v31, v23 offset:384
    ds_read_b32 v32, v23 offset:512
    ds_read_b32 v33, v23 offset:640
    ds_read_b32 v34, v23 offset:768
    ds_read_b32 v35, v23 offset:896
    ds_read_b32 v47, v22 offset:2048
    s_waitcnt lgkmcnt(15)
    v_mfma_f32_32x32x16_bf16 v[80:95], v[144:147], v[176:179], v[80:95]
    ds_read_b64_tr_b16 v[144:145], v219 offset:32768
    ds_read_b64_tr_b16 v[146:147], v219 offset:33792
    v_mfma_f32_32x32x16_bf16 v[80:95], v[148:151], v[180:183], v[80:95]
    ds_read_b64_tr_b16 v[148:149], v219 offset:36864
    ds_read_b64_tr_b16 v[150:151], v219 offset:37888
    s_waitcnt lgkmcnt(4)
    v_and_b32 v48, v48, v58
    v_and_b32 v49, v49, v58
    v_mul_f32 v47, s59, v47
    s_nop 0
    v_mfma_f32_32x32x8_bf16 v[64:79], v[28:29], v[48:49], v[64:79]
    s_cmp_eq_u32 s35, 1
    s_cbranch_scc1 interleave_layers__softmax_full_mha__sliding_local_dilated__prompt_kernel_f_e1
    s_cmp_eq_u32 s35, 2
    s_cbranch_scc1 interleave_layers__softmax_full_mha__sliding_local_dilated__prompt_kernel_f_e2
    s_cmp_eq_u32 s35, 3
    s_cbranch_scc1 interleave_layers__softmax_full_mha__sliding_local_dilated__prompt_kernel_f_e3
    s_cmp_eq_u32 s35, 4
    s_cbranch_scc1 interleave_layers__softmax_full_mha__sliding_local_dilated__prompt_kernel_f_e4
    v_mfma_f32_32x32x16_bf16 v[80:95], v[152:155], v[184:187], v[80:95]
    ds_read_b64_tr_b16 v[152:153], v219 offset:40960
    ds_read_b64_tr_b16 v[154:155], v219 offset:41984
    v_mfma_f32_32x32x16_bf16 v[80:95], v[156:159], v[188:191], v[80:95]
    ds_read_b64_tr_b16 v[156:157], v219 offset:45056
    ds_read_b64_tr_b16 v[158:159], v219 offset:46080
    v_mfma_f32_32x32x8_bf16 v[80:95], v[30:31], v[48:49], v[80:95]
    v_mul_f32 v64, v64, v47
    v_mul_f32 v65, v65, v47
    v_mul_f32 v66, v66, v47
    v_mul_f32 v67, v67, v47
    v_mul_f32 v68, v68, v47
    v_mul_f32 v69, v69, v47
    v_mul_f32 v70, v70, v47
    v_mul_f32 v71, v71, v47
    v_mul_f32 v72, v72, v47
    v_mul_f32 v73, v73, v47
    v_mul_f32 v74, v74, v47
    v_mul_f32 v75, v75, v47
    v_mul_f32 v76, v76, v47
    v_mul_f32 v77, v77, v47
    v_mul_f32 v78, v78, v47
    v_mul_f32 v79, v79, v47
    v_cvt_pk_bf16_f32 v64, v64, v65
    v_cvt_pk_bf16_f32 v65, v66, v67
    v_cvt_pk_bf16_f32 v66, v68, v69
    v_cvt_pk_bf16_f32 v67, v70, v71
    v_cvt_pk_bf16_f32 v68, v72, v73
    v_cvt_pk_bf16_f32 v69, v74, v75
    v_cvt_pk_bf16_f32 v70, v76, v77
    v_cvt_pk_bf16_f32 v71, v78, v79
    v_permlane32_swap_b32 v64, v66
    v_permlane32_swap_b32 v65, v67
    v_permlane32_swap_b32 v68, v70
    v_permlane32_swap_b32 v69, v71
    buffer_store_dwordx4 v[64:67], v18, s[12:15], s33 offen offset:0 sc1
    s_mul_i32 s36, s34, 1
    s_add_u32 s36, s36, s33
    s_add_u32 s38, s33, s34
    s_mov_b64 exec, s[30:31]
    buffer_store_dwordx4 v[68:71], v16, s[12:15], s36 offen offset:0 sc1
    s_mov_b64 exec, s[28:29]
    buffer_store_dwordx2 v[68:69], v17, s[12:15], s33 offen offset:1024 sc1
    buffer_store_dwordx2 v[70:71], v17, s[12:15], s38 offen offset:1024 sc1
    s_mov_b64 exec, -1
    v_mfma_f32_32x32x16_bf16 v[96:111], v[128:131], v[176:179], v[96:111]
    v_mfma_f32_32x32x16_bf16 v[96:111], v[132:135], v[180:183], v[96:111]
    v_mfma_f32_32x32x16_bf16 v[96:111], v[136:139], v[184:187], v[96:111]
    v_mul_f32 v80, v80, v47
    v_mul_f32 v81, v81, v47
    v_mul_f32 v82, v82, v47
    v_mul_f32 v83, v83, v47
    v_mfma_f32_32x32x16_bf16 v[96:111], v[140:143], v[188:191], v[96:111]
    v_mul_f32 v84, v84, v47
    v_mul_f32 v85, v85, v47
    v_mul_f32 v86, v86, v47
    v_mul_f32 v87, v87, v47
    v_mfma_f32_32x32x8_bf16 v[96:111], v[32:33], v[48:49], v[96:111]
    v_mul_f32 v88, v88, v47
    v_mul_f32 v89, v89, v47
    v_mul_f32 v90, v90, v47
    v_mul_f32 v91, v91, v47
    v_mul_f32 v92, v92, v47
    v_mul_f32 v93, v93, v47
    v_mul_f32 v94, v94, v47
    v_mul_f32 v95, v95, v47
    v_cvt_pk_bf16_f32 v80, v80, v81
    v_cvt_pk_bf16_f32 v81, v82, v83
    v_cvt_pk_bf16_f32 v82, v84, v85
    v_cvt_pk_bf16_f32 v83, v86, v87
    v_cvt_pk_bf16_f32 v84, v88, v89
    v_cvt_pk_bf16_f32 v85, v90, v91
    v_cvt_pk_bf16_f32 v86, v92, v93
    v_cvt_pk_bf16_f32 v87, v94, v95
    v_permlane32_swap_b32 v80, v82
    v_permlane32_swap_b32 v81, v83
    v_permlane32_swap_b32 v84, v86
    v_permlane32_swap_b32 v85, v87
    s_mul_i32 s36, s34, 1
    s_add_u32 s36, s36, s33
    buffer_store_dwordx4 v[80:83], v19, s[12:15], s36 offen offset:512 sc1
    s_mul_i32 s36, s34, 2
    s_add_u32 s36, s36, s33
    s_mul_i32 s37, s34, 2
    s_add_u32 s37, s37, s33
    s_add_u32 s38, s37, s34
    s_mov_b64 exec, s[28:29]
    buffer_store_dwordx4 v[84:87], v16, s[12:15], s36 offen offset:512 sc1
    s_mov_b64 exec, s[30:31]
    buffer_store_dwordx2 v[84:85], v17, s[12:15], s37 offen offset:1024 sc1
    buffer_store_dwordx2 v[86:87], v17, s[12:15], s38 offen offset:1024 sc1
    s_mov_b64 exec, -1
    s_waitcnt lgkmcnt(4)
    v_mfma_f32_32x32x16_bf16 v[112:127], v[144:147], v[176:179], v[112:127]
    v_mfma_f32_32x32x16_bf16 v[112:127], v[148:151], v[180:183], v[112:127]
    s_waitcnt lgkmcnt(0)
    v_mfma_f32_32x32x16_bf16 v[112:127], v[152:155], v[184:187], v[112:127]
    v_mul_f32 v96, v96, v47
    v_mul_f32 v97, v97, v47
    v_mul_f32 v98, v98, v47
    v_mul_f32 v99, v99, v47
    v_mfma_f32_32x32x16_bf16 v[112:127], v[156:159], v[188:191], v[112:127]
    v_mul_f32 v100, v100, v47
    v_mul_f32 v101, v101, v47
    v_mul_f32 v102, v102, v47
    v_mul_f32 v103, v103, v47
    v_mfma_f32_32x32x8_bf16 v[112:127], v[34:35], v[48:49], v[112:127]
    v_mul_f32 v104, v104, v47
    v_mul_f32 v105, v105, v47
    v_mul_f32 v106, v106, v47
    v_mul_f32 v107, v107, v47
    v_mul_f32 v108, v108, v47
    v_mul_f32 v109, v109, v47
    v_mul_f32 v110, v110, v47
    v_mul_f32 v111, v111, v47
    v_cvt_pk_bf16_f32 v96, v96, v97
    v_cvt_pk_bf16_f32 v97, v98, v99
    v_cvt_pk_bf16_f32 v98, v100, v101
    v_cvt_pk_bf16_f32 v99, v102, v103
    v_cvt_pk_bf16_f32 v100, v104, v105
    v_cvt_pk_bf16_f32 v101, v106, v107
    v_cvt_pk_bf16_f32 v102, v108, v109
    v_cvt_pk_bf16_f32 v103, v110, v111
    v_permlane32_swap_b32 v96, v98
    v_permlane32_swap_b32 v97, v99
    v_permlane32_swap_b32 v100, v102
    v_permlane32_swap_b32 v101, v103
    s_mul_i32 s36, s34, 3
    s_add_u32 s36, s36, s33
    buffer_store_dwordx4 v[96:99], v18, s[12:15], s36 offen offset:0 sc1
    s_mul_i32 s36, s34, 4
    s_add_u32 s36, s36, s33
    buffer_store_dwordx4 v[100:103], v18, s[12:15], s36 offen offset:0 sc1
    v_mul_f32 v112, v112, v47
    v_mul_f32 v113, v113, v47
    v_mul_f32 v114, v114, v47
    v_mul_f32 v115, v115, v47
    v_mul_f32 v116, v116, v47
    v_mul_f32 v117, v117, v47
    v_mul_f32 v118, v118, v47
    v_mul_f32 v119, v119, v47
    v_mul_f32 v120, v120, v47
    v_mul_f32 v121, v121, v47
    v_mul_f32 v122, v122, v47
    v_mul_f32 v123, v123, v47
    v_mul_f32 v124, v124, v47
    v_mul_f32 v125, v125, v47
    v_mul_f32 v126, v126, v47
    v_mul_f32 v127, v127, v47
    v_cvt_pk_bf16_f32 v112, v112, v113
    v_cvt_pk_bf16_f32 v113, v114, v115
    v_cvt_pk_bf16_f32 v114, v116, v117
    v_cvt_pk_bf16_f32 v115, v118, v119
    v_cvt_pk_bf16_f32 v116, v120, v121
    v_cvt_pk_bf16_f32 v117, v122, v123
    v_cvt_pk_bf16_f32 v118, v124, v125
    v_cvt_pk_bf16_f32 v119, v126, v127
    v_permlane32_swap_b32 v112, v114
    v_permlane32_swap_b32 v113, v115
    v_permlane32_swap_b32 v116, v118
    v_permlane32_swap_b32 v117, v119
    s_mul_i32 s36, s34, 5
    s_add_u32 s36, s36, s33
    s_mul_i32 s37, s34, 4
    s_add_u32 s37, s37, s33
    s_add_u32 s38, s37, s34
    s_mov_b64 exec, s[30:31]
    buffer_store_dwordx4 v[112:115], v16, s[12:15], s36 offen offset:0 sc1
    s_mov_b64 exec, s[28:29]
    buffer_store_dwordx2 v[112:113], v17, s[12:15], s37 offen offset:1024 sc1
    buffer_store_dwordx2 v[114:115], v17, s[12:15], s38 offen offset:1024 sc1
    s_mov_b64 exec, -1
    s_mul_i32 s36, s34, 5
    s_add_u32 s36, s36, s33
    buffer_store_dwordx4 v[116:119], v19, s[12:15], s36 offen offset:512 sc1
    s_branch interleave_layers__softmax_full_mha__sliding_local_dilated__prompt_kernel_f_fin5
interleave_layers__softmax_full_mha__sliding_local_dilated__prompt_kernel_f_e1:
    v_mfma_f32_32x32x16_bf16 v[80:95], v[152:155], v[184:187], v[80:95]
    ds_read_b64_tr_b16 v[152:153], v219 offset:40960
    ds_read_b64_tr_b16 v[154:155], v219 offset:41984
    v_mfma_f32_32x32x16_bf16 v[80:95], v[156:159], v[188:191], v[80:95]
    ds_read_b64_tr_b16 v[156:157], v219 offset:45056
    ds_read_b64_tr_b16 v[158:159], v219 offset:46080
    v_mfma_f32_32x32x8_bf16 v[80:95], v[30:31], v[48:49], v[80:95]
    v_mul_f32 v64, v64, v47
    v_mul_f32 v65, v65, v47
    v_mul_f32 v66, v66, v47
    v_mul_f32 v67, v67, v47
    v_mul_f32 v68, v68, v47
    v_mul_f32 v69, v69, v47
    v_mul_f32 v70, v70, v47
    v_mul_f32 v71, v71, v47
    v_mul_f32 v72, v72, v47
    v_mul_f32 v73, v73, v47
    v_mul_f32 v74, v74, v47
    v_mul_f32 v75, v75, v47
    v_mul_f32 v76, v76, v47
    v_mul_f32 v77, v77, v47
    v_mul_f32 v78, v78, v47
    v_mul_f32 v79, v79, v47
    v_cvt_pk_bf16_f32 v64, v64, v65
    v_cvt_pk_bf16_f32 v65, v66, v67
    v_cvt_pk_bf16_f32 v66, v68, v69
    v_cvt_pk_bf16_f32 v67, v70, v71
    v_cvt_pk_bf16_f32 v68, v72, v73
    v_cvt_pk_bf16_f32 v69, v74, v75
    v_cvt_pk_bf16_f32 v70, v76, v77
    v_cvt_pk_bf16_f32 v71, v78, v79
    v_permlane32_swap_b32 v64, v66
    v_permlane32_swap_b32 v65, v67
    v_permlane32_swap_b32 v68, v70
    v_permlane32_swap_b32 v69, v71
    s_mul_i32 s36, s34, 6
    s_add_u32 s36, s36, s33
    s_mul_i32 s37, s34, 6
    s_add_u32 s37, s37, s33
    s_add_u32 s38, s37, s34
    s_mov_b64 exec, s[28:29]
    buffer_store_dwordx4 v[64:67], v16, s[12:15], s36 offen offset:512 sc1
    s_mov_b64 exec, s[30:31]
    buffer_store_dwordx2 v[64:65], v17, s[12:15], s37 offen offset:1024 sc1
    buffer_store_dwordx2 v[66:67], v17, s[12:15], s38 offen offset:1024 sc1
    s_mov_b64 exec, -1
    s_mul_i32 s36, s34, 7
    s_add_u32 s36, s36, s33
    buffer_store_dwordx4 v[68:71], v18, s[12:15], s36 offen offset:0 sc1
    v_mfma_f32_32x32x16_bf16 v[96:111], v[128:131], v[176:179], v[96:111]
    v_mfma_f32_32x32x16_bf16 v[96:111], v[132:135], v[180:183], v[96:111]
    v_mfma_f32_32x32x16_bf16 v[96:111], v[136:139], v[184:187], v[96:111]
    v_mul_f32 v80, v80, v47
    v_mul_f32 v81, v81, v47
    v_mul_f32 v82, v82, v47
    v_mul_f32 v83, v83, v47
    v_mfma_f32_32x32x16_bf16 v[96:111], v[140:143], v[188:191], v[96:111]
    v_mul_f32 v84, v84, v47
    v_mul_f32 v85, v85, v47
    v_mul_f32 v86, v86, v47
    v_mul_f32 v87, v87, v47
    v_mfma_f32_32x32x8_bf16 v[96:111], v[32:33], v[48:49], v[96:111]
    v_mul_f32 v88, v88, v47
    v_mul_f32 v89, v89, v47
    v_mul_f32 v90, v90, v47
    v_mul_f32 v91, v91, v47
    v_mul_f32 v92, v92, v47
    v_mul_f32 v93, v93, v47
    v_mul_f32 v94, v94, v47
    v_mul_f32 v95, v95, v47
    v_cvt_pk_bf16_f32 v80, v80, v81
    v_cvt_pk_bf16_f32 v81, v82, v83
    v_cvt_pk_bf16_f32 v82, v84, v85
    v_cvt_pk_bf16_f32 v83, v86, v87
    v_cvt_pk_bf16_f32 v84, v88, v89
    v_cvt_pk_bf16_f32 v85, v90, v91
    v_cvt_pk_bf16_f32 v86, v92, v93
    v_cvt_pk_bf16_f32 v87, v94, v95
    v_permlane32_swap_b32 v80, v82
    v_permlane32_swap_b32 v81, v83
    v_permlane32_swap_b32 v84, v86
    v_permlane32_swap_b32 v85, v87
    s_mul_i32 s36, s34, 8
    s_add_u32 s36, s36, s33
    buffer_store_dwordx4 v[80:83], v18, s[12:15], s36 offen offset:0 sc1
    s_mul_i32 s36, s34, 9
    s_add_u32 s36, s36, s33
    s_mul_i32 s37, s34, 8
    s_add_u32 s37, s37, s33
    s_add_u32 s38, s37, s34
    s_mov_b64 exec, s[30:31]
    buffer_store_dwordx4 v[84:87], v16, s[12:15], s36 offen offset:0 sc1
    s_mov_b64 exec, s[28:29]
    buffer_store_dwordx2 v[84:85], v17, s[12:15], s37 offen offset:1024 sc1
    buffer_store_dwordx2 v[86:87], v17, s[12:15], s38 offen offset:1024 sc1
    s_mov_b64 exec, -1
    s_waitcnt lgkmcnt(4)
    v_mfma_f32_32x32x16_bf16 v[112:127], v[144:147], v[176:179], v[112:127]
    v_mfma_f32_32x32x16_bf16 v[112:127], v[148:151], v[180:183], v[112:127]
    s_waitcnt lgkmcnt(0)
    v_mfma_f32_32x32x16_bf16 v[112:127], v[152:155], v[184:187], v[112:127]
    v_mul_f32 v96, v96, v47
    v_mul_f32 v97, v97, v47
    v_mul_f32 v98, v98, v47
    v_mul_f32 v99, v99, v47
    v_mfma_f32_32x32x16_bf16 v[112:127], v[156:159], v[188:191], v[112:127]
    v_mul_f32 v100, v100, v47
    v_mul_f32 v101, v101, v47
    v_mul_f32 v102, v102, v47
    v_mul_f32 v103, v103, v47
    v_mfma_f32_32x32x8_bf16 v[112:127], v[34:35], v[48:49], v[112:127]
    v_mul_f32 v104, v104, v47
    v_mul_f32 v105, v105, v47
    v_mul_f32 v106, v106, v47
    v_mul_f32 v107, v107, v47
    v_mul_f32 v108, v108, v47
    v_mul_f32 v109, v109, v47
    v_mul_f32 v110, v110, v47
    v_mul_f32 v111, v111, v47
    v_cvt_pk_bf16_f32 v96, v96, v97
    v_cvt_pk_bf16_f32 v97, v98, v99
    v_cvt_pk_bf16_f32 v98, v100, v101
    v_cvt_pk_bf16_f32 v99, v102, v103
    v_cvt_pk_bf16_f32 v100, v104, v105
    v_cvt_pk_bf16_f32 v101, v106, v107
    v_cvt_pk_bf16_f32 v102, v108, v109
    v_cvt_pk_bf16_f32 v103, v110, v111
    v_permlane32_swap_b32 v96, v98
    v_permlane32_swap_b32 v97, v99
    v_permlane32_swap_b32 v100, v102
    v_permlane32_swap_b32 v101, v103
    s_mul_i32 s36, s34, 9
    s_add_u32 s36, s36, s33
    buffer_store_dwordx4 v[96:99], v19, s[12:15], s36 offen offset:512 sc1
    s_mul_i32 s36, s34, 10
    s_add_u32 s36, s36, s33
    s_mul_i32 s37, s34, 10
    s_add_u32 s37, s37, s33
    s_add_u32 s38, s37, s34
    s_mov_b64 exec, s[28:29]
    buffer_store_dwordx4 v[100:103], v16, s[12:15], s36 offen offset:512 sc1
    s_mov_b64 exec, s[30:31]
    buffer_store_dwordx2 v[100:101], v17, s[12:15], s37 offen offset:1024 sc1
    buffer_store_dwordx2 v[102:103], v17, s[12:15], s38 offen offset:1024 sc1
    s_mov_b64 exec, -1
    v_mul_f32 v112, v112, v47
    v_mul_f32 v113, v113, v47
    v_mul_f32 v114, v114, v47
    v_mul_f32 v115, v115, v47
    v_mul_f32 v116, v116, v47
    v_mul_f32 v117, v117, v47
    v_mul_f32 v118, v118, v47
    v_mul_f32 v119, v119, v47
    v_mul_f32 v120, v120, v47
    v_mul_f32 v121, v121, v47
    v_mul_f32 v122, v122, v47
    v_mul_f32 v123, v123, v47
    v_mul_f32 v124, v124, v47
    v_mul_f32 v125, v125, v47
    v_mul_f32 v126, v126, v47
    v_mul_f32 v127, v127, v47
    v_cvt_pk_bf16_f32 v112, v112, v113
    v_cvt_pk_bf16_f32 v113, v114, v115
    v_cvt_pk_bf16_f32 v114, v116, v117
    v_cvt_pk_bf16_f32 v115, v118, v119
    v_cvt_pk_bf16_f32 v116, v120, v121
    v_cvt_pk_bf16_f32 v117, v122, v123
    v_cvt_pk_bf16_f32 v118, v124, v125
    v_cvt_pk_bf16_f32 v119, v126, v127
    v_permlane32_swap_b32 v112, v114
    v_permlane32_swap_b32 v113, v115
    v_permlane32_swap_b32 v116, v118
    v_permlane32_swap_b32 v117, v119
    s_mul_i32 s36, s34, 11
    s_add_u32 s36, s36, s33
    buffer_store_dwordx4 v[112:115], v18, s[12:15], s36 offen offset:0 sc1
    s_mul_i32 s36, s34, 12
    s_add_u32 s36, s36, s33
    buffer_store_dwordx4 v[116:119], v18, s[12:15], s36 offen offset:0 sc1
    s_branch interleave_layers__softmax_full_mha__sliding_local_dilated__prompt_kernel_f_fin5
interleave_layers__softmax_full_mha__sliding_local_dilated__prompt_kernel_f_e2:
    v_mfma_f32_32x32x16_bf16 v[80:95], v[152:155], v[184:187], v[80:95]
    ds_read_b64_tr_b16 v[152:153], v219 offset:40960
    ds_read_b64_tr_b16 v[154:155], v219 offset:41984
    v_mfma_f32_32x32x16_bf16 v[80:95], v[156:159], v[188:191], v[80:95]
    ds_read_b64_tr_b16 v[156:157], v219 offset:45056
    ds_read_b64_tr_b16 v[158:159], v219 offset:46080
    v_mfma_f32_32x32x8_bf16 v[80:95], v[30:31], v[48:49], v[80:95]
    v_mul_f32 v64, v64, v47
    v_mul_f32 v65, v65, v47
    v_mul_f32 v66, v66, v47
    v_mul_f32 v67, v67, v47
    v_mul_f32 v68, v68, v47
    v_mul_f32 v69, v69, v47
    v_mul_f32 v70, v70, v47
    v_mul_f32 v71, v71, v47
    v_mul_f32 v72, v72, v47
    v_mul_f32 v73, v73, v47
    v_mul_f32 v74, v74, v47
    v_mul_f32 v75, v75, v47
    v_mul_f32 v76, v76, v47
    v_mul_f32 v77, v77, v47
    v_mul_f32 v78, v78, v47
    v_mul_f32 v79, v79, v47
    v_cvt_pk_bf16_f32 v64, v64, v65
    v_cvt_pk_bf16_f32 v65, v66, v67
    v_cvt_pk_bf16_f32 v66, v68, v69
    v_cvt_pk_bf16_f32 v67, v70, v71
    v_cvt_pk_bf16_f32 v68, v72, v73
    v_cvt_pk_bf16_f32 v69, v74, v75
    v_cvt_pk_bf16_f32 v70, v76, v77
    v_cvt_pk_bf16_f32 v71, v78, v79
    v_permlane32_swap_b32 v64, v66
    v_permlane32_swap_b32 v65, v67
    v_permlane32_swap_b32 v68, v70
    v_permlane32_swap_b32 v69, v71
    s_mul_i32 s36, s34, 13
    s_add_u32 s36, s36, s33
    s_mul_i32 s37, s34, 12
    s_add_u32 s37, s37, s33
    s_add_u32 s38, s37, s34
    s_mov_b64 exec, s[30:31]
    buffer_store_dwordx4 v[64:67], v16, s[12:15], s36 offen offset:0 sc1
    s_mov_b64 exec, s[28:29]
    buffer_store_dwordx2 v[64:65], v17, s[12:15], s37 offen offset:1024 sc1
    buffer_store_dwordx2 v[66:67], v17, s[12:15], s38 offen offset:1024 sc1
    s_mov_b64 exec, -1
    s_mul_i32 s36, s34, 13
    s_add_u32 s36, s36, s33
    buffer_store_dwordx4 v[68:71], v19, s[12:15], s36 offen offset:512 sc1
    v_mfma_f32_32x32x16_bf16 v[96:111], v[128:131], v[176:179], v[96:111]
    v_mfma_f32_32x32x16_bf16 v[96:111], v[132:135], v[180:183], v[96:111]
    v_mfma_f32_32x32x16_bf16 v[96:111], v[136:139], v[184:187], v[96:111]
    v_mul_f32 v80, v80, v47
    v_mul_f32 v81, v81, v47
    v_mul_f32 v82, v82, v47
    v_mul_f32 v83, v83, v47
    v_mfma_f32_32x32x16_bf16 v[96:111], v[140:143], v[188:191], v[96:111]
    v_mul_f32 v84, v84, v47
    v_mul_f32 v85, v85, v47
    v_mul_f32 v86, v86, v47
    v_mul_f32 v87, v87, v47
    v_mfma_f32_32x32x8_bf16 v[96:111], v[32:33], v[48:49], v[96:111]
    v_mul_f32 v88, v88, v47
    v_mul_f32 v89, v89, v47
    v_mul_f32 v90, v90, v47
    v_mul_f32 v91, v91, v47
    v_mul_f32 v92, v92, v47
    v_mul_f32 v93, v93, v47
    v_mul_f32 v94, v94, v47
    v_mul_f32 v95, v95, v47
    v_cvt_pk_bf16_f32 v80, v80, v81
    v_cvt_pk_bf16_f32 v81, v82, v83
    v_cvt_pk_bf16_f32 v82, v84, v85
    v_cvt_pk_bf16_f32 v83, v86, v87
    v_cvt_pk_bf16_f32 v84, v88, v89
    v_cvt_pk_bf16_f32 v85, v90, v91
    v_cvt_pk_bf16_f32 v86, v92, v93
    v_cvt_pk_bf16_f32 v87, v94, v95
    v_permlane32_swap_b32 v80, v82
    v_permlane32_swap_b32 v81, v83
    v_permlane32_swap_b32 v84, v86
    v_permlane32_swap_b32 v85, v87
    s_mul_i32 s36, s34, 14
    s_add_u32 s36, s36, s33
    s_mul_i32 s37, s34, 14
    s_add_u32 s37, s37, s33
    s_add_u32 s38, s37, s34
    s_mov_b64 exec, s[28:29]
    buffer_store_dwordx4 v[80:83], v16, s[12:15], s36 offen offset:512 sc1
    s_mov_b64 exec, s[30:31]
    buffer_store_dwordx2 v[80:81], v17, s[12:15], s37 offen offset:1024 sc1
    buffer_store_dwordx2 v[82:83], v17, s[12:15], s38 offen offset:1024 sc1
    s_mov_b64 exec, -1
    s_mul_i32 s36, s34, 15
    s_add_u32 s36, s36, s33
    buffer_store_dwordx4 v[84:87], v18, s[12:15], s36 offen offset:0 sc1
    s_waitcnt lgkmcnt(4)
    v_mfma_f32_32x32x16_bf16 v[112:127], v[144:147], v[176:179], v[112:127]
    v_mfma_f32_32x32x16_bf16 v[112:127], v[148:151], v[180:183], v[112:127]
    s_waitcnt lgkmcnt(0)
    v_mfma_f32_32x32x16_bf16 v[112:127], v[152:155], v[184:187], v[112:127]
    v_mul_f32 v96, v96, v47
    v_mul_f32 v97, v97, v47
    v_mul_f32 v98, v98, v47
    v_mul_f32 v99, v99, v47
    v_mfma_f32_32x32x16_bf16 v[112:127], v[156:159], v[188:191], v[112:127]
    v_mul_f32 v100, v100, v47
    v_mul_f32 v101, v101, v47
    v_mul_f32 v102, v102, v47
    v_mul_f32 v103, v103, v47
    v_mfma_f32_32x32x8_bf16 v[112:127], v[34:35], v[48:49], v[112:127]
    v_mul_f32 v104, v104, v47
    v_mul_f32 v105, v105, v47
    v_mul_f32 v106, v106, v47
    v_mul_f32 v107, v107, v47
    v_mul_f32 v108, v108, v47
    v_mul_f32 v109, v109, v47
    v_mul_f32 v110, v110, v47
    v_mul_f32 v111, v111, v47
    v_cvt_pk_bf16_f32 v96, v96, v97
    v_cvt_pk_bf16_f32 v97, v98, v99
    v_cvt_pk_bf16_f32 v98, v100, v101
    v_cvt_pk_bf16_f32 v99, v102, v103
    v_cvt_pk_bf16_f32 v100, v104, v105
    v_cvt_pk_bf16_f32 v101, v106, v107
    v_cvt_pk_bf16_f32 v102, v108, v109
    v_cvt_pk_bf16_f32 v103, v110, v111
    v_permlane32_swap_b32 v96, v98
    v_permlane32_swap_b32 v97, v99
    v_permlane32_swap_b32 v100, v102
    v_permlane32_swap_b32 v101, v103
    s_mul_i32 s36, s34, 16
    s_add_u32 s36, s36, s33
    buffer_store_dwordx4 v[96:99], v18, s[12:15], s36 offen offset:0 sc1
    s_mul_i32 s36, s34, 17
    s_add_u32 s36, s36, s33
    s_mul_i32 s37, s34, 16
    s_add_u32 s37, s37, s33
    s_add_u32 s38, s37, s34
    s_mov_b64 exec, s[30:31]
    buffer_store_dwordx4 v[100:103], v16, s[12:15], s36 offen offset:0 sc1
    s_mov_b64 exec, s[28:29]
    buffer_store_dwordx2 v[100:101], v17, s[12:15], s37 offen offset:1024 sc1
    buffer_store_dwordx2 v[102:103], v17, s[12:15], s38 offen offset:1024 sc1
    s_mov_b64 exec, -1
    v_mul_f32 v112, v112, v47
    v_mul_f32 v113, v113, v47
    v_mul_f32 v114, v114, v47
    v_mul_f32 v115, v115, v47
    v_mul_f32 v116, v116, v47
    v_mul_f32 v117, v117, v47
    v_mul_f32 v118, v118, v47
    v_mul_f32 v119, v119, v47
    v_mul_f32 v120, v120, v47
    v_mul_f32 v121, v121, v47
    v_mul_f32 v122, v122, v47
    v_mul_f32 v123, v123, v47
    v_mul_f32 v124, v124, v47
    v_mul_f32 v125, v125, v47
    v_mul_f32 v126, v126, v47
    v_mul_f32 v127, v127, v47
    v_cvt_pk_bf16_f32 v112, v112, v113
    v_cvt_pk_bf16_f32 v113, v114, v115
    v_cvt_pk_bf16_f32 v114, v116, v117
    v_cvt_pk_bf16_f32 v115, v118, v119
    v_cvt_pk_bf16_f32 v116, v120, v121
    v_cvt_pk_bf16_f32 v117, v122, v123
    v_cvt_pk_bf16_f32 v118, v124, v125
    v_cvt_pk_bf16_f32 v119, v126, v127
    v_permlane32_swap_b32 v112, v114
    v_permlane32_swap_b32 v113, v115
    v_permlane32_swap_b32 v116, v118
    v_permlane32_swap_b32 v117, v119
    s_mul_i32 s36, s34, 17
    s_add_u32 s36, s36, s33
    buffer_store_dwordx4 v[112:115], v19, s[12:15], s36 offen offset:512 sc1
    s_mul_i32 s36, s34, 18
    s_add_u32 s36, s36, s33
    s_mul_i32 s37, s34, 18
    s_add_u32 s37, s37, s33
    s_add_u32 s38, s37, s34
    s_mov_b64 exec, s[28:29]
    buffer_store_dwordx4 v[116:119], v16, s[12:15], s36 offen offset:512 sc1
    s_mov_b64 exec, s[30:31]
    buffer_store_dwordx2 v[116:117], v17, s[12:15], s37 offen offset:1024 sc1
    buffer_store_dwordx2 v[118:119], v17, s[12:15], s38 offen offset:1024 sc1
    s_mov_b64 exec, -1
    s_branch interleave_layers__softmax_full_mha__sliding_local_dilated__prompt_kernel_f_fin5
interleave_layers__softmax_full_mha__sliding_local_dilated__prompt_kernel_f_e3:
    v_mfma_f32_32x32x16_bf16 v[80:95], v[152:155], v[184:187], v[80:95]
    ds_read_b64_tr_b16 v[152:153], v219 offset:40960
    ds_read_b64_tr_b16 v[154:155], v219 offset:41984
    v_mfma_f32_32x32x16_bf16 v[80:95], v[156:159], v[188:191], v[80:95]
    ds_read_b64_tr_b16 v[156:157], v219 offset:45056
    ds_read_b64_tr_b16 v[158:159], v219 offset:46080
    v_mfma_f32_32x32x8_bf16 v[80:95], v[30:31], v[48:49], v[80:95]
    v_mul_f32 v64, v64, v47
    v_mul_f32 v65, v65, v47
    v_mul_f32 v66, v66, v47
    v_mul_f32 v67, v67, v47
    v_mul_f32 v68, v68, v47
    v_mul_f32 v69, v69, v47
    v_mul_f32 v70, v70, v47
    v_mul_f32 v71, v71, v47
    v_mul_f32 v72, v72, v47
    v_mul_f32 v73, v73, v47
    v_mul_f32 v74, v74, v47
    v_mul_f32 v75, v75, v47
    v_mul_f32 v76, v76, v47
    v_mul_f32 v77, v77, v47
    v_mul_f32 v78, v78, v47
    v_mul_f32 v79, v79, v47
    v_cvt_pk_bf16_f32 v64, v64, v65
    v_cvt_pk_bf16_f32 v65, v66, v67
    v_cvt_pk_bf16_f32 v66, v68, v69
    v_cvt_pk_bf16_f32 v67, v70, v71
    v_cvt_pk_bf16_f32 v68, v72, v73
    v_cvt_pk_bf16_f32 v69, v74, v75
    v_cvt_pk_bf16_f32 v70, v76, v77
    v_cvt_pk_bf16_f32 v71, v78, v79
    v_permlane32_swap_b32 v64, v66
    v_permlane32_swap_b32 v65, v67
    v_permlane32_swap_b32 v68, v70
    v_permlane32_swap_b32 v69, v71
    s_mul_i32 s36, s34, 19
    s_add_u32 s36, s36, s33
    buffer_store_dwordx4 v[64:67], v18, s[12:15], s36 offen offset:0 sc1
    s_mul_i32 s36, s34, 20
    s_add_u32 s36, s36, s33
    buffer_store_dwordx4 v[68:71], v18, s[12:15], s36 offen offset:0 sc1
    v_mfma_f32_32x32x16_bf16 v[96:111], v[128:131], v[176:179], v[96:111]
    v_mfma_f32_32x32x16_bf16 v[96:111], v[132:135], v[180:183], v[96:111]
    v_mfma_f32_32x32x16_bf16 v[96:111], v[136:139], v[184:187], v[96:111]
    v_mul_f32 v80, v80, v47
    v_mul_f32 v81, v81, v47
    v_mul_f32 v82, v82, v47
    v_mul_f32 v83, v83, v47
    v_mfma_f32_32x32x16_bf16 v[96:111], v[140:143], v[188:191], v[96:111]
    v_mul_f32 v84, v84, v47
    v_mul_f32 v85, v85, v47
    v_mul_f32 v86, v86, v47
    v_mul_f32 v87, v87, v47
    v_mfma_f32_32x32x8_bf16 v[96:111], v[32:33], v[48:49], v[96:111]
    v_mul_f32 v88, v88, v47
    v_mul_f32 v89, v89, v47
    v_mul_f32 v90, v90, v47
    v_mul_f32 v91, v91, v47
    v_mul_f32 v92, v92, v47
    v_mul_f32 v93, v93, v47
    v_mul_f32 v94, v94, v47
    v_mul_f32 v95, v95, v47
    v_cvt_pk_bf16_f32 v80, v80, v81
    v_cvt_pk_bf16_f32 v81, v82, v83
    v_cvt_pk_bf16_f32 v82, v84, v85
    v_cvt_pk_bf16_f32 v83, v86, v87
    v_cvt_pk_bf16_f32 v84, v88, v89
    v_cvt_pk_bf16_f32 v85, v90, v91
    v_cvt_pk_bf16_f32 v86, v92, v93
    v_cvt_pk_bf16_f32 v87, v94, v95
    v_permlane32_swap_b32 v80, v82
    v_permlane32_swap_b32 v81, v83
    v_permlane32_swap_b32 v84, v86
    v_permlane32_swap_b32 v85, v87
    s_mul_i32 s36, s34, 21
    s_add_u32 s36, s36, s33
    s_mul_i32 s37, s34, 20
    s_add_u32 s37, s37, s33
    s_add_u32 s38, s37, s34
    s_mov_b64 exec, s[30:31]
    buffer_store_dwordx4 v[80:83], v16, s[12:15], s36 offen offset:0 sc1
    s_mov_b64 exec, s[28:29]
    buffer_store_dwordx2 v[80:81], v17, s[12:15], s37 offen offset:1024 sc1
    buffer_store_dwordx2 v[82:83], v17, s[12:15], s38 offen offset:1024 sc1
    s_mov_b64 exec, -1
    s_mul_i32 s36, s34, 21
    s_add_u32 s36, s36, s33
    buffer_store_dwordx4 v[84:87], v19, s[12:15], s36 offen offset:512 sc1
    s_waitcnt lgkmcnt(4)
    v_mfma_f32_32x32x16_bf16 v[112:127], v[144:147], v[176:179], v[112:127]
    v_mfma_f32_32x32x16_bf16 v[112:127], v[148:151], v[180:183], v[112:127]
    s_waitcnt lgkmcnt(0)
    v_mfma_f32_32x32x16_bf16 v[112:127], v[152:155], v[184:187], v[112:127]
    v_mul_f32 v96, v96, v47
    v_mul_f32 v97, v97, v47
    v_mul_f32 v98, v98, v47
    v_mul_f32 v99, v99, v47
    v_mfma_f32_32x32x16_bf16 v[112:127], v[156:159], v[188:191], v[112:127]
    v_mul_f32 v100, v100, v47
    v_mul_f32 v101, v101, v47
    v_mul_f32 v102, v102, v47
    v_mul_f32 v103, v103, v47
    v_mfma_f32_32x32x8_bf16 v[112:127], v[34:35], v[48:49], v[112:127]
    v_mul_f32 v104, v104, v47
    v_mul_f32 v105, v105, v47
    v_mul_f32 v106, v106, v47
    v_mul_f32 v107, v107, v47
    v_mul_f32 v108, v108, v47
    v_mul_f32 v109, v109, v47
    v_mul_f32 v110, v110, v47
    v_mul_f32 v111, v111, v47
    v_cvt_pk_bf16_f32 v96, v96, v97
    v_cvt_pk_bf16_f32 v97, v98, v99
    v_cvt_pk_bf16_f32 v98, v100, v101
    v_cvt_pk_bf16_f32 v99, v102, v103
    v_cvt_pk_bf16_f32 v100, v104, v105
    v_cvt_pk_bf16_f32 v101, v106, v107
    v_cvt_pk_bf16_f32 v102, v108, v109
    v_cvt_pk_bf16_f32 v103, v110, v111
    v_permlane32_swap_b32 v96, v98
    v_permlane32_swap_b32 v97, v99
    v_permlane32_swap_b32 v100, v102
    v_permlane32_swap_b32 v101, v103
    s_mul_i32 s36, s34, 22
    s_add_u32 s36, s36, s33
    s_mul_i32 s37, s34, 22
    s_add_u32 s37, s37, s33
    s_add_u32 s38, s37, s34
    s_mov_b64 exec, s[28:29]
    buffer_store_dwordx4 v[96:99], v16, s[12:15], s36 offen offset:512 sc1
    s_mov_b64 exec, s[30:31]
    buffer_store_dwordx2 v[96:97], v17, s[12:15], s37 offen offset:1024 sc1
    buffer_store_dwordx2 v[98:99], v17, s[12:15], s38 offen offset:1024 sc1
    s_mov_b64 exec, -1
    s_mul_i32 s36, s34, 23
    s_add_u32 s36, s36, s33
    buffer_store_dwordx4 v[100:103], v18, s[12:15], s36 offen offset:0 sc1
    v_mul_f32 v112, v112, v47
    v_mul_f32 v113, v113, v47
    v_mul_f32 v114, v114, v47
    v_mul_f32 v115, v115, v47
    v_mul_f32 v116, v116, v47
    v_mul_f32 v117, v117, v47
    v_mul_f32 v118, v118, v47
    v_mul_f32 v119, v119, v47
    v_mul_f32 v120, v120, v47
    v_mul_f32 v121, v121, v47
    v_mul_f32 v122, v122, v47
    v_mul_f32 v123, v123, v47
    v_mul_f32 v124, v124, v47
    v_mul_f32 v125, v125, v47
    v_mul_f32 v126, v126, v47
    v_mul_f32 v127, v127, v47
    v_cvt_pk_bf16_f32 v112, v112, v113
    v_cvt_pk_bf16_f32 v113, v114, v115
    v_cvt_pk_bf16_f32 v114, v116, v117
    v_cvt_pk_bf16_f32 v115, v118, v119
    v_cvt_pk_bf16_f32 v116, v120, v121
    v_cvt_pk_bf16_f32 v117, v122, v123
    v_cvt_pk_bf16_f32 v118, v124, v125
    v_cvt_pk_bf16_f32 v119, v126, v127
    v_permlane32_swap_b32 v112, v114
    v_permlane32_swap_b32 v113, v115
    v_permlane32_swap_b32 v116, v118
    v_permlane32_swap_b32 v117, v119
    s_mul_i32 s36, s34, 24
    s_add_u32 s36, s36, s33
    buffer_store_dwordx4 v[112:115], v18, s[12:15], s36 offen offset:0 sc1
    s_mul_i32 s36, s34, 25
    s_add_u32 s36, s36, s33
    s_mul_i32 s37, s34, 24
    s_add_u32 s37, s37, s33
    s_add_u32 s38, s37, s34
    s_mov_b64 exec, s[30:31]
    buffer_store_dwordx4 v[116:119], v16, s[12:15], s36 offen offset:0 sc1
    s_mov_b64 exec, s[28:29]
    buffer_store_dwordx2 v[116:117], v17, s[12:15], s37 offen offset:1024 sc1
    buffer_store_dwordx2 v[118:119], v17, s[12:15], s38 offen offset:1024 sc1
    s_mov_b64 exec, -1
    s_branch interleave_layers__softmax_full_mha__sliding_local_dilated__prompt_kernel_f_fin5
interleave_layers__softmax_full_mha__sliding_local_dilated__prompt_kernel_f_e4:
    v_mfma_f32_32x32x16_bf16 v[80:95], v[152:155], v[184:187], v[80:95]
    ds_read_b64_tr_b16 v[152:153], v219 offset:40960
    ds_read_b64_tr_b16 v[154:155], v219 offset:41984
    v_mfma_f32_32x32x16_bf16 v[80:95], v[156:159], v[188:191], v[80:95]
    ds_read_b64_tr_b16 v[156:157], v219 offset:45056
    ds_read_b64_tr_b16 v[158:159], v219 offset:46080
    v_mfma_f32_32x32x8_bf16 v[80:95], v[30:31], v[48:49], v[80:95]
    v_mul_f32 v64, v64, v47
    v_mul_f32 v65, v65, v47
    v_mul_f32 v66, v66, v47
    v_mul_f32 v67, v67, v47
    v_mul_f32 v68, v68, v47
    v_mul_f32 v69, v69, v47
    v_mul_f32 v70, v70, v47
    v_mul_f32 v71, v71, v47
    v_mul_f32 v72, v72, v47
    v_mul_f32 v73, v73, v47
    v_mul_f32 v74, v74, v47
    v_mul_f32 v75, v75, v47
    v_mul_f32 v76, v76, v47
    v_mul_f32 v77, v77, v47
    v_mul_f32 v78, v78, v47
    v_mul_f32 v79, v79, v47
    v_cvt_pk_bf16_f32 v64, v64, v65
    v_cvt_pk_bf16_f32 v65, v66, v67
    v_cvt_pk_bf16_f32 v66, v68, v69
    v_cvt_pk_bf16_f32 v67, v70, v71
    v_cvt_pk_bf16_f32 v68, v72, v73
    v_cvt_pk_bf16_f32 v69, v74, v75
    v_cvt_pk_bf16_f32 v70, v76, v77
    v_cvt_pk_bf16_f32 v71, v78, v79
    v_permlane32_swap_b32 v64, v66
    v_permlane32_swap_b32 v65, v67
    v_permlane32_swap_b32 v68, v70
    v_permlane32_swap_b32 v69, v71
    s_mul_i32 s36, s34, 25
    s_add_u32 s36, s36, s33
    buffer_store_dwordx4 v[64:67], v19, s[12:15], s36 offen offset:512 sc1
    s_mul_i32 s36, s34, 26
    s_add_u32 s36, s36, s33
    s_mul_i32 s37, s34, 26
    s_add_u32 s37, s37, s33
    s_add_u32 s38, s37, s34
    s_mov_b64 exec, s[28:29]
    buffer_store_dwordx4 v[68:71], v16, s[12:15], s36 offen offset:512 sc1
    s_mov_b64 exec, s[30:31]
    buffer_store_dwordx2 v[68:69], v17, s[12:15], s37 offen offset:1024 sc1
    buffer_store_dwordx2 v[70:71], v17, s[12:15], s38 offen offset:1024 sc1
    s_mov_b64 exec, -1
    v_mfma_f32_32x32x16_bf16 v[96:111], v[128:131], v[176:179], v[96:111]
    v_mfma_f32_32x32x16_bf16 v[96:111], v[132:135], v[180:183], v[96:111]
    v_mfma_f32_32x32x16_bf16 v[96:111], v[136:139], v[184:187], v[96:111]
    v_mul_f32 v80, v80, v47
    v_mul_f32 v81, v81, v47
    v_mul_f32 v82, v82, v47
    v_mul_f32 v83, v83, v47
    v_mfma_f32_32x32x16_bf16 v[96:111], v[140:143], v[188:191], v[96:111]
    v_mul_f32 v84, v84, v47
    v_mul_f32 v85, v85, v47
    v_mul_f32 v86, v86, v47
    v_mul_f32 v87, v87, v47
    v_mfma_f32_32x32x8_bf16 v[96:111], v[32:33], v[48:49], v[96:111]
    v_mul_f32 v88, v88, v47
    v_mul_f32 v89, v89, v47
    v_mul_f32 v90, v90, v47
    v_mul_f32 v91, v91, v47
    v_mul_f32 v92, v92, v47
    v_mul_f32 v93, v93, v47
    v_mul_f32 v94, v94, v47
    v_mul_f32 v95, v95, v47
    v_cvt_pk_bf16_f32 v80, v80, v81
    v_cvt_pk_bf16_f32 v81, v82, v83
    v_cvt_pk_bf16_f32 v82, v84, v85
    v_cvt_pk_bf16_f32 v83, v86, v87
    v_cvt_pk_bf16_f32 v84, v88, v89
    v_cvt_pk_bf16_f32 v85, v90, v91
    v_cvt_pk_bf16_f32 v86, v92, v93
    v_cvt_pk_bf16_f32 v87, v94, v95
    v_permlane32_swap_b32 v80, v82
    v_permlane32_swap_b32 v81, v83
    v_permlane32_swap_b32 v84, v86
    v_permlane32_swap_b32 v85, v87
    s_mul_i32 s36, s34, 27
    s_add_u32 s36, s36, s33
    buffer_store_dwordx4 v[80:83], v18, s[12:15], s36 offen offset:0 sc1
    s_mul_i32 s36, s34, 28
    s_add_u32 s36, s36, s33
    buffer_store_dwordx4 v[84:87], v18, s[12:15], s36 offen offset:0 sc1
    s_waitcnt lgkmcnt(4)
    v_mfma_f32_32x32x16_bf16 v[112:127], v[144:147], v[176:179], v[112:127]
    v_mfma_f32_32x32x16_bf16 v[112:127], v[148:151], v[180:183], v[112:127]
    s_waitcnt lgkmcnt(0)
    v_mfma_f32_32x32x16_bf16 v[112:127], v[152:155], v[184:187], v[112:127]
    v_mul_f32 v96, v96, v47
    v_mul_f32 v97, v97, v47
    v_mul_f32 v98, v98, v47
    v_mul_f32 v99, v99, v47
    v_mfma_f32_32x32x16_bf16 v[112:127], v[156:159], v[188:191], v[112:127]
    v_mul_f32 v100, v100, v47
    v_mul_f32 v101, v101, v47
    v_mul_f32 v102, v102, v47
    v_mul_f32 v103, v103, v47
    v_mfma_f32_32x32x8_bf16 v[112:127], v[34:35], v[48:49], v[112:127]
    v_mul_f32 v104, v104, v47
    v_mul_f32 v105, v105, v47
    v_mul_f32 v106, v106, v47
    v_mul_f32 v107, v107, v47
    v_mul_f32 v108, v108, v47
    v_mul_f32 v109, v109, v47
    v_mul_f32 v110, v110, v47
    v_mul_f32 v111, v111, v47
    v_cvt_pk_bf16_f32 v96, v96, v97
    v_cvt_pk_bf16_f32 v97, v98, v99
    v_cvt_pk_bf16_f32 v98, v100, v101
    v_cvt_pk_bf16_f32 v99, v102, v103
    v_cvt_pk_bf16_f32 v100, v104, v105
    v_cvt_pk_bf16_f32 v101, v106, v107
    v_cvt_pk_bf16_f32 v102, v108, v109
    v_cvt_pk_bf16_f32 v103, v110, v111
    v_permlane32_swap_b32 v96, v98
    v_permlane32_swap_b32 v97, v99
    v_permlane32_swap_b32 v100, v102
    v_permlane32_swap_b32 v101, v103
    s_mul_i32 s36, s34, 29
    s_add_u32 s36, s36, s33
    s_mul_i32 s37, s34, 28
    s_add_u32 s37, s37, s33
    s_add_u32 s38, s37, s34
    s_mov_b64 exec, s[30:31]
    buffer_store_dwordx4 v[96:99], v16, s[12:15], s36 offen offset:0 sc1
    s_mov_b64 exec, s[28:29]
    buffer_store_dwordx2 v[96:97], v17, s[12:15], s37 offen offset:1024 sc1
    buffer_store_dwordx2 v[98:99], v17, s[12:15], s38 offen offset:1024 sc1
    s_mov_b64 exec, -1
    s_mul_i32 s36, s34, 29
    s_add_u32 s36, s36, s33
    buffer_store_dwordx4 v[100:103], v19, s[12:15], s36 offen offset:512 sc1
    v_mul_f32 v112, v112, v47
    v_mul_f32 v113, v113, v47
    v_mul_f32 v114, v114, v47
    v_mul_f32 v115, v115, v47
    v_mul_f32 v116, v116, v47
    v_mul_f32 v117, v117, v47
    v_mul_f32 v118, v118, v47
    v_mul_f32 v119, v119, v47
    v_mul_f32 v120, v120, v47
    v_mul_f32 v121, v121, v47
    v_mul_f32 v122, v122, v47
    v_mul_f32 v123, v123, v47
    v_mul_f32 v124, v124, v47
    v_mul_f32 v125, v125, v47
    v_mul_f32 v126, v126, v47
    v_mul_f32 v127, v127, v47
    v_cvt_pk_bf16_f32 v112, v112, v113
    v_cvt_pk_bf16_f32 v113, v114, v115
    v_cvt_pk_bf16_f32 v114, v116, v117
    v_cvt_pk_bf16_f32 v115, v118, v119
    v_cvt_pk_bf16_f32 v116, v120, v121
    v_cvt_pk_bf16_f32 v117, v122, v123
    v_cvt_pk_bf16_f32 v118, v124, v125
    v_cvt_pk_bf16_f32 v119, v126, v127
    v_permlane32_swap_b32 v112, v114
    v_permlane32_swap_b32 v113, v115
    v_permlane32_swap_b32 v116, v118
    v_permlane32_swap_b32 v117, v119
    s_mul_i32 s36, s34, 30
    s_add_u32 s36, s36, s33
    s_mul_i32 s37, s34, 30
    s_add_u32 s37, s37, s33
    s_add_u32 s38, s37, s34
    s_mov_b64 exec, s[28:29]
    buffer_store_dwordx4 v[112:115], v16, s[12:15], s36 offen offset:512 sc1
    s_mov_b64 exec, s[30:31]
    buffer_store_dwordx2 v[112:113], v17, s[12:15], s37 offen offset:1024 sc1
    buffer_store_dwordx2 v[114:115], v17, s[12:15], s38 offen offset:1024 sc1
    s_mov_b64 exec, -1
    s_mul_i32 s36, s34, 31
    s_add_u32 s36, s36, s33
    buffer_store_dwordx4 v[116:119], v18, s[12:15], s36 offen offset:0 sc1
    s_branch interleave_layers__softmax_full_mha__sliding_local_dilated__prompt_kernel_f_fin5
interleave_layers__softmax_full_mha__sliding_local_dilated__prompt_kernel_f_qv:
    s_barrier
    ds_read_b128 v[160:163], v224 offset:0
    ds_read_b128 v[164:167], v225 offset:0
    ds_read_b64_tr_b16 v[128:129], v216 offset:0
    ds_read_b64_tr_b16 v[130:131], v216 offset:1024
    ds_read_b64_tr_b16 v[132:133], v217 offset:0
    ds_read_b64_tr_b16 v[134:135], v217 offset:1024
    ds_read_b64_tr_b16 v[136:137], v218 offset:0
    ds_read_b64_tr_b16 v[138:139], v218 offset:1024
    ds_read_b64_tr_b16 v[140:141], v219 offset:0
    ds_read_b64_tr_b16 v[142:143], v219 offset:1024
    ds_read_b64_tr_b16 v[144:145], v216 offset:4096
    ds_read_b64_tr_b16 v[146:147], v216 offset:5120
    ds_read_b64_tr_b16 v[148:149], v217 offset:4096
    ds_read_b64_tr_b16 v[150:151], v217 offset:5120
    ds_read_b64_tr_b16 v[152:153], v218 offset:4096
    ds_read_b64_tr_b16 v[154:155], v218 offset:5120
    ds_read_b64_tr_b16 v[156:157], v219 offset:4096
    ds_read_b64_tr_b16 v[158:159], v219 offset:5120
    s_waitcnt lgkmcnt(12)
    v_mfma_f32_32x32x16_bf16 v[64:79], v[160:163], v[128:131], 0
    ds_read_b128 v[168:171], v226 offset:0
    ds_read_b128 v[172:175], v227 offset:0
    ds_read_b64_tr_b16 v[128:129], v216 offset:8192
    ds_read_b64_tr_b16 v[130:131], v216 offset:9216
    v_mfma_f32_32x32x16_bf16 v[80:95], v[160:163], v[132:135], 0
    ds_read_b64_tr_b16 v[132:133], v217 offset:8192
    ds_read_b64_tr_b16 v[134:135], v217 offset:9216
    s_waitcnt lgkmcnt(14)
    v_mfma_f32_32x32x16_bf16 v[96:111], v[160:163], v[136:139], 0
    ds_read_b64_tr_b16 v[136:137], v218 offset:8192
    ds_read_b64_tr_b16 v[138:139], v218 offset:9216
    v_mfma_f32_32x32x16_bf16 v[112:127], v[160:163], v[140:143], 0
    ds_read_b64_tr_b16 v[140:141], v219 offset:8192
    ds_read_b64_tr_b16 v[142:143], v219 offset:9216
    s_waitcnt lgkmcnt(14)
    v_mfma_f32_32x32x16_bf16 v[64:79], v[164:167], v[144:147], v[64:79]
    ds_read_b64_tr_b16 v[144:145], v216 offset:12288
    ds_read_b64_tr_b16 v[146:147], v216 offset:13312
    v_mfma_f32_32x32x16_bf16 v[80:95], v[164:167], v[148:151], v[80:95]
    ds_read_b64_tr_b16 v[148:149], v217 offset:12288
    ds_read_b64_tr_b16 v[150:151], v217 offset:13312
    s_waitcnt lgkmcnt(14)
    v_mfma_f32_32x32x16_bf16 v[96:111], v[164:167], v[152:155], v[96:111]
    ds_read_b64_tr_b16 v[152:153], v218 offset:12288
    ds_read_b64_tr_b16 v[154:155], v218 offset:13312
    v_mfma_f32_32x32x16_bf16 v[112:127], v[164:167], v[156:159], v[112:127]
    ds_read_b64_tr_b16 v[156:157], v219 offset:12288
    ds_read_b64_tr_b16 v[158:159], v219 offset:13312
    s_cmp_eq_u32 s17, 0
    s_cbranch_scc0 interleave_layers__softmax_full_mha__sliding_local_dilated__prompt_kernel_f_xv0
    s_add_u32 s32, s24, 0
    buffer_store_dwordx4 v[160:163], v8, s[12:15], s32 offen offset:0 sc1
    buffer_store_dwordx4 v[164:167], v8, s[12:15], s32 offen offset:512 sc1
interleave_layers__softmax_full_mha__sliding_local_dilated__prompt_kernel_f_xv0:
    s_waitcnt lgkmcnt(12)
    v_mfma_f32_32x32x16_bf16 v[64:79], v[168:171], v[128:131], v[64:79]
    s_barrier
    ds_read_b128 v[176:179], v224 offset:32768
    ds_read_b128 v[180:183], v225 offset:32768
    ds_read_b64_tr_b16 v[128:129], v216 offset:32768
    ds_read_b64_tr_b16 v[130:131], v216 offset:33792
    v_mfma_f32_32x32x16_bf16 v[80:95], v[168:171], v[132:135], v[80:95]
    ds_read_b64_tr_b16 v[132:133], v217 offset:32768
    ds_read_b64_tr_b16 v[134:135], v217 offset:33792
    s_waitcnt lgkmcnt(14)
    v_mfma_f32_32x32x16_bf16 v[96:111], v[168:171], v[136:139], v[96:111]
    ds_read_b64_tr_b16 v[136:137], v218 offset:32768
    ds_read_b64_tr_b16 v[138:139], v218 offset:33792
    v_mfma_f32_32x32x16_bf16 v[112:127], v[168:171], v[140:143], v[112:127]
    ds_read_b64_tr_b16 v[140:141], v219 offset:32768
    ds_read_b64_tr_b16 v[142:143], v219 offset:33792
    s_waitcnt lgkmcnt(14)
    v_mfma_f32_32x32x16_bf16 v[64:79], v[172:175], v[144:147], v[64:79]
    ds_read_b64_tr_b16 v[144:145], v216 offset:36864
    ds_read_b64_tr_b16 v[146:147], v216 offset:37888
    v_mfma_f32_32x32x16_bf16 v[80:95], v[172:175], v[148:151], v[80:95]
    ds_read_b64_tr_b16 v[148:149], v217 offset:36864
    ds_read_b64_tr_b16 v[150:151], v217 offset:37888
    s_waitcnt lgkmcnt(14)
    v_mfma_f32_32x32x16_bf16 v[96:111], v[172:175], v[152:155], v[96:111]
    ds_read_b64_tr_b16 v[152:153], v218 offset:36864
    ds_read_b64_tr_b16 v[154:155], v218 offset:37888
    v_mfma_f32_32x32x16_bf16 v[112:127], v[172:175], v[156:159], v[112:127]
    ds_read_b64_tr_b16 v[156:157], v219 offset:36864
    ds_read_b64_tr_b16 v[158:159], v219 offset:37888
    s_cmp_eq_u32 s17, 1
    s_cbranch_scc0 interleave_layers__softmax_full_mha__sliding_local_dilated__prompt_kernel_f_xv1
    s_add_u32 s32, s24, 1024
    buffer_store_dwordx4 v[168:171], v8, s[12:15], s32 offen offset:0 sc1
    buffer_store_dwordx4 v[172:175], v8, s[12:15], s32 offen offset:512 sc1
interleave_layers__softmax_full_mha__sliding_local_dilated__prompt_kernel_f_xv1:
    s_waitcnt lgkmcnt(12)
    v_mfma_f32_32x32x16_bf16 v[64:79], v[176:179], v[128:131], v[64:79]
    ds_read_b128 v[184:187], v226 offset:32768
    ds_read_b128 v[188:191], v227 offset:32768
    ds_read_b64_tr_b16 v[128:129], v216 offset:40960
    ds_read_b64_tr_b16 v[130:131], v216 offset:41984
    v_mfma_f32_32x32x16_bf16 v[80:95], v[176:179], v[132:135], v[80:95]
    ds_read_b64_tr_b16 v[132:133], v217 offset:40960
    ds_read_b64_tr_b16 v[134:135], v217 offset:41984
    s_waitcnt lgkmcnt(14)
    v_mfma_f32_32x32x16_bf16 v[96:111], v[176:179], v[136:139], v[96:111]
    ds_read_b64_tr_b16 v[136:137], v218 offset:40960
    ds_read_b64_tr_b16 v[138:139], v218 offset:41984
    v_mfma_f32_32x32x16_bf16 v[112:127], v[176:179], v[140:143], v[112:127]
    ds_read_b64_tr_b16 v[140:141], v219 offset:40960
    ds_read_b64_tr_b16 v[142:143], v219 offset:41984
    s_waitcnt lgkmcnt(14)
    v_mfma_f32_32x32x16_bf16 v[64:79], v[180:183], v[144:147], v[64:79]
    ds_read_b64_tr_b16 v[144:145], v216 offset:45056
    ds_read_b64_tr_b16 v[146:147], v216 offset:46080
    v_mfma_f32_32x32x16_bf16 v[80:95], v[180:183], v[148:151], v[80:95]
    ds_read_b64_tr_b16 v[148:149], v217 offset:45056
    ds_read_b64_tr_b16 v[150:151], v217 offset:46080
    s_waitcnt lgkmcnt(14)
    v_mfma_f32_32x32x16_bf16 v[96:111], v[180:183], v[152:155], v[96:111]
    ds_read_b64_tr_b16 v[152:153], v218 offset:45056
    ds_read_b64_tr_b16 v[154:155], v218 offset:46080
    v_mfma_f32_32x32x16_bf16 v[112:127], v[180:183], v[156:159], v[112:127]
    ds_read_b64_tr_b16 v[156:157], v219 offset:45056
    ds_read_b64_tr_b16 v[158:159], v219 offset:46080
    s_cmp_eq_u32 s17, 2
    s_cbranch_scc0 interleave_layers__softmax_full_mha__sliding_local_dilated__prompt_kernel_f_xv2
    s_add_u32 s32, s24, 2048
    buffer_store_dwordx4 v[176:179], v8, s[12:15], s32 offen offset:0 sc1
    buffer_store_dwordx4 v[180:183], v8, s[12:15], s32 offen offset:512 sc1
interleave_layers__softmax_full_mha__sliding_local_dilated__prompt_kernel_f_xv2:
    s_waitcnt lgkmcnt(12)
    v_mfma_f32_32x32x16_bf16 v[64:79], v[184:187], v[128:131], v[64:79]
    s_barrier
    ds_read_b128 v[160:163], v228 offset:0
    ds_read_b128 v[164:167], v229 offset:0
    ds_read_b64_tr_b16 v[128:129], v220 offset:0
    ds_read_b64_tr_b16 v[130:131], v220 offset:1024
    v_mfma_f32_32x32x16_bf16 v[80:95], v[184:187], v[132:135], v[80:95]
    ds_read_b64_tr_b16 v[132:133], v221 offset:0
    ds_read_b64_tr_b16 v[134:135], v221 offset:1024
    s_waitcnt lgkmcnt(14)
    v_mfma_f32_32x32x16_bf16 v[96:111], v[184:187], v[136:139], v[96:111]
    ds_read_b64_tr_b16 v[136:137], v222 offset:0
    ds_read_b64_tr_b16 v[138:139], v222 offset:1024
    v_mfma_f32_32x32x16_bf16 v[112:127], v[184:187], v[140:143], v[112:127]
    ds_read_b64_tr_b16 v[140:141], v223 offset:0
    ds_read_b64_tr_b16 v[142:143], v223 offset:1024
    s_waitcnt lgkmcnt(14)
    v_mfma_f32_32x32x16_bf16 v[64:79], v[188:191], v[144:147], v[64:79]
    ds_read_b64_tr_b16 v[144:145], v220 offset:4096
    ds_read_b64_tr_b16 v[146:147], v220 offset:5120
    v_mfma_f32_32x32x16_bf16 v[80:95], v[188:191], v[148:151], v[80:95]
    ds_read_b64_tr_b16 v[148:149], v221 offset:4096
    ds_read_b64_tr_b16 v[150:151], v221 offset:5120
    s_waitcnt lgkmcnt(14)
    v_mfma_f32_32x32x16_bf16 v[96:111], v[188:191], v[152:155], v[96:111]
    ds_read_b64_tr_b16 v[152:153], v222 offset:4096
    ds_read_b64_tr_b16 v[154:155], v222 offset:5120
    v_mfma_f32_32x32x16_bf16 v[112:127], v[188:191], v[156:159], v[112:127]
    ds_read_b64_tr_b16 v[156:157], v223 offset:4096
    ds_read_b64_tr_b16 v[158:159], v223 offset:5120
    s_cmp_eq_u32 s17, 3
    s_cbranch_scc0 interleave_layers__softmax_full_mha__sliding_local_dilated__prompt_kernel_f_xv3
    s_add_u32 s32, s24, 3072
    buffer_store_dwordx4 v[184:187], v8, s[12:15], s32 offen offset:0 sc1
    buffer_store_dwordx4 v[188:191], v8, s[12:15], s32 offen offset:512 sc1
interleave_layers__softmax_full_mha__sliding_local_dilated__prompt_kernel_f_xv3:
    s_waitcnt lgkmcnt(12)
    v_mfma_f32_32x32x16_bf16 v[64:79], v[160:163], v[128:131], v[64:79]
    ds_read_b128 v[168:171], v230 offset:0
    ds_read_b128 v[172:175], v231 offset:0
    ds_read_b64_tr_b16 v[128:129], v220 offset:8192
    ds_read_b64_tr_b16 v[130:131], v220 offset:9216
    s_sub_u32 s35, s17, 10
    v_mfma_f32_32x32x16_bf16 v[80:95], v[160:163], v[132:135], v[80:95]
    ds_read_b64_tr_b16 v[132:133], v221 offset:8192
    ds_read_b64_tr_b16 v[134:135], v221 offset:9216
    s_lshl_b32 s35, s35, 7
    s_waitcnt lgkmcnt(14)
    v_mfma_f32_32x32x16_bf16 v[96:111], v[160:163], v[136:139], v[96:111]
    ds_read_b64_tr_b16 v[136:137], v222 offset:8192
    ds_read_b64_tr_b16 v[138:139], v222 offset:9216
    s_and_b32 s36, s19, 31
    v_mfma_f32_32x32x16_bf16 v[112:127], v[160:163], v[140:143], v[112:127]
    ds_read_b64_tr_b16 v[140:141], v223 offset:8192
    ds_read_b64_tr_b16 v[142:143], v223 offset:9216
    s_lshl_b32 s36, s36, 1
    s_waitcnt lgkmcnt(14)
    v_mfma_f32_32x32x16_bf16 v[64:79], v[164:167], v[144:147], v[64:79]
    ds_read_b64_tr_b16 v[144:145], v220 offset:12288
    ds_read_b64_tr_b16 v[146:147], v220 offset:13312
    s_lshr_b32 s34, s19, 5
    v_mfma_f32_32x32x16_bf16 v[80:95], v[164:167], v[148:151], v[80:95]
    ds_read_b64_tr_b16 v[148:149], v221 offset:12288
    ds_read_b64_tr_b16 v[150:151], v221 offset:13312
    s_add_u32 s36, s36, s34
    s_waitcnt lgkmcnt(14)
    v_mfma_f32_32x32x16_bf16 v[96:111], v[164:167], v[152:155], v[96:111]
    ds_read_b64_tr_b16 v[152:153], v222 offset:12288
    ds_read_b64_tr_b16 v[154:155], v222 offset:13312
    s_add_u32 s36, s36, 44
    v_mfma_f32_32x32x16_bf16 v[112:127], v[164:167], v[156:159], v[112:127]
    ds_read_b64_tr_b16 v[156:157], v223 offset:12288
    ds_read_b64_tr_b16 v[158:159], v223 offset:13312
    s_and_b32 s36, s36, 63
    s_cmp_eq_u32 s17, 4
    s_cbranch_scc0 interleave_layers__softmax_full_mha__sliding_local_dilated__prompt_kernel_f_xv4
    s_add_u32 s32, s24, 4096
    buffer_store_dwordx4 v[160:163], v8, s[12:15], s32 offen offset:0 sc1
    buffer_store_dwordx4 v[164:167], v8, s[12:15], s32 offen offset:512 sc1
interleave_layers__softmax_full_mha__sliding_local_dilated__prompt_kernel_f_xv4:
    s_waitcnt lgkmcnt(12)
    v_mfma_f32_32x32x16_bf16 v[64:79], v[168:171], v[128:131], v[64:79]
    s_barrier
    ds_read_b128 v[176:179], v228 offset:32768
    ds_read_b128 v[180:183], v229 offset:32768
    ds_read_b64_tr_b16 v[128:129], v220 offset:32768
    ds_read_b64_tr_b16 v[130:131], v220 offset:33792
    s_mul_i32 s36, s36, 2560
    v_mfma_f32_32x32x16_bf16 v[80:95], v[168:171], v[132:135], v[80:95]
    ds_read_b64_tr_b16 v[132:133], v221 offset:32768
    ds_read_b64_tr_b16 v[134:135], v221 offset:33792
    s_add_u32 s33, s36, 5506304
    s_waitcnt lgkmcnt(14)
    v_mfma_f32_32x32x16_bf16 v[96:111], v[168:171], v[136:139], v[96:111]
    ds_read_b64_tr_b16 v[136:137], v222 offset:32768
    ds_read_b64_tr_b16 v[138:139], v222 offset:33792
    v_mul_u32_u24 v20, 320, v4
    v_mfma_f32_32x32x16_bf16 v[112:127], v[168:171], v[140:143], v[112:127]
    ds_read_b64_tr_b16 v[140:141], v223 offset:32768
    ds_read_b64_tr_b16 v[142:143], v223 offset:33792
    v_add_u32 v16, s35, v10
    s_waitcnt lgkmcnt(14)
    v_mfma_f32_32x32x16_bf16 v[64:79], v[172:175], v[144:147], v[64:79]
    ds_read_b64_tr_b16 v[144:145], v220 offset:36864
    ds_read_b64_tr_b16 v[146:147], v220 offset:37888
    v_mul_u32_u24 v17, 52429, v16
    v_mfma_f32_32x32x16_bf16 v[80:95], v[172:175], v[148:151], v[80:95]
    ds_read_b64_tr_b16 v[148:149], v221 offset:36864
    ds_read_b64_tr_b16 v[150:151], v221 offset:37888
    v_lshrrev_b32 v17, 20, v17
    s_waitcnt lgkmcnt(14)
    v_mfma_f32_32x32x16_bf16 v[96:111], v[172:175], v[152:155], v[96:111]
    ds_read_b64_tr_b16 v[152:153], v222 offset:36864
    ds_read_b64_tr_b16 v[154:155], v222 offset:37888
    v_mul_u32_u24 v18, 20, v17
    v_mfma_f32_32x32x16_bf16 v[112:127], v[172:175], v[156:159], v[112:127]
    ds_read_b64_tr_b16 v[156:157], v223 offset:36864
    ds_read_b64_tr_b16 v[158:159], v223 offset:37888
    v_sub_u32 v18, v16, v18
    s_cmp_eq_u32 s17, 5
    s_cbranch_scc0 interleave_layers__softmax_full_mha__sliding_local_dilated__prompt_kernel_f_xv5
    s_add_u32 s32, s24, 5120
    buffer_store_dwordx4 v[168:171], v8, s[12:15], s32 offen offset:0 sc1
    buffer_store_dwordx4 v[172:175], v8, s[12:15], s32 offen offset:512 sc1
interleave_layers__softmax_full_mha__sliding_local_dilated__prompt_kernel_f_xv5:
    s_waitcnt lgkmcnt(12)
    v_mfma_f32_32x32x16_bf16 v[64:79], v[176:179], v[128:131], v[64:79]
    ds_read_b128 v[184:187], v230 offset:32768
    ds_read_b128 v[188:191], v231 offset:32768
    ds_read_b64_tr_b16 v[128:129], v220 offset:40960
    ds_read_b64_tr_b16 v[130:131], v220 offset:41984
    v_mul_u32_u24 v17, 163840, v17
    v_mfma_f32_32x32x16_bf16 v[80:95], v[176:179], v[132:135], v[80:95]
    ds_read_b64_tr_b16 v[132:133], v221 offset:40960
    ds_read_b64_tr_b16 v[134:135], v221 offset:41984
    v_lshl_add_u32 v17, v18, 4, v17
    s_waitcnt lgkmcnt(14)
    v_mfma_f32_32x32x16_bf16 v[96:111], v[176:179], v[136:139], v[96:111]
    ds_read_b64_tr_b16 v[136:137], v222 offset:40960
    ds_read_b64_tr_b16 v[138:139], v222 offset:41984
    v_add_u32 v24, v17, v20
    v_mfma_f32_32x32x16_bf16 v[112:127], v[176:179], v[140:143], v[112:127]
    ds_read_b64_tr_b16 v[140:141], v223 offset:40960
    ds_read_b64_tr_b16 v[142:143], v223 offset:41984
    v_add_u32 v16, s35, v10
    s_waitcnt lgkmcnt(14)
    v_mfma_f32_32x32x16_bf16 v[64:79], v[180:183], v[144:147], v[64:79]
    ds_read_b64_tr_b16 v[144:145], v220 offset:45056
    ds_read_b64_tr_b16 v[146:147], v220 offset:46080
    v_add_u32 v16, 32, v16
    v_mfma_f32_32x32x16_bf16 v[80:95], v[180:183], v[148:151], v[80:95]
    ds_read_b64_tr_b16 v[148:149], v221 offset:45056
    ds_read_b64_tr_b16 v[150:151], v221 offset:46080
    v_mul_u32_u24 v17, 52429, v16
    s_waitcnt lgkmcnt(14)
    v_mfma_f32_32x32x16_bf16 v[96:111], v[180:183], v[152:155], v[96:111]
    ds_read_b64_tr_b16 v[152:153], v222 offset:45056
    ds_read_b64_tr_b16 v[154:155], v222 offset:46080
    v_lshrrev_b32 v17, 20, v17
    v_mfma_f32_32x32x16_bf16 v[112:127], v[180:183], v[156:159], v[112:127]
    ds_read_b64_tr_b16 v[156:157], v223 offset:45056
    ds_read_b64_tr_b16 v[158:159], v223 offset:46080
    v_mul_u32_u24 v18, 20, v17
    s_cmp_eq_u32 s17, 6
    s_cbranch_scc0 interleave_layers__softmax_full_mha__sliding_local_dilated__prompt_kernel_f_xv6
    s_add_u32 s32, s24, 6144
    buffer_store_dwordx4 v[176:179], v8, s[12:15], s32 offen offset:0 sc1
    buffer_store_dwordx4 v[180:183], v8, s[12:15], s32 offen offset:512 sc1
interleave_layers__softmax_full_mha__sliding_local_dilated__prompt_kernel_f_xv6:
    s_waitcnt lgkmcnt(12)
    v_mfma_f32_32x32x16_bf16 v[64:79], v[184:187], v[128:131], v[64:79]
    s_barrier
    ds_read_b128 v[160:163], v224 offset:0
    ds_read_b128 v[164:167], v225 offset:0
    ds_read_b64_tr_b16 v[128:129], v216 offset:0
    ds_read_b64_tr_b16 v[130:131], v216 offset:1024
    v_sub_u32 v18, v16, v18
    v_mfma_f32_32x32x16_bf16 v[80:95], v[184:187], v[132:135], v[80:95]
    ds_read_b64_tr_b16 v[132:133], v217 offset:0
    ds_read_b64_tr_b16 v[134:135], v217 offset:1024
    v_mul_u32_u24 v17, 163840, v17
    s_waitcnt lgkmcnt(14)
    v_mfma_f32_32x32x16_bf16 v[96:111], v[184:187], v[136:139], v[96:111]
    ds_read_b64_tr_b16 v[136:137], v218 offset:0
    ds_read_b64_tr_b16 v[138:139], v218 offset:1024
    v_lshl_add_u32 v17, v18, 4, v17
    v_mfma_f32_32x32x16_bf16 v[112:127], v[184:187], v[140:143], v[112:127]
    ds_read_b64_tr_b16 v[140:141], v219 offset:0
    ds_read_b64_tr_b16 v[142:143], v219 offset:1024
    v_add_u32 v25, v17, v20
    s_waitcnt lgkmcnt(14)
    v_mfma_f32_32x32x16_bf16 v[64:79], v[188:191], v[144:147], v[64:79]
    ds_read_b64_tr_b16 v[144:145], v216 offset:4096
    ds_read_b64_tr_b16 v[146:147], v216 offset:5120
    v_add_u32 v16, s35, v10
    v_mfma_f32_32x32x16_bf16 v[80:95], v[188:191], v[148:151], v[80:95]
    ds_read_b64_tr_b16 v[148:149], v217 offset:4096
    ds_read_b64_tr_b16 v[150:151], v217 offset:5120
    v_add_u32 v16, 64, v16
    s_waitcnt lgkmcnt(14)
    v_mfma_f32_32x32x16_bf16 v[96:111], v[188:191], v[152:155], v[96:111]
    ds_read_b64_tr_b16 v[152:153], v218 offset:4096
    ds_read_b64_tr_b16 v[154:155], v218 offset:5120
    v_mul_u32_u24 v17, 52429, v16
    v_mfma_f32_32x32x16_bf16 v[112:127], v[188:191], v[156:159], v[112:127]
    ds_read_b64_tr_b16 v[156:157], v219 offset:4096
    ds_read_b64_tr_b16 v[158:159], v219 offset:5120
    v_lshrrev_b32 v17, 20, v17
    s_cmp_eq_u32 s17, 7
    s_cbranch_scc0 interleave_layers__softmax_full_mha__sliding_local_dilated__prompt_kernel_f_xv7
    s_add_u32 s32, s24, 7168
    buffer_store_dwordx4 v[184:187], v8, s[12:15], s32 offen offset:0 sc1
    buffer_store_dwordx4 v[188:191], v8, s[12:15], s32 offen offset:512 sc1
interleave_layers__softmax_full_mha__sliding_local_dilated__prompt_kernel_f_xv7:
    s_waitcnt lgkmcnt(12)
    v_mfma_f32_32x32x16_bf16 v[64:79], v[160:163], v[128:131], v[64:79]
    ds_read_b128 v[168:171], v226 offset:0
    ds_read_b128 v[172:175], v227 offset:0
    ds_read_b64_tr_b16 v[128:129], v216 offset:8192
    ds_read_b64_tr_b16 v[130:131], v216 offset:9216
    v_mul_u32_u24 v18, 20, v17
    v_mfma_f32_32x32x16_bf16 v[80:95], v[160:163], v[132:135], v[80:95]
    ds_read_b64_tr_b16 v[132:133], v217 offset:8192
    ds_read_b64_tr_b16 v[134:135], v217 offset:9216
    v_sub_u32 v18, v16, v18
    s_waitcnt lgkmcnt(14)
    v_mfma_f32_32x32x16_bf16 v[96:111], v[160:163], v[136:139], v[96:111]
    ds_read_b64_tr_b16 v[136:137], v218 offset:8192
    ds_read_b64_tr_b16 v[138:139], v218 offset:9216
    v_mul_u32_u24 v17, 163840, v17
    v_mfma_f32_32x32x16_bf16 v[112:127], v[160:163], v[140:143], v[112:127]
    ds_read_b64_tr_b16 v[140:141], v219 offset:8192
    ds_read_b64_tr_b16 v[142:143], v219 offset:9216
    v_lshl_add_u32 v17, v18, 4, v17
    s_waitcnt lgkmcnt(14)
    v_mfma_f32_32x32x16_bf16 v[64:79], v[164:167], v[144:147], v[64:79]
    ds_read_b64_tr_b16 v[144:145], v216 offset:12288
    ds_read_b64_tr_b16 v[146:147], v216 offset:13312
    v_add_u32 v26, v17, v20
    v_mfma_f32_32x32x16_bf16 v[80:95], v[164:167], v[148:151], v[80:95]
    ds_read_b64_tr_b16 v[148:149], v217 offset:12288
    ds_read_b64_tr_b16 v[150:151], v217 offset:13312
    v_add_u32 v16, s35, v10
    s_waitcnt lgkmcnt(14)
    v_mfma_f32_32x32x16_bf16 v[96:111], v[164:167], v[152:155], v[96:111]
    ds_read_b64_tr_b16 v[152:153], v218 offset:12288
    ds_read_b64_tr_b16 v[154:155], v218 offset:13312
    v_add_u32 v16, 96, v16
    v_mfma_f32_32x32x16_bf16 v[112:127], v[164:167], v[156:159], v[112:127]
    ds_read_b64_tr_b16 v[156:157], v219 offset:12288
    ds_read_b64_tr_b16 v[158:159], v219 offset:13312
    v_mul_u32_u24 v17, 52429, v16
    s_cmp_eq_u32 s17, 8
    s_cbranch_scc0 interleave_layers__softmax_full_mha__sliding_local_dilated__prompt_kernel_f_xv8
    s_add_u32 s32, s24, 8192
    buffer_store_dwordx4 v[160:163], v8, s[12:15], s32 offen offset:0 sc1
    buffer_store_dwordx4 v[164:167], v8, s[12:15], s32 offen offset:512 sc1
interleave_layers__softmax_full_mha__sliding_local_dilated__prompt_kernel_f_xv8:
    s_waitcnt lgkmcnt(12)
    v_mfma_f32_32x32x16_bf16 v[64:79], v[168:171], v[128:131], v[64:79]
    s_barrier
    ds_read_b128 v[176:179], v224 offset:32768
    ds_read_b128 v[180:183], v225 offset:32768
    ds_read_b64_tr_b16 v[128:129], v216 offset:32768
    ds_read_b64_tr_b16 v[130:131], v216 offset:33792
    v_lshrrev_b32 v17, 20, v17
    v_mfma_f32_32x32x16_bf16 v[80:95], v[168:171], v[132:135], v[80:95]
    ds_read_b64_tr_b16 v[132:133], v217 offset:32768
    ds_read_b64_tr_b16 v[134:135], v217 offset:33792
    v_mul_u32_u24 v18, 20, v17
    s_waitcnt lgkmcnt(14)
    v_mfma_f32_32x32x16_bf16 v[96:111], v[168:171], v[136:139], v[96:111]
    ds_read_b64_tr_b16 v[136:137], v218 offset:32768
    ds_read_b64_tr_b16 v[138:139], v218 offset:33792
    v_sub_u32 v18, v16, v18
    v_mfma_f32_32x32x16_bf16 v[112:127], v[168:171], v[140:143], v[112:127]
    ds_read_b64_tr_b16 v[140:141], v219 offset:32768
    ds_read_b64_tr_b16 v[142:143], v219 offset:33792
    v_mul_u32_u24 v17, 163840, v17
    s_waitcnt lgkmcnt(14)
    v_mfma_f32_32x32x16_bf16 v[64:79], v[172:175], v[144:147], v[64:79]
    ds_read_b64_tr_b16 v[144:145], v216 offset:36864
    ds_read_b64_tr_b16 v[146:147], v216 offset:37888
    v_lshl_add_u32 v17, v18, 4, v17
    v_mfma_f32_32x32x16_bf16 v[80:95], v[172:175], v[148:151], v[80:95]
    ds_read_b64_tr_b16 v[148:149], v217 offset:36864
    ds_read_b64_tr_b16 v[150:151], v217 offset:37888
    v_add_u32 v27, v17, v20
    s_waitcnt lgkmcnt(14)
    v_mfma_f32_32x32x16_bf16 v[96:111], v[172:175], v[152:155], v[96:111]
    ds_read_b64_tr_b16 v[152:153], v218 offset:36864
    ds_read_b64_tr_b16 v[154:155], v218 offset:37888
    v_mfma_f32_32x32x16_bf16 v[112:127], v[172:175], v[156:159], v[112:127]
    ds_read_b64_tr_b16 v[156:157], v219 offset:36864
    ds_read_b64_tr_b16 v[158:159], v219 offset:37888
    s_cmp_eq_u32 s17, 9
    s_cbranch_scc0 interleave_layers__softmax_full_mha__sliding_local_dilated__prompt_kernel_f_xv9
    s_add_u32 s32, s24, 9216
    buffer_store_dwordx4 v[168:171], v8, s[12:15], s32 offen offset:0 sc1
    buffer_store_dwordx4 v[172:175], v8, s[12:15], s32 offen offset:512 sc1
interleave_layers__softmax_full_mha__sliding_local_dilated__prompt_kernel_f_xv9:
    s_waitcnt lgkmcnt(12)
    v_mfma_f32_32x32x16_bf16 v[64:79], v[176:179], v[128:131], v[64:79]
    ds_read_b128 v[184:187], v226 offset:32768
    ds_read_b128 v[188:191], v227 offset:32768
    ds_read_b64_tr_b16 v[128:129], v216 offset:40960
    ds_read_b64_tr_b16 v[130:131], v216 offset:41984
    v_mfma_f32_32x32x16_bf16 v[80:95], v[176:179], v[132:135], v[80:95]
    ds_read_b64_tr_b16 v[132:133], v217 offset:40960
    ds_read_b64_tr_b16 v[134:135], v217 offset:41984
    s_waitcnt lgkmcnt(14)
    v_mfma_f32_32x32x16_bf16 v[96:111], v[176:179], v[136:139], v[96:111]
    ds_read_b64_tr_b16 v[136:137], v218 offset:40960
    ds_read_b64_tr_b16 v[138:139], v218 offset:41984
    v_mfma_f32_32x32x16_bf16 v[112:127], v[176:179], v[140:143], v[112:127]
    ds_read_b64_tr_b16 v[140:141], v219 offset:40960
    ds_read_b64_tr_b16 v[142:143], v219 offset:41984
    s_waitcnt lgkmcnt(14)
    v_mfma_f32_32x32x16_bf16 v[64:79], v[180:183], v[144:147], v[64:79]
    ds_read_b64_tr_b16 v[144:145], v216 offset:45056
    ds_read_b64_tr_b16 v[146:147], v216 offset:46080
    v_mfma_f32_32x32x16_bf16 v[80:95], v[180:183], v[148:151], v[80:95]
    ds_read_b64_tr_b16 v[148:149], v217 offset:45056
    ds_read_b64_tr_b16 v[150:151], v217 offset:46080
    s_waitcnt lgkmcnt(14)
    v_mfma_f32_32x32x16_bf16 v[96:111], v[180:183], v[152:155], v[96:111]
    ds_read_b64_tr_b16 v[152:153], v218 offset:45056
    ds_read_b64_tr_b16 v[154:155], v218 offset:46080
    v_mfma_f32_32x32x16_bf16 v[112:127], v[180:183], v[156:159], v[112:127]
    ds_read_b64_tr_b16 v[156:157], v219 offset:45056
    ds_read_b64_tr_b16 v[158:159], v219 offset:46080
    s_cmp_eq_u32 s17, 10
    s_cbranch_scc0 interleave_layers__softmax_full_mha__sliding_local_dilated__prompt_kernel_f_xv10
    s_add_u32 s32, s24, 10240
    buffer_store_dwordx4 v[176:179], v8, s[12:15], s32 offen offset:0 sc1
    buffer_store_dwordx4 v[180:183], v8, s[12:15], s32 offen offset:512 sc1
interleave_layers__softmax_full_mha__sliding_local_dilated__prompt_kernel_f_xv10:
    s_waitcnt lgkmcnt(12)
    v_mfma_f32_32x32x16_bf16 v[64:79], v[184:187], v[128:131], v[64:79]
    s_barrier
    ds_read_b128 v[160:163], v228 offset:0
    ds_read_b128 v[164:167], v229 offset:0
    ds_read_b64_tr_b16 v[128:129], v220 offset:0
    ds_read_b64_tr_b16 v[130:131], v220 offset:1024
    v_mfma_f32_32x32x16_bf16 v[80:95], v[184:187], v[132:135], v[80:95]
    ds_read_b64_tr_b16 v[132:133], v221 offset:0
    ds_read_b64_tr_b16 v[134:135], v221 offset:1024
    s_waitcnt lgkmcnt(14)
    v_mfma_f32_32x32x16_bf16 v[96:111], v[184:187], v[136:139], v[96:111]
    ds_read_b64_tr_b16 v[136:137], v222 offset:0
    ds_read_b64_tr_b16 v[138:139], v222 offset:1024
    v_mfma_f32_32x32x16_bf16 v[112:127], v[184:187], v[140:143], v[112:127]
    ds_read_b64_tr_b16 v[140:141], v223 offset:0
    ds_read_b64_tr_b16 v[142:143], v223 offset:1024
    s_waitcnt lgkmcnt(14)
    v_mfma_f32_32x32x16_bf16 v[64:79], v[188:191], v[144:147], v[64:79]
    ds_read_b64_tr_b16 v[144:145], v220 offset:4096
    ds_read_b64_tr_b16 v[146:147], v220 offset:5120
    v_mfma_f32_32x32x16_bf16 v[80:95], v[188:191], v[148:151], v[80:95]
    ds_read_b64_tr_b16 v[148:149], v221 offset:4096
    ds_read_b64_tr_b16 v[150:151], v221 offset:5120
    s_waitcnt lgkmcnt(14)
    v_mfma_f32_32x32x16_bf16 v[96:111], v[188:191], v[152:155], v[96:111]
    ds_read_b64_tr_b16 v[152:153], v222 offset:4096
    ds_read_b64_tr_b16 v[154:155], v222 offset:5120
    v_mfma_f32_32x32x16_bf16 v[112:127], v[188:191], v[156:159], v[112:127]
    ds_read_b64_tr_b16 v[156:157], v223 offset:4096
    ds_read_b64_tr_b16 v[158:159], v223 offset:5120
    s_cmp_eq_u32 s17, 11
    s_cbranch_scc0 interleave_layers__softmax_full_mha__sliding_local_dilated__prompt_kernel_f_xv11
    s_add_u32 s32, s24, 11264
    buffer_store_dwordx4 v[184:187], v8, s[12:15], s32 offen offset:0 sc1
    buffer_store_dwordx4 v[188:191], v8, s[12:15], s32 offen offset:512 sc1
interleave_layers__softmax_full_mha__sliding_local_dilated__prompt_kernel_f_xv11:
    s_waitcnt lgkmcnt(12)
    v_mfma_f32_32x32x16_bf16 v[64:79], v[160:163], v[128:131], v[64:79]
    ds_read_b128 v[168:171], v230 offset:0
    ds_read_b128 v[172:175], v231 offset:0
    ds_read_b64_tr_b16 v[128:129], v220 offset:8192
    ds_read_b64_tr_b16 v[130:131], v220 offset:9216
    v_mfma_f32_32x32x16_bf16 v[80:95], v[160:163], v[132:135], v[80:95]
    ds_read_b64_tr_b16 v[132:133], v221 offset:8192
    ds_read_b64_tr_b16 v[134:135], v221 offset:9216
    s_waitcnt lgkmcnt(14)
    v_mfma_f32_32x32x16_bf16 v[96:111], v[160:163], v[136:139], v[96:111]
    ds_read_b64_tr_b16 v[136:137], v222 offset:8192
    ds_read_b64_tr_b16 v[138:139], v222 offset:9216
    v_mfma_f32_32x32x16_bf16 v[112:127], v[160:163], v[140:143], v[112:127]
    ds_read_b64_tr_b16 v[140:141], v223 offset:8192
    ds_read_b64_tr_b16 v[142:143], v223 offset:9216
    s_waitcnt lgkmcnt(14)
    v_mfma_f32_32x32x16_bf16 v[64:79], v[164:167], v[144:147], v[64:79]
    ds_read_b64_tr_b16 v[144:145], v220 offset:12288
    ds_read_b64_tr_b16 v[146:147], v220 offset:13312
    v_mfma_f32_32x32x16_bf16 v[80:95], v[164:167], v[148:151], v[80:95]
    ds_read_b64_tr_b16 v[148:149], v221 offset:12288
    ds_read_b64_tr_b16 v[150:151], v221 offset:13312
    s_waitcnt lgkmcnt(14)
    v_mfma_f32_32x32x16_bf16 v[96:111], v[164:167], v[152:155], v[96:111]
    ds_read_b64_tr_b16 v[152:153], v222 offset:12288
    ds_read_b64_tr_b16 v[154:155], v222 offset:13312
    v_mfma_f32_32x32x16_bf16 v[112:127], v[164:167], v[156:159], v[112:127]
    ds_read_b64_tr_b16 v[156:157], v223 offset:12288
    ds_read_b64_tr_b16 v[158:159], v223 offset:13312
    s_cmp_eq_u32 s17, 12
    s_cbranch_scc0 interleave_layers__softmax_full_mha__sliding_local_dilated__prompt_kernel_f_xv12
    s_add_u32 s32, s24, 12288
    buffer_store_dwordx4 v[160:163], v8, s[12:15], s32 offen offset:0 sc1
    buffer_store_dwordx4 v[164:167], v8, s[12:15], s32 offen offset:512 sc1
interleave_layers__softmax_full_mha__sliding_local_dilated__prompt_kernel_f_xv12:
    s_waitcnt lgkmcnt(12)
    v_mfma_f32_32x32x16_bf16 v[64:79], v[168:171], v[128:131], v[64:79]
    s_barrier
    ds_read_b128 v[176:179], v228 offset:32768
    ds_read_b128 v[180:183], v229 offset:32768
    ds_read_b64_tr_b16 v[128:129], v220 offset:32768
    ds_read_b64_tr_b16 v[130:131], v220 offset:33792
    v_mfma_f32_32x32x16_bf16 v[80:95], v[168:171], v[132:135], v[80:95]
    ds_read_b64_tr_b16 v[132:133], v221 offset:32768
    ds_read_b64_tr_b16 v[134:135], v221 offset:33792
    s_waitcnt lgkmcnt(14)
    v_mfma_f32_32x32x16_bf16 v[96:111], v[168:171], v[136:139], v[96:111]
    ds_read_b64_tr_b16 v[136:137], v222 offset:32768
    ds_read_b64_tr_b16 v[138:139], v222 offset:33792
    v_mfma_f32_32x32x16_bf16 v[112:127], v[168:171], v[140:143], v[112:127]
    ds_read_b64_tr_b16 v[140:141], v223 offset:32768
    ds_read_b64_tr_b16 v[142:143], v223 offset:33792
    s_waitcnt lgkmcnt(14)
    v_mfma_f32_32x32x16_bf16 v[64:79], v[172:175], v[144:147], v[64:79]
    ds_read_b64_tr_b16 v[144:145], v220 offset:36864
    ds_read_b64_tr_b16 v[146:147], v220 offset:37888
    v_mfma_f32_32x32x16_bf16 v[80:95], v[172:175], v[148:151], v[80:95]
    ds_read_b64_tr_b16 v[148:149], v221 offset:36864
    ds_read_b64_tr_b16 v[150:151], v221 offset:37888
    s_waitcnt lgkmcnt(14)
    v_mfma_f32_32x32x16_bf16 v[96:111], v[172:175], v[152:155], v[96:111]
    ds_read_b64_tr_b16 v[152:153], v222 offset:36864
    ds_read_b64_tr_b16 v[154:155], v222 offset:37888
    v_mfma_f32_32x32x16_bf16 v[112:127], v[172:175], v[156:159], v[112:127]
    ds_read_b64_tr_b16 v[156:157], v223 offset:36864
    ds_read_b64_tr_b16 v[158:159], v223 offset:37888
    s_cmp_eq_u32 s17, 13
    s_cbranch_scc0 interleave_layers__softmax_full_mha__sliding_local_dilated__prompt_kernel_f_xv13
    s_add_u32 s32, s24, 13312
    buffer_store_dwordx4 v[168:171], v8, s[12:15], s32 offen offset:0 sc1
    buffer_store_dwordx4 v[172:175], v8, s[12:15], s32 offen offset:512 sc1
interleave_layers__softmax_full_mha__sliding_local_dilated__prompt_kernel_f_xv13:
    s_waitcnt lgkmcnt(12)
    v_mfma_f32_32x32x16_bf16 v[64:79], v[176:179], v[128:131], v[64:79]
    ds_read_b128 v[184:187], v230 offset:32768
    ds_read_b128 v[188:191], v231 offset:32768
    ds_read_b64_tr_b16 v[128:129], v220 offset:40960
    ds_read_b64_tr_b16 v[130:131], v220 offset:41984
    v_mfma_f32_32x32x16_bf16 v[80:95], v[176:179], v[132:135], v[80:95]
    ds_read_b64_tr_b16 v[132:133], v221 offset:40960
    ds_read_b64_tr_b16 v[134:135], v221 offset:41984
    s_waitcnt lgkmcnt(14)
    v_mfma_f32_32x32x16_bf16 v[96:111], v[176:179], v[136:139], v[96:111]
    ds_read_b64_tr_b16 v[136:137], v222 offset:40960
    ds_read_b64_tr_b16 v[138:139], v222 offset:41984
    v_mfma_f32_32x32x16_bf16 v[112:127], v[176:179], v[140:143], v[112:127]
    ds_read_b64_tr_b16 v[140:141], v223 offset:40960
    ds_read_b64_tr_b16 v[142:143], v223 offset:41984
    s_waitcnt lgkmcnt(14)
    v_mfma_f32_32x32x16_bf16 v[64:79], v[180:183], v[144:147], v[64:79]
    ds_read_b64_tr_b16 v[144:145], v220 offset:45056
    ds_read_b64_tr_b16 v[146:147], v220 offset:46080
    v_mfma_f32_32x32x16_bf16 v[80:95], v[180:183], v[148:151], v[80:95]
    ds_read_b64_tr_b16 v[148:149], v221 offset:45056
    ds_read_b64_tr_b16 v[150:151], v221 offset:46080
    s_waitcnt lgkmcnt(14)
    v_mfma_f32_32x32x16_bf16 v[96:111], v[180:183], v[152:155], v[96:111]
    ds_read_b64_tr_b16 v[152:153], v222 offset:45056
    ds_read_b64_tr_b16 v[154:155], v222 offset:46080
    v_mfma_f32_32x32x16_bf16 v[112:127], v[180:183], v[156:159], v[112:127]
    ds_read_b64_tr_b16 v[156:157], v223 offset:45056
    ds_read_b64_tr_b16 v[158:159], v223 offset:46080
    s_cmp_eq_u32 s17, 14
    s_cbranch_scc0 interleave_layers__softmax_full_mha__sliding_local_dilated__prompt_kernel_f_xv14
    s_add_u32 s32, s24, 14336
    buffer_store_dwordx4 v[176:179], v8, s[12:15], s32 offen offset:0 sc1
    buffer_store_dwordx4 v[180:183], v8, s[12:15], s32 offen offset:512 sc1
interleave_layers__softmax_full_mha__sliding_local_dilated__prompt_kernel_f_xv14:
    s_waitcnt lgkmcnt(12)
    v_mfma_f32_32x32x16_bf16 v[64:79], v[184:187], v[128:131], v[64:79]
    s_barrier
    ds_read_b128 v[160:163], v224 offset:0
    ds_read_b128 v[164:167], v225 offset:0
    ds_read_b64_tr_b16 v[128:129], v216 offset:0
    ds_read_b64_tr_b16 v[130:131], v216 offset:1024
    v_mfma_f32_32x32x16_bf16 v[80:95], v[184:187], v[132:135], v[80:95]
    ds_read_b64_tr_b16 v[132:133], v217 offset:0
    ds_read_b64_tr_b16 v[134:135], v217 offset:1024
    s_waitcnt lgkmcnt(14)
    v_mfma_f32_32x32x16_bf16 v[96:111], v[184:187], v[136:139], v[96:111]
    ds_read_b64_tr_b16 v[136:137], v218 offset:0
    ds_read_b64_tr_b16 v[138:139], v218 offset:1024
    v_mfma_f32_32x32x16_bf16 v[112:127], v[184:187], v[140:143], v[112:127]
    ds_read_b64_tr_b16 v[140:141], v219 offset:0
    ds_read_b64_tr_b16 v[142:143], v219 offset:1024
    s_waitcnt lgkmcnt(14)
    v_mfma_f32_32x32x16_bf16 v[64:79], v[188:191], v[144:147], v[64:79]
    ds_read_b64_tr_b16 v[144:145], v216 offset:4096
    ds_read_b64_tr_b16 v[146:147], v216 offset:5120
    v_mfma_f32_32x32x16_bf16 v[80:95], v[188:191], v[148:151], v[80:95]
    ds_read_b64_tr_b16 v[148:149], v217 offset:4096
    ds_read_b64_tr_b16 v[150:151], v217 offset:5120
    s_waitcnt lgkmcnt(14)
    v_mfma_f32_32x32x16_bf16 v[96:111], v[188:191], v[152:155], v[96:111]
    ds_read_b64_tr_b16 v[152:153], v218 offset:4096
    ds_read_b64_tr_b16 v[154:155], v218 offset:5120
    v_mfma_f32_32x32x16_bf16 v[112:127], v[188:191], v[156:159], v[112:127]
    ds_read_b64_tr_b16 v[156:157], v219 offset:4096
    ds_read_b64_tr_b16 v[158:159], v219 offset:5120
    s_cmp_eq_u32 s17, 0
    s_cbranch_scc0 interleave_layers__softmax_full_mha__sliding_local_dilated__prompt_kernel_f_xv15
    s_add_u32 s32, s24, 15360
    buffer_store_dwordx4 v[184:187], v8, s[12:15], s32 offen offset:0 sc1
    buffer_store_dwordx4 v[188:191], v8, s[12:15], s32 offen offset:512 sc1
interleave_layers__softmax_full_mha__sliding_local_dilated__prompt_kernel_f_xv15:
    s_waitcnt lgkmcnt(12)
    v_mfma_f32_32x32x16_bf16 v[64:79], v[160:163], v[128:131], v[64:79]
    ds_read_b128 v[168:171], v226 offset:0
    ds_read_b128 v[172:175], v227 offset:0
    ds_read_b64_tr_b16 v[128:129], v216 offset:8192
    ds_read_b64_tr_b16 v[130:131], v216 offset:9216
    v_mfma_f32_32x32x16_bf16 v[80:95], v[160:163], v[132:135], v[80:95]
    ds_read_b64_tr_b16 v[132:133], v217 offset:8192
    ds_read_b64_tr_b16 v[134:135], v217 offset:9216
    s_waitcnt lgkmcnt(14)
    v_mfma_f32_32x32x16_bf16 v[96:111], v[160:163], v[136:139], v[96:111]
    ds_read_b64_tr_b16 v[136:137], v218 offset:8192
    ds_read_b64_tr_b16 v[138:139], v218 offset:9216
    v_mfma_f32_32x32x16_bf16 v[112:127], v[160:163], v[140:143], v[112:127]
    ds_read_b64_tr_b16 v[140:141], v219 offset:8192
    ds_read_b64_tr_b16 v[142:143], v219 offset:9216
    s_waitcnt lgkmcnt(14)
    v_mfma_f32_32x32x16_bf16 v[64:79], v[164:167], v[144:147], v[64:79]
    ds_read_b64_tr_b16 v[144:145], v216 offset:12288
    ds_read_b64_tr_b16 v[146:147], v216 offset:13312
    v_mfma_f32_32x32x16_bf16 v[80:95], v[164:167], v[148:151], v[80:95]
    ds_read_b64_tr_b16 v[148:149], v217 offset:12288
    ds_read_b64_tr_b16 v[150:151], v217 offset:13312
    s_waitcnt lgkmcnt(14)
    v_mfma_f32_32x32x16_bf16 v[96:111], v[164:167], v[152:155], v[96:111]
    ds_read_b64_tr_b16 v[152:153], v218 offset:12288
    ds_read_b64_tr_b16 v[154:155], v218 offset:13312
    v_mfma_f32_32x32x16_bf16 v[112:127], v[164:167], v[156:159], v[112:127]
    ds_read_b64_tr_b16 v[156:157], v219 offset:12288
    ds_read_b64_tr_b16 v[158:159], v219 offset:13312
    s_cmp_eq_u32 s17, 1
    s_cbranch_scc0 interleave_layers__softmax_full_mha__sliding_local_dilated__prompt_kernel_f_xv16
    s_add_u32 s32, s24, 16384
    buffer_store_dwordx4 v[160:163], v8, s[12:15], s32 offen offset:0 sc1
    buffer_store_dwordx4 v[164:167], v8, s[12:15], s32 offen offset:512 sc1
interleave_layers__softmax_full_mha__sliding_local_dilated__prompt_kernel_f_xv16:
    s_waitcnt lgkmcnt(12)
    v_mfma_f32_32x32x16_bf16 v[64:79], v[168:171], v[128:131], v[64:79]
    s_barrier
    ds_read_b128 v[176:179], v224 offset:32768
    ds_read_b128 v[180:183], v225 offset:32768
    ds_read_b64_tr_b16 v[128:129], v216 offset:32768
    ds_read_b64_tr_b16 v[130:131], v216 offset:33792
    v_mfma_f32_32x32x16_bf16 v[80:95], v[168:171], v[132:135], v[80:95]
    ds_read_b64_tr_b16 v[132:133], v216 offset:36864
    ds_read_b64_tr_b16 v[134:135], v216 offset:37888
    s_waitcnt lgkmcnt(14)
    v_mfma_f32_32x32x16_bf16 v[96:111], v[168:171], v[136:139], v[96:111]
    ds_read_b128 v[184:187], v226 offset:32768
    ds_read_b128 v[188:191], v227 offset:32768
    ds_read_b64_tr_b16 v[136:137], v216 offset:40960
    ds_read_b64_tr_b16 v[138:139], v216 offset:41984
    v_mfma_f32_32x32x16_bf16 v[112:127], v[168:171], v[140:143], v[112:127]
    ds_read_b64_tr_b16 v[140:141], v216 offset:45056
    ds_read_b64_tr_b16 v[142:143], v216 offset:46080
    s_waitcnt lgkmcnt(15)
    v_mfma_f32_32x32x16_bf16 v[64:79], v[172:175], v[144:147], v[64:79]
    ds_read_b64_tr_b16 v[144:145], v217 offset:32768
    ds_read_b64_tr_b16 v[146:147], v217 offset:33792
    v_mfma_f32_32x32x16_bf16 v[80:95], v[172:175], v[148:151], v[80:95]
    ds_read_b64_tr_b16 v[148:149], v217 offset:36864
    ds_read_b64_tr_b16 v[150:151], v217 offset:37888
    s_waitcnt lgkmcnt(15)
    v_mfma_f32_32x32x16_bf16 v[96:111], v[172:175], v[152:155], v[96:111]
    ds_read_b64_tr_b16 v[152:153], v217 offset:40960
    ds_read_b64_tr_b16 v[154:155], v217 offset:41984
    v_mfma_f32_32x32x16_bf16 v[112:127], v[172:175], v[156:159], v[112:127]
    ds_read_b64_tr_b16 v[156:157], v217 offset:45056
    ds_read_b64_tr_b16 v[158:159], v217 offset:46080
    s_cmp_eq_u32 s17, 2
    s_cbranch_scc0 interleave_layers__softmax_full_mha__sliding_local_dilated__prompt_kernel_f_xv17
    s_add_u32 s32, s24, 17408
    buffer_store_dwordx4 v[168:171], v8, s[12:15], s32 offen offset:0 sc1
    buffer_store_dwordx4 v[172:175], v8, s[12:15], s32 offen offset:512 sc1
interleave_layers__softmax_full_mha__sliding_local_dilated__prompt_kernel_f_xv17:
    v_lshlrev_b32 v23, 2, v10
    v_add_u32 v23, 65536, v23
    s_lshl_b32 s32, s18, 8
    v_add_u32 v22, s32, v23
    v_lshlrev_b32 v21, 4, v4
    s_add_u32 s32, s32, 65536
    v_add_u32 v21, s32, v21
    s_waitcnt lgkmcnt(14)
    v_mfma_f32_32x32x16_bf16 v[64:79], v[176:179], v[128:131], v[64:79]
    ds_read_b64_tr_b16 v[128:129], v218 offset:32768
    ds_read_b64_tr_b16 v[130:131], v218 offset:33792
    v_mfma_f32_32x32x16_bf16 v[64:79], v[180:183], v[132:135], v[64:79]
    ds_read_b64_tr_b16 v[132:133], v218 offset:36864
    ds_read_b64_tr_b16 v[134:135], v218 offset:37888
    s_waitcnt lgkmcnt(12)
    v_mfma_f32_32x32x16_bf16 v[64:79], v[184:187], v[136:139], v[64:79]
    ds_read_b64_tr_b16 v[136:137], v218 offset:40960
    ds_read_b64_tr_b16 v[138:139], v218 offset:41984
    v_mfma_f32_32x32x16_bf16 v[64:79], v[188:191], v[140:143], v[64:79]
    ds_read_b64_tr_b16 v[140:141], v218 offset:45056
    ds_read_b64_tr_b16 v[142:143], v218 offset:46080
    s_cmp_eq_u32 s17, 3
    s_cbranch_scc0 interleave_layers__softmax_full_mha__sliding_local_dilated__prompt_kernel_f_xv18
    s_add_u32 s32, s24, 18432
    buffer_store_dwordx4 v[176:179], v8, s[12:15], s32 offen offset:0 sc1
    buffer_store_dwordx4 v[180:183], v8, s[12:15], s32 offen offset:512 sc1
interleave_layers__softmax_full_mha__sliding_local_dilated__prompt_kernel_f_xv18:
    s_cmp_eq_u32 s17, 4
    s_cbranch_scc0 interleave_layers__softmax_full_mha__sliding_local_dilated__prompt_kernel_f_xv19
    s_add_u32 s32, s24, 19456
    buffer_store_dwordx4 v[184:187], v8, s[12:15], s32 offen offset:0 sc1
    buffer_store_dwordx4 v[188:191], v8, s[12:15], s32 offen offset:512 sc1
interleave_layers__softmax_full_mha__sliding_local_dilated__prompt_kernel_f_xv19:
    s_barrier
    ds_read_b32 v48, v22 offset:1024
    ds_read_b32 v49, v22 offset:1152
    ds_read_b32 v28, v23 offset:0
    ds_read_b32 v29, v23 offset:128
    ds_read_b32 v30, v23 offset:256
    ds_read_b32 v31, v23 offset:384
    ds_read_b32 v32, v23 offset:512
    ds_read_b32 v33, v23 offset:640
    ds_read_b32 v34, v23 offset:768
    ds_read_b32 v35, v23 offset:896
    ds_read_b128 v[200:203], v21 offset:2048
    ds_read_b128 v[204:207], v21 offset:2080
    ds_read_b128 v[208:211], v21 offset:2112
    ds_read_b128 v[212:215], v21 offset:2144
    s_waitcnt lgkmcnt(15)
    v_mfma_f32_32x32x16_bf16 v[80:95], v[176:179], v[144:147], v[80:95]
    ds_read_b64_tr_b16 v[144:145], v219 offset:32768
    ds_read_b64_tr_b16 v[146:147], v219 offset:33792
    v_mfma_f32_32x32x16_bf16 v[80:95], v[180:183], v[148:151], v[80:95]
    ds_read_b64_tr_b16 v[148:149], v219 offset:36864
    ds_read_b64_tr_b16 v[150:151], v219 offset:37888
    s_waitcnt lgkmcnt(4)
    v_and_b32 v48, v48, v58
    v_and_b32 v49, v49, v58
    s_nop 1
    v_mfma_f32_32x32x8_bf16 v[64:79], v[48:49], v[28:29], v[64:79]
    v_mfma_f32_32x32x16_bf16 v[80:95], v[184:187], v[152:155], v[80:95]
    ds_read_b64_tr_b16 v[152:153], v219 offset:40960
    ds_read_b64_tr_b16 v[154:155], v219 offset:41984
    v_mfma_f32_32x32x16_bf16 v[80:95], v[188:191], v[156:159], v[80:95]
    ds_read_b64_tr_b16 v[156:157], v219 offset:45056
    ds_read_b64_tr_b16 v[158:159], v219 offset:46080
    v_mfma_f32_32x32x8_bf16 v[80:95], v[48:49], v[30:31], v[80:95]
    s_nop 4
    v_mul_f32 v64, v64, v200
    v_mul_f32 v65, v65, v201
    v_mul_f32 v66, v66, v202
    v_mul_f32 v67, v67, v203
    v_mul_f32 v68, v68, v204
    v_mul_f32 v69, v69, v205
    v_mul_f32 v70, v70, v206
    v_mul_f32 v71, v71, v207
    v_mul_f32 v72, v72, v208
    v_mul_f32 v73, v73, v209
    v_mul_f32 v74, v74, v210
    v_mul_f32 v75, v75, v211
    v_mul_f32 v76, v76, v212
    v_mul_f32 v77, v77, v213
    v_mul_f32 v78, v78, v214
    v_mul_f32 v79, v79, v215
    v_cvt_pk_bf16_f32 v64, v64, v65
    v_cvt_pk_bf16_f32 v65, v66, v67
    v_cvt_pk_bf16_f32 v66, v68, v69
    v_cvt_pk_bf16_f32 v67, v70, v71
    v_cvt_pk_bf16_f32 v68, v72, v73
    v_cvt_pk_bf16_f32 v69, v74, v75
    v_cvt_pk_bf16_f32 v70, v76, v77
    v_cvt_pk_bf16_f32 v71, v78, v79
    buffer_store_dwordx4 v[64:67], v24, s[12:15], s33 offen offset:0 sc1
    buffer_store_dwordx4 v[68:71], v24, s[12:15], s33 offen offset:640 sc1
    v_mfma_f32_32x32x16_bf16 v[96:111], v[176:179], v[128:131], v[96:111]
    v_mfma_f32_32x32x16_bf16 v[96:111], v[180:183], v[132:135], v[96:111]
    v_mfma_f32_32x32x16_bf16 v[96:111], v[184:187], v[136:139], v[96:111]
    v_mul_f32 v80, v80, v200
    v_mul_f32 v81, v81, v201
    v_mul_f32 v82, v82, v202
    v_mul_f32 v83, v83, v203
    v_mfma_f32_32x32x16_bf16 v[96:111], v[188:191], v[140:143], v[96:111]
    v_mul_f32 v84, v84, v204
    v_mul_f32 v85, v85, v205
    v_mul_f32 v86, v86, v206
    v_mul_f32 v87, v87, v207
    v_mfma_f32_32x32x8_bf16 v[96:111], v[48:49], v[32:33], v[96:111]
    v_mul_f32 v88, v88, v208
    v_mul_f32 v89, v89, v209
    v_mul_f32 v90, v90, v210
    v_mul_f32 v91, v91, v211
    v_mul_f32 v92, v92, v212
    v_mul_f32 v93, v93, v213
    v_mul_f32 v94, v94, v214
    v_mul_f32 v95, v95, v215
    v_cvt_pk_bf16_f32 v80, v80, v81
    v_cvt_pk_bf16_f32 v81, v82, v83
    v_cvt_pk_bf16_f32 v82, v84, v85
    v_cvt_pk_bf16_f32 v83, v86, v87
    v_cvt_pk_bf16_f32 v84, v88, v89
    v_cvt_pk_bf16_f32 v85, v90, v91
    v_cvt_pk_bf16_f32 v86, v92, v93
    v_cvt_pk_bf16_f32 v87, v94, v95
    buffer_store_dwordx4 v[80:83], v25, s[12:15], s33 offen offset:0 sc1
    buffer_store_dwordx4 v[84:87], v25, s[12:15], s33 offen offset:640 sc1
    s_waitcnt lgkmcnt(4)
    v_mfma_f32_32x32x16_bf16 v[112:127], v[176:179], v[144:147], v[112:127]
    v_mfma_f32_32x32x16_bf16 v[112:127], v[180:183], v[148:151], v[112:127]
    s_waitcnt lgkmcnt(0)
    v_mfma_f32_32x32x16_bf16 v[112:127], v[184:187], v[152:155], v[112:127]
    v_mul_f32 v96, v96, v200
    v_mul_f32 v97, v97, v201
    v_mul_f32 v98, v98, v202
    v_mul_f32 v99, v99, v203
    v_mfma_f32_32x32x16_bf16 v[112:127], v[188:191], v[156:159], v[112:127]
    v_mul_f32 v100, v100, v204
    v_mul_f32 v101, v101, v205
    v_mul_f32 v102, v102, v206
    v_mul_f32 v103, v103, v207
    v_mfma_f32_32x32x8_bf16 v[112:127], v[48:49], v[34:35], v[112:127]
    v_mul_f32 v104, v104, v208
    v_mul_f32 v105, v105, v209
    v_mul_f32 v106, v106, v210
    v_mul_f32 v107, v107, v211
    v_mul_f32 v108, v108, v212
    v_mul_f32 v109, v109, v213
    v_mul_f32 v110, v110, v214
    v_mul_f32 v111, v111, v215
    v_cvt_pk_bf16_f32 v96, v96, v97
    v_cvt_pk_bf16_f32 v97, v98, v99
    v_cvt_pk_bf16_f32 v98, v100, v101
    v_cvt_pk_bf16_f32 v99, v102, v103
    v_cvt_pk_bf16_f32 v100, v104, v105
    v_cvt_pk_bf16_f32 v101, v106, v107
    v_cvt_pk_bf16_f32 v102, v108, v109
    v_cvt_pk_bf16_f32 v103, v110, v111
    buffer_store_dwordx4 v[96:99], v26, s[12:15], s33 offen offset:0 sc1
    buffer_store_dwordx4 v[100:103], v26, s[12:15], s33 offen offset:640 sc1
    v_mul_f32 v112, v112, v200
    v_mul_f32 v113, v113, v201
    v_mul_f32 v114, v114, v202
    v_mul_f32 v115, v115, v203
    v_mul_f32 v116, v116, v204
    v_mul_f32 v117, v117, v205
    v_mul_f32 v118, v118, v206
    v_mul_f32 v119, v119, v207
    v_mul_f32 v120, v120, v208
    v_mul_f32 v121, v121, v209
    v_mul_f32 v122, v122, v210
    v_mul_f32 v123, v123, v211
    v_mul_f32 v124, v124, v212
    v_mul_f32 v125, v125, v213
    v_mul_f32 v126, v126, v214
    v_mul_f32 v127, v127, v215
    v_cvt_pk_bf16_f32 v112, v112, v113
    v_cvt_pk_bf16_f32 v113, v114, v115
    v_cvt_pk_bf16_f32 v114, v116, v117
    v_cvt_pk_bf16_f32 v115, v118, v119
    v_cvt_pk_bf16_f32 v116, v120, v121
    v_cvt_pk_bf16_f32 v117, v122, v123
    v_cvt_pk_bf16_f32 v118, v124, v125
    v_cvt_pk_bf16_f32 v119, v126, v127
    buffer_store_dwordx4 v[112:115], v27, s[12:15], s33 offen offset:0 sc1
    buffer_store_dwordx4 v[116:119], v27, s[12:15], s33 offen offset:640 sc1
interleave_layers__softmax_full_mha__sliding_local_dilated__prompt_kernel_f_fin5:
    s_barrier
    s_lshl_b32 s48, s17, 11
    s_add_u32 s48, s48, 33280
    v_lshlrev_b32 v241, 8, v1
    s_mov_b64 s[56:57], 0xff
    v_mov_b32 v243, 163816
    v_mov_b32 v240, 1
    s_mov_b64 exec, 1
    s_waitcnt vmcnt(0)
    ds_add_rtn_u32 v242, v243, v240 offset:0
    s_waitcnt lgkmcnt(0)
    v_readfirstlane_b32 s49, v242
    s_mov_b64 exec, s[56:57]
    s_cmp_eq_u32 s49, 7
    s_cbranch_scc0 interleave_layers__softmax_full_mha__sliding_local_dilated__prompt_kernel_sf_sg
    buffer_atomic_add v240, v241, s[12:15], s48 offen sc1
interleave_layers__softmax_full_mha__sliding_local_dilated__prompt_kernel_sf_sg:
    s_mov_b64 exec, -1
    s_branch interleave_layers__softmax_full_mha__sliding_local_dilated__prompt_kernel_t0
interleave_layers__softmax_full_mha__sliding_local_dilated__prompt_kernel_f_ld:
    s_setprio 2
    v_lshrrev_b32 v16, 4, v1
    v_and_b32 v17, 3, v2
    v_lshl_add_u32 v18, v17, 2, v16
    v_mul_u32_u24 v20, 3840, v18
    v_xor_b32 v18, v13, v16
    v_lshl_add_u32 v20, v18, 6, v20
    v_lshl_add_u32 v20, v6, 4, v20
    v_lshrrev_b32 v18, 3, v1
    v_lshl_add_u32 v19, v17, 5, v18
    v_and_b32 v23, 7, v1
    v_add_u32 v42, 0, v19
    v_bfe_u32 v43, v42, 1, 3
    v_xor_b32 v43, v43, v23
    v_mul_u32_u24 v42, 1280, v42
    v_lshl_add_u32 v48, v43, 4, v42
    v_add_u32 v42, 8, v19
    v_bfe_u32 v43, v42, 1, 3
    v_xor_b32 v43, v43, v23
    v_mul_u32_u24 v42, 1280, v42
    v_lshl_add_u32 v49, v43, 4, v42
    v_subrev_u32 v49, 1024, v49
    v_add_u32 v42, 16, v19
    v_bfe_u32 v43, v42, 1, 3
    v_xor_b32 v43, v43, v23
    v_mul_u32_u24 v42, 1280, v42
    v_lshl_add_u32 v50, v43, 4, v42
    v_subrev_u32 v50, 2048, v50
    v_add_u32 v42, 24, v19
    v_bfe_u32 v43, v42, 1, 3
    v_xor_b32 v43, v43, v23
    v_mul_u32_u24 v42, 1280, v42
    v_lshl_add_u32 v51, v43, 4, v42
    v_subrev_u32 v51, 3072, v51
    s_lshl_b32 s25, s17, 8
    s_mul_i32 s24, s16, 163840
    s_lshl_b32 s26, s39, 12
    s_waitcnt lgkmcnt(0)
    s_mov_b32 s8, s60
    s_and_b32 s9, s61, 0xffff
    s_mov_b32 s10, 2621440
    s_mov_b32 s11, 0x20000
    s_mov_b32 s28, s62
    s_and_b32 s29, s63, 0xffff
    s_mov_b32 s30, 2457600
    s_mov_b32 s31, 0x20000
    s_mov_b32 s12, s6
    s_and_b32 s13, s7, 0xffff
    s_mov_b32 s14, 29851648
    s_mov_b32 s15, 0x20000
    s_add_u32 m0, s45, 16384
    s_add_u32 s32, s25, 0
    buffer_load_dwordx4 v20, s[28:31], s32 offen  lds
    s_add_u32 m0, s26, 0
    s_add_u32 s33, s24, 0
    buffer_load_dwordx4 v48, s[8:11], s33 offen offset:0  lds
    s_add_u32 m0, s45, 20480
    s_add_u32 s32, s25, 61440
    buffer_load_dwordx4 v20, s[28:31], s32 offen  lds
    s_add_u32 m0, s26, 0
    s_add_u32 s33, s24, 0
    buffer_load_dwordx4 v49, s[8:11], s33 offen offset:1024  lds
    s_add_u32 m0, s45, 24576
    s_add_u32 s32, s25, 122880
    buffer_load_dwordx4 v20, s[28:31], s32 offen  lds
    s_add_u32 m0, s26, 0
    s_add_u32 s33, s24, 0
    buffer_load_dwordx4 v50, s[8:11], s33 offen offset:2048  lds
    s_add_u32 m0, s45, 28672
    s_add_u32 s32, s25, 184320
    buffer_load_dwordx4 v20, s[28:31], s32 offen  lds
    s_add_u32 m0, s26, 0
    s_add_u32 s33, s24, 0
    buffer_load_dwordx4 v51, s[8:11], s33 offen offset:3072  lds
    v_xor_b32 v15, v17, v13
    v_lshl_add_u32 v40, v15, 6, v14
    v_add_u32 v41, 65536, v40
    v_and_b32 v42, 1, v16
    v_cmp_eq_u32 vcc, v42, v5
    v_mov_b32 v43, 0x3f803f80
    s_nop 0
    v_cndmask_b32 v60, 0, v43, vcc
    v_cndmask_b32 v61, 0, v43, vcc
    v_cndmask_b32 v62, 0, v43, vcc
    v_cndmask_b32 v63, 0, v43, vcc
    s_mov_b32 s52, s4
    s_and_b32 s53, s5, 0xffff
    s_mov_b32 s54, 256
    s_mov_b32 s55, 0x20000
    s_mul_i32 s27, s17, 163840
    s_add_u32 s27, s27, s45
    s_add_u32 s27, s27, 18939904
    s_waitcnt vmcnt(0)
    s_barrier
    s_add_u32 m0, s45, 49152
    s_add_u32 s32, s25, 245760
    buffer_load_dwordx4 v20, s[28:31], s32 offen  lds
    s_add_u32 m0, s26, 32768
    s_add_u32 s33, s24, 128
    buffer_load_dwordx4 v48, s[8:11], s33 offen offset:0  lds
    s_add_u32 m0, s45, 53248
    s_add_u32 s32, s25, 307200
    buffer_load_dwordx4 v20, s[28:31], s32 offen  lds
    s_add_u32 m0, s26, 32768
    s_add_u32 s33, s24, 128
    buffer_load_dwordx4 v49, s[8:11], s33 offen offset:1024  lds
    s_add_u32 m0, s45, 57344
    s_add_u32 s32, s25, 368640
    buffer_load_dwordx4 v20, s[28:31], s32 offen  lds
    s_add_u32 m0, s26, 32768
    s_add_u32 s33, s24, 128
    buffer_load_dwordx4 v50, s[8:11], s33 offen offset:2048  lds
    s_add_u32 m0, s45, 61440
    s_add_u32 s32, s25, 430080
    buffer_load_dwordx4 v20, s[28:31], s32 offen  lds
    s_add_u32 m0, s26, 32768
    s_add_u32 s33, s24, 128
    buffer_load_dwordx4 v51, s[8:11], s33 offen offset:3072  lds
    ds_read_b64_tr_b16 v[136:137], v40 offset:0
    ds_read_b64_tr_b16 v[138:139], v40 offset:1024
    ds_read_b64_tr_b16 v[140:141], v40 offset:4096
    ds_read_b64_tr_b16 v[142:143], v40 offset:5120
    ds_read_b64_tr_b16 v[144:145], v40 offset:8192
    ds_read_b64_tr_b16 v[146:147], v40 offset:9216
    ds_read_b64_tr_b16 v[148:149], v40 offset:12288
    ds_read_b64_tr_b16 v[150:151], v40 offset:13312
    s_add_u32 m0, s45, 81920
    s_add_u32 s32, s25, 491520
    buffer_load_dwordx4 v20, s[28:31], s32 offen  lds
    s_add_u32 m0, s26, 65536
    s_add_u32 s33, s24, 256
    buffer_load_dwordx4 v48, s[8:11], s33 offen offset:0  lds
    s_waitcnt lgkmcnt(0)
    v_mfma_f32_16x16x32_bf16 v[64:67], v[60:63], v[136:139], 0
    s_add_u32 m0, s45, 86016
    s_add_u32 s32, s25, 552960
    buffer_load_dwordx4 v20, s[28:31], s32 offen  lds
    v_mfma_f32_16x16x32_bf16 v[64:67], v[60:63], v[140:143], v[64:67]
    s_add_u32 m0, s26, 65536
    s_add_u32 s33, s24, 256
    buffer_load_dwordx4 v49, s[8:11], s33 offen offset:1024  lds
    v_mfma_f32_16x16x32_bf16 v[64:67], v[60:63], v[144:147], v[64:67]
    s_add_u32 m0, s45, 90112
    s_add_u32 s32, s25, 614400
    buffer_load_dwordx4 v20, s[28:31], s32 offen  lds
    v_mfma_f32_16x16x32_bf16 v[64:67], v[60:63], v[148:151], v[64:67]
    s_add_u32 m0, s26, 65536
    s_add_u32 s33, s24, 256
    buffer_load_dwordx4 v50, s[8:11], s33 offen offset:2048  lds
    s_add_u32 m0, s45, 94208
    s_add_u32 s32, s25, 675840
    buffer_load_dwordx4 v20, s[28:31], s32 offen  lds
    s_add_u32 m0, s26, 65536
    s_add_u32 s33, s24, 256
    buffer_load_dwordx4 v51, s[8:11], s33 offen offset:3072  lds
    s_cmp_eq_u32 s16, 0
    s_cbranch_scc0 interleave_layers__softmax_full_mha__sliding_local_dilated__prompt_kernel_f_w0
    v_mov_b32 v112, v136
    v_mov_b32 v113, v137
    v_mov_b32 v114, v138
    v_mov_b32 v115, v139
    v_mov_b32 v116, v140
    v_mov_b32 v117, v141
    v_mov_b32 v118, v142
    v_mov_b32 v119, v143
interleave_layers__softmax_full_mha__sliding_local_dilated__prompt_kernel_f_w0:
    s_cmp_eq_u32 s16, 1
    s_cbranch_scc0 interleave_layers__softmax_full_mha__sliding_local_dilated__prompt_kernel_f_w1
    v_mov_b32 v112, v144
    v_mov_b32 v113, v145
    v_mov_b32 v114, v146
    v_mov_b32 v115, v147
    v_mov_b32 v116, v148
    v_mov_b32 v117, v149
    v_mov_b32 v118, v150
    v_mov_b32 v119, v151
interleave_layers__softmax_full_mha__sliding_local_dilated__prompt_kernel_f_w1:
    s_waitcnt vmcnt(8)
    s_barrier
    ds_read_b64_tr_b16 v[136:137], v40 offset:32768
    ds_read_b64_tr_b16 v[138:139], v40 offset:33792
    ds_read_b64_tr_b16 v[140:141], v40 offset:36864
    ds_read_b64_tr_b16 v[142:143], v40 offset:37888
    ds_read_b64_tr_b16 v[144:145], v40 offset:40960
    ds_read_b64_tr_b16 v[146:147], v40 offset:41984
    ds_read_b64_tr_b16 v[148:149], v40 offset:45056
    ds_read_b64_tr_b16 v[150:151], v40 offset:46080
    s_add_u32 m0, s45, 114688
    s_add_u32 s32, s25, 737280
    buffer_load_dwordx4 v20, s[28:31], s32 offen  lds
    s_add_u32 m0, s26, 98304
    s_add_u32 s33, s24, 384
    buffer_load_dwordx4 v48, s[8:11], s33 offen offset:0  lds
    s_waitcnt lgkmcnt(0)
    v_mfma_f32_16x16x32_bf16 v[64:67], v[60:63], v[136:139], v[64:67]
    s_add_u32 m0, s45, 118784
    s_add_u32 s32, s25, 798720
    buffer_load_dwordx4 v20, s[28:31], s32 offen  lds
    v_mfma_f32_16x16x32_bf16 v[64:67], v[60:63], v[140:143], v[64:67]
    s_add_u32 m0, s26, 98304
    s_add_u32 s33, s24, 384
    buffer_load_dwordx4 v49, s[8:11], s33 offen offset:1024  lds
    v_mfma_f32_16x16x32_bf16 v[64:67], v[60:63], v[144:147], v[64:67]
    s_add_u32 m0, s45, 122880
    s_add_u32 s32, s25, 860160
    buffer_load_dwordx4 v20, s[28:31], s32 offen  lds
    v_mfma_f32_16x16x32_bf16 v[64:67], v[60:63], v[148:151], v[64:67]
    s_add_u32 m0, s26, 98304
    s_add_u32 s33, s24, 384
    buffer_load_dwordx4 v50, s[8:11], s33 offen offset:2048  lds
    s_add_u32 m0, s45, 126976
    s_add_u32 s32, s25, 921600
    buffer_load_dwordx4 v20, s[28:31], s32 offen  lds
    s_add_u32 m0, s26, 98304
    s_add_u32 s33, s24, 384
    buffer_load_dwordx4 v51, s[8:11], s33 offen offset:3072  lds
    s_cmp_eq_u32 s16, 2
    s_cbranch_scc0 interleave_layers__softmax_full_mha__sliding_local_dilated__prompt_kernel_f_w2
    v_mov_b32 v112, v136
    v_mov_b32 v113, v137
    v_mov_b32 v114, v138
    v_mov_b32 v115, v139
    v_mov_b32 v116, v140
    v_mov_b32 v117, v141
    v_mov_b32 v118, v142
    v_mov_b32 v119, v143
interleave_layers__softmax_full_mha__sliding_local_dilated__prompt_kernel_f_w2:
    s_cmp_eq_u32 s16, 3
    s_cbranch_scc0 interleave_layers__softmax_full_mha__sliding_local_dilated__prompt_kernel_f_w3
    v_mov_b32 v112, v144
    v_mov_b32 v113, v145
    v_mov_b32 v114, v146
    v_mov_b32 v115, v147
    v_mov_b32 v116, v148
    v_mov_b32 v117, v149
    v_mov_b32 v118, v150
    v_mov_b32 v119, v151
interleave_layers__softmax_full_mha__sliding_local_dilated__prompt_kernel_f_w3:
    s_waitcnt vmcnt(8)
    s_barrier
    ds_read_b64_tr_b16 v[136:137], v41 offset:0
    ds_read_b64_tr_b16 v[138:139], v41 offset:1024
    ds_read_b64_tr_b16 v[140:141], v41 offset:4096
    ds_read_b64_tr_b16 v[142:143], v41 offset:5120
    ds_read_b64_tr_b16 v[144:145], v41 offset:8192
    ds_read_b64_tr_b16 v[146:147], v41 offset:9216
    ds_read_b64_tr_b16 v[148:149], v41 offset:12288
    ds_read_b64_tr_b16 v[150:151], v41 offset:13312
    s_add_u32 m0, s45, 16384
    s_add_u32 s32, s25, 983040
    buffer_load_dwordx4 v20, s[28:31], s32 offen  lds
    s_add_u32 m0, s26, 0
    s_add_u32 s33, s24, 512
    buffer_load_dwordx4 v48, s[8:11], s33 offen offset:0  lds
    s_waitcnt lgkmcnt(0)
    v_mfma_f32_16x16x32_bf16 v[64:67], v[60:63], v[136:139], v[64:67]
    s_add_u32 m0, s45, 20480
    s_add_u32 s32, s25, 1044480
    buffer_load_dwordx4 v20, s[28:31], s32 offen  lds
    v_mfma_f32_16x16x32_bf16 v[64:67], v[60:63], v[140:143], v[64:67]
    s_add_u32 m0, s26, 0
    s_add_u32 s33, s24, 512
    buffer_load_dwordx4 v49, s[8:11], s33 offen offset:1024  lds
    v_mfma_f32_16x16x32_bf16 v[64:67], v[60:63], v[144:147], v[64:67]
    s_add_u32 m0, s45, 24576
    s_add_u32 s32, s25, 1105920
    buffer_load_dwordx4 v20, s[28:31], s32 offen  lds
    v_mfma_f32_16x16x32_bf16 v[64:67], v[60:63], v[148:151], v[64:67]
    s_add_u32 m0, s26, 0
    s_add_u32 s33, s24, 512
    buffer_load_dwordx4 v50, s[8:11], s33 offen offset:2048  lds
    s_add_u32 m0, s45, 28672
    s_add_u32 s32, s25, 1167360
    buffer_load_dwordx4 v20, s[28:31], s32 offen  lds
    s_add_u32 m0, s26, 0
    s_add_u32 s33, s24, 512
    buffer_load_dwordx4 v51, s[8:11], s33 offen offset:3072  lds
    s_cmp_eq_u32 s16, 4
    s_cbranch_scc0 interleave_layers__softmax_full_mha__sliding_local_dilated__prompt_kernel_f_w4
    v_mov_b32 v112, v136
    v_mov_b32 v113, v137
    v_mov_b32 v114, v138
    v_mov_b32 v115, v139
    v_mov_b32 v116, v140
    v_mov_b32 v117, v141
    v_mov_b32 v118, v142
    v_mov_b32 v119, v143
interleave_layers__softmax_full_mha__sliding_local_dilated__prompt_kernel_f_w4:
    s_cmp_eq_u32 s16, 5
    s_cbranch_scc0 interleave_layers__softmax_full_mha__sliding_local_dilated__prompt_kernel_f_w5
    v_mov_b32 v112, v144
    v_mov_b32 v113, v145
    v_mov_b32 v114, v146
    v_mov_b32 v115, v147
    v_mov_b32 v116, v148
    v_mov_b32 v117, v149
    v_mov_b32 v118, v150
    v_mov_b32 v119, v151
interleave_layers__softmax_full_mha__sliding_local_dilated__prompt_kernel_f_w5:
    s_waitcnt vmcnt(8)
    s_barrier
    ds_read_b64_tr_b16 v[136:137], v41 offset:32768
    ds_read_b64_tr_b16 v[138:139], v41 offset:33792
    ds_read_b64_tr_b16 v[140:141], v41 offset:36864
    ds_read_b64_tr_b16 v[142:143], v41 offset:37888
    ds_read_b64_tr_b16 v[144:145], v41 offset:40960
    ds_read_b64_tr_b16 v[146:147], v41 offset:41984
    ds_read_b64_tr_b16 v[148:149], v41 offset:45056
    ds_read_b64_tr_b16 v[150:151], v41 offset:46080
    s_add_u32 m0, s45, 49152
    s_add_u32 s32, s25, 1228800
    buffer_load_dwordx4 v20, s[28:31], s32 offen  lds
    s_add_u32 m0, s26, 32768
    s_add_u32 s33, s24, 640
    buffer_load_dwordx4 v48, s[8:11], s33 offen offset:0  lds
    s_waitcnt lgkmcnt(0)
    v_mfma_f32_16x16x32_bf16 v[64:67], v[60:63], v[136:139], v[64:67]
    s_add_u32 m0, s45, 53248
    s_add_u32 s32, s25, 1290240
    buffer_load_dwordx4 v20, s[28:31], s32 offen  lds
    v_mfma_f32_16x16x32_bf16 v[64:67], v[60:63], v[140:143], v[64:67]
    s_add_u32 m0, s26, 32768
    s_add_u32 s33, s24, 640
    buffer_load_dwordx4 v49, s[8:11], s33 offen offset:1024  lds
    v_mfma_f32_16x16x32_bf16 v[64:67], v[60:63], v[144:147], v[64:67]
    s_add_u32 m0, s45, 57344
    s_add_u32 s32, s25, 1351680
    buffer_load_dwordx4 v20, s[28:31], s32 offen  lds
    v_mfma_f32_16x16x32_bf16 v[64:67], v[60:63], v[148:151], v[64:67]
    s_add_u32 m0, s26, 32768
    s_add_u32 s33, s24, 640
    buffer_load_dwordx4 v50, s[8:11], s33 offen offset:2048  lds
    s_add_u32 m0, s45, 61440
    s_add_u32 s32, s25, 1413120
    buffer_load_dwordx4 v20, s[28:31], s32 offen  lds
    s_add_u32 m0, s26, 32768
    s_add_u32 s33, s24, 640
    buffer_load_dwordx4 v51, s[8:11], s33 offen offset:3072  lds
    s_cmp_eq_u32 s16, 6
    s_cbranch_scc0 interleave_layers__softmax_full_mha__sliding_local_dilated__prompt_kernel_f_w6
    v_mov_b32 v112, v136
    v_mov_b32 v113, v137
    v_mov_b32 v114, v138
    v_mov_b32 v115, v139
    v_mov_b32 v116, v140
    v_mov_b32 v117, v141
    v_mov_b32 v118, v142
    v_mov_b32 v119, v143
interleave_layers__softmax_full_mha__sliding_local_dilated__prompt_kernel_f_w6:
    s_cmp_eq_u32 s16, 7
    s_cbranch_scc0 interleave_layers__softmax_full_mha__sliding_local_dilated__prompt_kernel_f_w7
    v_mov_b32 v112, v144
    v_mov_b32 v113, v145
    v_mov_b32 v114, v146
    v_mov_b32 v115, v147
    v_mov_b32 v116, v148
    v_mov_b32 v117, v149
    v_mov_b32 v118, v150
    v_mov_b32 v119, v151
interleave_layers__softmax_full_mha__sliding_local_dilated__prompt_kernel_f_w7:
    s_waitcnt vmcnt(8)
    s_barrier
    ds_read_b64_tr_b16 v[136:137], v40 offset:0
    ds_read_b64_tr_b16 v[138:139], v40 offset:1024
    ds_read_b64_tr_b16 v[140:141], v40 offset:4096
    ds_read_b64_tr_b16 v[142:143], v40 offset:5120
    ds_read_b64_tr_b16 v[144:145], v40 offset:8192
    ds_read_b64_tr_b16 v[146:147], v40 offset:9216
    ds_read_b64_tr_b16 v[148:149], v40 offset:12288
    ds_read_b64_tr_b16 v[150:151], v40 offset:13312
    s_add_u32 m0, s45, 81920
    s_add_u32 s32, s25, 1474560
    buffer_load_dwordx4 v20, s[28:31], s32 offen  lds
    s_add_u32 m0, s26, 65536
    s_add_u32 s33, s24, 768
    buffer_load_dwordx4 v48, s[8:11], s33 offen offset:0  lds
    s_waitcnt lgkmcnt(0)
    v_mfma_f32_16x16x32_bf16 v[64:67], v[60:63], v[136:139], v[64:67]
    s_add_u32 m0, s45, 86016
    s_add_u32 s32, s25, 1536000
    buffer_load_dwordx4 v20, s[28:31], s32 offen  lds
    v_mfma_f32_16x16x32_bf16 v[64:67], v[60:63], v[140:143], v[64:67]
    s_add_u32 m0, s26, 65536
    s_add_u32 s33, s24, 768
    buffer_load_dwordx4 v49, s[8:11], s33 offen offset:1024  lds
    v_mfma_f32_16x16x32_bf16 v[64:67], v[60:63], v[144:147], v[64:67]
    s_add_u32 m0, s45, 90112
    s_add_u32 s32, s25, 1597440
    buffer_load_dwordx4 v20, s[28:31], s32 offen  lds
    v_mfma_f32_16x16x32_bf16 v[64:67], v[60:63], v[148:151], v[64:67]
    s_add_u32 m0, s26, 65536
    s_add_u32 s33, s24, 768
    buffer_load_dwordx4 v50, s[8:11], s33 offen offset:2048  lds
    s_add_u32 m0, s45, 94208
    s_add_u32 s32, s25, 1658880
    buffer_load_dwordx4 v20, s[28:31], s32 offen  lds
    s_add_u32 m0, s26, 65536
    s_add_u32 s33, s24, 768
    buffer_load_dwordx4 v51, s[8:11], s33 offen offset:3072  lds
    s_cmp_eq_u32 s16, 8
    s_cbranch_scc0 interleave_layers__softmax_full_mha__sliding_local_dilated__prompt_kernel_f_w8
    v_mov_b32 v112, v136
    v_mov_b32 v113, v137
    v_mov_b32 v114, v138
    v_mov_b32 v115, v139
    v_mov_b32 v116, v140
    v_mov_b32 v117, v141
    v_mov_b32 v118, v142
    v_mov_b32 v119, v143
interleave_layers__softmax_full_mha__sliding_local_dilated__prompt_kernel_f_w8:
    s_cmp_eq_u32 s16, 9
    s_cbranch_scc0 interleave_layers__softmax_full_mha__sliding_local_dilated__prompt_kernel_f_w9
    v_mov_b32 v112, v144
    v_mov_b32 v113, v145
    v_mov_b32 v114, v146
    v_mov_b32 v115, v147
    v_mov_b32 v116, v148
    v_mov_b32 v117, v149
    v_mov_b32 v118, v150
    v_mov_b32 v119, v151
interleave_layers__softmax_full_mha__sliding_local_dilated__prompt_kernel_f_w9:
    s_waitcnt vmcnt(8)
    s_barrier
    ds_read_b64_tr_b16 v[136:137], v40 offset:32768
    ds_read_b64_tr_b16 v[138:139], v40 offset:33792
    ds_read_b64_tr_b16 v[140:141], v40 offset:36864
    ds_read_b64_tr_b16 v[142:143], v40 offset:37888
    ds_read_b64_tr_b16 v[144:145], v40 offset:40960
    ds_read_b64_tr_b16 v[146:147], v40 offset:41984
    ds_read_b64_tr_b16 v[148:149], v40 offset:45056
    ds_read_b64_tr_b16 v[150:151], v40 offset:46080
    s_add_u32 m0, s45, 114688
    s_add_u32 s32, s25, 1720320
    buffer_load_dwordx4 v20, s[28:31], s32 offen  lds
    s_add_u32 m0, s26, 98304
    s_add_u32 s33, s24, 896
    buffer_load_dwordx4 v48, s[8:11], s33 offen offset:0  lds
    s_waitcnt lgkmcnt(0)
    v_mfma_f32_16x16x32_bf16 v[64:67], v[60:63], v[136:139], v[64:67]
    s_add_u32 m0, s45, 118784
    s_add_u32 s32, s25, 1781760
    buffer_load_dwordx4 v20, s[28:31], s32 offen  lds
    v_mfma_f32_16x16x32_bf16 v[64:67], v[60:63], v[140:143], v[64:67]
    s_add_u32 m0, s26, 98304
    s_add_u32 s33, s24, 896
    buffer_load_dwordx4 v49, s[8:11], s33 offen offset:1024  lds
    v_mfma_f32_16x16x32_bf16 v[64:67], v[60:63], v[144:147], v[64:67]
    s_add_u32 m0, s45, 122880
    s_add_u32 s32, s25, 1843200
    buffer_load_dwordx4 v20, s[28:31], s32 offen  lds
    v_mfma_f32_16x16x32_bf16 v[64:67], v[60:63], v[148:151], v[64:67]
    s_add_u32 m0, s26, 98304
    s_add_u32 s33, s24, 896
    buffer_load_dwordx4 v50, s[8:11], s33 offen offset:2048  lds
    s_add_u32 m0, s45, 126976
    s_add_u32 s32, s25, 1904640
    buffer_load_dwordx4 v20, s[28:31], s32 offen  lds
    s_add_u32 m0, s26, 98304
    s_add_u32 s33, s24, 896
    buffer_load_dwordx4 v51, s[8:11], s33 offen offset:3072  lds
    s_cmp_eq_u32 s16, 10
    s_cbranch_scc0 interleave_layers__softmax_full_mha__sliding_local_dilated__prompt_kernel_f_w10
    v_mov_b32 v112, v136
    v_mov_b32 v113, v137
    v_mov_b32 v114, v138
    v_mov_b32 v115, v139
    v_mov_b32 v116, v140
    v_mov_b32 v117, v141
    v_mov_b32 v118, v142
    v_mov_b32 v119, v143
interleave_layers__softmax_full_mha__sliding_local_dilated__prompt_kernel_f_w10:
    s_cmp_eq_u32 s16, 11
    s_cbranch_scc0 interleave_layers__softmax_full_mha__sliding_local_dilated__prompt_kernel_f_w11
    v_mov_b32 v112, v144
    v_mov_b32 v113, v145
    v_mov_b32 v114, v146
    v_mov_b32 v115, v147
    v_mov_b32 v116, v148
    v_mov_b32 v117, v149
    v_mov_b32 v118, v150
    v_mov_b32 v119, v151
interleave_layers__softmax_full_mha__sliding_local_dilated__prompt_kernel_f_w11:
    s_waitcnt vmcnt(8)
    s_barrier
    ds_read_b64_tr_b16 v[136:137], v41 offset:0
    ds_read_b64_tr_b16 v[138:139], v41 offset:1024
    ds_read_b64_tr_b16 v[140:141], v41 offset:4096
    ds_read_b64_tr_b16 v[142:143], v41 offset:5120
    ds_read_b64_tr_b16 v[144:145], v41 offset:8192
    ds_read_b64_tr_b16 v[146:147], v41 offset:9216
    ds_read_b64_tr_b16 v[148:149], v41 offset:12288
    ds_read_b64_tr_b16 v[150:151], v41 offset:13312
    s_add_u32 m0, s45, 16384
    s_add_u32 s32, s25, 1966080
    buffer_load_dwordx4 v20, s[28:31], s32 offen  lds
    s_add_u32 m0, s26, 0
    s_add_u32 s33, s24, 1024
    buffer_load_dwordx4 v48, s[8:11], s33 offen offset:0  lds
    s_waitcnt lgkmcnt(0)
    v_mfma_f32_16x16x32_bf16 v[64:67], v[60:63], v[136:139], v[64:67]
    s_add_u32 m0, s45, 20480
    s_add_u32 s32, s25, 2027520
    buffer_load_dwordx4 v20, s[28:31], s32 offen  lds
    v_mfma_f32_16x16x32_bf16 v[64:67], v[60:63], v[140:143], v[64:67]
    s_add_u32 m0, s26, 0
    s_add_u32 s33, s24, 1024
    buffer_load_dwordx4 v49, s[8:11], s33 offen offset:1024  lds
    v_mfma_f32_16x16x32_bf16 v[64:67], v[60:63], v[144:147], v[64:67]
    s_add_u32 m0, s45, 24576
    s_add_u32 s32, s25, 2088960
    buffer_load_dwordx4 v20, s[28:31], s32 offen  lds
    v_mfma_f32_16x16x32_bf16 v[64:67], v[60:63], v[148:151], v[64:67]
    s_add_u32 m0, s26, 0
    s_add_u32 s33, s24, 1024
    buffer_load_dwordx4 v50, s[8:11], s33 offen offset:2048  lds
    s_add_u32 m0, s45, 28672
    s_add_u32 s32, s25, 2150400
    buffer_load_dwordx4 v20, s[28:31], s32 offen  lds
    s_add_u32 m0, s26, 0
    s_add_u32 s33, s24, 1024
    buffer_load_dwordx4 v51, s[8:11], s33 offen offset:3072  lds
    s_cmp_eq_u32 s16, 12
    s_cbranch_scc0 interleave_layers__softmax_full_mha__sliding_local_dilated__prompt_kernel_f_w12
    v_mov_b32 v112, v136
    v_mov_b32 v113, v137
    v_mov_b32 v114, v138
    v_mov_b32 v115, v139
    v_mov_b32 v116, v140
    v_mov_b32 v117, v141
    v_mov_b32 v118, v142
    v_mov_b32 v119, v143
interleave_layers__softmax_full_mha__sliding_local_dilated__prompt_kernel_f_w12:
    s_cmp_eq_u32 s16, 13
    s_cbranch_scc0 interleave_layers__softmax_full_mha__sliding_local_dilated__prompt_kernel_f_w13
    v_mov_b32 v112, v144
    v_mov_b32 v113, v145
    v_mov_b32 v114, v146
    v_mov_b32 v115, v147
    v_mov_b32 v116, v148
    v_mov_b32 v117, v149
    v_mov_b32 v118, v150
    v_mov_b32 v119, v151
interleave_layers__softmax_full_mha__sliding_local_dilated__prompt_kernel_f_w13:
    s_waitcnt vmcnt(8)
    s_barrier
    ds_read_b64_tr_b16 v[136:137], v41 offset:32768
    ds_read_b64_tr_b16 v[138:139], v41 offset:33792
    ds_read_b64_tr_b16 v[140:141], v41 offset:36864
    ds_read_b64_tr_b16 v[142:143], v41 offset:37888
    ds_read_b64_tr_b16 v[144:145], v41 offset:40960
    ds_read_b64_tr_b16 v[146:147], v41 offset:41984
    ds_read_b64_tr_b16 v[148:149], v41 offset:45056
    ds_read_b64_tr_b16 v[150:151], v41 offset:46080
    s_add_u32 m0, s45, 49152
    s_add_u32 s32, s25, 2211840
    buffer_load_dwordx4 v20, s[28:31], s32 offen  lds
    s_add_u32 m0, s26, 32768
    s_add_u32 s33, s24, 1152
    buffer_load_dwordx4 v48, s[8:11], s33 offen offset:0  lds
    s_waitcnt lgkmcnt(0)
    v_mfma_f32_16x16x32_bf16 v[64:67], v[60:63], v[136:139], v[64:67]
    s_add_u32 m0, s45, 53248
    s_add_u32 s32, s25, 2273280
    buffer_load_dwordx4 v20, s[28:31], s32 offen  lds
    v_mfma_f32_16x16x32_bf16 v[64:67], v[60:63], v[140:143], v[64:67]
    s_add_u32 m0, s26, 32768
    s_add_u32 s33, s24, 1152
    buffer_load_dwordx4 v49, s[8:11], s33 offen offset:1024  lds
    v_mfma_f32_16x16x32_bf16 v[64:67], v[60:63], v[144:147], v[64:67]
    s_add_u32 m0, s45, 57344
    s_add_u32 s32, s25, 2334720
    buffer_load_dwordx4 v20, s[28:31], s32 offen  lds
    v_mfma_f32_16x16x32_bf16 v[64:67], v[60:63], v[148:151], v[64:67]
    s_add_u32 m0, s26, 32768
    s_add_u32 s33, s24, 1152
    buffer_load_dwordx4 v50, s[8:11], s33 offen offset:2048  lds
    s_add_u32 m0, s45, 61440
    s_add_u32 s32, s25, 2396160
    buffer_load_dwordx4 v20, s[28:31], s32 offen  lds
    s_add_u32 m0, s26, 32768
    s_add_u32 s33, s24, 1152
    buffer_load_dwordx4 v51, s[8:11], s33 offen offset:3072  lds
    s_cmp_eq_u32 s16, 14
    s_cbranch_scc0 interleave_layers__softmax_full_mha__sliding_local_dilated__prompt_kernel_f_w14
    v_mov_b32 v112, v136
    v_mov_b32 v113, v137
    v_mov_b32 v114, v138
    v_mov_b32 v115, v139
    v_mov_b32 v116, v140
    v_mov_b32 v117, v141
    v_mov_b32 v118, v142
    v_mov_b32 v119, v143
interleave_layers__softmax_full_mha__sliding_local_dilated__prompt_kernel_f_w14:
    s_cmp_eq_u32 s16, 15
    s_cbranch_scc0 interleave_layers__softmax_full_mha__sliding_local_dilated__prompt_kernel_f_w15
    v_mov_b32 v112, v144
    v_mov_b32 v113, v145
    v_mov_b32 v114, v146
    v_mov_b32 v115, v147
    v_mov_b32 v116, v148
    v_mov_b32 v117, v149
    v_mov_b32 v118, v150
    v_mov_b32 v119, v151
interleave_layers__softmax_full_mha__sliding_local_dilated__prompt_kernel_f_w15:
    s_waitcnt vmcnt(8)
    s_barrier
    ds_read_b64_tr_b16 v[136:137], v40 offset:0
    ds_read_b64_tr_b16 v[138:139], v40 offset:1024
    ds_read_b64_tr_b16 v[140:141], v40 offset:4096
    ds_read_b64_tr_b16 v[142:143], v40 offset:5120
    ds_read_b64_tr_b16 v[144:145], v40 offset:8192
    ds_read_b64_tr_b16 v[146:147], v40 offset:9216
    ds_read_b64_tr_b16 v[148:149], v40 offset:12288
    ds_read_b64_tr_b16 v[150:151], v40 offset:13312
    s_waitcnt lgkmcnt(0)
    v_mfma_f32_16x16x32_bf16 v[64:67], v[60:63], v[136:139], v[64:67]
    v_mfma_f32_16x16x32_bf16 v[64:67], v[60:63], v[140:143], v[64:67]
    v_mfma_f32_16x16x32_bf16 v[64:67], v[60:63], v[144:147], v[64:67]
    v_mfma_f32_16x16x32_bf16 v[64:67], v[60:63], v[148:151], v[64:67]
    s_cmp_eq_u32 s16, 0
    s_cbranch_scc0 interleave_layers__softmax_full_mha__sliding_local_dilated__prompt_kernel_f_w16
    v_mov_b32 v120, v136
    v_mov_b32 v121, v137
    v_mov_b32 v122, v138
    v_mov_b32 v123, v139
    v_mov_b32 v124, v140
    v_mov_b32 v125, v141
    v_mov_b32 v126, v142
    v_mov_b32 v127, v143
interleave_layers__softmax_full_mha__sliding_local_dilated__prompt_kernel_f_w16:
    s_cmp_eq_u32 s16, 1
    s_cbranch_scc0 interleave_layers__softmax_full_mha__sliding_local_dilated__prompt_kernel_f_w17
    v_mov_b32 v120, v144
    v_mov_b32 v121, v145
    v_mov_b32 v122, v146
    v_mov_b32 v123, v147
    v_mov_b32 v124, v148
    v_mov_b32 v125, v149
    v_mov_b32 v126, v150
    v_mov_b32 v127, v151
interleave_layers__softmax_full_mha__sliding_local_dilated__prompt_kernel_f_w17:
    v_and_b32 v24, 15, v1
    v_lshlrev_b32 v24, 2, v24
    s_mov_b32 s33, 0
interleave_layers__softmax_full_mha__sliding_local_dilated__prompt_kernel_f_pl:
    buffer_load_dword v25, v24, s[52:55], 0 offen sc1
    s_add_u32 s33, s33, 1
    s_waitcnt vmcnt(0)
    v_cmp_eq_u32 vcc, 0, v25
    s_cmp_ge_u32 s33, 0x20000
    s_cbranch_scc1 interleave_layers__softmax_full_mha__sliding_local_dilated__prompt_kernel_f_px
    s_cbranch_vccnz interleave_layers__softmax_full_mha__sliding_local_dilated__prompt_kernel_f_pl
interleave_layers__softmax_full_mha__sliding_local_dilated__prompt_kernel_f_px:
    v_lshlrev_b32 v24, 3, v10
    s_lshl_b32 s32, s16, 10
    s_lshl_b32 s33, s39, 8
    s_add_u32 s32, s32, s33
    s_add_u32 s32, s32, 2752512
    buffer_load_dwordx2 v[44:45], v24, s[12:15], s32 offen sc1
    s_barrier
    ds_read_b64_tr_b16 v[136:137], v40 offset:32768
    ds_read_b64_tr_b16 v[138:139], v40 offset:33792
    ds_read_b64_tr_b16 v[140:141], v40 offset:36864
    ds_read_b64_tr_b16 v[142:143], v40 offset:37888
    ds_read_b64_tr_b16 v[144:145], v40 offset:40960
    ds_read_b64_tr_b16 v[146:147], v40 offset:41984
    ds_read_b64_tr_b16 v[148:149], v40 offset:45056
    ds_read_b64_tr_b16 v[150:151], v40 offset:46080
    s_waitcnt lgkmcnt(0)
    v_mfma_f32_16x16x32_bf16 v[64:67], v[60:63], v[136:139], v[64:67]
    v_mfma_f32_16x16x32_bf16 v[64:67], v[60:63], v[140:143], v[64:67]
    v_mfma_f32_16x16x32_bf16 v[64:67], v[60:63], v[144:147], v[64:67]
    v_mfma_f32_16x16x32_bf16 v[64:67], v[60:63], v[148:151], v[64:67]
    s_cmp_eq_u32 s16, 2
    s_cbranch_scc0 interleave_layers__softmax_full_mha__sliding_local_dilated__prompt_kernel_f_w18
    v_mov_b32 v120, v136
    v_mov_b32 v121, v137
    v_mov_b32 v122, v138
    v_mov_b32 v123, v139
    v_mov_b32 v124, v140
    v_mov_b32 v125, v141
    v_mov_b32 v126, v142
    v_mov_b32 v127, v143
interleave_layers__softmax_full_mha__sliding_local_dilated__prompt_kernel_f_w18:
    s_cmp_eq_u32 s16, 3
    s_cbranch_scc0 interleave_layers__softmax_full_mha__sliding_local_dilated__prompt_kernel_f_w19
    v_mov_b32 v120, v144
    v_mov_b32 v121, v145
    v_mov_b32 v122, v146
    v_mov_b32 v123, v147
    v_mov_b32 v124, v148
    v_mov_b32 v125, v149
    v_mov_b32 v126, v150
    v_mov_b32 v127, v151
interleave_layers__softmax_full_mha__sliding_local_dilated__prompt_kernel_f_w19:
    s_waitcnt vmcnt(0)
    s_lshl_b32 s32, s16, 13
    s_add_u32 s32, s32, s27
    s_add_u32 s33, s32, 4096
    buffer_store_dwordx4 v[112:115], v3, s[12:15], s32 offen sc1
    buffer_store_dwordx4 v[116:119], v3, s[12:15], s33 offen sc1
    v_mul_f32 v28, 0x3acccccd, v44
    v_mul_f32 v30, 0x3acccccd, v45
    v_fma_f32 v30, -v28, v28, v30
    v_max_f32 v30, 0, v30
    v_add_f32 v30, 0x3727c5ac, v30
    v_rsq_f32 v29, v30
    s_nop 0
    v_lshlrev_b32 v42, 2, v5
    ds_bpermute_b32 v68, v42, v64
    ds_bpermute_b32 v69, v42, v65
    v_cmp_eq_u32 vcc, 1, v7
    v_xor_b32 v37, 0x80000000, v28
    v_and_b32 v36, 0xffff0000, v37
    v_sub_f32 v38, v37, v36
    v_cvt_pk_bf16_f32 v32, v36, v36
    v_cvt_pk_bf16_f32 v33, v38, 0
    s_waitcnt lgkmcnt(0)
    v_cndmask_b32 v64, v68, v69, vcc
    v_and_b32 v36, 0xffff0000, v64
    v_sub_f32 v38, v64, v36
    v_cvt_pk_bf16_f32 v34, v36, v38
    v_lshrrev_b32 v35, 16, v36
    v_lshlrev_b32 v24, 2, v10
    s_lshl_b32 s32, s39, 8
    s_add_u32 s32, s32, 65536
    v_add_u32 v24, s32, v24
    ds_write_b32 v24, v34
    ds_write_b32 v24, v35 offset:128
    ds_write_b32 v24, v32 offset:1024
    ds_write_b32 v24, v33 offset:1152
    ds_write_b32 v24, v29 offset:2048
    s_waitcnt lgkmcnt(0)
    s_barrier
    v_mov_b32 v243, 163816
    v_mov_b32 v240, 0
    v_mov_b32 v241, 0
    ds_write_b64 v243, v[240:241]
    s_waitcnt lgkmcnt(0)
    s_barrier
    v_mov_b32 v44, v64
    s_cmp_ge_u32 s16, 4
    s_cbranch_scc1 interleave_layers__softmax_full_mha__sliding_local_dilated__prompt_kernel_f_le
    s_lshl_b32 s32, s16, 13
    s_add_u32 s32, s32, s27
    s_add_u32 s32, s32, 131072
    s_add_u32 s33, s32, 4096
    buffer_store_dwordx4 v[120:123], v3, s[12:15], s32 offen sc1
    buffer_store_dwordx4 v[124:127], v3, s[12:15], s33 offen sc1
    s_cmp_eq_u32 s16, 0
    s_cbranch_scc0 interleave_layers__softmax_full_mha__sliding_local_dilated__prompt_kernel_f_le
    v_mov_b32 v45, 0
    v_mov_b32 v46, 0
    v_mov_b32 v47, 0
    v_lshlrev_b32 v24, 4, v10
    s_lshl_b32 s32, s17, 11
    s_lshl_b32 s33, s39, 9
    s_add_u32 s32, s32, s33
    s_add_u32 s32, s32, 18743296
    s_mov_b32 exec_hi, 0
    buffer_store_dwordx4 v[44:47], v24, s[12:15], s32 offen sc1
interleave_layers__softmax_full_mha__sliding_local_dilated__prompt_kernel_f_le:
    s_mov_b64 exec, -1
    s_lshl_b32 s48, s17, 11
    s_add_u32 s48, s48, 33280
    v_lshlrev_b32 v241, 8, v1
    s_mov_b64 s[56:57], 0xff
    v_mov_b32 v243, 163816
    v_mov_b32 v240, 1
    s_mov_b64 exec, 1
    s_waitcnt vmcnt(0)
    ds_add_rtn_u32 v242, v243, v240 offset:0
    s_waitcnt lgkmcnt(0)
    v_readfirstlane_b32 s49, v242
    s_mov_b64 exec, s[56:57]
    s_cmp_eq_u32 s49, 7
    s_cbranch_scc0 interleave_layers__softmax_full_mha__sliding_local_dilated__prompt_kernel_sfl_sg
    buffer_atomic_add v240, v241, s[12:15], s48 offen sc1
interleave_layers__softmax_full_mha__sliding_local_dilated__prompt_kernel_sfl_sg:
    s_mov_b64 exec, -1
    s_branch interleave_layers__softmax_full_mha__sliding_local_dilated__prompt_kernel_t0
interleave_layers__softmax_full_mha__sliding_local_dilated__prompt_kernel_f_ub:
    s_waitcnt lgkmcnt(0)
    s_mov_b32 s8, s60
    s_and_b32 s9, s61, 0xffff
    s_mov_b32 s10, 2621440
    s_mov_b32 s11, 0x20000
    s_mov_b32 s28, s62
    s_and_b32 s29, s63, 0xffff
    s_mov_b32 s30, 2457600
    s_mov_b32 s31, 0x20000
    s_mov_b32 s12, s6
    s_and_b32 s13, s7, 0xffff
    s_mov_b32 s14, 29851648
    s_mov_b32 s15, 0x20000
    v_lshrrev_b32 v4, 3, v1
    v_lshl_add_u32 v4, v2, 4, v4
    v_mul_u32_u24 v5, 1280, v4
    v_and_b32 v6, 7, v1
    v_lshl_add_u32 v5, v6, 4, v5
    s_mul_i32 s24, s16, 163840
    s_add_u32 s25, s24, 10240
    buffer_load_dwordx4 v[24:27], v5, s[8:11], s24 offen offset:0
    buffer_load_dwordx4 v[28:31], v5, s[8:11], s24 offen offset:128
    buffer_load_dwordx4 v[32:35], v5, s[8:11], s24 offen offset:256
    buffer_load_dwordx4 v[36:39], v5, s[8:11], s24 offen offset:384
    buffer_load_dwordx4 v[40:43], v5, s[8:11], s24 offen offset:512
    buffer_load_dwordx4 v[44:47], v5, s[8:11], s24 offen offset:640
    buffer_load_dwordx4 v[48:51], v5, s[8:11], s24 offen offset:768
    buffer_load_dwordx4 v[52:55], v5, s[8:11], s24 offen offset:896
    buffer_load_dwordx4 v[56:59], v5, s[8:11], s24 offen offset:1024
    buffer_load_dwordx4 v[60:63], v5, s[8:11], s24 offen offset:1152
    buffer_load_dwordx4 v[64:67], v5, s[8:11], s25 offen offset:0
    buffer_load_dwordx4 v[68:71], v5, s[8:11], s25 offen offset:128
    buffer_load_dwordx4 v[72:75], v5, s[8:11], s25 offen offset:256
    buffer_load_dwordx4 v[76:79], v5, s[8:11], s25 offen offset:384
    buffer_load_dwordx4 v[80:83], v5, s[8:11], s25 offen offset:512
    buffer_load_dwordx4 v[84:87], v5, s[8:11], s25 offen offset:640
    buffer_load_dwordx4 v[88:91], v5, s[8:11], s25 offen offset:768
    buffer_load_dwordx4 v[92:95], v5, s[8:11], s25 offen offset:896
    buffer_load_dwordx4 v[96:99], v5, s[8:11], s25 offen offset:1024
    buffer_load_dwordx4 v[100:103], v5, s[8:11], s25 offen offset:1152
    v_mov_b32 v8, 0
    v_mov_b32 v9, 0
    v_mov_b32 v10, 0
    v_mov_b32 v11, 0
    v_mov_b32 v12, 0
    v_mov_b32 v13, 0
    v_mov_b32 v14, 0
    v_mov_b32 v15, 0
    v_mov_b32 v7, 0x3f803f80
    v_lshlrev_b32 v16, 4, v0
    s_and_b32 s26, s16, 7
    s_lshl_b32 s26, s26, 13
    s_add_u32 s26, s26, 0
    s_cmp_ge_u32 s16, 8
    s_cselect_b32 s27, 65536, 0
    s_add_u32 s26, s26, s27
    buffer_store_dwordx4 v[12:15], v16, s[12:15], s26 offen sc1
    s_waitcnt vmcnt(20)
    v_dot2_f32_bf16 v8, v24, v7, v8
    v_dot2_f32_bf16 v9, v24, v24, v9
    v_dot2_f32_bf16 v8, v25, v7, v8
    v_dot2_f32_bf16 v9, v25, v25, v9
    v_dot2_f32_bf16 v8, v26, v7, v8
    v_dot2_f32_bf16 v9, v26, v26, v9
    v_dot2_f32_bf16 v8, v27, v7, v8
    v_dot2_f32_bf16 v9, v27, v27, v9
    s_waitcnt vmcnt(19)
    v_dot2_f32_bf16 v8, v28, v7, v8
    v_dot2_f32_bf16 v9, v28, v28, v9
    v_dot2_f32_bf16 v8, v29, v7, v8
    v_dot2_f32_bf16 v9, v29, v29, v9
    v_dot2_f32_bf16 v8, v30, v7, v8
    v_dot2_f32_bf16 v9, v30, v30, v9
    v_dot2_f32_bf16 v8, v31, v7, v8
    v_dot2_f32_bf16 v9, v31, v31, v9
    s_waitcnt vmcnt(18)
    v_dot2_f32_bf16 v8, v32, v7, v8
    v_dot2_f32_bf16 v9, v32, v32, v9
    v_dot2_f32_bf16 v8, v33, v7, v8
    v_dot2_f32_bf16 v9, v33, v33, v9
    v_dot2_f32_bf16 v8, v34, v7, v8
    v_dot2_f32_bf16 v9, v34, v34, v9
    v_dot2_f32_bf16 v8, v35, v7, v8
    v_dot2_f32_bf16 v9, v35, v35, v9
    s_waitcnt vmcnt(17)
    v_dot2_f32_bf16 v8, v36, v7, v8
    v_dot2_f32_bf16 v9, v36, v36, v9
    v_dot2_f32_bf16 v8, v37, v7, v8
    v_dot2_f32_bf16 v9, v37, v37, v9
    v_dot2_f32_bf16 v8, v38, v7, v8
    v_dot2_f32_bf16 v9, v38, v38, v9
    v_dot2_f32_bf16 v8, v39, v7, v8
    v_dot2_f32_bf16 v9, v39, v39, v9
    s_waitcnt vmcnt(16)
    v_dot2_f32_bf16 v8, v40, v7, v8
    v_dot2_f32_bf16 v9, v40, v40, v9
    v_dot2_f32_bf16 v8, v41, v7, v8
    v_dot2_f32_bf16 v9, v41, v41, v9
    v_dot2_f32_bf16 v8, v42, v7, v8
    v_dot2_f32_bf16 v9, v42, v42, v9
    v_dot2_f32_bf16 v8, v43, v7, v8
    v_dot2_f32_bf16 v9, v43, v43, v9
    s_waitcnt vmcnt(15)
    v_dot2_f32_bf16 v8, v44, v7, v8
    v_dot2_f32_bf16 v9, v44, v44, v9
    v_dot2_f32_bf16 v8, v45, v7, v8
    v_dot2_f32_bf16 v9, v45, v45, v9
    v_dot2_f32_bf16 v8, v46, v7, v8
    v_dot2_f32_bf16 v9, v46, v46, v9
    v_dot2_f32_bf16 v8, v47, v7, v8
    v_dot2_f32_bf16 v9, v47, v47, v9
    s_waitcnt vmcnt(14)
    v_dot2_f32_bf16 v8, v48, v7, v8
    v_dot2_f32_bf16 v9, v48, v48, v9
    v_dot2_f32_bf16 v8, v49, v7, v8
    v_dot2_f32_bf16 v9, v49, v49, v9
    v_dot2_f32_bf16 v8, v50, v7, v8
    v_dot2_f32_bf16 v9, v50, v50, v9
    v_dot2_f32_bf16 v8, v51, v7, v8
    v_dot2_f32_bf16 v9, v51, v51, v9
    s_waitcnt vmcnt(13)
    v_dot2_f32_bf16 v8, v52, v7, v8
    v_dot2_f32_bf16 v9, v52, v52, v9
    v_dot2_f32_bf16 v8, v53, v7, v8
    v_dot2_f32_bf16 v9, v53, v53, v9
    v_dot2_f32_bf16 v8, v54, v7, v8
    v_dot2_f32_bf16 v9, v54, v54, v9
    v_dot2_f32_bf16 v8, v55, v7, v8
    v_dot2_f32_bf16 v9, v55, v55, v9
    s_waitcnt vmcnt(12)
    v_dot2_f32_bf16 v8, v56, v7, v8
    v_dot2_f32_bf16 v9, v56, v56, v9
    v_dot2_f32_bf16 v8, v57, v7, v8
    v_dot2_f32_bf16 v9, v57, v57, v9
    v_dot2_f32_bf16 v8, v58, v7, v8
    v_dot2_f32_bf16 v9, v58, v58, v9
    v_dot2_f32_bf16 v8, v59, v7, v8
    v_dot2_f32_bf16 v9, v59, v59, v9
    s_waitcnt vmcnt(11)
    v_dot2_f32_bf16 v8, v60, v7, v8
    v_dot2_f32_bf16 v9, v60, v60, v9
    v_dot2_f32_bf16 v8, v61, v7, v8
    v_dot2_f32_bf16 v9, v61, v61, v9
    v_dot2_f32_bf16 v8, v62, v7, v8
    v_dot2_f32_bf16 v9, v62, v62, v9
    v_dot2_f32_bf16 v8, v63, v7, v8
    v_dot2_f32_bf16 v9, v63, v63, v9
    s_waitcnt vmcnt(10)
    v_dot2_f32_bf16 v10, v64, v7, v10
    v_dot2_f32_bf16 v11, v64, v64, v11
    v_dot2_f32_bf16 v10, v65, v7, v10
    v_dot2_f32_bf16 v11, v65, v65, v11
    v_dot2_f32_bf16 v10, v66, v7, v10
    v_dot2_f32_bf16 v11, v66, v66, v11
    v_dot2_f32_bf16 v10, v67, v7, v10
    v_dot2_f32_bf16 v11, v67, v67, v11
    s_waitcnt vmcnt(9)
    v_dot2_f32_bf16 v10, v68, v7, v10
    v_dot2_f32_bf16 v11, v68, v68, v11
    v_dot2_f32_bf16 v10, v69, v7, v10
    v_dot2_f32_bf16 v11, v69, v69, v11
    v_dot2_f32_bf16 v10, v70, v7, v10
    v_dot2_f32_bf16 v11, v70, v70, v11
    v_dot2_f32_bf16 v10, v71, v7, v10
    v_dot2_f32_bf16 v11, v71, v71, v11
    s_waitcnt vmcnt(8)
    v_dot2_f32_bf16 v10, v72, v7, v10
    v_dot2_f32_bf16 v11, v72, v72, v11
    v_dot2_f32_bf16 v10, v73, v7, v10
    v_dot2_f32_bf16 v11, v73, v73, v11
    v_dot2_f32_bf16 v10, v74, v7, v10
    v_dot2_f32_bf16 v11, v74, v74, v11
    v_dot2_f32_bf16 v10, v75, v7, v10
    v_dot2_f32_bf16 v11, v75, v75, v11
    s_waitcnt vmcnt(7)
    v_dot2_f32_bf16 v10, v76, v7, v10
    v_dot2_f32_bf16 v11, v76, v76, v11
    v_dot2_f32_bf16 v10, v77, v7, v10
    v_dot2_f32_bf16 v11, v77, v77, v11
    v_dot2_f32_bf16 v10, v78, v7, v10
    v_dot2_f32_bf16 v11, v78, v78, v11
    v_dot2_f32_bf16 v10, v79, v7, v10
    v_dot2_f32_bf16 v11, v79, v79, v11
    s_waitcnt vmcnt(6)
    v_dot2_f32_bf16 v10, v80, v7, v10
    v_dot2_f32_bf16 v11, v80, v80, v11
    v_dot2_f32_bf16 v10, v81, v7, v10
    v_dot2_f32_bf16 v11, v81, v81, v11
    v_dot2_f32_bf16 v10, v82, v7, v10
    v_dot2_f32_bf16 v11, v82, v82, v11
    v_dot2_f32_bf16 v10, v83, v7, v10
    v_dot2_f32_bf16 v11, v83, v83, v11
    s_waitcnt vmcnt(5)
    v_dot2_f32_bf16 v10, v84, v7, v10
    v_dot2_f32_bf16 v11, v84, v84, v11
    v_dot2_f32_bf16 v10, v85, v7, v10
    v_dot2_f32_bf16 v11, v85, v85, v11
    v_dot2_f32_bf16 v10, v86, v7, v10
    v_dot2_f32_bf16 v11, v86, v86, v11
    v_dot2_f32_bf16 v10, v87, v7, v10
    v_dot2_f32_bf16 v11, v87, v87, v11
    s_waitcnt vmcnt(4)
    v_dot2_f32_bf16 v10, v88, v7, v10
    v_dot2_f32_bf16 v11, v88, v88, v11
    v_dot2_f32_bf16 v10, v89, v7, v10
    v_dot2_f32_bf16 v11, v89, v89, v11
    v_dot2_f32_bf16 v10, v90, v7, v10
    v_dot2_f32_bf16 v11, v90, v90, v11
    v_dot2_f32_bf16 v10, v91, v7, v10
    v_dot2_f32_bf16 v11, v91, v91, v11
    s_waitcnt vmcnt(3)
    v_dot2_f32_bf16 v10, v92, v7, v10
    v_dot2_f32_bf16 v11, v92, v92, v11
    v_dot2_f32_bf16 v10, v93, v7, v10
    v_dot2_f32_bf16 v11, v93, v93, v11
    v_dot2_f32_bf16 v10, v94, v7, v10
    v_dot2_f32_bf16 v11, v94, v94, v11
    v_dot2_f32_bf16 v10, v95, v7, v10
    v_dot2_f32_bf16 v11, v95, v95, v11
    s_waitcnt vmcnt(2)
    v_dot2_f32_bf16 v10, v96, v7, v10
    v_dot2_f32_bf16 v11, v96, v96, v11
    v_dot2_f32_bf16 v10, v97, v7, v10
    v_dot2_f32_bf16 v11, v97, v97, v11
    v_dot2_f32_bf16 v10, v98, v7, v10
    v_dot2_f32_bf16 v11, v98, v98, v11
    v_dot2_f32_bf16 v10, v99, v7, v10
    v_dot2_f32_bf16 v11, v99, v99, v11
    s_waitcnt vmcnt(1)
    v_dot2_f32_bf16 v10, v100, v7, v10
    v_dot2_f32_bf16 v11, v100, v100, v11
    v_dot2_f32_bf16 v10, v101, v7, v10
    v_dot2_f32_bf16 v11, v101, v101, v11
    v_dot2_f32_bf16 v10, v102, v7, v10
    v_dot2_f32_bf16 v11, v102, v102, v11
    v_dot2_f32_bf16 v10, v103, v7, v10
    v_dot2_f32_bf16 v11, v103, v103, v11
    v_add_f32_dpp v8, v8, v8 quad_perm:[1,0,3,2] row_mask:0xf bank_mask:0xf
    v_add_f32_dpp v9, v9, v9 quad_perm:[1,0,3,2] row_mask:0xf bank_mask:0xf
    v_add_f32_dpp v10, v10, v10 quad_perm:[1,0,3,2] row_mask:0xf bank_mask:0xf
    v_add_f32_dpp v11, v11, v11 quad_perm:[1,0,3,2] row_mask:0xf bank_mask:0xf
    v_add_f32_dpp v8, v8, v8 quad_perm:[2,3,0,1] row_mask:0xf bank_mask:0xf
    v_add_f32_dpp v9, v9, v9 quad_perm:[2,3,0,1] row_mask:0xf bank_mask:0xf
    v_add_f32_dpp v10, v10, v10 quad_perm:[2,3,0,1] row_mask:0xf bank_mask:0xf
    v_add_f32_dpp v11, v11, v11 quad_perm:[2,3,0,1] row_mask:0xf bank_mask:0xf
    v_add_f32_dpp v8, v8, v8 row_half_mirror row_mask:0xf bank_mask:0xf
    v_add_f32_dpp v9, v9, v9 row_half_mirror row_mask:0xf bank_mask:0xf
    v_add_f32_dpp v10, v10, v10 row_half_mirror row_mask:0xf bank_mask:0xf
    v_add_f32_dpp v11, v11, v11 row_half_mirror row_mask:0xf bank_mask:0xf
    v_lshlrev_b32 v4, 3, v4
    s_lshl_b32 s26, s16, 10
    s_add_u32 s26, s26, 2752512
    v_cmp_eq_u32 vcc, 0, v6
    s_mov_b32 s52, s4
    s_and_b32 s53, s5, 0xffff
    s_mov_b32 s54, 256
    s_mov_b32 s55, 0x20000
    s_mov_b64 exec, vcc
    buffer_store_dwordx2 v[8:9], v4, s[12:15], s26 offen sc1
    buffer_store_dwordx2 v[10:11], v4, s[12:15], s26 offen offset:64 sc1
    s_mov_b64 exec, -1
    v_mov_b32 v243, 163816
    v_mov_b32 v240, 0
    v_mov_b32 v241, 0
    ds_write_b64 v243, v[240:241]
    s_waitcnt lgkmcnt(0)
    s_waitcnt vmcnt(0)
    s_barrier
    s_cmp_ge_u32 s18, 4
    s_cbranch_scc1 interleave_layers__softmax_full_mha__sliding_local_dilated__prompt_kernel_f_u2
    s_getpc_b64 s[34:35]
interleave_layers__softmax_full_mha__sliding_local_dilated__prompt_kernel_f_pcu:
    s_sub_u32 s34, s34, interleave_layers__softmax_full_mha__sliding_local_dilated__prompt_kernel_f_pcu - interleave_layers__softmax_full_mha__sliding_local_dilated__prompt_kernel
    s_subb_u32 s35, s35, 0
    v_lshlrev_b32 v242, 4, v0
    s_lshl_b32 s36, s21, 12
    v_add_u32 v242, s36, v242
    v_and_b32 v242, 0xffffffc0, v242
    v_min_u32 v242, code_end - interleave_layers__softmax_full_mha__sliding_local_dilated__prompt_kernel - 4, v242
    global_load_dword v243, v242, s[34:35]
    s_cmp_eq_u32 s18, 0
    s_cbranch_scc0 interleave_layers__softmax_full_mha__sliding_local_dilated__prompt_kernel_f_u2
    v_mov_b32 v4, 0
    v_mov_b32 v5, 1
    s_lshl_b32 s26, s16, 2
    s_mov_b64 exec, 1
    buffer_store_dword v5, v4, s[52:55], s26 offen sc1
    s_mov_b64 exec, 0xffff
    v_lshlrev_b32 v4, 2, v1
    s_mov_b32 s33, 0
interleave_layers__softmax_full_mha__sliding_local_dilated__prompt_kernel_f_u1:
    buffer_load_dword v5, v4, s[52:55], 0 offen sc1
    s_add_u32 s33, s33, 1
    s_waitcnt vmcnt(0)
    v_cmp_eq_u32 vcc, 0, v5
    s_cmp_ge_u32 s33, 0x20000
    s_cbranch_scc1 interleave_layers__softmax_full_mha__sliding_local_dilated__prompt_kernel_f_u2
    s_cbranch_vccnz interleave_layers__softmax_full_mha__sliding_local_dilated__prompt_kernel_f_u1
interleave_layers__softmax_full_mha__sliding_local_dilated__prompt_kernel_f_u2:
    s_mov_b64 exec, -1
    s_waitcnt vmcnt(0)
interleave_layers__softmax_full_mha__sliding_local_dilated__prompt_kernel_t0:
    s_load_dwordx2 s[46:47], s[0:1], 48
    s_mov_b32 s3, 0
    s_mov_b32 s8, s6
    s_and_b32 s9, s7, 0xffff
    s_mov_b32 s10, 131072
    s_mov_b32 s11, 0x20000
    s_waitcnt lgkmcnt(0)
    s_mov_b32 s60, s46
    s_and_b32 s61, s47, 0xffff
    s_mov_b32 s62, 2621440
    s_mov_b32 s63, 0x20000
interleave_layers__softmax_full_mha__sliding_local_dilated__prompt_kernel_top:
    s_setprio 0
    s_lshl_b32 s22, s20, 2
    s_and_b32 s23, s21, 3
    s_add_u32 s16, s22, s23
    s_lshr_b32 s17, s21, 2
    v_and_b32 v3, 31, v1
    v_lshrrev_b32 v7, 5, v1
    v_lshlrev_b32 v22, 4, v1
    v_lshlrev_b32 v23, 3, v3
    s_mul_i32 s19, s16, 163840
    s_lshr_b32 s41, s18, 2
    s_lshl_b32 s23, s17, 3
    s_lshl_b32 s22, s39, 1
    s_add_u32 s23, s23, s22
    s_add_u32 s23, s23, s41
    s_lshr_b32 s22, s19, 1
    s_add_u32 s22, s22, 2883584
    s_mul_i32 s24, s23, 1280
    s_add_u32 s24, s24, s22
    s_xor_b32 s40, s23, 1
    s_mul_i32 s40, s40, 1280
    s_add_u32 s40, s40, s22
    s_mul_i32 s42, s41, 2560
    s_add_u32 s42, s42, 112640
    s_lshl_b32 s25, s18, 10
    s_add_u32 s26, s19, 5505024
    v_add_u32 v4, s42, v22
    v_add_u32 v5, s42, v23
    v_add_u32 v5, 1024, v5
    v_lshl_add_u32 v5, v7, 20, v5
    v_mul_u32_u24 v21, 20, v7
    v_add_u32 v21, v21, v3
    v_lshlrev_b32 v21, 4, v21
    v_add_u32 v21, 1280, v21
    v_add_u32 v6, s42, v21
    s_mov_b32 s28, 0x000fffff
    s_mov_b32 s29, 0x000fffff
    v_cmp_eq_u32 vcc, 20, v3
    v_mov_b32 v20, 0x3f803f80
    s_nop 0
    v_cndmask_b32 v20, 0, v20, vcc
    v_mov_b32 v40, v20
    v_mov_b32 v41, v20
    v_mov_b32 v42, v20
    v_mov_b32 v43, v20
    v_mov_b32 v44, v20
    v_mov_b32 v45, v20
    v_mov_b32 v46, v20
    v_mov_b32 v47, v20
    v_mov_b32 v48, v20
    v_mov_b32 v49, v20
    v_mov_b32 v50, v20
    v_mov_b32 v51, v20
    v_mov_b32 v52, v20
    v_mov_b32 v53, v20
    v_mov_b32 v54, v20
    v_mov_b32 v55, v20
    v_mov_b32 v96, 0
    v_mov_b32 v97, 0
    v_mov_b32 v98, 0
    v_mov_b32 v99, 0
    v_mov_b32 v100, 0
    v_mov_b32 v101, 0
    v_mov_b32 v102, 0
    v_mov_b32 v103, 0
    v_mov_b32 v104, 0
    v_mov_b32 v105, 0
    v_mov_b32 v106, 0
    v_mov_b32 v107, 0
    v_mov_b32 v108, 0
    v_mov_b32 v109, 0
    v_mov_b32 v110, 0
    v_mov_b32 v111, 0
    v_mov_b32 v112, 0
    v_mov_b32 v113, 0
    v_mov_b32 v114, 0
    v_mov_b32 v115, 0
    v_mov_b32 v116, 0
    v_mov_b32 v117, 0
    v_mov_b32 v118, 0
    v_mov_b32 v119, 0
    v_mov_b32 v120, 0
    v_mov_b32 v121, 0
    v_mov_b32 v122, 0
    v_mov_b32 v123, 0
    v_mov_b32 v124, 0
    v_mov_b32 v125, 0
    v_mov_b32 v126, 0
    v_mov_b32 v127, 0
    v_mov_b32 v92, 0
    v_mov_b32 v93, 0
    v_mov_b32 v94, 0
    v_mov_b32 v95, 0
    v_subrev_u32 v30, 1, v7
    s_lshl_b32 s43, s21, 2
    s_add_u32 s43, s43, s39
    s_mul_i32 s43, s43, 27648
    s_add_u32 s43, s43, 21397504
    s_mul_i32 s32, s23, 40960
    s_add_u32 s32, s32, 10747904
    s_lshr_b32 s51, s16, 1
    s_lshl_b32 s51, s51, 10
    s_and_b32 s34, s16, 1
    s_lshl_b32 s34, s34, 9
    s_add_u32 s51, s51, s34
    s_add_u32 s51, s51, s32
    s_lshr_b32 s52, s16, 3
    s_add_u32 s52, s52, 16
    s_lshl_b32 s52, s52, 10
    s_add_u32 s52, s52, s32
    s_and_b32 s35, s16, 3
    s_lshl_b32 s35, s35, 8
    s_add_u32 s52, s52, s35
    s_bfe_u32 s35, s16, 0x10002
    s_lshl_b32 s35, s35, 3
    s_add_u32 s52, s52, s35
    v_lshrrev_b32 v38, 4, v3
    v_mul_u32_u24 v38, 20480, v38
    v_and_b32 v39, 15, v3
    v_lshl_add_u32 v38, v39, 4, v38
    v_lshl_add_u32 v39, v7, 8, v38
    s_mul_i32 s32, s18, 3072
    s_xor_b32 s33, s18, 4
    s_mul_i32 s33, s33, 3072
    v_add_u32 v132, 137216, v22
    v_add_u32 v133, s33, v132
    v_add_u32 v132, s32, v132
    s_load_dwordx4 s[84:87], s[0:1], 32
    s_load_dwordx2 s[88:89], s[0:1], 16
    s_mul_i32 s49, s2, 3
    s_add_u32 s49, s49, s18
    s_sub_u32 s49, s49, 4
    s_sub_u32 s32, s18, 4
    s_cmp_lt_u32 s32, 3
    s_cselect_b32 s49, s49, 959
    s_cmp_eq_u32 s3, 0
    s_cselect_b32 s49, s49, 959
    s_lshl_b32 s35, s39, 13
    s_add_u32 s35, s35, 112640
    s_mul_i32 s36, s49, 3277
    s_lshr_b32 s36, s36, 16
    s_mul_i32 s37, s36, 20
    s_sub_u32 s37, s49, s37
    v_and_b32 v140, 15, v1
    v_lshrrev_b32 v141, 2, v140
    v_and_b32 v142, 3, v1
    s_waitcnt lgkmcnt(0)
    v_lshrrev_b32 v136, 4, v1
    v_mov_b32 v152, 0
    v_mov_b32 v153, 0
    v_mov_b32 v154, 0
    v_mov_b32 v155, 0
    v_mov_b32 v156, 0
    v_mov_b32 v144, 0
    v_mov_b32 v145, 0
    v_mov_b32 v146, 0
    v_mov_b32 v147, 0
    v_mov_b32 v148, 0
    v_mov_b32 v149, 0
    v_mov_b32 v150, 0
    v_mov_b32 v151, 0
    s_mov_b32 s5, 0
    s_mov_b32 s53, 0x7ff00000
    s_mov_b32 s54, s53
    s_mov_b32 s58, s53
    s_cmp_ge_u32 s49, 320
    s_cbranch_scc1 interleave_layers__softmax_full_mha__sliding_local_dilated__prompt_kernel_ss1
    s_mov_b32 s88, s84
    s_and_b32 s89, s85, 0xffff
    s_mov_b32 s90, 2457600
    s_mov_b32 s91, 0x20000
    s_mul_i32 s5, s37, 122880
    s_mul_i32 s32, s36, 80
    s_add_u32 s5, s5, s32
    v_lshlrev_b32 v137, 2, v136
    v_xor_b32 v137, v137, v140
    v_min_u32 v137, 14, v137
    v_mul_u32_u24 v138, 52, v137
    v_lshrrev_b32 v138, 8, v138
    v_mul_u32_u24 v138, 1200, v138
    v_lshl_add_u32 v138, v137, 4, v138
    v_mul_u32_u24 v137, 3840, v136
    v_add_u32 v152, v138, v137
    v_lshrrev_b32 v137, 5, v1
    v_lshl_add_u32 v137, v137, 3, v141
    v_lshlrev_b32 v137, 8, v137
    v_and_b32 v138, 1, v136
    v_lshl_add_u32 v137, v138, 5, v137
    v_lshl_add_u32 v137, v142, 3, v137
    v_add_u32 v137, s35, v137
    v_xor_b32 v139, 0, v141
    v_lshl_add_u32 v144, v139, 6, v137
    v_xor_b32 v139, 1, v141
    v_lshl_add_u32 v145, v139, 6, v137
    v_xor_b32 v139, 2, v141
    v_lshl_add_u32 v146, v139, 6, v137
    v_xor_b32 v139, 3, v141
    v_lshl_add_u32 v147, v139, 6, v137
    s_mul_i32 s53, s36, 163840
    s_lshl_b32 s54, s37, 13
    s_add_u32 s53, s53, s54
    s_add_u32 s53, s53, 22216704
    s_add_u32 s54, s53, 4096
    s_mov_b32 s58, s54
    s_branch interleave_layers__softmax_full_mha__sliding_local_dilated__prompt_kernel_ss2
interleave_layers__softmax_full_mha__sliding_local_dilated__prompt_kernel_ss1:
    s_cmp_ge_u32 s36, 24
    s_cselect_b32 s32, s86, s88
    s_cselect_b32 s33, s87, s89
    s_mov_b32 s88, s32
    s_and_b32 s89, s33, 0xffff
    s_mov_b32 s90, 819200
    s_mov_b32 s91, 0x20000
    s_cmp_ge_u32 s49, 640
    s_cbranch_scc1 interleave_layers__softmax_full_mha__sliding_local_dilated__prompt_kernel_ss2
    s_and_b32 s32, s36, 7
    s_mul_i32 s32, s32, 160
    s_mul_i32 s5, s37, 40
    s_sub_u32 s34, s37, 16
    s_mul_i32 s34, s34, 160
    s_add_u32 s34, s34, 16
    s_cmp_lt_u32 s37, 16
    s_cselect_b32 s5, s5, s34
    s_cselect_b32 s33, 4, 2
    s_cselect_b32 s34, 4, 16
    s_mul_i32 s5, s5, 1280
    s_add_u32 s5, s5, s32
    v_add_u32 v137, 0, v1
    v_mul_u32_u24 v138, 6554, v137
    v_lshrrev_b32 v138, 16, v138
    v_lshrrev_b32 v139, s33, v138
    v_mul_u32_u24 v139, s34, v139
    v_mul_u32_u24 v139, 1280, v139
    v_mul_u32_u24 v138, 1120, v138
    v_add_u32 v139, v139, v138
    v_lshl_add_u32 v152, v137, 4, v139
    v_add_u32 v137, 64, v1
    v_mul_u32_u24 v138, 6554, v137
    v_lshrrev_b32 v138, 16, v138
    v_lshrrev_b32 v139, s33, v138
    v_mul_u32_u24 v139, s34, v139
    v_mul_u32_u24 v139, 1280, v139
    v_mul_u32_u24 v138, 1120, v138
    v_add_u32 v139, v139, v138
    v_lshl_add_u32 v153, v137, 4, v139
    v_add_u32 v137, 128, v1
    v_mul_u32_u24 v138, 6554, v137
    v_lshrrev_b32 v138, 16, v138
    v_lshrrev_b32 v139, s33, v138
    v_mul_u32_u24 v139, s34, v139
    v_mul_u32_u24 v139, 1280, v139
    v_mul_u32_u24 v138, 1120, v138
    v_add_u32 v139, v139, v138
    v_lshl_add_u32 v154, v137, 4, v139
    v_add_u32 v137, 192, v1
    v_mul_u32_u24 v138, 6554, v137
    v_lshrrev_b32 v138, 16, v138
    v_lshrrev_b32 v139, s33, v138
    v_mul_u32_u24 v139, s34, v139
    v_mul_u32_u24 v139, 1280, v139
    v_mul_u32_u24 v138, 1120, v138
    v_add_u32 v139, v139, v138
    v_lshl_add_u32 v155, v137, 4, v139
    v_add_u32 v137, 256, v1
    v_mul_u32_u24 v138, 6554, v137
    v_lshrrev_b32 v138, 16, v138
    v_lshrrev_b32 v139, s33, v138
    v_mul_u32_u24 v139, s34, v139
    v_mul_u32_u24 v139, 1280, v139
    v_mul_u32_u24 v138, 1120, v138
    v_add_u32 v139, v139, v138
    v_lshl_add_u32 v156, v137, 4, v139
    v_lshlrev_b32 v137, 2, v136
    s_mov_b32 s32, 2560
    s_cmp_ge_u32 s36, 24
    s_cbranch_scc1 interleave_layers__softmax_full_mha__sliding_local_dilated__prompt_kernel_sf3
    s_cmp_ge_u32 s37, 16
    s_cbranch_scc1 interleave_layers__softmax_full_mha__sliding_local_dilated__prompt_kernel_sf3
    v_lshrrev_b32 v137, 1, v136
    v_lshlrev_b32 v137, 4, v137
    v_and_b32 v138, 1, v136
    v_lshl_add_u32 v137, v138, 2, v137
    s_mov_b32 s32, 1280
interleave_layers__softmax_full_mha__sliding_local_dilated__prompt_kernel_sf3:
    v_add_u32 v137, v137, v141
    v_mul_u32_u24 v137, 160, v137
    v_add_u32 v137, s35, v137
    s_and_b32 s33, s36, 1
    s_lshl_b32 s34, s33, 5
    s_xor_b32 s33, s33, 1
    s_lshl_b32 s33, s33, 7
    v_lshl_add_u32 v144, v142, 4, v137
    v_add_u32 v144, s34, v144
    v_add_u32 v145, s32, v144
    v_lshl_add_u32 v146, v142, 3, v137
    v_add_u32 v146, s33, v146
    v_add_u32 v147, s32, v146
    s_cmp_ge_u32 s36, 24
    s_cselect_b32 s53, 3440640, 0
    s_and_b32 s54, s36, 7
    s_mul_i32 s54, s54, 102400
    s_add_u32 s53, s53, s54
    s_mul_i32 s54, s37, 5120
    s_add_u32 s53, s53, s54
    s_add_u32 s53, s53, 21397504
    s_add_u32 s54, s53, 4096
interleave_layers__softmax_full_mha__sliding_local_dilated__prompt_kernel_ss2:
    s_lshl_b32 s38, s49, 9
    s_add_u32 s38, s38, 18776064
    s_cmp_ge_u32 s49, 320
    s_cselect_b32 s38, 0x7ff00000, s38
    v_lshlrev_b32 v143, 2, v1
    s_cmp_lt_u32 s49, 640
    s_cselect_b32 s4, 2, 0
    s_cmp_lt_u32 s49, 320
    s_cselect_b32 s4, 1, s4
    s_and_b32 s55, s49, 15
    s_lshl_b32 s55, s55, 8
    s_add_u32 s55, s55, 94720
    s_lshl_b32 s59, s2, 2
    s_add_u32 s59, s59, s39
    s_mul_i32 s50, s17, 102400
    s_add_u32 s50, s50, s25
    s_add_u32 s50, s50, 21397504
    s_mul_i32 s59, s59, 7808
    s_add_u32 s59, s59, 10747904
    v_lshlrev_b32 v234, 7, v1
    v_lshlrev_b32 v134, 11, v1
    s_lshl_b32 s32, s17, 8
    s_add_u32 s32, s32, 33280
    v_add_u32 v134, s32, v134
    v_lshlrev_b32 v135, 8, v1
    v_add_u32 v135, 90624, v135
    v_cmp_gt_u32 vcc, 16, v1
    s_nop 1
    v_cndmask_b32 v134, v135, v134, vcc
    v_cndmask_b32 v131, 40, 16, vcc
    v_mov_b32 v135, 64
    v_mov_b32 v243, 163816
    s_mov_b32 s49, 0
    s_cmp_eq_u32 s18, 0
    s_cbranch_scc0 interleave_layers__softmax_full_mha__sliding_local_dilated__prompt_kernel_t_sp
    s_lshl_b32 s48, s17, 8
    s_add_u32 s48, s48, 33280
    v_mov_b32 v242, 16
    s_mul_i32 s32, s16, 20
    s_add_u32 s33, s32, 19
    s_lshr_b32 s32, s32, 7
    s_lshr_b32 s33, s33, 7
    s_sub_u32 s33, s33, s32
    v_lshrrev_b32 v241, 1, v1
    v_mul_u32_u24 v241, 5, v241
    v_and_b32 v240, s33, v1
    v_add3_u32 v241, v241, v240, s32
    v_lshlrev_b32 v241, 11, v241
    s_mov_b64 s[56:57], 63
    s_mov_b64 exec, s[56:57]
interleave_layers__softmax_full_mha__sliding_local_dilated__prompt_kernel_t_pl:
    v_mov_b32 v240, 0
    buffer_atomic_add v240, v241, s[8:11], s48 offen sc0 sc1
    s_add_u32 s49, s49, 1
    s_waitcnt vmcnt(0)
    v_cmp_ge_u32 vcc, v240, v242
    s_cmp_ge_u32 s49, 0x20000
    s_cbranch_scc1 interleave_layers__softmax_full_mha__sliding_local_dilated__prompt_kernel_t_px
    s_cmp_eq_u64 vcc, exec
    s_cbranch_scc0 interleave_layers__softmax_full_mha__sliding_local_dilated__prompt_kernel_t_pl
interleave_layers__softmax_full_mha__sliding_local_dilated__prompt_kernel_t_px:
    s_mov_b64 exec, 1
    v_mov_b32 v240, 1
    ds_write_b32 v243, v240 offset:4
    s_branch interleave_layers__softmax_full_mha__sliding_local_dilated__prompt_kernel_t_go
interleave_layers__softmax_full_mha__sliding_local_dilated__prompt_kernel_t_sp:
    s_sleep 1
    ds_read_b32 v240, v243 offset:4
    s_add_u32 s49, s49, 1
    s_waitcnt lgkmcnt(0)
    v_readfirstlane_b32 s44, v240
    s_cmp_ge_u32 s49, 0x400000
    s_cbranch_scc1 interleave_layers__softmax_full_mha__sliding_local_dilated__prompt_kernel_t_go
    s_cmp_eq_u32 s44, 0
    s_cbranch_scc1 interleave_layers__softmax_full_mha__sliding_local_dilated__prompt_kernel_t_sp
interleave_layers__softmax_full_mha__sliding_local_dilated__prompt_kernel_t_go:
    s_mov_b64 exec, -1
    s_or_b32 s44, s3, s41
    s_xor_b32 s44, s44, 1
    s_add_u32 m0, s25, 112640
    s_add_u32 s27, s26, m0
    buffer_load_dwordx4 v22, s[12:15], s27 offen sc1 lds
    s_add_u32 m0, s25, 120832
    s_add_u32 s27, s26, m0
    buffer_load_dwordx4 v22, s[12:15], s27 offen sc1 lds
    buffer_load_dwordx4 v[8:11], v22, s[12:15], s24 offen sc1
    buffer_load_dwordx2 v[12:13], v23, s[12:15], s24 offen offset:1024 sc1
    buffer_load_dwordx4 v[14:17], v22, s[12:15], s40 offen sc1
    buffer_load_dwordx2 v[18:19], v23, s[12:15], s40 offen offset:1024 sc1
    s_waitcnt vmcnt(4)
    s_barrier
    ds_read_b128 v[24:27], v4 offset:0
    ds_read_b64 v[28:29], v5 offset:0
    s_mov_b64 exec, s[28:29]
    ds_read_b128 v[40:43], v6 offset:0
    ds_read_b128 v[44:47], v6 offset:640
    s_mov_b64 exec, -1
    ds_read_b128 v[32:35], v4 offset:5120
    ds_read_b64 v[36:37], v5 offset:5120
    s_add_u32 m0, s25, 129024
    s_add_u32 s27, s26, m0
    buffer_load_dwordx4 v22, s[12:15], s27 offen sc1 lds
    s_add_u32 m0, s25, 137216
    s_add_u32 s27, s26, m0
    buffer_load_dwordx4 v22, s[12:15], s27 offen sc1 lds
    s_waitcnt vmcnt(4)
    v_and_b32 v12, v12, v30
    v_and_b32 v13, v13, v30
    s_waitcnt lgkmcnt(4)
    v_mfma_f32_32x32x16_bf16 v[56:71], v[24:27], v[8:11], 0
    s_nop 10
    v_mfma_f32_32x32x8_bf16 v[56:71], v[28:29], v[12:13], v[56:71]
    s_waitcnt vmcnt(2)
    v_and_b32 v18, v18, v30
    v_and_b32 v19, v19, v30
    s_nop 7
    v_mfma_f32_32x32x16_bf16 v[72:87], v[24:27], v[14:17], 0
    v_exp_f32 v56, v56
    v_exp_f32 v57, v57
    v_exp_f32 v58, v58
    v_exp_f32 v59, v59
    v_mfma_f32_32x32x16_bf16 v[112:127], v[52:55], v[92:95], v[112:127]
    s_mov_b64 exec, s[28:29]
    ds_read_b128 v[48:51], v6 offset:5120
    ds_read_b128 v[52:55], v6 offset:5760
    s_mov_b64 exec, -1
    s_add_u32 m0, s25, 145408
    s_add_u32 s27, s26, m0
    buffer_load_dwordx4 v22, s[12:15], s27 offen sc1 lds
    s_add_u32 m0, s25, 153600
    s_add_u32 s27, s26, m0
    buffer_load_dwordx4 v22, s[12:15], s27 offen sc1 lds
    v_exp_f32 v60, v60
    v_exp_f32 v61, v61
    v_exp_f32 v62, v62
    v_exp_f32 v63, v63
    v_cvt_pk_bf16_f32 v88, v56, v57
    v_cvt_pk_bf16_f32 v89, v58, v59
    v_cvt_pk_bf16_f32 v90, v60, v61
    v_cvt_pk_bf16_f32 v91, v62, v63
    v_mfma_f32_32x32x8_bf16 v[72:87], v[28:29], v[18:19], v[72:87]
    v_exp_f32 v64, v64
    v_exp_f32 v65, v65
    v_exp_f32 v66, v66
    v_exp_f32 v67, v67
    s_waitcnt lgkmcnt(4)
    v_mfma_f32_32x32x16_bf16 v[96:111], v[40:43], v[88:91], v[96:111]
    v_exp_f32 v68, v68
    v_exp_f32 v69, v69
    v_exp_f32 v70, v70
    v_exp_f32 v71, v71
    v_cvt_pk_bf16_f32 v92, v64, v65
    v_cvt_pk_bf16_f32 v93, v66, v67
    v_cvt_pk_bf16_f32 v94, v68, v69
    v_cvt_pk_bf16_f32 v95, v70, v71
    s_waitcnt lgkmcnt(2)
    v_mfma_f32_32x32x16_bf16 v[56:71], v[32:35], v[8:11], 0
    ds_read_b128 v[24:27], v4 offset:10240
    ds_read_b64 v[28:29], v5 offset:10240
    v_exp_f32 v72, v72
    v_exp_f32 v73, v73
    v_exp_f32 v74, v74
    v_exp_f32 v75, v75
    v_mfma_f32_32x32x16_bf16 v[96:111], v[44:47], v[92:95], v[96:111]
    s_cmp_lt_u32 s18, 2
    s_cselect_b32 s27, 163840, 0
    s_add_u32 s27, s27, s25
    s_sub_u32 m0, s27, 2048
    s_add_u32 s27, s26, m0
    buffer_load_dwordx4 v22, s[12:15], s27 offen sc1 lds
    s_add_u32 m0, s25, 6144
    s_add_u32 s27, s26, m0
    buffer_load_dwordx4 v22, s[12:15], s27 offen sc1 lds
    v_exp_f32 v76, v76
    v_exp_f32 v77, v77
    v_exp_f32 v78, v78
    v_exp_f32 v79, v79
    v_cvt_pk_bf16_f32 v88, v72, v73
    v_cvt_pk_bf16_f32 v89, v74, v75
    v_cvt_pk_bf16_f32 v90, v76, v77
    v_cvt_pk_bf16_f32 v91, v78, v79
    v_mfma_f32_32x32x8_bf16 v[56:71], v[36:37], v[12:13], v[56:71]
    v_exp_f32 v80, v80
    v_exp_f32 v81, v81
    v_exp_f32 v82, v82
    v_exp_f32 v83, v83
    v_mfma_f32_32x32x16_bf16 v[112:127], v[40:43], v[88:91], v[112:127]
    v_exp_f32 v84, v84
    v_exp_f32 v85, v85
    v_exp_f32 v86, v86
    v_exp_f32 v87, v87
    v_cvt_pk_bf16_f32 v92, v80, v81
    v_cvt_pk_bf16_f32 v93, v82, v83
    v_cvt_pk_bf16_f32 v94, v84, v85
    v_cvt_pk_bf16_f32 v95, v86, v87
    s_waitcnt vmcnt(4)
    s_barrier
    s_cmp_ge_u32 s18, 4
    s_cbranch_scc0 interleave_layers__softmax_full_mha__sliding_local_dilated__prompt_kernel_hk1
    s_setprio 1
interleave_layers__softmax_full_mha__sliding_local_dilated__prompt_kernel_hk1:
    v_mfma_f32_32x32x16_bf16 v[72:87], v[32:35], v[14:17], 0
    v_exp_f32 v56, v56
    v_exp_f32 v57, v57
    v_exp_f32 v58, v58
    v_exp_f32 v59, v59
    v_mfma_f32_32x32x16_bf16 v[112:127], v[44:47], v[92:95], v[112:127]
    s_mov_b64 exec, s[28:29]
    ds_read_b128 v[40:43], v6 offset:10240
    ds_read_b128 v[44:47], v6 offset:10880
    s_mov_b64 exec, -1
    s_add_u32 m0, s25, 14336
    s_add_u32 s27, s26, m0
    buffer_load_dwordx4 v22, s[12:15], s27 offen sc1 lds
    s_add_u32 m0, s25, 22528
    s_add_u32 s27, s26, m0
    buffer_load_dwordx4 v22, s[12:15], s27 offen sc1 lds
    v_exp_f32 v60, v60
    v_exp_f32 v61, v61
    v_exp_f32 v62, v62
    v_exp_f32 v63, v63
    v_cvt_pk_bf16_f32 v88, v56, v57
    v_cvt_pk_bf16_f32 v89, v58, v59
    v_cvt_pk_bf16_f32 v90, v60, v61
    v_cvt_pk_bf16_f32 v91, v62, v63
    v_mfma_f32_32x32x8_bf16 v[72:87], v[36:37], v[18:19], v[72:87]
    v_exp_f32 v64, v64
    v_exp_f32 v65, v65
    v_exp_f32 v66, v66
    v_exp_f32 v67, v67
    s_waitcnt lgkmcnt(4)
    v_mfma_f32_32x32x16_bf16 v[96:111], v[48:51], v[88:91], v[96:111]
    v_exp_f32 v68, v68
    v_exp_f32 v69, v69
    v_exp_f32 v70, v70
    v_exp_f32 v71, v71
    v_cvt_pk_bf16_f32 v92, v64, v65
    v_cvt_pk_bf16_f32 v93, v66, v67
    v_cvt_pk_bf16_f32 v94, v68, v69
    v_cvt_pk_bf16_f32 v95, v70, v71
    s_waitcnt lgkmcnt(2)
    v_mfma_f32_32x32x16_bf16 v[56:71], v[24:27], v[8:11], 0
    ds_read_b128 v[32:35], v4 offset:15360
    ds_read_b64 v[36:37], v5 offset:15360
    v_exp_f32 v72, v72
    v_exp_f32 v73, v73
    v_exp_f32 v74, v74
    v_exp_f32 v75, v75
    v_mfma_f32_32x32x16_bf16 v[96:111], v[52:55], v[92:95], v[96:111]
    s_add_u32 m0, s25, 30720
    s_add_u32 s27, s26, m0
    buffer_load_dwordx4 v22, s[12:15], s27 offen sc1 lds
    s_add_u32 m0, s25, 38912
    s_add_u32 s27, s26, m0
    buffer_load_dwordx4 v22, s[12:15], s27 offen sc1 lds
    v_exp_f32 v76, v76
    v_exp_f32 v77, v77
    v_exp_f32 v78, v78
    v_exp_f32 v79, v79
    v_cvt_pk_bf16_f32 v88, v72, v73
    v_cvt_pk_bf16_f32 v89, v74, v75
    v_cvt_pk_bf16_f32 v90, v76, v77
    v_cvt_pk_bf16_f32 v91, v78, v79
    v_mfma_f32_32x32x8_bf16 v[56:71], v[28:29], v[12:13], v[56:71]
    v_exp_f32 v80, v80
    v_exp_f32 v81, v81
    v_exp_f32 v82, v82
    v_exp_f32 v83, v83
    v_mfma_f32_32x32x16_bf16 v[112:127], v[48:51], v[88:91], v[112:127]
    v_exp_f32 v84, v84
    v_exp_f32 v85, v85
    v_exp_f32 v86, v86
    v_exp_f32 v87, v87
    v_cvt_pk_bf16_f32 v92, v80, v81
    v_cvt_pk_bf16_f32 v93, v82, v83
    v_cvt_pk_bf16_f32 v94, v84, v85
    v_cvt_pk_bf16_f32 v95, v86, v87
    v_mfma_f32_32x32x16_bf16 v[72:87], v[24:27], v[14:17], 0
    v_exp_f32 v56, v56
    v_exp_f32 v57, v57
    v_exp_f32 v58, v58
    v_exp_f32 v59, v59
    v_mfma_f32_32x32x16_bf16 v[112:127], v[52:55], v[92:95], v[112:127]
    s_mov_b64 exec, s[28:29]
    ds_read_b128 v[48:51], v6 offset:15360
    ds_read_b128 v[52:55], v6 offset:16000
    s_mov_b64 exec, -1
    s_add_u32 m0, s25, 47104
    s_add_u32 s27, s26, m0
    buffer_load_dwordx4 v22, s[12:15], s27 offen sc1 lds
    s_add_u32 m0, s25, 55296
    s_add_u32 s27, s26, m0
    buffer_load_dwordx4 v22, s[12:15], s27 offen sc1 lds
    v_exp_f32 v60, v60
    v_exp_f32 v61, v61
    v_exp_f32 v62, v62
    v_exp_f32 v63, v63
    v_cvt_pk_bf16_f32 v88, v56, v57
    v_cvt_pk_bf16_f32 v89, v58, v59
    v_cvt_pk_bf16_f32 v90, v60, v61
    v_cvt_pk_bf16_f32 v91, v62, v63
    v_mfma_f32_32x32x8_bf16 v[72:87], v[28:29], v[18:19], v[72:87]
    v_exp_f32 v64, v64
    v_exp_f32 v65, v65
    v_exp_f32 v66, v66
    v_exp_f32 v67, v67
    s_waitcnt lgkmcnt(4)
    v_mfma_f32_32x32x16_bf16 v[96:111], v[40:43], v[88:91], v[96:111]
    v_exp_f32 v68, v68
    v_exp_f32 v69, v69
    v_exp_f32 v70, v70
    v_exp_f32 v71, v71
    v_cvt_pk_bf16_f32 v92, v64, v65
    v_cvt_pk_bf16_f32 v93, v66, v67
    v_cvt_pk_bf16_f32 v94, v68, v69
    v_cvt_pk_bf16_f32 v95, v70, v71
    s_waitcnt lgkmcnt(2)
    v_mfma_f32_32x32x16_bf16 v[56:71], v[32:35], v[8:11], 0
    ds_read_b128 v[24:27], v4 offset:20480
    ds_read_b64 v[28:29], v5 offset:20480
    v_exp_f32 v72, v72
    v_exp_f32 v73, v73
    v_exp_f32 v74, v74
    v_exp_f32 v75, v75
    v_mfma_f32_32x32x16_bf16 v[96:111], v[44:47], v[92:95], v[96:111]
    s_add_u32 m0, s25, 63488
    s_add_u32 s27, s26, m0
    buffer_load_dwordx4 v22, s[12:15], s27 offen sc1 lds
    s_add_u32 m0, s25, 71680
    s_add_u32 s27, s26, m0
    buffer_load_dwordx4 v22, s[12:15], s27 offen sc1 lds
    v_exp_f32 v76, v76
    v_exp_f32 v77, v77
    v_exp_f32 v78, v78
    v_exp_f32 v79, v79
    v_cvt_pk_bf16_f32 v88, v72, v73
    v_cvt_pk_bf16_f32 v89, v74, v75
    v_cvt_pk_bf16_f32 v90, v76, v77
    v_cvt_pk_bf16_f32 v91, v78, v79
    v_mfma_f32_32x32x8_bf16 v[56:71], v[36:37], v[12:13], v[56:71]
    v_exp_f32 v80, v80
    v_exp_f32 v81, v81
    v_exp_f32 v82, v82
    v_exp_f32 v83, v83
    v_mfma_f32_32x32x16_bf16 v[112:127], v[40:43], v[88:91], v[112:127]
    v_exp_f32 v84, v84
    v_exp_f32 v85, v85
    v_exp_f32 v86, v86
    v_exp_f32 v87, v87
    v_cvt_pk_bf16_f32 v92, v80, v81
    v_cvt_pk_bf16_f32 v93, v82, v83
    v_cvt_pk_bf16_f32 v94, v84, v85
    v_cvt_pk_bf16_f32 v95, v86, v87
    v_mfma_f32_32x32x16_bf16 v[72:87], v[32:35], v[14:17], 0
    v_exp_f32 v56, v56
    v_exp_f32 v57, v57
    v_exp_f32 v58, v58
    v_exp_f32 v59, v59
    v_mfma_f32_32x32x16_bf16 v[112:127], v[44:47], v[92:95], v[112:127]
    s_mov_b64 exec, s[28:29]
    ds_read_b128 v[40:43], v6 offset:20480
    ds_read_b128 v[44:47], v6 offset:21120
    s_mov_b64 exec, -1
    s_add_u32 m0, s25, 79872
    s_add_u32 s27, s26, m0
    buffer_load_dwordx4 v22, s[12:15], s27 offen sc1 lds
    s_add_u32 m0, s25, 88064
    s_add_u32 s27, s26, m0
    buffer_load_dwordx4 v22, s[12:15], s27 offen sc1 lds
    s_setprio 0
    v_exp_f32 v60, v60
    v_exp_f32 v61, v61
    v_exp_f32 v62, v62
    v_exp_f32 v63, v63
    v_cvt_pk_bf16_f32 v88, v56, v57
    v_cvt_pk_bf16_f32 v89, v58, v59
    v_cvt_pk_bf16_f32 v90, v60, v61
    v_cvt_pk_bf16_f32 v91, v62, v63
    v_mfma_f32_32x32x8_bf16 v[72:87], v[36:37], v[18:19], v[72:87]
    v_exp_f32 v64, v64
    v_exp_f32 v65, v65
    v_exp_f32 v66, v66
    v_exp_f32 v67, v67
    s_waitcnt lgkmcnt(4)
    v_mfma_f32_32x32x16_bf16 v[96:111], v[48:51], v[88:91], v[96:111]
    v_exp_f32 v68, v68
    v_exp_f32 v69, v69
    v_exp_f32 v70, v70
    v_exp_f32 v71, v71
    v_cvt_pk_bf16_f32 v92, v64, v65
    v_cvt_pk_bf16_f32 v93, v66, v67
    v_cvt_pk_bf16_f32 v94, v68, v69
    v_cvt_pk_bf16_f32 v95, v70, v71
    s_waitcnt lgkmcnt(2)
    v_mfma_f32_32x32x16_bf16 v[56:71], v[24:27], v[8:11], 0
    ds_read_b128 v[32:35], v4 offset:25600
    ds_read_b64 v[36:37], v5 offset:25600
    v_exp_f32 v72, v72
    v_exp_f32 v73, v73
    v_exp_f32 v74, v74
    v_exp_f32 v75, v75
    v_mfma_f32_32x32x16_bf16 v[96:111], v[52:55], v[92:95], v[96:111]
    s_add_u32 m0, s25, 96256
    s_add_u32 s27, s26, m0
    buffer_load_dwordx4 v22, s[12:15], s27 offen sc1 lds
    s_add_u32 m0, s25, 104448
    s_add_u32 s27, s26, m0
    buffer_load_dwordx4 v22, s[12:15], s27 offen sc1 lds
    v_exp_f32 v76, v76
    v_exp_f32 v77, v77
    v_exp_f32 v78, v78
    v_exp_f32 v79, v79
    v_cvt_pk_bf16_f32 v88, v72, v73
    v_cvt_pk_bf16_f32 v89, v74, v75
    v_cvt_pk_bf16_f32 v90, v76, v77
    v_cvt_pk_bf16_f32 v91, v78, v79
    v_mfma_f32_32x32x8_bf16 v[56:71], v[28:29], v[12:13], v[56:71]
    v_exp_f32 v80, v80
    v_exp_f32 v81, v81
    v_exp_f32 v82, v82
    v_exp_f32 v83, v83
    v_mfma_f32_32x32x16_bf16 v[112:127], v[48:51], v[88:91], v[112:127]
    v_exp_f32 v84, v84
    v_exp_f32 v85, v85
    v_exp_f32 v86, v86
    v_exp_f32 v87, v87
    v_cvt_pk_bf16_f32 v92, v80, v81
    v_cvt_pk_bf16_f32 v93, v82, v83
    v_cvt_pk_bf16_f32 v94, v84, v85
    v_cvt_pk_bf16_f32 v95, v86, v87
    s_waitcnt vmcnt(12)
    s_barrier
    s_cmp_ge_u32 s18, 4
    s_cbranch_scc0 interleave_layers__softmax_full_mha__sliding_local_dilated__prompt_kernel_hk2
    s_setprio 1
interleave_layers__softmax_full_mha__sliding_local_dilated__prompt_kernel_hk2:
    v_mfma_f32_32x32x16_bf16 v[72:87], v[24:27], v[14:17], 0
    v_exp_f32 v56, v56
    v_exp_f32 v57, v57
    v_exp_f32 v58, v58
    v_exp_f32 v59, v59
    v_mfma_f32_32x32x16_bf16 v[112:127], v[52:55], v[92:95], v[112:127]
    s_mov_b64 exec, s[28:29]
    ds_read_b128 v[48:51], v6 offset:25600
    ds_read_b128 v[52:55], v6 offset:26240
    s_mov_b64 exec, -1
    v_exp_f32 v60, v60
    v_exp_f32 v61, v61
    v_exp_f32 v62, v62
    v_exp_f32 v63, v63
    v_cvt_pk_bf16_f32 v88, v56, v57
    v_cvt_pk_bf16_f32 v89, v58, v59
    v_cvt_pk_bf16_f32 v90, v60, v61
    v_cvt_pk_bf16_f32 v91, v62, v63
    v_mfma_f32_32x32x8_bf16 v[72:87], v[28:29], v[18:19], v[72:87]
    v_exp_f32 v64, v64
    v_exp_f32 v65, v65
    v_exp_f32 v66, v66
    v_exp_f32 v67, v67
    s_waitcnt lgkmcnt(4)
    v_mfma_f32_32x32x16_bf16 v[96:111], v[40:43], v[88:91], v[96:111]
    v_exp_f32 v68, v68
    v_exp_f32 v69, v69
    v_exp_f32 v70, v70
    v_exp_f32 v71, v71
    v_cvt_pk_bf16_f32 v92, v64, v65
    v_cvt_pk_bf16_f32 v93, v66, v67
    v_cvt_pk_bf16_f32 v94, v68, v69
    v_cvt_pk_bf16_f32 v95, v70, v71
    s_waitcnt lgkmcnt(2)
    v_mfma_f32_32x32x16_bf16 v[56:71], v[32:35], v[8:11], 0
    ds_read_b128 v[24:27], v4 offset:30720
    ds_read_b64 v[28:29], v5 offset:30720
    v_exp_f32 v72, v72
    v_exp_f32 v73, v73
    v_exp_f32 v74, v74
    v_exp_f32 v75, v75
    v_mfma_f32_32x32x16_bf16 v[96:111], v[44:47], v[92:95], v[96:111]
    v_exp_f32 v76, v76
    v_exp_f32 v77, v77
    v_exp_f32 v78, v78
    v_exp_f32 v79, v79
    v_cvt_pk_bf16_f32 v88, v72, v73
    v_cvt_pk_bf16_f32 v89, v74, v75
    v_cvt_pk_bf16_f32 v90, v76, v77
    v_cvt_pk_bf16_f32 v91, v78, v79
    v_mfma_f32_32x32x8_bf16 v[56:71], v[36:37], v[12:13], v[56:71]
    v_exp_f32 v80, v80
    v_exp_f32 v81, v81
    v_exp_f32 v82, v82
    v_exp_f32 v83, v83
    v_mfma_f32_32x32x16_bf16 v[112:127], v[40:43], v[88:91], v[112:127]
    v_exp_f32 v84, v84
    v_exp_f32 v85, v85
    v_exp_f32 v86, v86
    v_exp_f32 v87, v87
    v_cvt_pk_bf16_f32 v92, v80, v81
    v_cvt_pk_bf16_f32 v93, v82, v83
    v_cvt_pk_bf16_f32 v94, v84, v85
    v_cvt_pk_bf16_f32 v95, v86, v87
    v_mfma_f32_32x32x16_bf16 v[72:87], v[32:35], v[14:17], 0
    v_exp_f32 v56, v56
    v_exp_f32 v57, v57
    v_exp_f32 v58, v58
    v_exp_f32 v59, v59
    v_mfma_f32_32x32x16_bf16 v[112:127], v[44:47], v[92:95], v[112:127]
    s_mov_b64 exec, s[28:29]
    ds_read_b128 v[40:43], v6 offset:30720
    ds_read_b128 v[44:47], v6 offset:31360
    s_mov_b64 exec, -1
    v_exp_f32 v60, v60
    v_exp_f32 v61, v61
    v_exp_f32 v62, v62
    v_exp_f32 v63, v63
    v_cvt_pk_bf16_f32 v88, v56, v57
    v_cvt_pk_bf16_f32 v89, v58, v59
    v_cvt_pk_bf16_f32 v90, v60, v61
    v_cvt_pk_bf16_f32 v91, v62, v63
    v_mfma_f32_32x32x8_bf16 v[72:87], v[36:37], v[18:19], v[72:87]
    v_exp_f32 v64, v64
    v_exp_f32 v65, v65
    v_exp_f32 v66, v66
    v_exp_f32 v67, v67
    s_waitcnt lgkmcnt(4)
    v_mfma_f32_32x32x16_bf16 v[96:111], v[48:51], v[88:91], v[96:111]
    v_exp_f32 v68, v68
    v_exp_f32 v69, v69
    v_exp_f32 v70, v70
    v_exp_f32 v71, v71
    v_cvt_pk_bf16_f32 v92, v64, v65
    v_cvt_pk_bf16_f32 v93, v66, v67
    v_cvt_pk_bf16_f32 v94, v68, v69
    v_cvt_pk_bf16_f32 v95, v70, v71
    s_waitcnt lgkmcnt(2)
    v_mfma_f32_32x32x16_bf16 v[56:71], v[24:27], v[8:11], 0
    ds_read_b128 v[32:35], v4 offset:35840
    ds_read_b64 v[36:37], v5 offset:35840
    v_exp_f32 v72, v72
    v_exp_f32 v73, v73
    v_exp_f32 v74, v74
    v_exp_f32 v75, v75
    v_mfma_f32_32x32x16_bf16 v[96:111], v[52:55], v[92:95], v[96:111]
    v_exp_f32 v76, v76
    v_exp_f32 v77, v77
    v_exp_f32 v78, v78
    v_exp_f32 v79, v79
    v_cvt_pk_bf16_f32 v88, v72, v73
    v_cvt_pk_bf16_f32 v89, v74, v75
    v_cvt_pk_bf16_f32 v90, v76, v77
    v_cvt_pk_bf16_f32 v91, v78, v79
    v_mfma_f32_32x32x8_bf16 v[56:71], v[28:29], v[12:13], v[56:71]
    v_exp_f32 v80, v80
    v_exp_f32 v81, v81
    v_exp_f32 v82, v82
    v_exp_f32 v83, v83
    v_mfma_f32_32x32x16_bf16 v[112:127], v[48:51], v[88:91], v[112:127]
    v_exp_f32 v84, v84
    v_exp_f32 v85, v85
    v_exp_f32 v86, v86
    v_exp_f32 v87, v87
    v_cvt_pk_bf16_f32 v92, v80, v81
    v_cvt_pk_bf16_f32 v93, v82, v83
    v_cvt_pk_bf16_f32 v94, v84, v85
    v_cvt_pk_bf16_f32 v95, v86, v87
    v_mfma_f32_32x32x16_bf16 v[72:87], v[24:27], v[14:17], 0
    v_exp_f32 v56, v56
    v_exp_f32 v57, v57
    v_exp_f32 v58, v58
    v_exp_f32 v59, v59
    v_mfma_f32_32x32x16_bf16 v[112:127], v[52:55], v[92:95], v[112:127]
    s_mov_b64 exec, s[28:29]
    ds_read_b128 v[48:51], v6 offset:35840
    ds_read_b128 v[52:55], v6 offset:36480
    s_mov_b64 exec, -1
    v_exp_f32 v60, v60
    v_exp_f32 v61, v61
    v_exp_f32 v62, v62
    v_exp_f32 v63, v63
    v_cvt_pk_bf16_f32 v88, v56, v57
    v_cvt_pk_bf16_f32 v89, v58, v59
    v_cvt_pk_bf16_f32 v90, v60, v61
    v_cvt_pk_bf16_f32 v91, v62, v63
    v_mfma_f32_32x32x8_bf16 v[72:87], v[28:29], v[18:19], v[72:87]
    v_exp_f32 v64, v64
    v_exp_f32 v65, v65
    v_exp_f32 v66, v66
    v_exp_f32 v67, v67
    s_waitcnt lgkmcnt(4)
    v_mfma_f32_32x32x16_bf16 v[96:111], v[40:43], v[88:91], v[96:111]
    v_exp_f32 v68, v68
    v_exp_f32 v69, v69
    v_exp_f32 v70, v70
    v_exp_f32 v71, v71
    v_cvt_pk_bf16_f32 v92, v64, v65
    v_cvt_pk_bf16_f32 v93, v66, v67
    v_cvt_pk_bf16_f32 v94, v68, v69
    v_cvt_pk_bf16_f32 v95, v70, v71
    s_waitcnt lgkmcnt(2)
    v_mfma_f32_32x32x16_bf16 v[56:71], v[32:35], v[8:11], 0
    ds_read_b128 v[24:27], v4 offset:40960
    ds_read_b64 v[28:29], v5 offset:40960
    v_exp_f32 v72, v72
    v_exp_f32 v73, v73
    v_exp_f32 v74, v74
    v_exp_f32 v75, v75
    v_mfma_f32_32x32x16_bf16 v[96:111], v[44:47], v[92:95], v[96:111]
    v_exp_f32 v76, v76
    v_exp_f32 v77, v77
    v_exp_f32 v78, v78
    v_exp_f32 v79, v79
    v_cvt_pk_bf16_f32 v88, v72, v73
    v_cvt_pk_bf16_f32 v89, v74, v75
    v_cvt_pk_bf16_f32 v90, v76, v77
    v_cvt_pk_bf16_f32 v91, v78, v79
    v_mfma_f32_32x32x8_bf16 v[56:71], v[36:37], v[12:13], v[56:71]
    v_exp_f32 v80, v80
    v_exp_f32 v81, v81
    v_exp_f32 v82, v82
    v_exp_f32 v83, v83
    v_mfma_f32_32x32x16_bf16 v[112:127], v[40:43], v[88:91], v[112:127]
    v_exp_f32 v84, v84
    v_exp_f32 v85, v85
    v_exp_f32 v86, v86
    v_exp_f32 v87, v87
    v_cvt_pk_bf16_f32 v92, v80, v81
    v_cvt_pk_bf16_f32 v93, v82, v83
    v_cvt_pk_bf16_f32 v94, v84, v85
    v_cvt_pk_bf16_f32 v95, v86, v87
    v_mfma_f32_32x32x16_bf16 v[72:87], v[32:35], v[14:17], 0
    v_exp_f32 v56, v56
    v_exp_f32 v57, v57
    v_exp_f32 v58, v58
    v_exp_f32 v59, v59
    v_mfma_f32_32x32x16_bf16 v[112:127], v[44:47], v[92:95], v[112:127]
    s_mov_b64 exec, s[28:29]
    ds_read_b128 v[40:43], v6 offset:40960
    ds_read_b128 v[44:47], v6 offset:41600
    s_mov_b64 exec, -1
    s_waitcnt vmcnt(0)
    s_cmp_lg_u32 s44, 0
    s_cbranch_scc0 interleave_layers__softmax_full_mha__sliding_local_dilated__prompt_kernel_hk3
    buffer_load_dword v235, v234, s[12:15], s59 offen
interleave_layers__softmax_full_mha__sliding_local_dilated__prompt_kernel_hk3:
    v_exp_f32 v60, v60
    v_exp_f32 v61, v61
    v_exp_f32 v62, v62
    v_exp_f32 v63, v63
    v_cvt_pk_bf16_f32 v88, v56, v57
    v_cvt_pk_bf16_f32 v89, v58, v59
    v_cvt_pk_bf16_f32 v90, v60, v61
    v_cvt_pk_bf16_f32 v91, v62, v63
    v_mfma_f32_32x32x8_bf16 v[72:87], v[36:37], v[18:19], v[72:87]
    v_exp_f32 v64, v64
    v_exp_f32 v65, v65
    v_exp_f32 v66, v66
    v_exp_f32 v67, v67
    s_waitcnt lgkmcnt(4)
    v_mfma_f32_32x32x16_bf16 v[96:111], v[48:51], v[88:91], v[96:111]
    v_exp_f32 v68, v68
    v_exp_f32 v69, v69
    v_exp_f32 v70, v70
    v_exp_f32 v71, v71
    v_cvt_pk_bf16_f32 v92, v64, v65
    v_cvt_pk_bf16_f32 v93, v66, v67
    v_cvt_pk_bf16_f32 v94, v68, v69
    v_cvt_pk_bf16_f32 v95, v70, v71
    s_waitcnt lgkmcnt(2)
    v_mfma_f32_32x32x16_bf16 v[56:71], v[24:27], v[8:11], 0
    ds_read_b128 v[32:35], v4 offset:46080
    ds_read_b64 v[36:37], v5 offset:46080
    v_exp_f32 v72, v72
    v_exp_f32 v73, v73
    v_exp_f32 v74, v74
    v_exp_f32 v75, v75
    v_mfma_f32_32x32x16_bf16 v[96:111], v[52:55], v[92:95], v[96:111]
    v_exp_f32 v76, v76
    v_exp_f32 v77, v77
    v_exp_f32 v78, v78
    v_exp_f32 v79, v79
    v_cvt_pk_bf16_f32 v88, v72, v73
    v_cvt_pk_bf16_f32 v89, v74, v75
    v_cvt_pk_bf16_f32 v90, v76, v77
    v_cvt_pk_bf16_f32 v91, v78, v79
    v_mfma_f32_32x32x8_bf16 v[56:71], v[28:29], v[12:13], v[56:71]
    v_exp_f32 v80, v80
    v_exp_f32 v81, v81
    v_exp_f32 v82, v82
    v_exp_f32 v83, v83
    v_mfma_f32_32x32x16_bf16 v[112:127], v[48:51], v[88:91], v[112:127]
    v_exp_f32 v84, v84
    v_exp_f32 v85, v85
    v_exp_f32 v86, v86
    v_exp_f32 v87, v87
    v_cvt_pk_bf16_f32 v92, v80, v81
    v_cvt_pk_bf16_f32 v93, v82, v83
    v_cvt_pk_bf16_f32 v94, v84, v85
    v_cvt_pk_bf16_f32 v95, v86, v87
    v_mfma_f32_32x32x16_bf16 v[72:87], v[24:27], v[14:17], 0
    v_exp_f32 v56, v56
    v_exp_f32 v57, v57
    v_exp_f32 v58, v58
    v_exp_f32 v59, v59
    v_mfma_f32_32x32x16_bf16 v[112:127], v[52:55], v[92:95], v[112:127]
    s_mov_b64 exec, s[28:29]
    ds_read_b128 v[48:51], v6 offset:46080
    ds_read_b128 v[52:55], v6 offset:46720
    s_mov_b64 exec, -1
    v_exp_f32 v60, v60
    v_exp_f32 v61, v61
    v_exp_f32 v62, v62
    v_exp_f32 v63, v63
    v_cvt_pk_bf16_f32 v88, v56, v57
    v_cvt_pk_bf16_f32 v89, v58, v59
    v_cvt_pk_bf16_f32 v90, v60, v61
    v_cvt_pk_bf16_f32 v91, v62, v63
    v_mfma_f32_32x32x8_bf16 v[72:87], v[28:29], v[18:19], v[72:87]
    v_exp_f32 v64, v64
    v_exp_f32 v65, v65
    v_exp_f32 v66, v66
    v_exp_f32 v67, v67
    s_waitcnt lgkmcnt(4)
    v_mfma_f32_32x32x16_bf16 v[96:111], v[40:43], v[88:91], v[96:111]
    v_exp_f32 v68, v68
    v_exp_f32 v69, v69
    v_exp_f32 v70, v70
    v_exp_f32 v71, v71
    v_cvt_pk_bf16_f32 v92, v64, v65
    v_cvt_pk_bf16_f32 v93, v66, v67
    v_cvt_pk_bf16_f32 v94, v68, v69
    v_cvt_pk_bf16_f32 v95, v70, v71
    s_waitcnt lgkmcnt(2)
    v_mfma_f32_32x32x16_bf16 v[56:71], v[32:35], v[8:11], 0
    v_subrev_u32 v4, 112640, v4
    v_subrev_u32 v5, 112640, v5
    ds_read_b128 v[24:27], v4 offset:0
    ds_read_b64 v[28:29], v5 offset:0
    v_exp_f32 v72, v72
    v_exp_f32 v73, v73
    v_exp_f32 v74, v74
    v_exp_f32 v75, v75
    v_mfma_f32_32x32x16_bf16 v[96:111], v[44:47], v[92:95], v[96:111]
    s_setprio 0
    v_exp_f32 v76, v76
    v_exp_f32 v77, v77
    v_exp_f32 v78, v78
    v_exp_f32 v79, v79
    v_cvt_pk_bf16_f32 v88, v72, v73
    v_cvt_pk_bf16_f32 v89, v74, v75
    v_cvt_pk_bf16_f32 v90, v76, v77
    v_cvt_pk_bf16_f32 v91, v78, v79
    v_mfma_f32_32x32x8_bf16 v[56:71], v[36:37], v[12:13], v[56:71]
    v_exp_f32 v80, v80
    v_exp_f32 v81, v81
    v_exp_f32 v82, v82
    v_exp_f32 v83, v83
    v_mfma_f32_32x32x16_bf16 v[112:127], v[40:43], v[88:91], v[112:127]
    v_exp_f32 v84, v84
    v_exp_f32 v85, v85
    v_exp_f32 v86, v86
    v_exp_f32 v87, v87
    v_cvt_pk_bf16_f32 v92, v80, v81
    v_cvt_pk_bf16_f32 v93, v82, v83
    v_cvt_pk_bf16_f32 v94, v84, v85
    v_cvt_pk_bf16_f32 v95, v86, v87
    v_mfma_f32_32x32x16_bf16 v[72:87], v[32:35], v[14:17], 0
    v_exp_f32 v56, v56
    v_exp_f32 v57, v57
    v_exp_f32 v58, v58
    v_exp_f32 v59, v59
    v_mfma_f32_32x32x16_bf16 v[112:127], v[44:47], v[92:95], v[112:127]
    v_subrev_u32 v6, 112640, v6
    s_mov_b64 exec, s[28:29]
    ds_read_b128 v[40:43], v6 offset:0
    ds_read_b128 v[44:47], v6 offset:640
    s_mov_b64 exec, -1
    v_exp_f32 v60, v60
    v_exp_f32 v61, v61
    v_exp_f32 v62, v62
    v_exp_f32 v63, v63
    v_cvt_pk_bf16_f32 v88, v56, v57
    v_cvt_pk_bf16_f32 v89, v58, v59
    v_cvt_pk_bf16_f32 v90, v60, v61
    v_cvt_pk_bf16_f32 v91, v62, v63
    v_mfma_f32_32x32x8_bf16 v[72:87], v[36:37], v[18:19], v[72:87]
    v_exp_f32 v64, v64
    v_exp_f32 v65, v65
    v_exp_f32 v66, v66
    v_exp_f32 v67, v67
    s_waitcnt lgkmcnt(4)
    v_mfma_f32_32x32x16_bf16 v[96:111], v[48:51], v[88:91], v[96:111]
    v_exp_f32 v68, v68
    v_exp_f32 v69, v69
    v_exp_f32 v70, v70
    v_exp_f32 v71, v71
    v_cvt_pk_bf16_f32 v92, v64, v65
    v_cvt_pk_bf16_f32 v93, v66, v67
    v_cvt_pk_bf16_f32 v94, v68, v69
    v_cvt_pk_bf16_f32 v95, v70, v71
    s_waitcnt lgkmcnt(2)
    v_mfma_f32_32x32x16_bf16 v[56:71], v[24:27], v[8:11], 0
    ds_read_b128 v[32:35], v4 offset:5120
    ds_read_b64 v[36:37], v5 offset:5120
    v_exp_f32 v72, v72
    v_exp_f32 v73, v73
    v_exp_f32 v74, v74
    v_exp_f32 v75, v75
    v_mfma_f32_32x32x16_bf16 v[96:111], v[52:55], v[92:95], v[96:111]
    v_exp_f32 v76, v76
    v_exp_f32 v77, v77
    v_exp_f32 v78, v78
    v_exp_f32 v79, v79
    v_cvt_pk_bf16_f32 v88, v72, v73
    v_cvt_pk_bf16_f32 v89, v74, v75
    v_cvt_pk_bf16_f32 v90, v76, v77
    v_cvt_pk_bf16_f32 v91, v78, v79
    v_mfma_f32_32x32x8_bf16 v[56:71], v[28:29], v[12:13], v[56:71]
    v_exp_f32 v80, v80
    v_exp_f32 v81, v81
    v_exp_f32 v82, v82
    v_exp_f32 v83, v83
    v_mfma_f32_32x32x16_bf16 v[112:127], v[48:51], v[88:91], v[112:127]
    v_exp_f32 v84, v84
    v_exp_f32 v85, v85
    v_exp_f32 v86, v86
    v_exp_f32 v87, v87
    v_cvt_pk_bf16_f32 v92, v80, v81
    v_cvt_pk_bf16_f32 v93, v82, v83
    v_cvt_pk_bf16_f32 v94, v84, v85
    v_cvt_pk_bf16_f32 v95, v86, v87
    s_barrier
    s_cmp_ge_u32 s18, 4
    s_cbranch_scc0 interleave_layers__softmax_full_mha__sliding_local_dilated__prompt_kernel_hk4
    s_setprio 1
interleave_layers__softmax_full_mha__sliding_local_dilated__prompt_kernel_hk4:
    v_mfma_f32_32x32x16_bf16 v[72:87], v[24:27], v[14:17], 0
    v_exp_f32 v56, v56
    v_exp_f32 v57, v57
    v_exp_f32 v58, v58
    v_exp_f32 v59, v59
    v_mfma_f32_32x32x16_bf16 v[112:127], v[52:55], v[92:95], v[112:127]
    s_mov_b64 exec, s[28:29]
    ds_read_b128 v[48:51], v6 offset:5120
    ds_read_b128 v[52:55], v6 offset:5760
    s_mov_b64 exec, -1
    s_cmp_eq_u32 s18, 4
    s_cbranch_scc0 interleave_layers__softmax_full_mha__sliding_local_dilated__prompt_kernel_hk5
    v_mov_b32 v243, 163824
    v_mov_b32 v240, 0
    v_mov_b32 v241, 0
    v_mov_b32 v242, 0
    ds_write_b96 v243, v[240:242]
    ds_write_b32 v243, v240 offset:12
interleave_layers__softmax_full_mha__sliding_local_dilated__prompt_kernel_hk5:
    v_exp_f32 v60, v60
    v_exp_f32 v61, v61
    v_exp_f32 v62, v62
    v_exp_f32 v63, v63
    v_cvt_pk_bf16_f32 v88, v56, v57
    v_cvt_pk_bf16_f32 v89, v58, v59
    v_cvt_pk_bf16_f32 v90, v60, v61
    v_cvt_pk_bf16_f32 v91, v62, v63
    v_mfma_f32_32x32x8_bf16 v[72:87], v[28:29], v[18:19], v[72:87]
    v_exp_f32 v64, v64
    v_exp_f32 v65, v65
    v_exp_f32 v66, v66
    v_exp_f32 v67, v67
    s_waitcnt lgkmcnt(4)
    v_mfma_f32_32x32x16_bf16 v[96:111], v[40:43], v[88:91], v[96:111]
    v_exp_f32 v68, v68
    v_exp_f32 v69, v69
    v_exp_f32 v70, v70
    v_exp_f32 v71, v71
    v_cvt_pk_bf16_f32 v92, v64, v65
    v_cvt_pk_bf16_f32 v93, v66, v67
    v_cvt_pk_bf16_f32 v94, v68, v69
    v_cvt_pk_bf16_f32 v95, v70, v71
    s_waitcnt lgkmcnt(2)
    v_mfma_f32_32x32x16_bf16 v[56:71], v[32:35], v[8:11], 0
    ds_read_b128 v[24:27], v4 offset:10240
    ds_read_b64 v[28:29], v5 offset:10240
    v_exp_f32 v72, v72
    v_exp_f32 v73, v73
    v_exp_f32 v74, v74
    v_exp_f32 v75, v75
    v_mfma_f32_32x32x16_bf16 v[96:111], v[44:47], v[92:95], v[96:111]
    s_cmp_lg_u32 s4, 0
    s_cbranch_scc0 interleave_layers__softmax_full_mha__sliding_local_dilated__prompt_kernel_hk6
    s_cmp_eq_u32 s4, 1
    s_cbranch_scc0 interleave_layers__softmax_full_mha__sliding_local_dilated__prompt_kernel_i1
    s_add_u32 m0, s35, 0
    s_add_u32 s27, s5, 0
    buffer_load_dwordx4 v152, s[88:91], s27 offen nt lds
    s_add_u32 m0, s35, 1024
    s_add_u32 s27, s5, 15360
    buffer_load_dwordx4 v152, s[88:91], s27 offen nt lds
    s_add_u32 m0, s35, 2048
    s_add_u32 s27, s5, 30720
    buffer_load_dwordx4 v152, s[88:91], s27 offen nt lds
    s_add_u32 m0, s35, 3072
    s_add_u32 s27, s5, 46080
    buffer_load_dwordx4 v152, s[88:91], s27 offen nt lds
    s_add_u32 m0, s35, 4096
    s_add_u32 s27, s5, 61440
    buffer_load_dwordx4 v152, s[88:91], s27 offen nt lds
    s_add_u32 m0, s35, 5120
    s_add_u32 s27, s5, 76800
    buffer_load_dwordx4 v152, s[88:91], s27 offen nt lds
    s_add_u32 m0, s35, 6144
    s_add_u32 s27, s5, 92160
    buffer_load_dwordx4 v152, s[88:91], s27 offen nt lds
    s_add_u32 m0, s35, 7168
    s_add_u32 s27, s5, 107520
    buffer_load_dwordx4 v152, s[88:91], s27 offen nt lds
    s_branch interleave_layers__softmax_full_mha__sliding_local_dilated__prompt_kernel_i2
interleave_layers__softmax_full_mha__sliding_local_dilated__prompt_kernel_i1:
    s_add_u32 m0, s35, 0
    s_nop 0
    buffer_load_dwordx4 v152, s[88:91], s5 offen nt lds
    s_add_u32 m0, s35, 1024
    s_nop 0
    buffer_load_dwordx4 v153, s[88:91], s5 offen nt lds
    s_add_u32 m0, s35, 2048
    s_nop 0
    buffer_load_dwordx4 v154, s[88:91], s5 offen nt lds
    s_add_u32 m0, s35, 3072
    s_nop 0
    buffer_load_dwordx4 v155, s[88:91], s5 offen nt lds
    s_add_u32 m0, s35, 4096
    s_nop 0
    buffer_load_dwordx4 v156, s[88:91], s5 offen nt lds
interleave_layers__softmax_full_mha__sliding_local_dilated__prompt_kernel_i2:
interleave_layers__softmax_full_mha__sliding_local_dilated__prompt_kernel_hk6:
    v_exp_f32 v76, v76
    v_exp_f32 v77, v77
    v_exp_f32 v78, v78
    v_exp_f32 v79, v79
    v_cvt_pk_bf16_f32 v88, v72, v73
    v_cvt_pk_bf16_f32 v89, v74, v75
    v_cvt_pk_bf16_f32 v90, v76, v77
    v_cvt_pk_bf16_f32 v91, v78, v79
    v_mfma_f32_32x32x8_bf16 v[56:71], v[36:37], v[12:13], v[56:71]
    v_exp_f32 v80, v80
    v_exp_f32 v81, v81
    v_exp_f32 v82, v82
    v_exp_f32 v83, v83
    v_mfma_f32_32x32x16_bf16 v[112:127], v[40:43], v[88:91], v[112:127]
    v_exp_f32 v84, v84
    v_exp_f32 v85, v85
    v_exp_f32 v86, v86
    v_exp_f32 v87, v87
    v_cvt_pk_bf16_f32 v92, v80, v81
    v_cvt_pk_bf16_f32 v93, v82, v83
    v_cvt_pk_bf16_f32 v94, v84, v85
    v_cvt_pk_bf16_f32 v95, v86, v87
    v_mfma_f32_32x32x16_bf16 v[72:87], v[32:35], v[14:17], 0
    v_exp_f32 v56, v56
    v_exp_f32 v57, v57
    v_exp_f32 v58, v58
    v_exp_f32 v59, v59
    v_mfma_f32_32x32x16_bf16 v[112:127], v[44:47], v[92:95], v[112:127]
    s_mov_b64 exec, s[28:29]
    ds_read_b128 v[40:43], v6 offset:10240
    ds_read_b128 v[44:47], v6 offset:10880
    s_mov_b64 exec, -1
    v_exp_f32 v60, v60
    v_exp_f32 v61, v61
    v_exp_f32 v62, v62
    v_exp_f32 v63, v63
    v_cvt_pk_bf16_f32 v88, v56, v57
    v_cvt_pk_bf16_f32 v89, v58, v59
    v_cvt_pk_bf16_f32 v90, v60, v61
    v_cvt_pk_bf16_f32 v91, v62, v63
    v_mfma_f32_32x32x8_bf16 v[72:87], v[36:37], v[18:19], v[72:87]
    v_exp_f32 v64, v64
    v_exp_f32 v65, v65
    v_exp_f32 v66, v66
    v_exp_f32 v67, v67
    s_waitcnt lgkmcnt(4)
    v_mfma_f32_32x32x16_bf16 v[96:111], v[48:51], v[88:91], v[96:111]
    v_exp_f32 v68, v68
    v_exp_f32 v69, v69
    v_exp_f32 v70, v70
    v_exp_f32 v71, v71
    v_cvt_pk_bf16_f32 v92, v64, v65
    v_cvt_pk_bf16_f32 v93, v66, v67
    v_cvt_pk_bf16_f32 v94, v68, v69
    v_cvt_pk_bf16_f32 v95, v70, v71
    s_waitcnt lgkmcnt(2)
    v_mfma_f32_32x32x16_bf16 v[56:71], v[24:27], v[8:11], 0
    ds_read_b128 v[32:35], v4 offset:15360
    ds_read_b64 v[36:37], v5 offset:15360
    v_exp_f32 v72, v72
    v_exp_f32 v73, v73
    v_exp_f32 v74, v74
    v_exp_f32 v75, v75
    v_mfma_f32_32x32x16_bf16 v[96:111], v[52:55], v[92:95], v[96:111]
    v_exp_f32 v76, v76
    v_exp_f32 v77, v77
    v_exp_f32 v78, v78
    v_exp_f32 v79, v79
    v_cvt_pk_bf16_f32 v88, v72, v73
    v_cvt_pk_bf16_f32 v89, v74, v75
    v_cvt_pk_bf16_f32 v90, v76, v77
    v_cvt_pk_bf16_f32 v91, v78, v79
    v_mfma_f32_32x32x8_bf16 v[56:71], v[28:29], v[12:13], v[56:71]
    v_exp_f32 v80, v80
    v_exp_f32 v81, v81
    v_exp_f32 v82, v82
    v_exp_f32 v83, v83
    v_mfma_f32_32x32x16_bf16 v[112:127], v[48:51], v[88:91], v[112:127]
    v_exp_f32 v84, v84
    v_exp_f32 v85, v85
    v_exp_f32 v86, v86
    v_exp_f32 v87, v87
    v_cvt_pk_bf16_f32 v92, v80, v81
    v_cvt_pk_bf16_f32 v93, v82, v83
    v_cvt_pk_bf16_f32 v94, v84, v85
    v_cvt_pk_bf16_f32 v95, v86, v87
    v_mfma_f32_32x32x16_bf16 v[72:87], v[24:27], v[14:17], 0
    v_exp_f32 v56, v56
    v_exp_f32 v57, v57
    v_exp_f32 v58, v58
    v_exp_f32 v59, v59
    v_mfma_f32_32x32x16_bf16 v[112:127], v[52:55], v[92:95], v[112:127]
    s_mov_b64 exec, s[28:29]
    ds_read_b128 v[48:51], v6 offset:15360
    ds_read_b128 v[52:55], v6 offset:16000
    s_mov_b64 exec, -1
    v_exp_f32 v60, v60
    v_exp_f32 v61, v61
    v_exp_f32 v62, v62
    v_exp_f32 v63, v63
    v_cvt_pk_bf16_f32 v88, v56, v57
    v_cvt_pk_bf16_f32 v89, v58, v59
    v_cvt_pk_bf16_f32 v90, v60, v61
    v_cvt_pk_bf16_f32 v91, v62, v63
    v_mfma_f32_32x32x8_bf16 v[72:87], v[28:29], v[18:19], v[72:87]
    v_exp_f32 v64, v64
    v_exp_f32 v65, v65
    v_exp_f32 v66, v66
    v_exp_f32 v67, v67
    s_waitcnt lgkmcnt(4)
    v_mfma_f32_32x32x16_bf16 v[96:111], v[40:43], v[88:91], v[96:111]
    v_exp_f32 v68, v68
    v_exp_f32 v69, v69
    v_exp_f32 v70, v70
    v_exp_f32 v71, v71
    v_cvt_pk_bf16_f32 v92, v64, v65
    v_cvt_pk_bf16_f32 v93, v66, v67
    v_cvt_pk_bf16_f32 v94, v68, v69
    v_cvt_pk_bf16_f32 v95, v70, v71
    s_waitcnt lgkmcnt(2)
    v_mfma_f32_32x32x16_bf16 v[56:71], v[32:35], v[8:11], 0
    ds_read_b128 v[24:27], v4 offset:20480
    ds_read_b64 v[28:29], v5 offset:20480
    v_exp_f32 v72, v72
    v_exp_f32 v73, v73
    v_exp_f32 v74, v74
    v_exp_f32 v75, v75
    v_mfma_f32_32x32x16_bf16 v[96:111], v[44:47], v[92:95], v[96:111]
    v_exp_f32 v76, v76
    v_exp_f32 v77, v77
    v_exp_f32 v78, v78
    v_exp_f32 v79, v79
    v_cvt_pk_bf16_f32 v88, v72, v73
    v_cvt_pk_bf16_f32 v89, v74, v75
    v_cvt_pk_bf16_f32 v90, v76, v77
    v_cvt_pk_bf16_f32 v91, v78, v79
    v_mfma_f32_32x32x8_bf16 v[56:71], v[36:37], v[12:13], v[56:71]
    v_exp_f32 v80, v80
    v_exp_f32 v81, v81
    v_exp_f32 v82, v82
    v_exp_f32 v83, v83
    v_mfma_f32_32x32x16_bf16 v[112:127], v[40:43], v[88:91], v[112:127]
    v_exp_f32 v84, v84
    v_exp_f32 v85, v85
    v_exp_f32 v86, v86
    v_exp_f32 v87, v87
    v_cvt_pk_bf16_f32 v92, v80, v81
    v_cvt_pk_bf16_f32 v93, v82, v83
    v_cvt_pk_bf16_f32 v94, v84, v85
    v_cvt_pk_bf16_f32 v95, v86, v87
    v_mfma_f32_32x32x16_bf16 v[72:87], v[32:35], v[14:17], 0
    v_exp_f32 v56, v56
    v_exp_f32 v57, v57
    v_exp_f32 v58, v58
    v_exp_f32 v59, v59
    v_mfma_f32_32x32x16_bf16 v[112:127], v[44:47], v[92:95], v[112:127]
    s_mov_b64 exec, s[28:29]
    ds_read_b128 v[40:43], v6 offset:20480
    ds_read_b128 v[44:47], v6 offset:21120
    s_mov_b64 exec, -1
    v_exp_f32 v60, v60
    v_exp_f32 v61, v61
    v_exp_f32 v62, v62
    v_exp_f32 v63, v63
    v_cvt_pk_bf16_f32 v88, v56, v57
    v_cvt_pk_bf16_f32 v89, v58, v59
    v_cvt_pk_bf16_f32 v90, v60, v61
    v_cvt_pk_bf16_f32 v91, v62, v63
    v_mfma_f32_32x32x8_bf16 v[72:87], v[36:37], v[18:19], v[72:87]
    v_exp_f32 v64, v64
    v_exp_f32 v65, v65
    v_exp_f32 v66, v66
    v_exp_f32 v67, v67
    s_waitcnt lgkmcnt(4)
    v_mfma_f32_32x32x16_bf16 v[96:111], v[48:51], v[88:91], v[96:111]
    v_exp_f32 v68, v68
    v_exp_f32 v69, v69
    v_exp_f32 v70, v70
    v_exp_f32 v71, v71
    v_cvt_pk_bf16_f32 v92, v64, v65
    v_cvt_pk_bf16_f32 v93, v66, v67
    v_cvt_pk_bf16_f32 v94, v68, v69
    v_cvt_pk_bf16_f32 v95, v70, v71
    s_waitcnt lgkmcnt(2)
    v_mfma_f32_32x32x16_bf16 v[56:71], v[24:27], v[8:11], 0
    ds_read_b128 v[32:35], v4 offset:25600
    ds_read_b64 v[36:37], v5 offset:25600
    v_exp_f32 v72, v72
    v_exp_f32 v73, v73
    v_exp_f32 v74, v74
    v_exp_f32 v75, v75
    v_mfma_f32_32x32x16_bf16 v[96:111], v[52:55], v[92:95], v[96:111]
    v_exp_f32 v76, v76
    v_exp_f32 v77, v77
    v_exp_f32 v78, v78
    v_exp_f32 v79, v79
    v_cvt_pk_bf16_f32 v88, v72, v73
    v_cvt_pk_bf16_f32 v89, v74, v75
    v_cvt_pk_bf16_f32 v90, v76, v77
    v_cvt_pk_bf16_f32 v91, v78, v79
    v_mfma_f32_32x32x8_bf16 v[56:71], v[28:29], v[12:13], v[56:71]
    v_exp_f32 v80, v80
    v_exp_f32 v81, v81
    v_exp_f32 v82, v82
    v_exp_f32 v83, v83
    v_mfma_f32_32x32x16_bf16 v[112:127], v[48:51], v[88:91], v[112:127]
    v_exp_f32 v84, v84
    v_exp_f32 v85, v85
    v_exp_f32 v86, v86
    v_exp_f32 v87, v87
    v_cvt_pk_bf16_f32 v92, v80, v81
    v_cvt_pk_bf16_f32 v93, v82, v83
    v_cvt_pk_bf16_f32 v94, v84, v85
    v_cvt_pk_bf16_f32 v95, v86, v87
    v_mfma_f32_32x32x16_bf16 v[72:87], v[24:27], v[14:17], 0
    v_exp_f32 v56, v56
    v_exp_f32 v57, v57
    v_exp_f32 v58, v58
    v_exp_f32 v59, v59
    v_mfma_f32_32x32x16_bf16 v[112:127], v[52:55], v[92:95], v[112:127]
    s_mov_b64 exec, s[28:29]
    ds_read_b128 v[48:51], v6 offset:25600
    ds_read_b128 v[52:55], v6 offset:26240
    s_mov_b64 exec, -1
    v_exp_f32 v60, v60
    v_exp_f32 v61, v61
    v_exp_f32 v62, v62
    v_exp_f32 v63, v63
    v_cvt_pk_bf16_f32 v88, v56, v57
    v_cvt_pk_bf16_f32 v89, v58, v59
    v_cvt_pk_bf16_f32 v90, v60, v61
    v_cvt_pk_bf16_f32 v91, v62, v63
    v_mfma_f32_32x32x8_bf16 v[72:87], v[28:29], v[18:19], v[72:87]
    v_exp_f32 v64, v64
    v_exp_f32 v65, v65
    v_exp_f32 v66, v66
    v_exp_f32 v67, v67
    s_waitcnt lgkmcnt(4)
    v_mfma_f32_32x32x16_bf16 v[96:111], v[40:43], v[88:91], v[96:111]
    v_exp_f32 v68, v68
    v_exp_f32 v69, v69
    v_exp_f32 v70, v70
    v_exp_f32 v71, v71
    v_cvt_pk_bf16_f32 v92, v64, v65
    v_cvt_pk_bf16_f32 v93, v66, v67
    v_cvt_pk_bf16_f32 v94, v68, v69
    v_cvt_pk_bf16_f32 v95, v70, v71
    s_waitcnt lgkmcnt(2)
    v_mfma_f32_32x32x16_bf16 v[56:71], v[32:35], v[8:11], 0
    ds_read_b128 v[24:27], v4 offset:30720
    ds_read_b64 v[28:29], v5 offset:30720
    v_exp_f32 v72, v72
    v_exp_f32 v73, v73
    v_exp_f32 v74, v74
    v_exp_f32 v75, v75
    v_mfma_f32_32x32x16_bf16 v[96:111], v[44:47], v[92:95], v[96:111]
    v_exp_f32 v76, v76
    v_exp_f32 v77, v77
    v_exp_f32 v78, v78
    v_exp_f32 v79, v79
    v_cvt_pk_bf16_f32 v88, v72, v73
    v_cvt_pk_bf16_f32 v89, v74, v75
    v_cvt_pk_bf16_f32 v90, v76, v77
    v_cvt_pk_bf16_f32 v91, v78, v79
    v_mfma_f32_32x32x8_bf16 v[56:71], v[36:37], v[12:13], v[56:71]
    v_exp_f32 v80, v80
    v_exp_f32 v81, v81
    v_exp_f32 v82, v82
    v_exp_f32 v83, v83
    v_mfma_f32_32x32x16_bf16 v[112:127], v[40:43], v[88:91], v[112:127]
    v_exp_f32 v84, v84
    v_exp_f32 v85, v85
    v_exp_f32 v86, v86
    v_exp_f32 v87, v87
    v_cvt_pk_bf16_f32 v92, v80, v81
    v_cvt_pk_bf16_f32 v93, v82, v83
    v_cvt_pk_bf16_f32 v94, v84, v85
    v_cvt_pk_bf16_f32 v95, v86, v87
    v_mfma_f32_32x32x16_bf16 v[72:87], v[32:35], v[14:17], 0
    v_exp_f32 v56, v56
    v_exp_f32 v57, v57
    v_exp_f32 v58, v58
    v_exp_f32 v59, v59
    v_mfma_f32_32x32x16_bf16 v[112:127], v[44:47], v[92:95], v[112:127]
    s_mov_b64 exec, s[28:29]
    ds_read_b128 v[40:43], v6 offset:30720
    ds_read_b128 v[44:47], v6 offset:31360
    s_mov_b64 exec, -1
    s_cmp_lt_u32 s18, 4
    s_cbranch_scc0 interleave_layers__softmax_full_mha__sliding_local_dilated__prompt_kernel_hk7
    buffer_load_dwordx4 v[208:211], v22, s[12:15], s43 offen sc1
    s_add_u32 s43, s43, 1024
    buffer_load_dwordx4 v[208:211], v22, s[12:15], s43 offen sc1
    s_add_u32 s43, s43, 1024
interleave_layers__softmax_full_mha__sliding_local_dilated__prompt_kernel_hk7:
    v_exp_f32 v60, v60
    v_exp_f32 v61, v61
    v_exp_f32 v62, v62
    v_exp_f32 v63, v63
    v_cvt_pk_bf16_f32 v88, v56, v57
    v_cvt_pk_bf16_f32 v89, v58, v59
    v_cvt_pk_bf16_f32 v90, v60, v61
    v_cvt_pk_bf16_f32 v91, v62, v63
    v_mfma_f32_32x32x8_bf16 v[72:87], v[36:37], v[18:19], v[72:87]
    v_exp_f32 v64, v64
    v_exp_f32 v65, v65
    v_exp_f32 v66, v66
    v_exp_f32 v67, v67
    s_waitcnt lgkmcnt(4)
    v_mfma_f32_32x32x16_bf16 v[96:111], v[48:51], v[88:91], v[96:111]
    v_exp_f32 v68, v68
    v_exp_f32 v69, v69
    v_exp_f32 v70, v70
    v_exp_f32 v71, v71
    v_cvt_pk_bf16_f32 v92, v64, v65
    v_cvt_pk_bf16_f32 v93, v66, v67
    v_cvt_pk_bf16_f32 v94, v68, v69
    v_cvt_pk_bf16_f32 v95, v70, v71
    s_waitcnt lgkmcnt(2)
    v_mfma_f32_32x32x16_bf16 v[56:71], v[24:27], v[8:11], 0
    ds_read_b128 v[32:35], v4 offset:35840
    ds_read_b64 v[36:37], v5 offset:35840
    v_exp_f32 v72, v72
    v_exp_f32 v73, v73
    v_exp_f32 v74, v74
    v_exp_f32 v75, v75
    v_mfma_f32_32x32x16_bf16 v[96:111], v[52:55], v[92:95], v[96:111]
    v_exp_f32 v76, v76
    v_exp_f32 v77, v77
    v_exp_f32 v78, v78
    v_exp_f32 v79, v79
    v_cvt_pk_bf16_f32 v88, v72, v73
    v_cvt_pk_bf16_f32 v89, v74, v75
    v_cvt_pk_bf16_f32 v90, v76, v77
    v_cvt_pk_bf16_f32 v91, v78, v79
    v_mfma_f32_32x32x8_bf16 v[56:71], v[28:29], v[12:13], v[56:71]
    v_exp_f32 v80, v80
    v_exp_f32 v81, v81
    v_exp_f32 v82, v82
    v_exp_f32 v83, v83
    v_mfma_f32_32x32x16_bf16 v[112:127], v[48:51], v[88:91], v[112:127]
    v_exp_f32 v84, v84
    v_exp_f32 v85, v85
    v_exp_f32 v86, v86
    v_exp_f32 v87, v87
    v_cvt_pk_bf16_f32 v92, v80, v81
    v_cvt_pk_bf16_f32 v93, v82, v83
    v_cvt_pk_bf16_f32 v94, v84, v85
    v_cvt_pk_bf16_f32 v95, v86, v87
    v_mfma_f32_32x32x16_bf16 v[72:87], v[24:27], v[14:17], 0
    v_exp_f32 v56, v56
    v_exp_f32 v57, v57
    v_exp_f32 v58, v58
    v_exp_f32 v59, v59
    v_mfma_f32_32x32x16_bf16 v[112:127], v[52:55], v[92:95], v[112:127]
    s_mov_b64 exec, s[28:29]
    ds_read_b128 v[48:51], v6 offset:35840
    ds_read_b128 v[52:55], v6 offset:36480
    s_mov_b64 exec, -1
    s_cmp_lt_u32 s18, 4
    s_cbranch_scc0 interleave_layers__softmax_full_mha__sliding_local_dilated__prompt_kernel_hk8
    buffer_load_dwordx4 v[208:211], v22, s[12:15], s43 offen sc1
    s_add_u32 s43, s43, 1024
    buffer_load_dwordx4 v[208:211], v22, s[12:15], s43 offen sc1
    s_add_u32 s43, s43, 1024
interleave_layers__softmax_full_mha__sliding_local_dilated__prompt_kernel_hk8:
    v_exp_f32 v60, v60
    v_exp_f32 v61, v61
    v_exp_f32 v62, v62
    v_exp_f32 v63, v63
    v_cvt_pk_bf16_f32 v88, v56, v57
    v_cvt_pk_bf16_f32 v89, v58, v59
    v_cvt_pk_bf16_f32 v90, v60, v61
    v_cvt_pk_bf16_f32 v91, v62, v63
    v_mfma_f32_32x32x8_bf16 v[72:87], v[28:29], v[18:19], v[72:87]
    v_exp_f32 v64, v64
    v_exp_f32 v65, v65
    v_exp_f32 v66, v66
    v_exp_f32 v67, v67
    s_waitcnt lgkmcnt(4)
    v_mfma_f32_32x32x16_bf16 v[96:111], v[40:43], v[88:91], v[96:111]
    v_exp_f32 v68, v68
    v_exp_f32 v69, v69
    v_exp_f32 v70, v70
    v_exp_f32 v71, v71
    v_cvt_pk_bf16_f32 v92, v64, v65
    v_cvt_pk_bf16_f32 v93, v66, v67
    v_cvt_pk_bf16_f32 v94, v68, v69
    v_cvt_pk_bf16_f32 v95, v70, v71
    s_waitcnt lgkmcnt(2)
    v_mfma_f32_32x32x16_bf16 v[56:71], v[32:35], v[8:11], 0
    ds_read_b128 v[24:27], v4 offset:40960
    ds_read_b64 v[28:29], v5 offset:40960
    v_exp_f32 v72, v72
    v_exp_f32 v73, v73
    v_exp_f32 v74, v74
    v_exp_f32 v75, v75
    v_mfma_f32_32x32x16_bf16 v[96:111], v[44:47], v[92:95], v[96:111]
    s_cmp_lg_u32 s4, 0
    s_cbranch_scc0 interleave_layers__softmax_full_mha__sliding_local_dilated__prompt_kernel_hk9
    s_waitcnt vmcnt(0)
    s_cmp_eq_u32 s4, 1
    s_cbranch_scc0 interleave_layers__softmax_full_mha__sliding_local_dilated__prompt_kernel_r1
    ds_read_b64_tr_b16 v[160:161], v144 offset:0
    ds_read_b64_tr_b16 v[162:163], v144 offset:1024
    ds_read_b64_tr_b16 v[164:165], v145 offset:0
    ds_read_b64_tr_b16 v[166:167], v145 offset:1024
    ds_read_b64_tr_b16 v[168:169], v146 offset:0
    ds_read_b64_tr_b16 v[170:171], v146 offset:1024
    ds_read_b64_tr_b16 v[172:173], v147 offset:0
    ds_read_b64_tr_b16 v[174:175], v147 offset:1024
    ds_read_b64_tr_b16 v[176:177], v144 offset:4096
    ds_read_b64_tr_b16 v[178:179], v144 offset:5120
    ds_read_b64_tr_b16 v[180:181], v145 offset:4096
    ds_read_b64_tr_b16 v[182:183], v145 offset:5120
    ds_read_b64_tr_b16 v[184:185], v146 offset:4096
    ds_read_b64_tr_b16 v[186:187], v146 offset:5120
    ds_read_b64_tr_b16 v[188:189], v147 offset:4096
    ds_read_b64_tr_b16 v[190:191], v147 offset:5120
    s_branch interleave_layers__softmax_full_mha__sliding_local_dilated__prompt_kernel_r2
interleave_layers__softmax_full_mha__sliding_local_dilated__prompt_kernel_r1:
    ds_read_b64_tr_b16 v[160:161], v144 offset:0
    ds_read_b64_tr_b16 v[162:163], v145 offset:0
    ds_read_b64_tr_b16 v[164:165], v144 offset:8
    ds_read_b64_tr_b16 v[166:167], v145 offset:8
    ds_read_b64_tr_b16 v[168:169], v144 offset:64
    ds_read_b64_tr_b16 v[170:171], v145 offset:64
    ds_read_b64_tr_b16 v[172:173], v144 offset:72
    ds_read_b64_tr_b16 v[174:175], v145 offset:72
    ds_read_b64_tr_b16 v[176:177], v146 offset:0
    ds_read_b64_tr_b16 v[178:179], v147 offset:0
interleave_layers__softmax_full_mha__sliding_local_dilated__prompt_kernel_r2:
interleave_layers__softmax_full_mha__sliding_local_dilated__prompt_kernel_hk9:
    v_exp_f32 v76, v76
    v_exp_f32 v77, v77
    v_exp_f32 v78, v78
    v_exp_f32 v79, v79
    v_cvt_pk_bf16_f32 v88, v72, v73
    v_cvt_pk_bf16_f32 v89, v74, v75
    v_cvt_pk_bf16_f32 v90, v76, v77
    v_cvt_pk_bf16_f32 v91, v78, v79
    v_mfma_f32_32x32x8_bf16 v[56:71], v[36:37], v[12:13], v[56:71]
    v_exp_f32 v80, v80
    v_exp_f32 v81, v81
    v_exp_f32 v82, v82
    v_exp_f32 v83, v83
    v_mfma_f32_32x32x16_bf16 v[112:127], v[40:43], v[88:91], v[112:127]
    v_exp_f32 v84, v84
    v_exp_f32 v85, v85
    v_exp_f32 v86, v86
    v_exp_f32 v87, v87
    v_cvt_pk_bf16_f32 v92, v80, v81
    v_cvt_pk_bf16_f32 v93, v82, v83
    v_cvt_pk_bf16_f32 v94, v84, v85
    v_cvt_pk_bf16_f32 v95, v86, v87
    v_mfma_f32_32x32x16_bf16 v[72:87], v[32:35], v[14:17], 0
    v_exp_f32 v56, v56
    v_exp_f32 v57, v57
    v_exp_f32 v58, v58
    v_exp_f32 v59, v59
    v_mfma_f32_32x32x16_bf16 v[112:127], v[44:47], v[92:95], v[112:127]
    s_mov_b64 exec, s[28:29]
    ds_read_b128 v[40:43], v6 offset:40960
    ds_read_b128 v[44:47], v6 offset:41600
    s_mov_b64 exec, -1
    s_cmp_lg_u32 s4, 0
    s_cbranch_scc0 interleave_layers__softmax_full_mha__sliding_local_dilated__prompt_kernel_hk10
    s_waitcnt lgkmcnt(0)
interleave_layers__softmax_full_mha__sliding_local_dilated__prompt_kernel_hk10:
    s_cmp_lt_u32 s18, 4
    s_cbranch_scc0 interleave_layers__softmax_full_mha__sliding_local_dilated__prompt_kernel_hk11
    buffer_load_dwordx4 v[208:211], v22, s[12:15], s43 offen sc1
    s_add_u32 s43, s43, 1024
    buffer_load_dwordx4 v[208:211], v22, s[12:15], s43 offen sc1
    s_add_u32 s43, s43, 1024
interleave_layers__softmax_full_mha__sliding_local_dilated__prompt_kernel_hk11:
    v_exp_f32 v60, v60
    v_exp_f32 v61, v61
    v_exp_f32 v62, v62
    v_exp_f32 v63, v63
    v_cvt_pk_bf16_f32 v88, v56, v57
    v_cvt_pk_bf16_f32 v89, v58, v59
    v_cvt_pk_bf16_f32 v90, v60, v61
    v_cvt_pk_bf16_f32 v91, v62, v63
    v_mfma_f32_32x32x8_bf16 v[72:87], v[36:37], v[18:19], v[72:87]
    v_exp_f32 v64, v64
    v_exp_f32 v65, v65
    v_exp_f32 v66, v66
    v_exp_f32 v67, v67
    s_waitcnt lgkmcnt(4)
    v_mfma_f32_32x32x16_bf16 v[96:111], v[48:51], v[88:91], v[96:111]
    v_exp_f32 v68, v68
    v_exp_f32 v69, v69
    v_exp_f32 v70, v70
    v_exp_f32 v71, v71
    v_cvt_pk_bf16_f32 v92, v64, v65
    v_cvt_pk_bf16_f32 v93, v66, v67
    v_cvt_pk_bf16_f32 v94, v68, v69
    v_cvt_pk_bf16_f32 v95, v70, v71
    s_waitcnt lgkmcnt(2)
    v_mfma_f32_32x32x16_bf16 v[56:71], v[24:27], v[8:11], 0
    ds_read_b128 v[32:35], v4 offset:46080
    ds_read_b64 v[36:37], v5 offset:46080
    v_exp_f32 v72, v72
    v_exp_f32 v73, v73
    v_exp_f32 v74, v74
    v_exp_f32 v75, v75
    v_mfma_f32_32x32x16_bf16 v[96:111], v[52:55], v[92:95], v[96:111]
    s_cmp_eq_u32 s4, 1
    s_cbranch_scc0 interleave_layers__softmax_full_mha__sliding_local_dilated__prompt_kernel_hk12
    v_mov_b32 v228, 0x3f803f80
    v_mov_b32 v229, 0x3f803f80
    v_mov_b32 v230, 0x3f803f80
    v_mov_b32 v231, 0x3f803f80
    s_nop 1
    v_mfma_f32_32x32x16_bf16 v[192:207], v[228:231], v[160:163], 0
    v_mfma_f32_32x32x16_bf16 v[212:227], v[228:231], v[164:167], 0
    v_mfma_f32_32x32x16_bf16 v[192:207], v[228:231], v[176:179], v[192:207]
    v_mfma_f32_32x32x16_bf16 v[212:227], v[228:231], v[180:183], v[212:227]
interleave_layers__softmax_full_mha__sliding_local_dilated__prompt_kernel_hk12:
    s_cmp_lg_u32 s4, 0
    s_cbranch_scc0 interleave_layers__softmax_full_mha__sliding_local_dilated__prompt_kernel_hk13
    buffer_store_dwordx4 v[160:163], v22, s[12:15], s53 offen offset:0 sc1
interleave_layers__softmax_full_mha__sliding_local_dilated__prompt_kernel_hk13:
    v_exp_f32 v76, v76
    v_exp_f32 v77, v77
    v_exp_f32 v78, v78
    v_exp_f32 v79, v79
    v_cvt_pk_bf16_f32 v88, v72, v73
    v_cvt_pk_bf16_f32 v89, v74, v75
    v_cvt_pk_bf16_f32 v90, v76, v77
    v_cvt_pk_bf16_f32 v91, v78, v79
    v_mfma_f32_32x32x8_bf16 v[56:71], v[28:29], v[12:13], v[56:71]
    v_exp_f32 v80, v80
    v_exp_f32 v81, v81
    v_exp_f32 v82, v82
    v_exp_f32 v83, v83
    v_mfma_f32_32x32x16_bf16 v[112:127], v[48:51], v[88:91], v[112:127]
    v_exp_f32 v84, v84
    v_exp_f32 v85, v85
    v_exp_f32 v86, v86
    v_exp_f32 v87, v87
    v_cvt_pk_bf16_f32 v92, v80, v81
    v_cvt_pk_bf16_f32 v93, v82, v83
    v_cvt_pk_bf16_f32 v94, v84, v85
    v_cvt_pk_bf16_f32 v95, v86, v87
    v_mfma_f32_32x32x16_bf16 v[72:87], v[24:27], v[14:17], 0
    v_exp_f32 v56, v56
    v_exp_f32 v57, v57
    v_exp_f32 v58, v58
    v_exp_f32 v59, v59
    v_mfma_f32_32x32x16_bf16 v[112:127], v[52:55], v[92:95], v[112:127]
    s_mov_b64 exec, s[28:29]
    ds_read_b128 v[48:51], v6 offset:46080
    ds_read_b128 v[52:55], v6 offset:46720
    s_mov_b64 exec, -1
    s_cmp_eq_u32 s4, 1
    s_cbranch_scc0 interleave_layers__softmax_full_mha__sliding_local_dilated__prompt_kernel_hk14
    v_cmp_gt_u32 vcc, 32, v1
    s_nop 1
    v_cndmask_b32 v232, v212, v192, vcc
    buffer_store_dword v232, v143, s[12:15], s38 offen offset:0 sc1
interleave_layers__softmax_full_mha__sliding_local_dilated__prompt_kernel_hk14:
    s_cmp_lt_u32 s18, 4
    s_cbranch_scc0 interleave_layers__softmax_full_mha__sliding_local_dilated__prompt_kernel_hk15
    buffer_load_dwordx4 v[208:211], v22, s[12:15], s43 offen sc1
    s_add_u32 s43, s43, 1024
    buffer_load_dwordx4 v[208:211], v22, s[12:15], s43 offen sc1
    s_add_u32 s43, s43, 1024
interleave_layers__softmax_full_mha__sliding_local_dilated__prompt_kernel_hk15:
    v_exp_f32 v60, v60
    v_exp_f32 v61, v61
    v_exp_f32 v62, v62
    v_exp_f32 v63, v63
    v_cvt_pk_bf16_f32 v88, v56, v57
    v_cvt_pk_bf16_f32 v89, v58, v59
    v_cvt_pk_bf16_f32 v90, v60, v61
    v_cvt_pk_bf16_f32 v91, v62, v63
    v_mfma_f32_32x32x8_bf16 v[72:87], v[28:29], v[18:19], v[72:87]
    v_exp_f32 v64, v64
    v_exp_f32 v65, v65
    v_exp_f32 v66, v66
    v_exp_f32 v67, v67
    s_waitcnt lgkmcnt(4)
    v_mfma_f32_32x32x16_bf16 v[96:111], v[40:43], v[88:91], v[96:111]
    v_exp_f32 v68, v68
    v_exp_f32 v69, v69
    v_exp_f32 v70, v70
    v_exp_f32 v71, v71
    v_cvt_pk_bf16_f32 v92, v64, v65
    v_cvt_pk_bf16_f32 v93, v66, v67
    v_cvt_pk_bf16_f32 v94, v68, v69
    v_cvt_pk_bf16_f32 v95, v70, v71
    s_waitcnt lgkmcnt(2)
    v_mfma_f32_32x32x16_bf16 v[56:71], v[32:35], v[8:11], 0
    ds_read_b128 v[24:27], v4 offset:51200
    ds_read_b64 v[28:29], v5 offset:51200
    v_exp_f32 v72, v72
    v_exp_f32 v73, v73
    v_exp_f32 v74, v74
    v_exp_f32 v75, v75
    v_mfma_f32_32x32x16_bf16 v[96:111], v[44:47], v[92:95], v[96:111]
    s_cmp_eq_u32 s4, 1
    s_cbranch_scc0 interleave_layers__softmax_full_mha__sliding_local_dilated__prompt_kernel_hk16
    v_mfma_f32_32x32x16_bf16 v[192:207], v[228:231], v[168:171], 0
    v_mfma_f32_32x32x16_bf16 v[212:227], v[228:231], v[172:175], 0
    v_mfma_f32_32x32x16_bf16 v[192:207], v[228:231], v[184:187], v[192:207]
    v_mfma_f32_32x32x16_bf16 v[212:227], v[228:231], v[188:191], v[212:227]
interleave_layers__softmax_full_mha__sliding_local_dilated__prompt_kernel_hk16:
    s_cmp_lg_u32 s4, 0
    s_cbranch_scc0 interleave_layers__softmax_full_mha__sliding_local_dilated__prompt_kernel_hk17
    buffer_store_dwordx4 v[164:167], v22, s[12:15], s53 offen offset:1024 sc1
interleave_layers__softmax_full_mha__sliding_local_dilated__prompt_kernel_hk17:
    v_exp_f32 v76, v76
    v_exp_f32 v77, v77
    v_exp_f32 v78, v78
    v_exp_f32 v79, v79
    v_cvt_pk_bf16_f32 v88, v72, v73
    v_cvt_pk_bf16_f32 v89, v74, v75
    v_cvt_pk_bf16_f32 v90, v76, v77
    v_cvt_pk_bf16_f32 v91, v78, v79
    v_mfma_f32_32x32x8_bf16 v[56:71], v[36:37], v[12:13], v[56:71]
    v_exp_f32 v80, v80
    v_exp_f32 v81, v81
    v_exp_f32 v82, v82
    v_exp_f32 v83, v83
    v_mfma_f32_32x32x16_bf16 v[112:127], v[40:43], v[88:91], v[112:127]
    v_exp_f32 v84, v84
    v_exp_f32 v85, v85
    v_exp_f32 v86, v86
    v_exp_f32 v87, v87
    v_cvt_pk_bf16_f32 v92, v80, v81
    v_cvt_pk_bf16_f32 v93, v82, v83
    v_cvt_pk_bf16_f32 v94, v84, v85
    v_cvt_pk_bf16_f32 v95, v86, v87
    v_mfma_f32_32x32x16_bf16 v[72:87], v[32:35], v[14:17], 0
    v_exp_f32 v56, v56
    v_exp_f32 v57, v57
    v_exp_f32 v58, v58
    v_exp_f32 v59, v59
    v_mfma_f32_32x32x16_bf16 v[112:127], v[44:47], v[92:95], v[112:127]
    s_mov_b64 exec, s[28:29]
    ds_read_b128 v[40:43], v6 offset:51200
    ds_read_b128 v[44:47], v6 offset:51840
    s_mov_b64 exec, -1
    s_cmp_eq_u32 s4, 1
    s_cbranch_scc0 interleave_layers__softmax_full_mha__sliding_local_dilated__prompt_kernel_hk18
    v_cmp_gt_u32 vcc, 32, v1
    s_nop 1
    v_cndmask_b32 v233, v212, v192, vcc
    buffer_store_dword v233, v143, s[12:15], s38 offen offset:256 sc1
interleave_layers__softmax_full_mha__sliding_local_dilated__prompt_kernel_hk18:
    s_cmp_lt_u32 s18, 4
    s_cbranch_scc0 interleave_layers__softmax_full_mha__sliding_local_dilated__prompt_kernel_hk19
    buffer_load_dwordx4 v[208:211], v22, s[12:15], s43 offen sc1
    s_add_u32 s43, s43, 1024
    buffer_load_dwordx4 v[208:211], v22, s[12:15], s43 offen sc1
    s_add_u32 s43, s43, 1024
interleave_layers__softmax_full_mha__sliding_local_dilated__prompt_kernel_hk19:
    v_exp_f32 v60, v60
    v_exp_f32 v61, v61
    v_exp_f32 v62, v62
    v_exp_f32 v63, v63
    v_cvt_pk_bf16_f32 v88, v56, v57
    v_cvt_pk_bf16_f32 v89, v58, v59
    v_cvt_pk_bf16_f32 v90, v60, v61
    v_cvt_pk_bf16_f32 v91, v62, v63
    v_mfma_f32_32x32x8_bf16 v[72:87], v[36:37], v[18:19], v[72:87]
    v_exp_f32 v64, v64
    v_exp_f32 v65, v65
    v_exp_f32 v66, v66
    v_exp_f32 v67, v67
    s_waitcnt lgkmcnt(4)
    v_mfma_f32_32x32x16_bf16 v[96:111], v[48:51], v[88:91], v[96:111]
    v_exp_f32 v68, v68
    v_exp_f32 v69, v69
    v_exp_f32 v70, v70
    v_exp_f32 v71, v71
    v_cvt_pk_bf16_f32 v92, v64, v65
    v_cvt_pk_bf16_f32 v93, v66, v67
    v_cvt_pk_bf16_f32 v94, v68, v69
    v_cvt_pk_bf16_f32 v95, v70, v71
    s_waitcnt lgkmcnt(2)
    v_mfma_f32_32x32x16_bf16 v[56:71], v[24:27], v[8:11], 0
    ds_read_b128 v[32:35], v4 offset:56320
    ds_read_b64 v[36:37], v5 offset:56320
    v_exp_f32 v72, v72
    v_exp_f32 v73, v73
    v_exp_f32 v74, v74
    v_exp_f32 v75, v75
    v_mfma_f32_32x32x16_bf16 v[96:111], v[52:55], v[92:95], v[96:111]
    s_cmp_lg_u32 s4, 0
    s_cbranch_scc0 interleave_layers__softmax_full_mha__sliding_local_dilated__prompt_kernel_hk20
    buffer_store_dwordx4 v[168:171], v22, s[12:15], s53 offen offset:2048 sc1
interleave_layers__softmax_full_mha__sliding_local_dilated__prompt_kernel_hk20:
    v_exp_f32 v76, v76
    v_exp_f32 v77, v77
    v_exp_f32 v78, v78
    v_exp_f32 v79, v79
    v_cvt_pk_bf16_f32 v88, v72, v73
    v_cvt_pk_bf16_f32 v89, v74, v75
    v_cvt_pk_bf16_f32 v90, v76, v77
    v_cvt_pk_bf16_f32 v91, v78, v79
    v_mfma_f32_32x32x8_bf16 v[56:71], v[28:29], v[12:13], v[56:71]
    v_exp_f32 v80, v80
    v_exp_f32 v81, v81
    v_exp_f32 v82, v82
    v_exp_f32 v83, v83
    v_mfma_f32_32x32x16_bf16 v[112:127], v[48:51], v[88:91], v[112:127]
    v_exp_f32 v84, v84
    v_exp_f32 v85, v85
    v_exp_f32 v86, v86
    v_exp_f32 v87, v87
    v_cvt_pk_bf16_f32 v92, v80, v81
    v_cvt_pk_bf16_f32 v93, v82, v83
    v_cvt_pk_bf16_f32 v94, v84, v85
    v_cvt_pk_bf16_f32 v95, v86, v87
    v_mfma_f32_32x32x16_bf16 v[72:87], v[24:27], v[14:17], 0
    v_exp_f32 v56, v56
    v_exp_f32 v57, v57
    v_exp_f32 v58, v58
    v_exp_f32 v59, v59
    v_mfma_f32_32x32x16_bf16 v[112:127], v[52:55], v[92:95], v[112:127]
    s_mov_b64 exec, s[28:29]
    ds_read_b128 v[48:51], v6 offset:56320
    ds_read_b128 v[52:55], v6 offset:56960
    s_mov_b64 exec, -1
    s_cmp_lt_u32 s18, 4
    s_cbranch_scc0 interleave_layers__softmax_full_mha__sliding_local_dilated__prompt_kernel_hk21
    buffer_load_dwordx4 v[208:211], v22, s[12:15], s43 offen sc1
    s_add_u32 s43, s43, 1024
    buffer_load_dwordx4 v[208:211], v22, s[12:15], s43 offen sc1
    s_add_u32 s43, s43, 1024
interleave_layers__softmax_full_mha__sliding_local_dilated__prompt_kernel_hk21:
    v_exp_f32 v60, v60
    v_exp_f32 v61, v61
    v_exp_f32 v62, v62
    v_exp_f32 v63, v63
    v_cvt_pk_bf16_f32 v88, v56, v57
    v_cvt_pk_bf16_f32 v89, v58, v59
    v_cvt_pk_bf16_f32 v90, v60, v61
    v_cvt_pk_bf16_f32 v91, v62, v63
    v_mfma_f32_32x32x8_bf16 v[72:87], v[28:29], v[18:19], v[72:87]
    v_exp_f32 v64, v64
    v_exp_f32 v65, v65
    v_exp_f32 v66, v66
    v_exp_f32 v67, v67
    s_waitcnt lgkmcnt(4)
    v_mfma_f32_32x32x16_bf16 v[96:111], v[40:43], v[88:91], v[96:111]
    v_exp_f32 v68, v68
    v_exp_f32 v69, v69
    v_exp_f32 v70, v70
    v_exp_f32 v71, v71
    v_cvt_pk_bf16_f32 v92, v64, v65
    v_cvt_pk_bf16_f32 v93, v66, v67
    v_cvt_pk_bf16_f32 v94, v68, v69
    v_cvt_pk_bf16_f32 v95, v70, v71
    s_waitcnt lgkmcnt(2)
    v_mfma_f32_32x32x16_bf16 v[56:71], v[32:35], v[8:11], 0
    v_add_u32 v4, 61440, v4
    v_add_u32 v5, 61440, v5
    ds_read_b128 v[24:27], v4 offset:0
    ds_read_b64 v[28:29], v5 offset:0
    v_exp_f32 v72, v72
    v_exp_f32 v73, v73
    v_exp_f32 v74, v74
    v_exp_f32 v75, v75
    v_mfma_f32_32x32x16_bf16 v[96:111], v[44:47], v[92:95], v[96:111]
    s_cmp_lg_u32 s4, 0
    s_cbranch_scc0 interleave_layers__softmax_full_mha__sliding_local_dilated__prompt_kernel_hk22
    buffer_store_dwordx4 v[172:175], v22, s[12:15], s53 offen offset:3072 sc1
interleave_layers__softmax_full_mha__sliding_local_dilated__prompt_kernel_hk22:
    v_exp_f32 v76, v76
    v_exp_f32 v77, v77
    v_exp_f32 v78, v78
    v_exp_f32 v79, v79
    v_cvt_pk_bf16_f32 v88, v72, v73
    v_cvt_pk_bf16_f32 v89, v74, v75
    v_cvt_pk_bf16_f32 v90, v76, v77
    v_cvt_pk_bf16_f32 v91, v78, v79
    v_mfma_f32_32x32x8_bf16 v[56:71], v[36:37], v[12:13], v[56:71]
    v_exp_f32 v80, v80
    v_exp_f32 v81, v81
    v_exp_f32 v82, v82
    v_exp_f32 v83, v83
    v_mfma_f32_32x32x16_bf16 v[112:127], v[40:43], v[88:91], v[112:127]
    v_exp_f32 v84, v84
    v_exp_f32 v85, v85
    v_exp_f32 v86, v86
    v_exp_f32 v87, v87
    v_cvt_pk_bf16_f32 v92, v80, v81
    v_cvt_pk_bf16_f32 v93, v82, v83
    v_cvt_pk_bf16_f32 v94, v84, v85
    v_cvt_pk_bf16_f32 v95, v86, v87
    v_mfma_f32_32x32x16_bf16 v[72:87], v[32:35], v[14:17], 0
    v_exp_f32 v56, v56
    v_exp_f32 v57, v57
    v_exp_f32 v58, v58
    v_exp_f32 v59, v59
    v_mfma_f32_32x32x16_bf16 v[112:127], v[44:47], v[92:95], v[112:127]
    v_add_u32 v6, 61440, v6
    s_mov_b64 exec, s[28:29]
    ds_read_b128 v[40:43], v6 offset:0
    ds_read_b128 v[44:47], v6 offset:640
    s_mov_b64 exec, -1
    s_cmp_lt_u32 s18, 4
    s_cbranch_scc0 interleave_layers__softmax_full_mha__sliding_local_dilated__prompt_kernel_hk23
    buffer_load_dwordx4 v[208:211], v22, s[12:15], s43 offen sc1
    s_add_u32 s43, s43, 1024
    buffer_load_dwordx4 v[208:211], v22, s[12:15], s43 offen sc1
    s_add_u32 s43, s43, 1024
interleave_layers__softmax_full_mha__sliding_local_dilated__prompt_kernel_hk23:
    v_exp_f32 v60, v60
    v_exp_f32 v61, v61
    v_exp_f32 v62, v62
    v_exp_f32 v63, v63
    v_cvt_pk_bf16_f32 v88, v56, v57
    v_cvt_pk_bf16_f32 v89, v58, v59
    v_cvt_pk_bf16_f32 v90, v60, v61
    v_cvt_pk_bf16_f32 v91, v62, v63
    v_mfma_f32_32x32x8_bf16 v[72:87], v[36:37], v[18:19], v[72:87]
    v_exp_f32 v64, v64
    v_exp_f32 v65, v65
    v_exp_f32 v66, v66
    v_exp_f32 v67, v67
    s_waitcnt lgkmcnt(4)
    v_mfma_f32_32x32x16_bf16 v[96:111], v[48:51], v[88:91], v[96:111]
    v_exp_f32 v68, v68
    v_exp_f32 v69, v69
    v_exp_f32 v70, v70
    v_exp_f32 v71, v71
    v_cvt_pk_bf16_f32 v92, v64, v65
    v_cvt_pk_bf16_f32 v93, v66, v67
    v_cvt_pk_bf16_f32 v94, v68, v69
    v_cvt_pk_bf16_f32 v95, v70, v71
    s_waitcnt lgkmcnt(2)
    v_mfma_f32_32x32x16_bf16 v[56:71], v[24:27], v[8:11], 0
    ds_read_b128 v[32:35], v4 offset:5120
    ds_read_b64 v[36:37], v5 offset:5120
    v_exp_f32 v72, v72
    v_exp_f32 v73, v73
    v_exp_f32 v74, v74
    v_exp_f32 v75, v75
    v_mfma_f32_32x32x16_bf16 v[96:111], v[52:55], v[92:95], v[96:111]
    s_cmp_lg_u32 s4, 0
    s_cbranch_scc0 interleave_layers__softmax_full_mha__sliding_local_dilated__prompt_kernel_hk24
    buffer_store_dwordx4 v[176:179], v22, s[12:15], s54 offen offset:0 sc1
interleave_layers__softmax_full_mha__sliding_local_dilated__prompt_kernel_hk24:
    v_exp_f32 v76, v76
    v_exp_f32 v77, v77
    v_exp_f32 v78, v78
    v_exp_f32 v79, v79
    v_cvt_pk_bf16_f32 v88, v72, v73
    v_cvt_pk_bf16_f32 v89, v74, v75
    v_cvt_pk_bf16_f32 v90, v76, v77
    v_cvt_pk_bf16_f32 v91, v78, v79
    v_mfma_f32_32x32x8_bf16 v[56:71], v[28:29], v[12:13], v[56:71]
    v_exp_f32 v80, v80
    v_exp_f32 v81, v81
    v_exp_f32 v82, v82
    v_exp_f32 v83, v83
    v_mfma_f32_32x32x16_bf16 v[112:127], v[48:51], v[88:91], v[112:127]
    v_exp_f32 v84, v84
    v_exp_f32 v85, v85
    v_exp_f32 v86, v86
    v_exp_f32 v87, v87
    v_cvt_pk_bf16_f32 v92, v80, v81
    v_cvt_pk_bf16_f32 v93, v82, v83
    v_cvt_pk_bf16_f32 v94, v84, v85
    v_cvt_pk_bf16_f32 v95, v86, v87
    v_mfma_f32_32x32x16_bf16 v[72:87], v[24:27], v[14:17], 0
    v_exp_f32 v56, v56
    v_exp_f32 v57, v57
    v_exp_f32 v58, v58
    v_exp_f32 v59, v59
    v_mfma_f32_32x32x16_bf16 v[112:127], v[52:55], v[92:95], v[112:127]
    s_mov_b64 exec, s[28:29]
    ds_read_b128 v[48:51], v6 offset:5120
    ds_read_b128 v[52:55], v6 offset:5760
    s_mov_b64 exec, -1
    s_cmp_lt_u32 s18, 4
    s_cbranch_scc0 interleave_layers__softmax_full_mha__sliding_local_dilated__prompt_kernel_hk25
    buffer_load_dwordx4 v[208:211], v22, s[12:15], s43 offen sc1
    s_add_u32 s43, s43, 1024
    buffer_load_dwordx4 v[208:211], v22, s[12:15], s43 offen sc1
    s_add_u32 s43, s43, 1024
interleave_layers__softmax_full_mha__sliding_local_dilated__prompt_kernel_hk25:
    v_exp_f32 v60, v60
    v_exp_f32 v61, v61
    v_exp_f32 v62, v62
    v_exp_f32 v63, v63
    v_cvt_pk_bf16_f32 v88, v56, v57
    v_cvt_pk_bf16_f32 v89, v58, v59
    v_cvt_pk_bf16_f32 v90, v60, v61
    v_cvt_pk_bf16_f32 v91, v62, v63
    v_mfma_f32_32x32x8_bf16 v[72:87], v[28:29], v[18:19], v[72:87]
    v_exp_f32 v64, v64
    v_exp_f32 v65, v65
    v_exp_f32 v66, v66
    v_exp_f32 v67, v67
    s_waitcnt lgkmcnt(4)
    v_mfma_f32_32x32x16_bf16 v[96:111], v[40:43], v[88:91], v[96:111]
    v_exp_f32 v68, v68
    v_exp_f32 v69, v69
    v_exp_f32 v70, v70
    v_exp_f32 v71, v71
    v_cvt_pk_bf16_f32 v92, v64, v65
    v_cvt_pk_bf16_f32 v93, v66, v67
    v_cvt_pk_bf16_f32 v94, v68, v69
    v_cvt_pk_bf16_f32 v95, v70, v71
    s_waitcnt lgkmcnt(2)
    v_mfma_f32_32x32x16_bf16 v[56:71], v[32:35], v[8:11], 0
    ds_read_b128 v[24:27], v4 offset:10240
    ds_read_b64 v[28:29], v5 offset:10240
    v_exp_f32 v72, v72
    v_exp_f32 v73, v73
    v_exp_f32 v74, v74
    v_exp_f32 v75, v75
    v_mfma_f32_32x32x16_bf16 v[96:111], v[44:47], v[92:95], v[96:111]
    s_cmp_lg_u32 s4, 0
    s_cbranch_scc0 interleave_layers__softmax_full_mha__sliding_local_dilated__prompt_kernel_hk26
    buffer_store_dwordx4 v[180:183], v22, s[12:15], s58 offen offset:1024 sc1
interleave_layers__softmax_full_mha__sliding_local_dilated__prompt_kernel_hk26:
    v_exp_f32 v76, v76
    v_exp_f32 v77, v77
    v_exp_f32 v78, v78
    v_exp_f32 v79, v79
    v_cvt_pk_bf16_f32 v88, v72, v73
    v_cvt_pk_bf16_f32 v89, v74, v75
    v_cvt_pk_bf16_f32 v90, v76, v77
    v_cvt_pk_bf16_f32 v91, v78, v79
    v_mfma_f32_32x32x8_bf16 v[56:71], v[36:37], v[12:13], v[56:71]
    v_exp_f32 v80, v80
    v_exp_f32 v81, v81
    v_exp_f32 v82, v82
    v_exp_f32 v83, v83
    v_mfma_f32_32x32x16_bf16 v[112:127], v[40:43], v[88:91], v[112:127]
    v_exp_f32 v84, v84
    v_exp_f32 v85, v85
    v_exp_f32 v86, v86
    v_exp_f32 v87, v87
    v_cvt_pk_bf16_f32 v92, v80, v81
    v_cvt_pk_bf16_f32 v93, v82, v83
    v_cvt_pk_bf16_f32 v94, v84, v85
    v_cvt_pk_bf16_f32 v95, v86, v87
    v_mfma_f32_32x32x16_bf16 v[72:87], v[32:35], v[14:17], 0
    v_exp_f32 v56, v56
    v_exp_f32 v57, v57
    v_exp_f32 v58, v58
    v_exp_f32 v59, v59
    v_mfma_f32_32x32x16_bf16 v[112:127], v[44:47], v[92:95], v[112:127]
    s_mov_b64 exec, s[28:29]
    ds_read_b128 v[40:43], v6 offset:10240
    ds_read_b128 v[44:47], v6 offset:10880
    s_mov_b64 exec, -1
    s_cmp_lt_u32 s18, 4
    s_cbranch_scc0 interleave_layers__softmax_full_mha__sliding_local_dilated__prompt_kernel_hk27
    buffer_load_dwordx4 v[208:211], v22, s[12:15], s43 offen sc1
    s_add_u32 s43, s43, 1024
    buffer_load_dwordx4 v[208:211], v22, s[12:15], s43 offen sc1
    s_add_u32 s43, s43, 1024
interleave_layers__softmax_full_mha__sliding_local_dilated__prompt_kernel_hk27:
    v_exp_f32 v60, v60
    v_exp_f32 v61, v61
    v_exp_f32 v62, v62
    v_exp_f32 v63, v63
    v_cvt_pk_bf16_f32 v88, v56, v57
    v_cvt_pk_bf16_f32 v89, v58, v59
    v_cvt_pk_bf16_f32 v90, v60, v61
    v_cvt_pk_bf16_f32 v91, v62, v63
    v_mfma_f32_32x32x8_bf16 v[72:87], v[36:37], v[18:19], v[72:87]
    v_exp_f32 v64, v64
    v_exp_f32 v65, v65
    v_exp_f32 v66, v66
    v_exp_f32 v67, v67
    s_waitcnt lgkmcnt(4)
    v_mfma_f32_32x32x16_bf16 v[96:111], v[48:51], v[88:91], v[96:111]
    v_exp_f32 v68, v68
    v_exp_f32 v69, v69
    v_exp_f32 v70, v70
    v_exp_f32 v71, v71
    v_cvt_pk_bf16_f32 v92, v64, v65
    v_cvt_pk_bf16_f32 v93, v66, v67
    v_cvt_pk_bf16_f32 v94, v68, v69
    v_cvt_pk_bf16_f32 v95, v70, v71
    s_waitcnt lgkmcnt(2)
    v_mfma_f32_32x32x16_bf16 v[56:71], v[24:27], v[8:11], 0
    ds_read_b128 v[32:35], v4 offset:15360
    ds_read_b64 v[36:37], v5 offset:15360
    v_exp_f32 v72, v72
    v_exp_f32 v73, v73
    v_exp_f32 v74, v74
    v_exp_f32 v75, v75
    v_mfma_f32_32x32x16_bf16 v[96:111], v[52:55], v[92:95], v[96:111]
    s_cmp_lg_u32 s4, 0
    s_cbranch_scc0 interleave_layers__softmax_full_mha__sliding_local_dilated__prompt_kernel_hk28
    buffer_store_dwordx4 v[184:187], v22, s[12:15], s58 offen offset:2048 sc1
interleave_layers__softmax_full_mha__sliding_local_dilated__prompt_kernel_hk28:
    v_exp_f32 v76, v76
    v_exp_f32 v77, v77
    v_exp_f32 v78, v78
    v_exp_f32 v79, v79
    v_cvt_pk_bf16_f32 v88, v72, v73
    v_cvt_pk_bf16_f32 v89, v74, v75
    v_cvt_pk_bf16_f32 v90, v76, v77
    v_cvt_pk_bf16_f32 v91, v78, v79
    v_mfma_f32_32x32x8_bf16 v[56:71], v[28:29], v[12:13], v[56:71]
    v_exp_f32 v80, v80
    v_exp_f32 v81, v81
    v_exp_f32 v82, v82
    v_exp_f32 v83, v83
    v_mfma_f32_32x32x16_bf16 v[112:127], v[48:51], v[88:91], v[112:127]
    v_exp_f32 v84, v84
    v_exp_f32 v85, v85
    v_exp_f32 v86, v86
    v_exp_f32 v87, v87
    v_cvt_pk_bf16_f32 v92, v80, v81
    v_cvt_pk_bf16_f32 v93, v82, v83
    v_cvt_pk_bf16_f32 v94, v84, v85
    v_cvt_pk_bf16_f32 v95, v86, v87
    v_mfma_f32_32x32x16_bf16 v[72:87], v[24:27], v[14:17], 0
    v_exp_f32 v56, v56
    v_exp_f32 v57, v57
    v_exp_f32 v58, v58
    v_exp_f32 v59, v59
    v_mfma_f32_32x32x16_bf16 v[112:127], v[52:55], v[92:95], v[112:127]
    s_mov_b64 exec, s[28:29]
    ds_read_b128 v[48:51], v6 offset:15360
    ds_read_b128 v[52:55], v6 offset:16000
    s_mov_b64 exec, -1
    s_cmp_lt_u32 s18, 4
    s_cbranch_scc0 interleave_layers__softmax_full_mha__sliding_local_dilated__prompt_kernel_hk29
    buffer_load_dwordx4 v[208:211], v22, s[12:15], s43 offen sc1
    s_add_u32 s43, s43, 1024
    buffer_load_dwordx4 v[208:211], v22, s[12:15], s43 offen sc1
    s_add_u32 s43, s43, 1024
interleave_layers__softmax_full_mha__sliding_local_dilated__prompt_kernel_hk29:
    v_exp_f32 v60, v60
    v_exp_f32 v61, v61
    v_exp_f32 v62, v62
    v_exp_f32 v63, v63
    v_cvt_pk_bf16_f32 v88, v56, v57
    v_cvt_pk_bf16_f32 v89, v58, v59
    v_cvt_pk_bf16_f32 v90, v60, v61
    v_cvt_pk_bf16_f32 v91, v62, v63
    v_mfma_f32_32x32x8_bf16 v[72:87], v[28:29], v[18:19], v[72:87]
    v_exp_f32 v64, v64
    v_exp_f32 v65, v65
    v_exp_f32 v66, v66
    v_exp_f32 v67, v67
    s_waitcnt lgkmcnt(4)
    v_mfma_f32_32x32x16_bf16 v[96:111], v[40:43], v[88:91], v[96:111]
    v_exp_f32 v68, v68
    v_exp_f32 v69, v69
    v_exp_f32 v70, v70
    v_exp_f32 v71, v71
    v_cvt_pk_bf16_f32 v92, v64, v65
    v_cvt_pk_bf16_f32 v93, v66, v67
    v_cvt_pk_bf16_f32 v94, v68, v69
    v_cvt_pk_bf16_f32 v95, v70, v71
    s_waitcnt lgkmcnt(2)
    v_mfma_f32_32x32x16_bf16 v[56:71], v[32:35], v[8:11], 0
    ds_read_b128 v[24:27], v4 offset:20480
    ds_read_b64 v[28:29], v5 offset:20480
    v_exp_f32 v72, v72
    v_exp_f32 v73, v73
    v_exp_f32 v74, v74
    v_exp_f32 v75, v75
    v_mfma_f32_32x32x16_bf16 v[96:111], v[44:47], v[92:95], v[96:111]
    s_cmp_lg_u32 s4, 0
    s_cbranch_scc0 interleave_layers__softmax_full_mha__sliding_local_dilated__prompt_kernel_hk30
    buffer_store_dwordx4 v[188:191], v22, s[12:15], s58 offen offset:3072 sc1
interleave_layers__softmax_full_mha__sliding_local_dilated__prompt_kernel_hk30:
    v_exp_f32 v76, v76
    v_exp_f32 v77, v77
    v_exp_f32 v78, v78
    v_exp_f32 v79, v79
    v_cvt_pk_bf16_f32 v88, v72, v73
    v_cvt_pk_bf16_f32 v89, v74, v75
    v_cvt_pk_bf16_f32 v90, v76, v77
    v_cvt_pk_bf16_f32 v91, v78, v79
    v_mfma_f32_32x32x8_bf16 v[56:71], v[36:37], v[12:13], v[56:71]
    v_exp_f32 v80, v80
    v_exp_f32 v81, v81
    v_exp_f32 v82, v82
    v_exp_f32 v83, v83
    v_mfma_f32_32x32x16_bf16 v[112:127], v[40:43], v[88:91], v[112:127]
    v_exp_f32 v84, v84
    v_exp_f32 v85, v85
    v_exp_f32 v86, v86
    v_exp_f32 v87, v87
    v_cvt_pk_bf16_f32 v92, v80, v81
    v_cvt_pk_bf16_f32 v93, v82, v83
    v_cvt_pk_bf16_f32 v94, v84, v85
    v_cvt_pk_bf16_f32 v95, v86, v87
    v_mfma_f32_32x32x16_bf16 v[72:87], v[32:35], v[14:17], 0
    v_exp_f32 v56, v56
    v_exp_f32 v57, v57
    v_exp_f32 v58, v58
    v_exp_f32 v59, v59
    v_mfma_f32_32x32x16_bf16 v[112:127], v[44:47], v[92:95], v[112:127]
    s_mov_b64 exec, s[28:29]
    ds_read_b128 v[40:43], v6 offset:20480
    ds_read_b128 v[44:47], v6 offset:21120
    s_mov_b64 exec, -1
    s_cmp_lt_u32 s18, 4
    s_cbranch_scc0 interleave_layers__softmax_full_mha__sliding_local_dilated__prompt_kernel_hk31
    buffer_load_dwordx4 v[208:211], v22, s[12:15], s43 offen sc1
    s_add_u32 s43, s43, 1024
    buffer_load_dwordx4 v[208:211], v22, s[12:15], s43 offen sc1
    s_add_u32 s43, s43, 1024
interleave_layers__softmax_full_mha__sliding_local_dilated__prompt_kernel_hk31:
    v_exp_f32 v60, v60
    v_exp_f32 v61, v61
    v_exp_f32 v62, v62
    v_exp_f32 v63, v63
    v_cvt_pk_bf16_f32 v88, v56, v57
    v_cvt_pk_bf16_f32 v89, v58, v59
    v_cvt_pk_bf16_f32 v90, v60, v61
    v_cvt_pk_bf16_f32 v91, v62, v63
    v_mfma_f32_32x32x8_bf16 v[72:87], v[36:37], v[18:19], v[72:87]
    v_exp_f32 v64, v64
    v_exp_f32 v65, v65
    v_exp_f32 v66, v66
    v_exp_f32 v67, v67
    s_waitcnt lgkmcnt(4)
    v_mfma_f32_32x32x16_bf16 v[96:111], v[48:51], v[88:91], v[96:111]
    v_exp_f32 v68, v68
    v_exp_f32 v69, v69
    v_exp_f32 v70, v70
    v_exp_f32 v71, v71
    v_cvt_pk_bf16_f32 v92, v64, v65
    v_cvt_pk_bf16_f32 v93, v66, v67
    v_cvt_pk_bf16_f32 v94, v68, v69
    v_cvt_pk_bf16_f32 v95, v70, v71
    s_waitcnt lgkmcnt(2)
    v_mfma_f32_32x32x16_bf16 v[56:71], v[24:27], v[8:11], 0
    ds_read_b128 v[32:35], v4 offset:25600
    ds_read_b64 v[36:37], v5 offset:25600
    v_exp_f32 v72, v72
    v_exp_f32 v73, v73
    v_exp_f32 v74, v74
    v_exp_f32 v75, v75
    v_mfma_f32_32x32x16_bf16 v[96:111], v[52:55], v[92:95], v[96:111]
    v_exp_f32 v76, v76
    v_exp_f32 v77, v77
    v_exp_f32 v78, v78
    v_exp_f32 v79, v79
    v_cvt_pk_bf16_f32 v88, v72, v73
    v_cvt_pk_bf16_f32 v89, v74, v75
    v_cvt_pk_bf16_f32 v90, v76, v77
    v_cvt_pk_bf16_f32 v91, v78, v79
    v_mfma_f32_32x32x8_bf16 v[56:71], v[28:29], v[12:13], v[56:71]
    v_exp_f32 v80, v80
    v_exp_f32 v81, v81
    v_exp_f32 v82, v82
    v_exp_f32 v83, v83
    v_mfma_f32_32x32x16_bf16 v[112:127], v[48:51], v[88:91], v[112:127]
    v_exp_f32 v84, v84
    v_exp_f32 v85, v85
    v_exp_f32 v86, v86
    v_exp_f32 v87, v87
    v_cvt_pk_bf16_f32 v92, v80, v81
    v_cvt_pk_bf16_f32 v93, v82, v83
    v_cvt_pk_bf16_f32 v94, v84, v85
    v_cvt_pk_bf16_f32 v95, v86, v87
    v_mfma_f32_32x32x16_bf16 v[72:87], v[24:27], v[14:17], 0
    v_exp_f32 v56, v56
    v_exp_f32 v57, v57
    v_exp_f32 v58, v58
    v_exp_f32 v59, v59
    v_mfma_f32_32x32x16_bf16 v[112:127], v[52:55], v[92:95], v[112:127]
    s_mov_b64 exec, s[28:29]
    ds_read_b128 v[48:51], v6 offset:25600
    ds_read_b128 v[52:55], v6 offset:26240
    s_mov_b64 exec, -1
    s_cmp_lg_u32 s4, 0
    s_cbranch_scc0 interleave_layers__softmax_full_mha__sliding_local_dilated__prompt_kernel_hk32
    v_mov_b32 v241, 0
    v_mov_b32 v240, 1
    s_waitcnt vmcnt(0)
    s_mov_b64 exec, 1
    buffer_atomic_add v240, v241, s[12:15], s55 offen sc1
    s_mov_b64 exec, -1
interleave_layers__softmax_full_mha__sliding_local_dilated__prompt_kernel_hk32:
    s_cmp_lt_u32 s18, 4
    s_cbranch_scc0 interleave_layers__softmax_full_mha__sliding_local_dilated__prompt_kernel_hk33
    buffer_load_dwordx4 v[208:211], v22, s[12:15], s43 offen sc1
    s_add_u32 s43, s43, 1024
    buffer_load_dwordx4 v[208:211], v22, s[12:15], s43 offen sc1
    s_add_u32 s43, s43, 1024
interleave_layers__softmax_full_mha__sliding_local_dilated__prompt_kernel_hk33:
    v_exp_f32 v60, v60
    v_exp_f32 v61, v61
    v_exp_f32 v62, v62
    v_exp_f32 v63, v63
    v_cvt_pk_bf16_f32 v88, v56, v57
    v_cvt_pk_bf16_f32 v89, v58, v59
    v_cvt_pk_bf16_f32 v90, v60, v61
    v_cvt_pk_bf16_f32 v91, v62, v63
    v_mfma_f32_32x32x8_bf16 v[72:87], v[28:29], v[18:19], v[72:87]
    v_exp_f32 v64, v64
    v_exp_f32 v65, v65
    v_exp_f32 v66, v66
    v_exp_f32 v67, v67
    s_waitcnt lgkmcnt(4)
    v_mfma_f32_32x32x16_bf16 v[96:111], v[40:43], v[88:91], v[96:111]
    v_exp_f32 v68, v68
    v_exp_f32 v69, v69
    v_exp_f32 v70, v70
    v_exp_f32 v71, v71
    v_cvt_pk_bf16_f32 v92, v64, v65
    v_cvt_pk_bf16_f32 v93, v66, v67
    v_cvt_pk_bf16_f32 v94, v68, v69
    v_cvt_pk_bf16_f32 v95, v70, v71
    s_waitcnt lgkmcnt(2)
    v_mfma_f32_32x32x16_bf16 v[56:71], v[32:35], v[8:11], 0
    ds_read_b128 v[24:27], v4 offset:30720
    ds_read_b64 v[28:29], v5 offset:30720
    v_exp_f32 v72, v72
    v_exp_f32 v73, v73
    v_exp_f32 v74, v74
    v_exp_f32 v75, v75
    v_mfma_f32_32x32x16_bf16 v[96:111], v[44:47], v[92:95], v[96:111]
    v_exp_f32 v76, v76
    v_exp_f32 v77, v77
    v_exp_f32 v78, v78
    v_exp_f32 v79, v79
    v_cvt_pk_bf16_f32 v88, v72, v73
    v_cvt_pk_bf16_f32 v89, v74, v75
    v_cvt_pk_bf16_f32 v90, v76, v77
    v_cvt_pk_bf16_f32 v91, v78, v79
    v_mfma_f32_32x32x8_bf16 v[56:71], v[36:37], v[12:13], v[56:71]
    v_exp_f32 v80, v80
    v_exp_f32 v81, v81
    v_exp_f32 v82, v82
    v_exp_f32 v83, v83
    v_mfma_f32_32x32x16_bf16 v[112:127], v[40:43], v[88:91], v[112:127]
    v_exp_f32 v84, v84
    v_exp_f32 v85, v85
    v_exp_f32 v86, v86
    v_exp_f32 v87, v87
    v_cvt_pk_bf16_f32 v92, v80, v81
    v_cvt_pk_bf16_f32 v93, v82, v83
    v_cvt_pk_bf16_f32 v94, v84, v85
    v_cvt_pk_bf16_f32 v95, v86, v87
    v_mfma_f32_32x32x16_bf16 v[72:87], v[32:35], v[14:17], 0
    v_exp_f32 v56, v56
    v_exp_f32 v57, v57
    v_exp_f32 v58, v58
    v_exp_f32 v59, v59
    v_mfma_f32_32x32x16_bf16 v[112:127], v[44:47], v[92:95], v[112:127]
    s_mov_b64 exec, s[28:29]
    ds_read_b128 v[40:43], v6 offset:30720
    ds_read_b128 v[44:47], v6 offset:31360
    s_mov_b64 exec, -1
    s_cmp_lt_u32 s18, 4
    s_cbranch_scc0 interleave_layers__softmax_full_mha__sliding_local_dilated__prompt_kernel_hk34
    buffer_load_dwordx4 v[208:211], v22, s[12:15], s43 offen sc1
    s_add_u32 s43, s43, 1024
    buffer_load_dwordx4 v[208:211], v22, s[12:15], s43 offen sc1
    s_add_u32 s43, s43, 1024
interleave_layers__softmax_full_mha__sliding_local_dilated__prompt_kernel_hk34:
    s_setprio 0
    v_exp_f32 v60, v60
    v_exp_f32 v61, v61
    v_exp_f32 v62, v62
    v_exp_f32 v63, v63
    v_cvt_pk_bf16_f32 v88, v56, v57
    v_cvt_pk_bf16_f32 v89, v58, v59
    v_cvt_pk_bf16_f32 v90, v60, v61
    v_cvt_pk_bf16_f32 v91, v62, v63
    v_mfma_f32_32x32x8_bf16 v[72:87], v[36:37], v[18:19], v[72:87]
    v_exp_f32 v64, v64
    v_exp_f32 v65, v65
    v_exp_f32 v66, v66
    v_exp_f32 v67, v67
    s_waitcnt lgkmcnt(4)
    v_mfma_f32_32x32x16_bf16 v[96:111], v[48:51], v[88:91], v[96:111]
    v_exp_f32 v68, v68
    v_exp_f32 v69, v69
    v_exp_f32 v70, v70
    v_exp_f32 v71, v71
    v_cvt_pk_bf16_f32 v92, v64, v65
    v_cvt_pk_bf16_f32 v93, v66, v67
    v_cvt_pk_bf16_f32 v94, v68, v69
    v_cvt_pk_bf16_f32 v95, v70, v71
    s_waitcnt lgkmcnt(2)
    v_mfma_f32_32x32x16_bf16 v[56:71], v[24:27], v[8:11], 0
    ds_read_b128 v[32:35], v4 offset:35840
    ds_read_b64 v[36:37], v5 offset:35840
    v_exp_f32 v72, v72
    v_exp_f32 v73, v73
    v_exp_f32 v74, v74
    v_exp_f32 v75, v75
    v_mfma_f32_32x32x16_bf16 v[96:111], v[52:55], v[92:95], v[96:111]
    s_cmp_eq_u32 s18, 0
    s_cbranch_scc0 interleave_layers__softmax_full_mha__sliding_local_dilated__prompt_kernel_hk35
    s_mov_b32 exec_lo, 0xffff7fff
    s_mov_b32 exec_hi, 0
    buffer_load_dword v135, v134, s[12:15], 0 offen sc1
    s_mov_b64 exec, -1
interleave_layers__softmax_full_mha__sliding_local_dilated__prompt_kernel_hk35:
    v_exp_f32 v76, v76
    v_exp_f32 v77, v77
    v_exp_f32 v78, v78
    v_exp_f32 v79, v79
    v_cvt_pk_bf16_f32 v88, v72, v73
    v_cvt_pk_bf16_f32 v89, v74, v75
    v_cvt_pk_bf16_f32 v90, v76, v77
    v_cvt_pk_bf16_f32 v91, v78, v79
    v_mfma_f32_32x32x8_bf16 v[56:71], v[28:29], v[12:13], v[56:71]
    v_exp_f32 v80, v80
    v_exp_f32 v81, v81
    v_exp_f32 v82, v82
    v_exp_f32 v83, v83
    v_mfma_f32_32x32x16_bf16 v[112:127], v[48:51], v[88:91], v[112:127]
    v_exp_f32 v84, v84
    v_exp_f32 v85, v85
    v_exp_f32 v86, v86
    v_exp_f32 v87, v87
    v_cvt_pk_bf16_f32 v92, v80, v81
    v_cvt_pk_bf16_f32 v93, v82, v83
    v_cvt_pk_bf16_f32 v94, v84, v85
    v_cvt_pk_bf16_f32 v95, v86, v87
    v_mfma_f32_32x32x16_bf16 v[72:87], v[24:27], v[14:17], 0
    v_exp_f32 v56, v56
    v_exp_f32 v57, v57
    v_exp_f32 v58, v58
    v_exp_f32 v59, v59
    v_mfma_f32_32x32x16_bf16 v[112:127], v[52:55], v[92:95], v[112:127]
    s_mov_b64 exec, s[28:29]
    ds_read_b128 v[48:51], v6 offset:35840
    ds_read_b128 v[52:55], v6 offset:36480
    s_mov_b64 exec, -1
    s_cmp_lt_u32 s18, 4
    s_cbranch_scc0 interleave_layers__softmax_full_mha__sliding_local_dilated__prompt_kernel_hk36
    buffer_load_dwordx4 v[208:211], v22, s[12:15], s43 offen sc1
    s_add_u32 s43, s43, 1024
    buffer_load_dwordx4 v[208:211], v22, s[12:15], s43 offen sc1
    s_add_u32 s43, s43, 1024
interleave_layers__softmax_full_mha__sliding_local_dilated__prompt_kernel_hk36:
    v_exp_f32 v60, v60
    v_exp_f32 v61, v61
    v_exp_f32 v62, v62
    v_exp_f32 v63, v63
    v_cvt_pk_bf16_f32 v88, v56, v57
    v_cvt_pk_bf16_f32 v89, v58, v59
    v_cvt_pk_bf16_f32 v90, v60, v61
    v_cvt_pk_bf16_f32 v91, v62, v63
    v_mfma_f32_32x32x8_bf16 v[72:87], v[28:29], v[18:19], v[72:87]
    v_exp_f32 v64, v64
    v_exp_f32 v65, v65
    v_exp_f32 v66, v66
    v_exp_f32 v67, v67
    s_waitcnt lgkmcnt(4)
    v_mfma_f32_32x32x16_bf16 v[96:111], v[40:43], v[88:91], v[96:111]
    v_exp_f32 v68, v68
    v_exp_f32 v69, v69
    v_exp_f32 v70, v70
    v_exp_f32 v71, v71
    v_cvt_pk_bf16_f32 v92, v64, v65
    v_cvt_pk_bf16_f32 v93, v66, v67
    v_cvt_pk_bf16_f32 v94, v68, v69
    v_cvt_pk_bf16_f32 v95, v70, v71
    s_waitcnt lgkmcnt(2)
    v_mfma_f32_32x32x16_bf16 v[56:71], v[32:35], v[8:11], 0
    ds_read_b128 v[24:27], v4 offset:40960
    ds_read_b64 v[28:29], v5 offset:40960
    v_exp_f32 v72, v72
    v_exp_f32 v73, v73
    v_exp_f32 v74, v74
    v_exp_f32 v75, v75
    v_mfma_f32_32x32x16_bf16 v[96:111], v[44:47], v[92:95], v[96:111]
    v_exp_f32 v76, v76
    v_exp_f32 v77, v77
    v_exp_f32 v78, v78
    v_exp_f32 v79, v79
    v_cvt_pk_bf16_f32 v88, v72, v73
    v_cvt_pk_bf16_f32 v89, v74, v75
    v_cvt_pk_bf16_f32 v90, v76, v77
    v_cvt_pk_bf16_f32 v91, v78, v79
    v_mfma_f32_32x32x8_bf16 v[56:71], v[36:37], v[12:13], v[56:71]
    v_exp_f32 v80, v80
    v_exp_f32 v81, v81
    v_exp_f32 v82, v82
    v_exp_f32 v83, v83
    v_mfma_f32_32x32x16_bf16 v[112:127], v[40:43], v[88:91], v[112:127]
    v_exp_f32 v84, v84
    v_exp_f32 v85, v85
    v_exp_f32 v86, v86
    v_exp_f32 v87, v87
    v_cvt_pk_bf16_f32 v92, v80, v81
    v_cvt_pk_bf16_f32 v93, v82, v83
    v_cvt_pk_bf16_f32 v94, v84, v85
    v_cvt_pk_bf16_f32 v95, v86, v87
    v_mfma_f32_32x32x16_bf16 v[72:87], v[32:35], v[14:17], 0
    v_exp_f32 v56, v56
    v_exp_f32 v57, v57
    v_exp_f32 v58, v58
    v_exp_f32 v59, v59
    v_mfma_f32_32x32x16_bf16 v[112:127], v[44:47], v[92:95], v[112:127]
    s_mov_b64 exec, s[28:29]
    ds_read_b128 v[40:43], v6 offset:40960
    ds_read_b128 v[44:47], v6 offset:41600
    s_mov_b64 exec, -1
    v_exp_f32 v60, v60
    v_exp_f32 v61, v61
    v_exp_f32 v62, v62
    v_exp_f32 v63, v63
    v_cvt_pk_bf16_f32 v88, v56, v57
    v_cvt_pk_bf16_f32 v89, v58, v59
    v_cvt_pk_bf16_f32 v90, v60, v61
    v_cvt_pk_bf16_f32 v91, v62, v63
    v_mfma_f32_32x32x8_bf16 v[72:87], v[36:37], v[18:19], v[72:87]
    v_exp_f32 v64, v64
    v_exp_f32 v65, v65
    v_exp_f32 v66, v66
    v_exp_f32 v67, v67
    s_waitcnt lgkmcnt(4)
    v_mfma_f32_32x32x16_bf16 v[96:111], v[48:51], v[88:91], v[96:111]
    v_exp_f32 v68, v68
    v_exp_f32 v69, v69
    v_exp_f32 v70, v70
    v_exp_f32 v71, v71
    v_cvt_pk_bf16_f32 v92, v64, v65
    v_cvt_pk_bf16_f32 v93, v66, v67
    v_cvt_pk_bf16_f32 v94, v68, v69
    v_cvt_pk_bf16_f32 v95, v70, v71
    s_waitcnt lgkmcnt(2)
    v_mfma_f32_32x32x16_bf16 v[56:71], v[24:27], v[8:11], 0
    ds_read_b128 v[32:35], v4 offset:46080
    ds_read_b64 v[36:37], v5 offset:46080
    v_exp_f32 v72, v72
    v_exp_f32 v73, v73
    v_exp_f32 v74, v74
    v_exp_f32 v75, v75
    v_mfma_f32_32x32x16_bf16 v[96:111], v[52:55], v[92:95], v[96:111]
    v_exp_f32 v76, v76
    v_exp_f32 v77, v77
    v_exp_f32 v78, v78
    v_exp_f32 v79, v79
    v_cvt_pk_bf16_f32 v88, v72, v73
    v_cvt_pk_bf16_f32 v89, v74, v75
    v_cvt_pk_bf16_f32 v90, v76, v77
    v_cvt_pk_bf16_f32 v91, v78, v79
    v_mfma_f32_32x32x8_bf16 v[56:71], v[28:29], v[12:13], v[56:71]
    v_exp_f32 v80, v80
    v_exp_f32 v81, v81
    v_exp_f32 v82, v82
    v_exp_f32 v83, v83
    v_mfma_f32_32x32x16_bf16 v[112:127], v[48:51], v[88:91], v[112:127]
    v_exp_f32 v84, v84
    v_exp_f32 v85, v85
    v_exp_f32 v86, v86
    v_exp_f32 v87, v87
    v_cvt_pk_bf16_f32 v92, v80, v81
    v_cvt_pk_bf16_f32 v93, v82, v83
    v_cvt_pk_bf16_f32 v94, v84, v85
    v_cvt_pk_bf16_f32 v95, v86, v87
    v_mfma_f32_32x32x16_bf16 v[72:87], v[24:27], v[14:17], 0
    v_exp_f32 v56, v56
    v_exp_f32 v57, v57
    v_exp_f32 v58, v58
    v_exp_f32 v59, v59
    v_mfma_f32_32x32x16_bf16 v[112:127], v[52:55], v[92:95], v[112:127]
    s_mov_b64 exec, s[28:29]
    ds_read_b128 v[48:51], v6 offset:46080
    ds_read_b128 v[52:55], v6 offset:46720
    s_mov_b64 exec, -1
    v_exp_f32 v60, v60
    v_exp_f32 v61, v61
    v_exp_f32 v62, v62
    v_exp_f32 v63, v63
    v_cvt_pk_bf16_f32 v88, v56, v57
    v_cvt_pk_bf16_f32 v89, v58, v59
    v_cvt_pk_bf16_f32 v90, v60, v61
    v_cvt_pk_bf16_f32 v91, v62, v63
    v_mfma_f32_32x32x8_bf16 v[72:87], v[28:29], v[18:19], v[72:87]
    v_exp_f32 v64, v64
    v_exp_f32 v65, v65
    v_exp_f32 v66, v66
    v_exp_f32 v67, v67
    s_waitcnt lgkmcnt(4)
    v_mfma_f32_32x32x16_bf16 v[96:111], v[40:43], v[88:91], v[96:111]
    v_exp_f32 v68, v68
    v_exp_f32 v69, v69
    v_exp_f32 v70, v70
    v_exp_f32 v71, v71
    v_cvt_pk_bf16_f32 v92, v64, v65
    v_cvt_pk_bf16_f32 v93, v66, v67
    v_cvt_pk_bf16_f32 v94, v68, v69
    v_cvt_pk_bf16_f32 v95, v70, v71
    s_waitcnt lgkmcnt(2)
    v_mfma_f32_32x32x16_bf16 v[56:71], v[32:35], v[8:11], 0
    v_exp_f32 v72, v72
    v_exp_f32 v73, v73
    v_exp_f32 v74, v74
    v_exp_f32 v75, v75
    v_mfma_f32_32x32x16_bf16 v[96:111], v[44:47], v[92:95], v[96:111]
    v_exp_f32 v76, v76
    v_exp_f32 v77, v77
    v_exp_f32 v78, v78
    v_exp_f32 v79, v79
    v_cvt_pk_bf16_f32 v88, v72, v73
    v_cvt_pk_bf16_f32 v89, v74, v75
    v_cvt_pk_bf16_f32 v90, v76, v77
    v_cvt_pk_bf16_f32 v91, v78, v79
    v_mfma_f32_32x32x8_bf16 v[56:71], v[36:37], v[12:13], v[56:71]
    v_exp_f32 v80, v80
    v_exp_f32 v81, v81
    v_exp_f32 v82, v82
    v_exp_f32 v83, v83
    v_mfma_f32_32x32x16_bf16 v[112:127], v[40:43], v[88:91], v[112:127]
    v_exp_f32 v84, v84
    v_exp_f32 v85, v85
    v_exp_f32 v86, v86
    v_exp_f32 v87, v87
    v_cvt_pk_bf16_f32 v92, v80, v81
    v_cvt_pk_bf16_f32 v93, v82, v83
    v_cvt_pk_bf16_f32 v94, v84, v85
    v_cvt_pk_bf16_f32 v95, v86, v87
    v_mfma_f32_32x32x16_bf16 v[72:87], v[32:35], v[14:17], 0
    v_exp_f32 v56, v56
    v_exp_f32 v57, v57
    v_exp_f32 v58, v58
    v_exp_f32 v59, v59
    v_mfma_f32_32x32x16_bf16 v[112:127], v[44:47], v[92:95], v[112:127]
    v_exp_f32 v60, v60
    v_exp_f32 v61, v61
    v_exp_f32 v62, v62
    v_exp_f32 v63, v63
    v_cvt_pk_bf16_f32 v88, v56, v57
    v_cvt_pk_bf16_f32 v89, v58, v59
    v_cvt_pk_bf16_f32 v90, v60, v61
    v_cvt_pk_bf16_f32 v91, v62, v63
    v_mfma_f32_32x32x8_bf16 v[72:87], v[36:37], v[18:19], v[72:87]
    v_exp_f32 v64, v64
    v_exp_f32 v65, v65
    v_exp_f32 v66, v66
    v_exp_f32 v67, v67
    s_waitcnt lgkmcnt(0)
    v_mfma_f32_32x32x16_bf16 v[96:111], v[48:51], v[88:91], v[96:111]
    v_exp_f32 v68, v68
    v_exp_f32 v69, v69
    v_exp_f32 v70, v70
    v_exp_f32 v71, v71
    v_cvt_pk_bf16_f32 v92, v64, v65
    v_cvt_pk_bf16_f32 v93, v66, v67
    v_cvt_pk_bf16_f32 v94, v68, v69
    v_cvt_pk_bf16_f32 v95, v70, v71
    s_waitcnt lgkmcnt(0)
    v_exp_f32 v72, v72
    v_exp_f32 v73, v73
    v_exp_f32 v74, v74
    v_exp_f32 v75, v75
    v_mfma_f32_32x32x16_bf16 v[96:111], v[52:55], v[92:95], v[96:111]
    v_exp_f32 v76, v76
    v_exp_f32 v77, v77
    v_exp_f32 v78, v78
    v_exp_f32 v79, v79
    v_cvt_pk_bf16_f32 v88, v72, v73
    v_cvt_pk_bf16_f32 v89, v74, v75
    v_cvt_pk_bf16_f32 v90, v76, v77
    v_cvt_pk_bf16_f32 v91, v78, v79
    v_exp_f32 v80, v80
    v_exp_f32 v81, v81
    v_exp_f32 v82, v82
    v_exp_f32 v83, v83
    v_mfma_f32_32x32x16_bf16 v[112:127], v[48:51], v[88:91], v[112:127]
    v_exp_f32 v84, v84
    v_exp_f32 v85, v85
    v_exp_f32 v86, v86
    v_exp_f32 v87, v87
    v_cvt_pk_bf16_f32 v92, v80, v81
    v_cvt_pk_bf16_f32 v93, v82, v83
    v_cvt_pk_bf16_f32 v94, v84, v85
    v_cvt_pk_bf16_f32 v95, v86, v87
    s_nop 1
    v_mfma_f32_32x32x16_bf16 v[112:127], v[52:55], v[92:95], v[112:127]
    s_mov_b32 s30, 0
    s_mov_b32 s32, 0x21800000
    s_mov_b32 s33, 0x71800000
    s_mov_b32 s34, 0x7e800000
interleave_layers__softmax_full_mha__sliding_local_dilated__prompt_kernel_scrok:
    s_nop 7
    ds_write_b128 v132, v[112:115] offset:0
    ds_write_b128 v132, v[116:119] offset:1024
    ds_write_b128 v132, v[120:123] offset:2048
    s_waitcnt vmcnt(0)
    v_cmp_gt_u32 vcc, v131, v135
    s_cbranch_vccnz interleave_layers__softmax_full_mha__sliding_local_dilated__prompt_kernel_late
interleave_layers__softmax_full_mha__sliding_local_dilated__prompt_kernel_lok:
    s_waitcnt lgkmcnt(0)
    s_barrier
    ds_read_b128 v[64:67], v133 offset:2048
    ds_read_b128 v[56:59], v133 offset:0
    ds_read_b128 v[60:63], v133 offset:1024
    s_waitcnt lgkmcnt(2)
    v_add_f32 v104, v104, v64
    v_add_f32 v105, v105, v65
    v_add_f32 v106, v106, v66
    v_add_f32 v107, v107, v67
    s_waitcnt lgkmcnt(0)
    v_add_f32 v96, v96, v56
    v_add_f32 v97, v97, v57
    v_add_f32 v98, v98, v58
    v_add_f32 v99, v99, v59
    v_add_f32 v100, v100, v60
    v_add_f32 v101, v101, v61
    v_add_f32 v102, v102, v62
    v_add_f32 v103, v103, v63
interleave_layers__softmax_full_mha__sliding_local_dilated__prompt_kernel_chk:
    v_mov_b32 v30, v104
    v_mov_b32 v31, v104
    v_max3_f32 v28, abs(v96), abs(v97), abs(v98)
    s_nop 0
    v_permlane32_swap_b32 v30, v31
    v_max3_f32 v28, abs(v99), abs(v100), v28
    v_rcp_f32 v30, v31
    v_max3_f32 v28, abs(v101), abs(v102), v28
    v_mul_f32 v72, v96, v30
    v_mul_f32 v73, v97, v30
    v_mul_f32 v74, v98, v30
    v_mul_f32 v75, v99, v30
    v_mul_f32 v76, v100, v30
    v_mul_f32 v77, v101, v30
    v_mul_f32 v78, v102, v30
    v_mul_f32 v79, v103, v30
    v_mul_f32 v80, v104, v30
    v_mul_f32 v81, v105, v30
    v_mul_f32 v82, v106, v30
    v_mul_f32 v83, v107, v30
    v_cvt_pk_bf16_f32 v88, v72, v73
    v_cvt_pk_bf16_f32 v89, v74, v75
    v_cvt_pk_bf16_f32 v90, v76, v77
    v_cvt_pk_bf16_f32 v91, v78, v79
    v_cvt_pk_bf16_f32 v92, v80, v81
    v_cvt_pk_bf16_f32 v93, v82, v83
    buffer_store_dwordx4 v[88:91], v39, s[12:15], s51 offen sc1
    s_mov_b32 exec_hi, 0
    buffer_store_dwordx2 v[92:93], v38, s[12:15], s52 offen sc1
    s_mov_b64 exec, -1
    s_add_u32 m0, s25, 0
    s_add_u32 s27, s50, 0
    buffer_load_dwordx4 v22, s[12:15], s27 offen sc1 lds
    s_add_u32 m0, s25, 8192
    s_add_u32 s27, s50, 8192
    buffer_load_dwordx4 v22, s[12:15], s27 offen sc1 lds
    s_add_u32 m0, s25, 16384
    s_add_u32 s27, s50, 16384
    buffer_load_dwordx4 v22, s[12:15], s27 offen sc1 lds
    v_max3_f32 v28, abs(v103), abs(v104), v28
    v_max3_f32 v28, abs(v105), abs(v106), v28
    v_max_f32 v28, abs(v107), v28
    v_cmp_le_f32 vcc, s32, v31
    v_cmp_ge_f32 s[36:37], s33, v31
    v_cmp_gt_f32 s[40:41], s34, v28
    s_and_b64 s[36:37], s[36:37], vcc
    s_and_b64 s[36:37], s[36:37], s[40:41]
    s_cmp_eq_u64 s[36:37], -1
    s_cbranch_scc0 interleave_layers__softmax_full_mha__sliding_local_dilated__prompt_kernel_slow
interleave_layers__softmax_full_mha__sliding_local_dilated__prompt_kernel_fin:
    v_lshlrev_b32 v3, 4, v1
    s_cmp_ge_u32 s18, 4
    s_cbranch_scc1 interleave_layers__softmax_full_mha__sliding_local_dilated__prompt_kernel_ld
    s_lshl_b32 s48, s17, 3
    s_and_b32 s49, s16, 1
    s_add_u32 s48, s48, s49
    s_lshl_b32 s48, s48, 8
    s_add_u32 s48, s48, 0
    v_lshlrev_b32 v241, 9, v1
    s_mov_b64 s[56:57], 15
    v_mov_b32 v243, 163816
    v_mov_b32 v240, 1
    s_mov_b64 exec, 1
    s_waitcnt vmcnt(0)
    ds_add_rtn_u32 v242, v243, v240 offset:8
    s_waitcnt lgkmcnt(0)
    v_readfirstlane_b32 s49, v242
    s_mov_b64 exec, s[56:57]
    s_cmp_eq_u32 s49, 7
    s_cbranch_scc0 interleave_layers__softmax_full_mha__sliding_local_dilated__prompt_kernel_s1_sg
    buffer_atomic_add v240, v241, s[8:11], s48 offen sc1
interleave_layers__softmax_full_mha__sliding_local_dilated__prompt_kernel_s1_sg:
    s_mov_b64 exec, -1
    s_lshl_b32 s22, s20, 2
    s_and_b32 s23, s21, 3
    s_add_u32 s16, s22, s23
    s_lshr_b32 s17, s21, 2
    s_lshl_b32 s19, s16, 2
    s_add_u32 s19, s19, s39
    s_mul_i32 s24, s19, 20480
    s_lshr_b32 s33, s17, 1
    s_mul_i32 s33, s33, 5120
    s_add_u32 s33, s33, s24
    s_and_b32 s34, s17, 1
    s_mul_i32 s35, s34, 3072
    s_add_u32 s35, s35, s33
    s_lshl_b32 s36, s34, 9
    s_add_u32 s36, s36, s33
    s_add_u32 s36, s36, 2048
    s_add_u32 s37, s35, 131072
    s_add_u32 s38, s36, 131072
    v_lshrrev_b32 v13, 5, v1
    v_lshlrev_b32 v13, 8, v13
    v_and_b32 v14, 15, v1
    v_lshl_add_u32 v13, v14, 4, v13
    v_bfe_u32 v14, v1, 4, 1
    v_lshl_add_u32 v13, v14, 3, v13
    buffer_load_dwordx4 v[44:47], v3, s[12:15], s37 offen sc1
    buffer_load_dwordx4 v[48:51], v3, s[12:15], s37 offen offset:1024 sc1
    buffer_load_dwordx2 v[52:53], v13, s[12:15], s38 offen sc1
    s_add_u32 s24, s24, 10747904
    s_add_u32 s25, s24, 4096
    s_add_u32 s26, s24, 8192
    s_add_u32 s27, s24, 12288
    s_add_u32 s28, s24, 16384
    v_lshrrev_b32 v9, 4, v1
    v_add_u32 v12, 61440, v3
    v_mov_b32 v243, 163816
    s_mov_b32 s49, 0
    s_cmp_eq_u32 s18, 0
    s_cbranch_scc0 interleave_layers__softmax_full_mha__sliding_local_dilated__prompt_kernel_p2_sp
    s_lshl_b32 s48, s16, 9
    s_add_u32 s48, s48, 0
    v_lshlrev_b32 v241, 8, v1
    v_mov_b32 v242, 16
    s_mov_b64 s[56:57], 3
    s_mov_b64 exec, s[56:57]
interleave_layers__softmax_full_mha__sliding_local_dilated__prompt_kernel_p2_pl:
    v_mov_b32 v240, 0
    buffer_atomic_add v240, v241, s[8:11], s48 offen sc0 sc1
    s_add_u32 s49, s49, 1
    s_waitcnt vmcnt(0)
    v_cmp_ge_u32 vcc, v240, v242
    s_cmp_ge_u32 s49, 0x20000
    s_cbranch_scc1 interleave_layers__softmax_full_mha__sliding_local_dilated__prompt_kernel_p2_px
    s_cmp_eq_u64 vcc, exec
    s_cbranch_scc0 interleave_layers__softmax_full_mha__sliding_local_dilated__prompt_kernel_p2_pl
interleave_layers__softmax_full_mha__sliding_local_dilated__prompt_kernel_p2_px:
    s_mov_b64 exec, 1
    v_mov_b32 v240, 1
    ds_write_b32 v243, v240 offset:12
    s_branch interleave_layers__softmax_full_mha__sliding_local_dilated__prompt_kernel_p2_go
interleave_layers__softmax_full_mha__sliding_local_dilated__prompt_kernel_p2_sp:
    s_sleep 1
    ds_read_b32 v240, v243 offset:12
    s_add_u32 s49, s49, 1
    s_waitcnt lgkmcnt(0)
    v_readfirstlane_b32 s44, v240
    s_cmp_ge_u32 s49, 0x400000
    s_cbranch_scc1 interleave_layers__softmax_full_mha__sliding_local_dilated__prompt_kernel_p2_go
    s_cmp_eq_u32 s44, 0
    s_cbranch_scc1 interleave_layers__softmax_full_mha__sliding_local_dilated__prompt_kernel_p2_sp
interleave_layers__softmax_full_mha__sliding_local_dilated__prompt_kernel_p2_go:
    s_mov_b64 exec, -1
    buffer_load_dwordx4 v[76:79], v3, s[12:15], s24 offen offset:0 sc1
    buffer_load_dwordx4 v[80:83], v3, s[12:15], s24 offen offset:1024 sc1
    buffer_load_dwordx4 v[84:87], v3, s[12:15], s24 offen offset:2048 sc1
    buffer_load_dwordx4 v[88:91], v3, s[12:15], s24 offen offset:3072 sc1
    buffer_load_dwordx4 v[92:95], v3, s[12:15], s25 offen offset:0 sc1
    buffer_load_dwordx4 v[96:99], v3, s[12:15], s25 offen offset:1024 sc1
    buffer_load_dwordx4 v[100:103], v3, s[12:15], s25 offen offset:2048 sc1
    buffer_load_dwordx4 v[104:107], v3, s[12:15], s25 offen offset:3072 sc1
    s_waitcnt vmcnt(8)
    v_lshlrev_b32 v24, 16, v44
    v_and_b32 v25, 0xffff0000, v44
    v_lshlrev_b32 v26, 16, v45
    v_and_b32 v27, 0xffff0000, v45
    v_lshlrev_b32 v28, 16, v46
    v_and_b32 v29, 0xffff0000, v46
    v_lshlrev_b32 v30, 16, v47
    v_and_b32 v31, 0xffff0000, v47
    v_lshlrev_b32 v32, 16, v48
    v_and_b32 v33, 0xffff0000, v48
    v_lshlrev_b32 v34, 16, v49
    v_and_b32 v35, 0xffff0000, v49
    v_lshlrev_b32 v36, 16, v50
    v_and_b32 v37, 0xffff0000, v50
    v_lshlrev_b32 v38, 16, v51
    v_and_b32 v39, 0xffff0000, v51
    v_lshlrev_b32 v40, 16, v52
    v_and_b32 v41, 0xffff0000, v52
    v_lshlrev_b32 v42, 16, v53
    v_and_b32 v43, 0xffff0000, v53
    s_add_u32 s37, s35, 15990784
    s_add_u32 s38, s36, 15990784
    s_lshl_b32 s32, s19, 10
    s_lshl_b32 s33, s17, 7
    s_add_u32 s32, s32, s33
    s_add_u32 s32, s32, 18612224
    v_lshlrev_b32 v16, 3, v1
    v_mov_b32 v18, 0
    v_mov_b32 v19, 0
    v_mov_b32 v20, 0
    v_mov_b32 v21, 0
    s_barrier
    ds_read_b128 v[156:159], v3 offset:0
    ds_read_b128 v[160:163], v3 offset:1024
    ds_read_b128 v[164:167], v3 offset:2048
    ds_read_b128 v[168:171], v3 offset:3072
    ds_read_b128 v[172:175], v3 offset:4096
    ds_read_b128 v[176:179], v3 offset:5120
    ds_read_b128 v[180:183], v3 offset:6144
    ds_read_b128 v[184:187], v3 offset:7168
    ds_read_b128 v[188:191], v3 offset:8192
    ds_read_b128 v[192:195], v3 offset:9216
    s_waitcnt vmcnt(7)
    s_waitcnt lgkmcnt(5)
    v_mfma_f32_16x16x32_bf16 v[24:27], v[156:159], v[76:79], v[24:27]
    ds_read_b128 v[156:159], v3 offset:10240
    buffer_load_dwordx4 v[108:111], v3, s[12:15], s26 offen offset:0 sc1
    v_mfma_f32_16x16x32_bf16 v[28:31], v[160:163], v[76:79], v[28:31]
    ds_read_b128 v[160:163], v3 offset:11264
    v_mfma_f32_16x16x32_bf16 v[32:35], v[164:167], v[76:79], v[32:35]
    ds_read_b128 v[164:167], v3 offset:12288
    v_mfma_f32_16x16x32_bf16 v[36:39], v[168:171], v[76:79], v[36:39]
    ds_read_b128 v[168:171], v3 offset:13312
    v_mfma_f32_16x16x32_bf16 v[40:43], v[172:175], v[76:79], v[40:43]
    ds_read_b128 v[172:175], v3 offset:14336
    s_waitcnt vmcnt(7)
    s_waitcnt lgkmcnt(5)
    v_mfma_f32_16x16x32_bf16 v[24:27], v[176:179], v[80:83], v[24:27]
    ds_read_b128 v[176:179], v3 offset:15360
    buffer_load_dwordx4 v[112:115], v3, s[12:15], s26 offen offset:1024 sc1
    v_mfma_f32_16x16x32_bf16 v[28:31], v[180:183], v[80:83], v[28:31]
    ds_read_b128 v[180:183], v3 offset:16384
    v_mfma_f32_16x16x32_bf16 v[32:35], v[184:187], v[80:83], v[32:35]
    ds_read_b128 v[184:187], v3 offset:17408
    v_mfma_f32_16x16x32_bf16 v[36:39], v[188:191], v[80:83], v[36:39]
    ds_read_b128 v[188:191], v3 offset:18432
    v_mfma_f32_16x16x32_bf16 v[40:43], v[192:195], v[80:83], v[40:43]
    ds_read_b128 v[192:195], v3 offset:19456
    s_waitcnt vmcnt(6)
    s_waitcnt lgkmcnt(5)
    v_mfma_f32_16x16x32_bf16 v[24:27], v[156:159], v[84:87], v[24:27]
    ds_read_b128 v[156:159], v3 offset:20480
    buffer_load_dwordx4 v[116:119], v3, s[12:15], s26 offen offset:2048 sc1
    v_mfma_f32_16x16x32_bf16 v[28:31], v[160:163], v[84:87], v[28:31]
    ds_read_b128 v[160:163], v3 offset:21504
    v_mfma_f32_16x16x32_bf16 v[32:35], v[164:167], v[84:87], v[32:35]
    ds_read_b128 v[164:167], v3 offset:22528
    v_mfma_f32_16x16x32_bf16 v[36:39], v[168:171], v[84:87], v[36:39]
    ds_read_b128 v[168:171], v3 offset:23552
    v_mfma_f32_16x16x32_bf16 v[40:43], v[172:175], v[84:87], v[40:43]
    ds_read_b128 v[172:175], v3 offset:24576
    s_waitcnt lgkmcnt(5)
    v_mfma_f32_16x16x32_bf16 v[24:27], v[176:179], v[88:91], v[24:27]
    ds_read_b128 v[176:179], v3 offset:25600
    buffer_load_dwordx4 v[120:123], v3, s[12:15], s26 offen offset:3072 sc1
    v_mfma_f32_16x16x32_bf16 v[28:31], v[180:183], v[88:91], v[28:31]
    ds_read_b128 v[180:183], v3 offset:26624
    v_mfma_f32_16x16x32_bf16 v[32:35], v[184:187], v[88:91], v[32:35]
    ds_read_b128 v[184:187], v3 offset:27648
    v_mfma_f32_16x16x32_bf16 v[36:39], v[188:191], v[88:91], v[36:39]
    ds_read_b128 v[188:191], v3 offset:28672
    v_mfma_f32_16x16x32_bf16 v[40:43], v[192:195], v[88:91], v[40:43]
    ds_read_b128 v[192:195], v3 offset:29696
    s_waitcnt vmcnt(6)
    s_waitcnt lgkmcnt(5)
    v_mfma_f32_16x16x32_bf16 v[24:27], v[156:159], v[92:95], v[24:27]
    ds_read_b128 v[156:159], v3 offset:30720
    buffer_load_dwordx4 v[124:127], v3, s[12:15], s27 offen offset:0 sc1
    v_mfma_f32_16x16x32_bf16 v[28:31], v[160:163], v[92:95], v[28:31]
    ds_read_b128 v[160:163], v3 offset:31744
    v_mfma_f32_16x16x32_bf16 v[32:35], v[164:167], v[92:95], v[32:35]
    ds_read_b128 v[164:167], v3 offset:32768
    v_mfma_f32_16x16x32_bf16 v[36:39], v[168:171], v[92:95], v[36:39]
    ds_read_b128 v[168:171], v3 offset:33792
    v_mfma_f32_16x16x32_bf16 v[40:43], v[172:175], v[92:95], v[40:43]
    ds_read_b128 v[172:175], v3 offset:34816
    s_waitcnt lgkmcnt(5)
    v_mfma_f32_16x16x32_bf16 v[24:27], v[176:179], v[96:99], v[24:27]
    ds_read_b128 v[176:179], v3 offset:35840
    buffer_load_dwordx4 v[128:131], v3, s[12:15], s27 offen offset:1024 sc1
    v_mfma_f32_16x16x32_bf16 v[28:31], v[180:183], v[96:99], v[28:31]
    ds_read_b128 v[180:183], v3 offset:36864
    v_mfma_f32_16x16x32_bf16 v[32:35], v[184:187], v[96:99], v[32:35]
    ds_read_b128 v[184:187], v3 offset:37888
    v_mfma_f32_16x16x32_bf16 v[36:39], v[188:191], v[96:99], v[36:39]
    ds_read_b128 v[188:191], v3 offset:38912
    v_mfma_f32_16x16x32_bf16 v[40:43], v[192:195], v[96:99], v[40:43]
    ds_read_b128 v[192:195], v3 offset:39936
    s_waitcnt vmcnt(6)
    s_waitcnt lgkmcnt(5)
    v_mfma_f32_16x16x32_bf16 v[24:27], v[156:159], v[100:103], v[24:27]
    ds_read_b128 v[156:159], v3 offset:40960
    buffer_load_dwordx4 v[132:135], v3, s[12:15], s27 offen offset:2048 sc1
    v_mfma_f32_16x16x32_bf16 v[28:31], v[160:163], v[100:103], v[28:31]
    ds_read_b128 v[160:163], v3 offset:41984
    v_mfma_f32_16x16x32_bf16 v[32:35], v[164:167], v[100:103], v[32:35]
    ds_read_b128 v[164:167], v3 offset:43008
    v_mfma_f32_16x16x32_bf16 v[36:39], v[168:171], v[100:103], v[36:39]
    ds_read_b128 v[168:171], v3 offset:44032
    v_mfma_f32_16x16x32_bf16 v[40:43], v[172:175], v[100:103], v[40:43]
    ds_read_b128 v[172:175], v3 offset:45056
    s_waitcnt lgkmcnt(5)
    v_mfma_f32_16x16x32_bf16 v[24:27], v[176:179], v[104:107], v[24:27]
    ds_read_b128 v[176:179], v3 offset:46080
    buffer_load_dwordx4 v[136:139], v3, s[12:15], s27 offen offset:3072 sc1
    v_mfma_f32_16x16x32_bf16 v[28:31], v[180:183], v[104:107], v[28:31]
    ds_read_b128 v[180:183], v3 offset:47104
    v_mfma_f32_16x16x32_bf16 v[32:35], v[184:187], v[104:107], v[32:35]
    ds_read_b128 v[184:187], v3 offset:48128
    v_mfma_f32_16x16x32_bf16 v[36:39], v[188:191], v[104:107], v[36:39]
    ds_read_b128 v[188:191], v3 offset:49152
    v_mfma_f32_16x16x32_bf16 v[40:43], v[192:195], v[104:107], v[40:43]
    ds_read_b128 v[192:195], v3 offset:50176
    s_waitcnt vmcnt(6)
    s_waitcnt lgkmcnt(5)
    v_mfma_f32_16x16x32_bf16 v[24:27], v[156:159], v[108:111], v[24:27]
    ds_read_b128 v[156:159], v3 offset:51200
    buffer_load_dwordx4 v[140:143], v3, s[12:15], s28 offen offset:0 sc1
    v_mfma_f32_16x16x32_bf16 v[28:31], v[160:163], v[108:111], v[28:31]
    ds_read_b128 v[160:163], v3 offset:52224
    v_mfma_f32_16x16x32_bf16 v[32:35], v[164:167], v[108:111], v[32:35]
    ds_read_b128 v[164:167], v3 offset:53248
    v_mfma_f32_16x16x32_bf16 v[36:39], v[168:171], v[108:111], v[36:39]
    ds_read_b128 v[168:171], v3 offset:54272
    v_mfma_f32_16x16x32_bf16 v[40:43], v[172:175], v[108:111], v[40:43]
    ds_read_b128 v[172:175], v3 offset:55296
    s_waitcnt lgkmcnt(5)
    v_mfma_f32_16x16x32_bf16 v[24:27], v[176:179], v[112:115], v[24:27]
    ds_read_b128 v[176:179], v3 offset:56320
    buffer_load_dwordx4 v[144:147], v3, s[12:15], s28 offen offset:1024 sc1
    v_mfma_f32_16x16x32_bf16 v[28:31], v[180:183], v[112:115], v[28:31]
    ds_read_b128 v[180:183], v3 offset:57344
    v_mfma_f32_16x16x32_bf16 v[32:35], v[184:187], v[112:115], v[32:35]
    ds_read_b128 v[184:187], v3 offset:58368
    v_mfma_f32_16x16x32_bf16 v[36:39], v[188:191], v[112:115], v[36:39]
    ds_read_b128 v[188:191], v3 offset:59392
    v_mfma_f32_16x16x32_bf16 v[40:43], v[192:195], v[112:115], v[40:43]
    ds_read_b128 v[192:195], v3 offset:60416
    s_waitcnt vmcnt(6)
    s_waitcnt lgkmcnt(5)
    v_mfma_f32_16x16x32_bf16 v[24:27], v[156:159], v[116:119], v[24:27]
    ds_read_b128 v[156:159], v12 offset:0
    buffer_load_dwordx4 v[148:151], v3, s[12:15], s28 offen offset:2048 sc1
    v_mfma_f32_16x16x32_bf16 v[28:31], v[160:163], v[116:119], v[28:31]
    ds_read_b128 v[160:163], v12 offset:1024
    v_mfma_f32_16x16x32_bf16 v[32:35], v[164:167], v[116:119], v[32:35]
    ds_read_b128 v[164:167], v12 offset:2048
    v_mfma_f32_16x16x32_bf16 v[36:39], v[168:171], v[116:119], v[36:39]
    ds_read_b128 v[168:171], v12 offset:3072
    v_mfma_f32_16x16x32_bf16 v[40:43], v[172:175], v[116:119], v[40:43]
    ds_read_b128 v[172:175], v12 offset:4096
    s_waitcnt lgkmcnt(5)
    v_mfma_f32_16x16x32_bf16 v[24:27], v[176:179], v[120:123], v[24:27]
    ds_read_b128 v[176:179], v12 offset:5120
    buffer_load_dwordx4 v[152:155], v3, s[12:15], s28 offen offset:3072 sc1
    v_mfma_f32_16x16x32_bf16 v[28:31], v[180:183], v[120:123], v[28:31]
    ds_read_b128 v[180:183], v12 offset:6144
    v_mfma_f32_16x16x32_bf16 v[32:35], v[184:187], v[120:123], v[32:35]
    ds_read_b128 v[184:187], v12 offset:7168
    v_mfma_f32_16x16x32_bf16 v[36:39], v[188:191], v[120:123], v[36:39]
    ds_read_b128 v[188:191], v12 offset:8192
    v_mfma_f32_16x16x32_bf16 v[40:43], v[192:195], v[120:123], v[40:43]
    ds_read_b128 v[192:195], v12 offset:9216
    s_waitcnt vmcnt(6)
    s_waitcnt lgkmcnt(5)
    s_barrier
    v_mfma_f32_16x16x32_bf16 v[24:27], v[156:159], v[124:127], v[24:27]
    ds_read_b128 v[156:159], v12 offset:10240
    v_mfma_f32_16x16x32_bf16 v[28:31], v[160:163], v[124:127], v[28:31]
    ds_read_b128 v[160:163], v12 offset:11264
    v_mfma_f32_16x16x32_bf16 v[32:35], v[164:167], v[124:127], v[32:35]
    ds_read_b128 v[164:167], v12 offset:15360
    v_mfma_f32_16x16x32_bf16 v[36:39], v[168:171], v[124:127], v[36:39]
    ds_read_b128 v[168:171], v12 offset:16384
    v_mfma_f32_16x16x32_bf16 v[40:43], v[172:175], v[124:127], v[40:43]
    ds_read_b128 v[172:175], v12 offset:20480
    s_waitcnt lgkmcnt(5)
    v_mfma_f32_16x16x32_bf16 v[24:27], v[176:179], v[128:131], v[24:27]
    ds_read_b128 v[176:179], v12 offset:21504
    v_mfma_f32_16x16x32_bf16 v[28:31], v[180:183], v[128:131], v[28:31]
    ds_read_b128 v[180:183], v12 offset:25600
    v_mfma_f32_16x16x32_bf16 v[32:35], v[184:187], v[128:131], v[32:35]
    ds_read_b128 v[184:187], v12 offset:26624
    v_mfma_f32_16x16x32_bf16 v[36:39], v[188:191], v[128:131], v[36:39]
    ds_read_b128 v[188:191], v12 offset:30720
    v_mfma_f32_16x16x32_bf16 v[40:43], v[192:195], v[128:131], v[40:43]
    ds_read_b128 v[192:195], v12 offset:31744
    s_waitcnt vmcnt(5)
    s_waitcnt lgkmcnt(5)
    v_mfma_f32_16x16x32_bf16 v[24:27], v[156:159], v[132:135], v[24:27]
    ds_read_b128 v[156:159], v12 offset:35840
    v_mfma_f32_16x16x32_bf16 v[28:31], v[160:163], v[132:135], v[28:31]
    ds_read_b128 v[160:163], v12 offset:36864
    s_waitcnt vmcnt(4)
    v_mfma_f32_16x16x32_bf16 v[24:27], v[164:167], v[136:139], v[24:27]
    ds_read_b128 v[164:167], v12 offset:12288
    v_mfma_f32_16x16x32_bf16 v[28:31], v[168:171], v[136:139], v[28:31]
    ds_read_b128 v[168:171], v12 offset:13312
    s_waitcnt vmcnt(3)
    v_mfma_f32_16x16x32_bf16 v[24:27], v[172:175], v[140:143], v[24:27]
    ds_read_b128 v[172:175], v12 offset:17408
    s_waitcnt lgkmcnt(5)
    v_mfma_f32_16x16x32_bf16 v[28:31], v[176:179], v[140:143], v[28:31]
    ds_read_b128 v[176:179], v12 offset:18432
    s_waitcnt vmcnt(2)
    v_mfma_f32_16x16x32_bf16 v[24:27], v[180:183], v[144:147], v[24:27]
    ds_read_b128 v[180:183], v12 offset:22528
    v_mfma_f32_16x16x32_bf16 v[28:31], v[184:187], v[144:147], v[28:31]
    ds_read_b128 v[184:187], v12 offset:23552
    s_waitcnt vmcnt(1)
    v_mfma_f32_16x16x32_bf16 v[24:27], v[188:191], v[148:151], v[24:27]
    ds_read_b128 v[188:191], v12 offset:27648
    v_mfma_f32_16x16x32_bf16 v[28:31], v[192:195], v[148:151], v[28:31]
    ds_read_b128 v[192:195], v12 offset:28672
    s_waitcnt vmcnt(0)
    s_waitcnt lgkmcnt(5)
    v_mfma_f32_16x16x32_bf16 v[24:27], v[156:159], v[152:155], v[24:27]
    ds_read_b128 v[156:159], v12 offset:32768
    v_mfma_f32_16x16x32_bf16 v[28:31], v[160:163], v[152:155], v[28:31]
    ds_read_b128 v[160:163], v12 offset:33792
    v_mfma_f32_16x16x32_bf16 v[32:35], v[164:167], v[132:135], v[32:35]
    ds_read_b128 v[164:167], v12 offset:37888
    v_mfma_f32_16x16x32_bf16 v[36:39], v[168:171], v[132:135], v[36:39]
    ds_read_b128 v[168:171], v12 offset:38912
    v_mfma_f32_16x16x32_bf16 v[32:35], v[172:175], v[136:139], v[32:35]
    ds_read_b128 v[172:175], v12 offset:14336
    s_waitcnt lgkmcnt(5)
    v_mfma_f32_16x16x32_bf16 v[36:39], v[176:179], v[136:139], v[36:39]
    ds_read_b128 v[176:179], v12 offset:19456
    v_cvt_pk_bf16_f32 v44, v24, v25
    v_cvt_pk_bf16_f32 v45, v26, v27
    v_mfma_f32_16x16x32_bf16 v[32:35], v[180:183], v[140:143], v[32:35]
    ds_read_b128 v[180:183], v12 offset:24576
    v_cvt_pk_bf16_f32 v46, v28, v29
    v_cvt_pk_bf16_f32 v47, v30, v31
    v_mfma_f32_16x16x32_bf16 v[36:39], v[184:187], v[140:143], v[36:39]
    ds_read_b128 v[184:187], v12 offset:29696
    buffer_store_dwordx4 v[44:47], v3, s[12:15], s37 offen offset:0 sc1
    v_add_f32 v18, v18, v24
    v_mfma_f32_16x16x32_bf16 v[32:35], v[188:191], v[144:147], v[32:35]
    ds_read_b128 v[188:191], v12 offset:34816
    v_fmac_f32 v19, v24, v24
    v_add_f32 v20, v20, v25
    v_mfma_f32_16x16x32_bf16 v[36:39], v[192:195], v[144:147], v[36:39]
    ds_read_b128 v[192:195], v12 offset:39936
    v_fmac_f32 v21, v25, v25
    v_add_f32 v18, v18, v26
    s_waitcnt lgkmcnt(5)
    v_mfma_f32_16x16x32_bf16 v[32:35], v[156:159], v[148:151], v[32:35]
    v_fmac_f32 v19, v26, v26
    v_add_f32 v20, v20, v27
    v_mfma_f32_16x16x32_bf16 v[36:39], v[160:163], v[148:151], v[36:39]
    v_fmac_f32 v21, v27, v27
    v_add_f32 v18, v18, v28
    v_mfma_f32_16x16x32_bf16 v[32:35], v[164:167], v[152:155], v[32:35]
    v_fmac_f32 v19, v28, v28
    v_add_f32 v20, v20, v29
    v_mfma_f32_16x16x32_bf16 v[36:39], v[168:171], v[152:155], v[36:39]
    v_fmac_f32 v21, v29, v29
    v_add_f32 v18, v18, v30
    v_fmac_f32 v19, v30, v30
    v_add_f32 v20, v20, v31
    v_fmac_f32 v21, v31, v31
    v_mfma_f32_16x16x32_bf16 v[40:43], v[172:175], v[132:135], v[40:43]
    s_waitcnt lgkmcnt(0)
    v_mfma_f32_16x16x32_bf16 v[40:43], v[176:179], v[136:139], v[40:43]
    v_mfma_f32_16x16x32_bf16 v[40:43], v[180:183], v[140:143], v[40:43]
    v_mfma_f32_16x16x32_bf16 v[40:43], v[184:187], v[144:147], v[40:43]
    v_cvt_pk_bf16_f32 v48, v32, v33
    v_cvt_pk_bf16_f32 v49, v34, v35
    v_mfma_f32_16x16x32_bf16 v[40:43], v[188:191], v[148:151], v[40:43]
    v_cvt_pk_bf16_f32 v50, v36, v37
    v_cvt_pk_bf16_f32 v51, v38, v39
    v_mfma_f32_16x16x32_bf16 v[40:43], v[192:195], v[152:155], v[40:43]
    buffer_store_dwordx4 v[48:51], v3, s[12:15], s37 offen offset:1024 sc1
    v_add_f32 v18, v18, v32
    v_fmac_f32 v19, v32, v32
    v_add_f32 v20, v20, v33
    v_fmac_f32 v21, v33, v33
    v_add_f32 v18, v18, v34
    v_fmac_f32 v19, v34, v34
    v_add_f32 v20, v20, v35
    v_fmac_f32 v21, v35, v35
    v_add_f32 v18, v18, v36
    v_fmac_f32 v19, v36, v36
    v_add_f32 v20, v20, v37
    v_fmac_f32 v21, v37, v37
    v_add_f32 v18, v18, v38
    v_fmac_f32 v19, v38, v38
    v_add_f32 v20, v20, v39
    v_fmac_f32 v21, v39, v39
    s_barrier
    v_cvt_pk_bf16_f32 v52, v40, v41
    v_cvt_pk_bf16_f32 v53, v42, v43
    buffer_store_dwordx2 v[52:53], v13, s[12:15], s38 offen sc1
    v_add_f32 v18, v18, v40
    v_fmac_f32 v19, v40, v40
    v_add_f32 v20, v20, v41
    v_fmac_f32 v21, v41, v41
    v_add_f32 v18, v18, v42
    v_fmac_f32 v19, v42, v42
    v_add_f32 v20, v20, v43
    v_fmac_f32 v21, v43, v43
    v_add_f32 v18, v18, v20
    v_add_f32 v19, v19, v21
    v_mov_b32 v20, v18
    v_mov_b32 v21, v19
    s_nop 0
    v_permlane16_swap_b32 v18, v20
    v_permlane16_swap_b32 v19, v21
    s_nop 0
    v_add_f32 v18, v18, v20
    v_add_f32 v19, v19, v21
    v_mov_b32 v20, v18
    v_mov_b32 v21, v19
    s_nop 0
    v_permlane32_swap_b32 v18, v20
    v_permlane32_swap_b32 v19, v21
    s_nop 0
    v_add_f32 v18, v18, v20
    v_add_f32 v19, v19, v21
    s_mov_b64 exec, 0xffff
    buffer_store_dwordx2 v[18:19], v16, s[12:15], s32 offen sc1
    s_lshr_b32 s48, s16, 1
    s_lshl_b32 s48, s48, 9
    s_add_u32 s48, s48, 16384
    v_mul_u32_u24 v241, 768, v1
    s_bitcmp1_b32 s16, 0
    s_cselect_b64 s[56:57], 3, 1
    v_mov_b32 v243, 163816
    v_mov_b32 v240, 1
    s_mov_b64 exec, 1
    s_waitcnt vmcnt(0)
    ds_add_rtn_u32 v242, v243, v240 offset:16
    s_waitcnt lgkmcnt(0)
    v_readfirstlane_b32 s49, v242
    s_mov_b64 exec, s[56:57]
    s_cmp_eq_u32 s49, 3
    s_cbranch_scc0 interleave_layers__softmax_full_mha__sliding_local_dilated__prompt_kernel_s2_sg
    buffer_atomic_add v240, v241, s[8:11], s48 offen sc1
interleave_layers__softmax_full_mha__sliding_local_dilated__prompt_kernel_s2_sg:
    s_mov_b64 exec, -1
    s_lshl_b32 s22, s20, 1
    s_and_b32 s23, s21, 1
    s_add_u32 s16, s22, s23
    s_lshr_b32 s17, s21, 1
    v_and_b32 v10, 31, v1
    v_lshrrev_b32 v4, 5, v1
    v_and_b32 v5, 15, v1
    s_lshl_b32 s19, s16, 2
    s_add_u32 s19, s19, s18
    v_bfe_u32 v7, v1, 4, 1
    v_mul_u32_u24 v8, 20480, v7
    v_lshl_add_u32 v8, v4, 8, v8
    v_lshl_add_u32 v8, v5, 4, v8
    v_lshlrev_b32 v11, 10, v7
    v_lshl_add_u32 v11, v4, 9, v11
    v_lshl_add_u32 v11, v5, 3, v11
    s_lshl_b32 s30, s19, 11
    s_add_u32 s30, s30, 18612224
    s_mul_i32 s24, s19, 40960
    s_add_u32 s24, s24, 15990784
    v_add_u32 v41, 65536, v3
    v_add_u32 v42, 131072, v3
    v_subrev_u32 v58, 1, v4
    v_not_b32 v59, v58
    v_lshrrev_b32 v6, 4, v1
    v_lshlrev_b32 v17, 2, v6
    v_sub_u32 v17, v5, v17
    v_mov_b32 v19, 0xf149f2ca
    v_subrev_u32 v18, 0, v17
    v_and_b32 v16, 0x80000001, v18
    v_cmp_eq_u32 vcc, 0, v16
    s_nop 1
    v_cndmask_b32 v200, v19, 0, vcc
    v_cmp_eq_u32 vcc, 0x80000000, v16
    s_nop 1
    v_cndmask_b32 v204, v19, 0, vcc
    v_subrev_u32 v18, 1, v17
    v_and_b32 v16, 0x80000001, v18
    v_cmp_eq_u32 vcc, 0, v16
    s_nop 1
    v_cndmask_b32 v201, v19, 0, vcc
    v_cmp_eq_u32 vcc, 0x80000000, v16
    s_nop 1
    v_cndmask_b32 v205, v19, 0, vcc
    v_subrev_u32 v18, 2, v17
    v_and_b32 v16, 0x80000001, v18
    v_cmp_eq_u32 vcc, 0, v16
    s_nop 1
    v_cndmask_b32 v202, v19, 0, vcc
    v_cmp_eq_u32 vcc, 0x80000000, v16
    s_nop 1
    v_cndmask_b32 v206, v19, 0, vcc
    v_subrev_u32 v18, 3, v17
    v_and_b32 v16, 0x80000001, v18
    v_cmp_eq_u32 vcc, 0, v16
    s_nop 1
    v_cndmask_b32 v203, v19, 0, vcc
    v_cmp_eq_u32 vcc, 0x80000000, v16
    s_nop 1
    v_cndmask_b32 v207, v19, 0, vcc
    s_cmp_eq_u32 s19, 0
    s_cselect_b32 s34, 0xf149f2ca, 0
    v_add_f32 v208, s34, v204
    v_add_f32 v209, s34, v205
    v_add_f32 v210, s34, v206
    v_add_f32 v211, s34, v207
    s_mul_i32 s35, s18, 9472
    s_add_u32 s35, s35, 88448
    v_mul_u32_u24 v16, 296, v10
    v_add_u32 v16, s35, v16
    v_add_u32 v16, 4736, v16
    v_lshl_add_u32 v212, v4, 3, v16
    v_lshl_add_u32 v213, v4, 5, v16
    v_mov_b32 v219, v16
    v_lshl_add_u32 v215, v4, 6, v16
    v_mul_u32_u24 v16, 296, v5
    v_add_u32 v16, s35, v16
    v_lshl_add_u32 v216, v6, 4, v16
    v_lshrrev_b32 v17, 2, v1
    v_mul_u32_u24 v16, 296, v17
    v_add_u32 v16, s35, v16
    v_and_b32 v17, 3, v1
    v_lshl_add_u32 v217, v17, 3, v16
    v_mul_u32_u24 v18, 40, v17
    v_add_u32 v18, 240, v18
    v_cmp_gt_u32 vcc, 2, v17
    v_mov_b32 v19, 288
    s_nop 0
    v_cndmask_b32 v18, v19, v18, vcc
    v_add_u32 v218, v16, v18
    v_lshlrev_b32 v43, 9, v7
    v_lshl_add_u32 v43, v5, 3, v43
    v_mov_b32 v220, 0
    v_mov_b32 v221, 0
    v_mov_b32 v222, 0x3f803f80
    v_mov_b32 v223, 0x3f803f80
    s_mul_i32 s25, s19, 40960
    s_add_u32 s25, s25, 13369344
    s_lshl_b32 s51, s17, 10
    s_add_u32 s51, s51, s25
    s_add_u32 s52, s51, 20480
    s_lshr_b32 s53, s17, 2
    s_add_u32 s53, s53, 16
    s_lshl_b32 s53, s53, 10
    s_add_u32 s53, s53, s25
    s_and_b32 s54, s17, 1
    s_lshl_b32 s54, s54, 9
    s_add_u32 s53, s53, s54
    s_bfe_u32 s54, s17, 0x10001
    s_lshl_b32 s54, s54, 3
    s_add_u32 s53, s53, s54
    s_add_u32 s54, s53, 20480
    s_cmp_eq_u32 s18, 1
    s_cbranch_scc0 interleave_layers__softmax_full_mha__sliding_local_dilated__prompt_kernel_ad
    v_lshlrev_b32 v16, 8, v1
    s_mov_b32 s49, 0
interleave_layers__softmax_full_mha__sliding_local_dilated__prompt_kernel_ap:
    buffer_load_dword v17, v16, s[8:11], 0 offen offset:0 sc1
    s_add_u32 s49, s49, 1
    s_waitcnt vmcnt(0)
    v_cmp_gt_u32 vcc, 16, v17
    s_cmp_ge_u32 s49, 0x20000
    s_cbranch_scc1 interleave_layers__softmax_full_mha__sliding_local_dilated__prompt_kernel_ad
    s_cbranch_vccnz interleave_layers__softmax_full_mha__sliding_local_dilated__prompt_kernel_ap
interleave_layers__softmax_full_mha__sliding_local_dilated__prompt_kernel_ad:
    v_mov_b32 v243, 163816
    s_mov_b32 s49, 0
    s_cmp_eq_u32 s18, 0
    s_cbranch_scc0 interleave_layers__softmax_full_mha__sliding_local_dilated__prompt_kernel_p3_sp
    s_lshl_b32 s48, s16, 9
    s_add_u32 s48, s48, 16384
    v_lshlrev_b32 v241, 8, v1
    v_lshlrev_b32 v242, 3, v1
    v_sub_u32 v242, 16, v242
    s_cmp_eq_u32 s16, 0
    s_cselect_b64 s[56:57], 1, 3
    s_mov_b64 exec, s[56:57]
interleave_layers__softmax_full_mha__sliding_local_dilated__prompt_kernel_p3_pl:
    v_mov_b32 v240, 0
    buffer_atomic_add v240, v241, s[8:11], s48 offen sc0 sc1
    s_add_u32 s49, s49, 1
    s_waitcnt vmcnt(0)
    v_cmp_ge_u32 vcc, v240, v242
    s_cmp_ge_u32 s49, 0x20000
    s_cbranch_scc1 interleave_layers__softmax_full_mha__sliding_local_dilated__prompt_kernel_p3_px
    s_cmp_eq_u64 vcc, exec
    s_cbranch_scc0 interleave_layers__softmax_full_mha__sliding_local_dilated__prompt_kernel_p3_pl
interleave_layers__softmax_full_mha__sliding_local_dilated__prompt_kernel_p3_px:
    s_mov_b64 exec, 1
    v_mov_b32 v240, 1
    ds_write_b32 v243, v240 offset:20
    s_branch interleave_layers__softmax_full_mha__sliding_local_dilated__prompt_kernel_p3_go
interleave_layers__softmax_full_mha__sliding_local_dilated__prompt_kernel_p3_sp:
    s_sleep 1
    ds_read_b32 v240, v243 offset:20
    s_add_u32 s49, s49, 1
    s_waitcnt lgkmcnt(0)
    v_readfirstlane_b32 s44, v240
    s_cmp_ge_u32 s49, 0x400000
    s_cbranch_scc1 interleave_layers__softmax_full_mha__sliding_local_dilated__prompt_kernel_p3_go
    s_cmp_eq_u32 s44, 0
    s_cbranch_scc1 interleave_layers__softmax_full_mha__sliding_local_dilated__prompt_kernel_p3_sp
interleave_layers__softmax_full_mha__sliding_local_dilated__prompt_kernel_p3_go:
    s_mov_b64 exec, -1
    buffer_load_dwordx4 v[160:163], v8, s[12:15], s24 offen offset:0 sc1
    buffer_load_dwordx4 v[164:167], v8, s[12:15], s24 offen offset:512 sc1
    buffer_load_dwordx2 v[16:17], v11, s[12:15], s30 offen offset:0 sc1
    buffer_load_dwordx2 v[18:19], v11, s[12:15], s30 offen offset:128 sc1
    buffer_load_dwordx2 v[20:21], v11, s[12:15], s30 offen offset:256 sc1
    buffer_load_dwordx2 v[22:23], v11, s[12:15], s30 offen offset:384 sc1
    buffer_load_dwordx4 v[168:171], v8, s[12:15], s24 offen offset:1024 sc1
    buffer_load_dwordx4 v[172:175], v8, s[12:15], s24 offen offset:1536 sc1
    buffer_load_dwordx4 v[176:179], v8, s[12:15], s24 offen offset:2048 sc1
    buffer_load_dwordx4 v[180:183], v8, s[12:15], s24 offen offset:2560 sc1
    buffer_load_dwordx4 v[184:187], v8, s[12:15], s24 offen offset:3072 sc1
    buffer_load_dwordx4 v[188:191], v8, s[12:15], s24 offen offset:3584 sc1
    s_barrier
    ds_read_b128 v[128:131], v3 offset:0
    ds_read_b128 v[132:135], v3 offset:1024
    ds_read_b128 v[136:139], v3 offset:2048
    ds_read_b128 v[140:143], v3 offset:3072
    ds_read_b128 v[144:147], v3 offset:4096
    ds_read_b128 v[148:151], v3 offset:5120
    ds_read_b128 v[152:155], v3 offset:6144
    ds_read_b128 v[156:159], v3 offset:7168
    s_waitcnt vmcnt(10)
    s_waitcnt lgkmcnt(6)
    v_mfma_f32_32x32x16_bf16 v[64:79], v[128:131], v[160:163], 0
    ds_read_b128 v[128:131], v3 offset:8192
    s_add_u32 s24, s24, 4096
    buffer_load_dwordx4 v[192:195], v8, s[12:15], s24 offen offset:0 sc1
    buffer_load_dwordx4 v[196:199], v8, s[12:15], s24 offen offset:512 sc1
    v_mfma_f32_32x32x16_bf16 v[80:95], v[132:135], v[160:163], 0
    ds_read_b128 v[132:135], v3 offset:9216
    s_waitcnt lgkmcnt(6)
    v_mfma_f32_32x32x16_bf16 v[96:111], v[136:139], v[160:163], 0
    ds_read_b128 v[136:139], v3 offset:10240
    v_mfma_f32_32x32x16_bf16 v[112:127], v[140:143], v[160:163], 0
    ds_read_b128 v[140:143], v3 offset:11264
    s_waitcnt lgkmcnt(6)
    v_mfma_f32_32x32x16_bf16 v[64:79], v[144:147], v[164:167], v[64:79]
    ds_read_b128 v[144:147], v3 offset:12288
    v_mfma_f32_32x32x16_bf16 v[80:95], v[148:151], v[164:167], v[80:95]
    ds_read_b128 v[148:151], v3 offset:13312
    s_waitcnt lgkmcnt(6)
    v_mfma_f32_32x32x16_bf16 v[96:111], v[152:155], v[164:167], v[96:111]
    ds_read_b128 v[152:155], v3 offset:14336
    v_mfma_f32_32x32x16_bf16 v[112:127], v[156:159], v[164:167], v[112:127]
    ds_read_b128 v[156:159], v3 offset:15360
    s_waitcnt vmcnt(6)
    s_waitcnt lgkmcnt(6)
    v_mfma_f32_32x32x16_bf16 v[64:79], v[128:131], v[168:171], v[64:79]
    ds_read_b128 v[128:131], v3 offset:16384
    buffer_load_dwordx4 v[160:163], v8, s[12:15], s24 offen offset:1024 sc1
    buffer_load_dwordx4 v[164:167], v8, s[12:15], s24 offen offset:1536 sc1
    v_add_f32 v16, v16, v18
    v_mfma_f32_32x32x16_bf16 v[80:95], v[132:135], v[168:171], v[80:95]
    ds_read_b128 v[132:135], v3 offset:17408
    v_add_f32 v17, v17, v19
    v_add_f32 v20, v20, v22
    s_waitcnt lgkmcnt(6)
    v_mfma_f32_32x32x16_bf16 v[96:111], v[136:139], v[168:171], v[96:111]
    ds_read_b128 v[136:139], v3 offset:18432
    v_add_f32 v21, v21, v23
    v_add_f32 v16, v16, v20
    v_mfma_f32_32x32x16_bf16 v[112:127], v[140:143], v[168:171], v[112:127]
    ds_read_b128 v[140:143], v3 offset:19456
    v_add_f32 v17, v17, v21
    v_mov_b32 v18, v16
    s_waitcnt lgkmcnt(6)
    v_mfma_f32_32x32x16_bf16 v[64:79], v[144:147], v[172:175], v[64:79]
    ds_read_b128 v[144:147], v3 offset:20480
    v_permlane32_swap_b32 v16, v18
    v_add_f32 v16, v16, v18
    v_mfma_f32_32x32x16_bf16 v[80:95], v[148:151], v[172:175], v[80:95]
    ds_read_b128 v[148:151], v3 offset:21504
    v_mov_b32 v18, v17
    s_nop 1
    v_permlane32_swap_b32 v17, v18
    s_waitcnt lgkmcnt(6)
    v_mfma_f32_32x32x16_bf16 v[96:111], v[152:155], v[172:175], v[96:111]
    ds_read_b128 v[152:155], v3 offset:22528
    v_add_f32 v17, v17, v18
    v_mul_f32 v46, 0x3acccccd, v16
    v_mfma_f32_32x32x16_bf16 v[112:127], v[156:159], v[172:175], v[112:127]
    ds_read_b128 v[156:159], v3 offset:23552
    v_mul_f32 v18, 0x3acccccd, v17
    v_fma_f32 v18, -v46, v46, v18
    s_waitcnt vmcnt(6)
    s_waitcnt lgkmcnt(6)
    v_mfma_f32_32x32x16_bf16 v[64:79], v[128:131], v[176:179], v[64:79]
    ds_read_b128 v[128:131], v3 offset:24576
    buffer_load_dwordx4 v[168:171], v8, s[12:15], s24 offen offset:2048 sc1
    buffer_load_dwordx4 v[172:175], v8, s[12:15], s24 offen offset:2560 sc1
    v_max_f32 v18, 0, v18
    v_add_f32 v18, 0x3727c5ac, v18
    v_mfma_f32_32x32x16_bf16 v[80:95], v[132:135], v[176:179], v[80:95]
    ds_read_b128 v[132:135], v3 offset:25600
    v_rsq_f32 v47, v18
    v_xor_b32 v19, 0x80000000, v46
    s_waitcnt lgkmcnt(6)
    v_mfma_f32_32x32x16_bf16 v[96:111], v[136:139], v[176:179], v[96:111]
    ds_read_b128 v[136:139], v3 offset:26624
    v_and_b32 v18, 0xffff0000, v19
    v_sub_f32 v20, v19, v18
    v_mfma_f32_32x32x16_bf16 v[112:127], v[140:143], v[176:179], v[112:127]
    ds_read_b128 v[140:143], v3 offset:27648
    v_cvt_pk_bf16_f32 v48, v18, v18
    v_cvt_pk_bf16_f32 v49, v20, 0
    s_waitcnt lgkmcnt(6)
    v_mfma_f32_32x32x16_bf16 v[64:79], v[144:147], v[180:183], v[64:79]
    ds_read_b128 v[144:147], v3 offset:28672
    v_and_b32 v48, v48, v58
    v_and_b32 v49, v49, v58
    v_mfma_f32_32x32x16_bf16 v[80:95], v[148:151], v[180:183], v[80:95]
    ds_read_b128 v[148:151], v3 offset:29696
    v_mul_f32 v45, 0x3ea52b5c, v47
    s_waitcnt lgkmcnt(6)
    v_mfma_f32_32x32x16_bf16 v[96:111], v[152:155], v[180:183], v[96:111]
    ds_read_b128 v[152:155], v3 offset:30720
    v_mfma_f32_32x32x16_bf16 v[112:127], v[156:159], v[180:183], v[112:127]
    ds_read_b128 v[156:159], v3 offset:31744
    s_waitcnt vmcnt(6)
    s_waitcnt lgkmcnt(6)
    v_mfma_f32_32x32x16_bf16 v[64:79], v[128:131], v[184:187], v[64:79]
    ds_read_b128 v[128:131], v3 offset:32768
    buffer_load_dwordx4 v[176:179], v8, s[12:15], s24 offen offset:3072 sc1
    buffer_load_dwordx4 v[180:183], v8, s[12:15], s24 offen offset:3584 sc1
    v_mfma_f32_32x32x16_bf16 v[80:95], v[132:135], v[184:187], v[80:95]
    ds_read_b128 v[132:135], v3 offset:33792
    s_waitcnt lgkmcnt(6)
    v_mfma_f32_32x32x16_bf16 v[96:111], v[136:139], v[184:187], v[96:111]
    ds_read_b128 v[136:139], v3 offset:34816
    v_mfma_f32_32x32x16_bf16 v[112:127], v[140:143], v[184:187], v[112:127]
    ds_read_b128 v[140:143], v3 offset:35840
    s_waitcnt lgkmcnt(6)
    v_mfma_f32_32x32x16_bf16 v[64:79], v[144:147], v[188:191], v[64:79]
    ds_read_b128 v[144:147], v3 offset:36864
    v_mfma_f32_32x32x16_bf16 v[80:95], v[148:151], v[188:191], v[80:95]
    ds_read_b128 v[148:151], v3 offset:37888
    s_waitcnt lgkmcnt(6)
    v_mfma_f32_32x32x16_bf16 v[96:111], v[152:155], v[188:191], v[96:111]
    ds_read_b128 v[152:155], v3 offset:38912
    v_mfma_f32_32x32x16_bf16 v[112:127], v[156:159], v[188:191], v[112:127]
    ds_read_b128 v[156:159], v3 offset:39936
    s_waitcnt vmcnt(6)
    s_waitcnt lgkmcnt(6)
    v_mfma_f32_32x32x16_bf16 v[64:79], v[128:131], v[192:195], v[64:79]
    ds_read_b128 v[128:131], v3 offset:40960
    s_add_u32 s24, s24, 4096
    buffer_load_dwordx4 v[184:187], v8, s[12:15], s24 offen offset:0 sc1
    buffer_load_dwordx4 v[188:191], v8, s[12:15], s24 offen offset:512 sc1
    v_mfma_f32_32x32x16_bf16 v[80:95], v[132:135], v[192:195], v[80:95]
    ds_read_b128 v[132:135], v3 offset:41984
    s_waitcnt lgkmcnt(6)
    v_mfma_f32_32x32x16_bf16 v[96:111], v[136:139], v[192:195], v[96:111]
    ds_read_b128 v[136:139], v3 offset:43008
    v_mfma_f32_32x32x16_bf16 v[112:127], v[140:143], v[192:195], v[112:127]
    ds_read_b128 v[140:143], v3 offset:44032
    s_waitcnt lgkmcnt(6)
    v_mfma_f32_32x32x16_bf16 v[64:79], v[144:147], v[196:199], v[64:79]
    ds_read_b128 v[144:147], v3 offset:45056
    v_mfma_f32_32x32x16_bf16 v[80:95], v[148:151], v[196:199], v[80:95]
    ds_read_b128 v[148:151], v3 offset:46080
    s_waitcnt lgkmcnt(6)
    v_mfma_f32_32x32x16_bf16 v[96:111], v[152:155], v[196:199], v[96:111]
    ds_read_b128 v[152:155], v3 offset:47104
    v_mfma_f32_32x32x16_bf16 v[112:127], v[156:159], v[196:199], v[112:127]
    ds_read_b128 v[156:159], v3 offset:48128
    s_waitcnt vmcnt(6)
    s_waitcnt lgkmcnt(6)
    v_mfma_f32_32x32x16_bf16 v[64:79], v[128:131], v[160:163], v[64:79]
    ds_read_b128 v[128:131], v3 offset:49152
    buffer_load_dwordx4 v[192:195], v8, s[12:15], s24 offen offset:1024 sc1
    buffer_load_dwordx4 v[196:199], v8, s[12:15], s24 offen offset:1536 sc1
    v_mfma_f32_32x32x16_bf16 v[80:95], v[132:135], v[160:163], v[80:95]
    ds_read_b128 v[132:135], v3 offset:50176
    s_waitcnt lgkmcnt(6)
    v_mfma_f32_32x32x16_bf16 v[96:111], v[136:139], v[160:163], v[96:111]
    ds_read_b128 v[136:139], v3 offset:51200
    v_mfma_f32_32x32x16_bf16 v[112:127], v[140:143], v[160:163], v[112:127]
    ds_read_b128 v[140:143], v3 offset:52224
    s_waitcnt lgkmcnt(6)
    v_mfma_f32_32x32x16_bf16 v[64:79], v[144:147], v[164:167], v[64:79]
    ds_read_b128 v[144:147], v3 offset:53248
    v_mfma_f32_32x32x16_bf16 v[80:95], v[148:151], v[164:167], v[80:95]
    ds_read_b128 v[148:151], v3 offset:54272
    s_waitcnt lgkmcnt(6)
    v_mfma_f32_32x32x16_bf16 v[96:111], v[152:155], v[164:167], v[96:111]
    ds_read_b128 v[152:155], v3 offset:55296
    v_mfma_f32_32x32x16_bf16 v[112:127], v[156:159], v[164:167], v[112:127]
    ds_read_b128 v[156:159], v3 offset:56320
    s_waitcnt vmcnt(6)
    s_barrier
    s_waitcnt lgkmcnt(6)
    v_mfma_f32_32x32x16_bf16 v[64:79], v[128:131], v[168:171], v[64:79]
    ds_read_b128 v[128:131], v3 offset:57344
    buffer_load_dwordx4 v[160:163], v8, s[12:15], s24 offen offset:2048 sc1
    buffer_load_dwordx4 v[164:167], v8, s[12:15], s24 offen offset:2560 sc1
    v_mfma_f32_32x32x16_bf16 v[80:95], v[132:135], v[168:171], v[80:95]
    ds_read_b128 v[132:135], v3 offset:58368
    s_waitcnt lgkmcnt(6)
    v_mfma_f32_32x32x16_bf16 v[96:111], v[136:139], v[168:171], v[96:111]
    ds_read_b128 v[136:139], v3 offset:59392
    v_mfma_f32_32x32x16_bf16 v[112:127], v[140:143], v[168:171], v[112:127]
    ds_read_b128 v[140:143], v3 offset:60416
    s_waitcnt lgkmcnt(6)
    v_mfma_f32_32x32x16_bf16 v[64:79], v[144:147], v[172:175], v[64:79]
    ds_read_b128 v[144:147], v3 offset:61440
    v_mfma_f32_32x32x16_bf16 v[80:95], v[148:151], v[172:175], v[80:95]
    ds_read_b128 v[148:151], v3 offset:62464
    s_waitcnt lgkmcnt(6)
    v_mfma_f32_32x32x16_bf16 v[96:111], v[152:155], v[172:175], v[96:111]
    ds_read_b128 v[152:155], v3 offset:63488
    v_mfma_f32_32x32x16_bf16 v[112:127], v[156:159], v[172:175], v[112:127]
    ds_read_b128 v[156:159], v3 offset:64512
    s_waitcnt vmcnt(6)
    s_waitcnt lgkmcnt(6)
    v_mfma_f32_32x32x16_bf16 v[64:79], v[128:131], v[176:179], v[64:79]
    ds_read_b128 v[128:131], v41 offset:0
    buffer_load_dwordx4 v[168:171], v8, s[12:15], s24 offen offset:3072 sc1
    buffer_load_dwordx4 v[172:175], v8, s[12:15], s24 offen offset:3584 sc1
    v_mfma_f32_32x32x16_bf16 v[80:95], v[132:135], v[176:179], v[80:95]
    ds_read_b128 v[132:135], v41 offset:1024
    s_waitcnt lgkmcnt(6)
    v_mfma_f32_32x32x16_bf16 v[96:111], v[136:139], v[176:179], v[96:111]
    ds_read_b128 v[136:139], v41 offset:2048
    v_mfma_f32_32x32x16_bf16 v[112:127], v[140:143], v[176:179], v[112:127]
    ds_read_b128 v[140:143], v41 offset:3072
    s_waitcnt lgkmcnt(6)
    v_mfma_f32_32x32x16_bf16 v[64:79], v[144:147], v[180:183], v[64:79]
    ds_read_b128 v[144:147], v41 offset:4096
    v_mfma_f32_32x32x16_bf16 v[80:95], v[148:151], v[180:183], v[80:95]
    ds_read_b128 v[148:151], v41 offset:5120
    s_waitcnt lgkmcnt(6)
    v_mfma_f32_32x32x16_bf16 v[96:111], v[152:155], v[180:183], v[96:111]
    ds_read_b128 v[152:155], v41 offset:6144
    v_mfma_f32_32x32x16_bf16 v[112:127], v[156:159], v[180:183], v[112:127]
    ds_read_b128 v[156:159], v41 offset:7168
    s_waitcnt vmcnt(6)
    s_waitcnt lgkmcnt(6)
    v_mfma_f32_32x32x16_bf16 v[64:79], v[128:131], v[184:187], v[64:79]
    ds_read_b128 v[128:131], v41 offset:8192
    s_add_u32 s24, s24, 4096
    buffer_load_dwordx4 v[176:179], v8, s[12:15], s24 offen offset:0 sc1
    buffer_load_dwordx4 v[180:183], v8, s[12:15], s24 offen offset:512 sc1
    ds_read_b64 v[50:51], v43 offset:3456
    ds_read_b64 v[52:53], v43 offset:7552
    v_mfma_f32_32x32x16_bf16 v[80:95], v[132:135], v[184:187], v[80:95]
    ds_read_b128 v[132:135], v41 offset:9216
    ds_read_b64 v[54:55], v43 offset:11648
    ds_read_b64 v[56:57], v43 offset:15744
    s_waitcnt lgkmcnt(10)
    v_mfma_f32_32x32x16_bf16 v[96:111], v[136:139], v[184:187], v[96:111]
    ds_read_b128 v[136:139], v41 offset:10240
    v_mfma_f32_32x32x16_bf16 v[112:127], v[140:143], v[184:187], v[112:127]
    ds_read_b128 v[140:143], v41 offset:11264
    s_waitcnt lgkmcnt(10)
    v_mfma_f32_32x32x16_bf16 v[64:79], v[144:147], v[188:191], v[64:79]
    ds_read_b128 v[144:147], v41 offset:12288
    v_mfma_f32_32x32x16_bf16 v[80:95], v[148:151], v[188:191], v[80:95]
    ds_read_b128 v[148:151], v41 offset:13312
    s_waitcnt lgkmcnt(10)
    v_mfma_f32_32x32x16_bf16 v[96:111], v[152:155], v[188:191], v[96:111]
    ds_read_b128 v[152:155], v41 offset:14336
    v_mfma_f32_32x32x16_bf16 v[112:127], v[156:159], v[188:191], v[112:127]
    ds_read_b128 v[156:159], v41 offset:15360
    s_waitcnt vmcnt(6)
    s_waitcnt lgkmcnt(8)
    v_mfma_f32_32x32x16_bf16 v[64:79], v[128:131], v[192:195], v[64:79]
    ds_read_b128 v[128:131], v41 offset:16384
    buffer_load_dwordx4 v[184:187], v8, s[12:15], s24 offen offset:1024 sc1
    buffer_load_dwordx4 v[188:191], v8, s[12:15], s24 offen offset:1536 sc1
    v_mfma_f32_32x32x16_bf16 v[80:95], v[132:135], v[192:195], v[80:95]
    ds_read_b128 v[132:135], v41 offset:17408
    s_waitcnt lgkmcnt(6)
    v_mfma_f32_32x32x16_bf16 v[96:111], v[136:139], v[192:195], v[96:111]
    ds_read_b128 v[136:139], v41 offset:18432
    v_mfma_f32_32x32x16_bf16 v[112:127], v[140:143], v[192:195], v[112:127]
    ds_read_b128 v[140:143], v41 offset:19456
    s_waitcnt lgkmcnt(6)
    v_mfma_f32_32x32x16_bf16 v[64:79], v[144:147], v[196:199], v[64:79]
    ds_read_b128 v[144:147], v41 offset:20480
    v_mfma_f32_32x32x16_bf16 v[80:95], v[148:151], v[196:199], v[80:95]
    ds_read_b128 v[148:151], v41 offset:21504
    s_waitcnt lgkmcnt(6)
    v_mfma_f32_32x32x16_bf16 v[96:111], v[152:155], v[196:199], v[96:111]
    ds_read_b128 v[152:155], v41 offset:22528
    v_mfma_f32_32x32x16_bf16 v[112:127], v[156:159], v[196:199], v[112:127]
    ds_read_b128 v[156:159], v41 offset:23552
    s_waitcnt vmcnt(6)
    s_waitcnt lgkmcnt(6)
    v_mfma_f32_32x32x16_bf16 v[64:79], v[128:131], v[160:163], v[64:79]
    ds_read_b128 v[128:131], v41 offset:24576
    buffer_load_dwordx4 v[192:195], v8, s[12:15], s24 offen offset:2048 sc1
    buffer_load_dwordx4 v[196:199], v8, s[12:15], s24 offen offset:2560 sc1
    v_mfma_f32_32x32x16_bf16 v[80:95], v[132:135], v[160:163], v[80:95]
    ds_read_b128 v[132:135], v41 offset:25600
    s_waitcnt lgkmcnt(6)
    v_mfma_f32_32x32x16_bf16 v[96:111], v[136:139], v[160:163], v[96:111]
    ds_read_b128 v[136:139], v41 offset:26624
    v_mfma_f32_32x32x16_bf16 v[112:127], v[140:143], v[160:163], v[112:127]
    ds_read_b128 v[140:143], v41 offset:27648
    s_waitcnt lgkmcnt(6)
    v_mfma_f32_32x32x16_bf16 v[64:79], v[144:147], v[164:167], v[64:79]
    ds_read_b128 v[144:147], v41 offset:28672
    v_mfma_f32_32x32x16_bf16 v[80:95], v[148:151], v[164:167], v[80:95]
    ds_read_b128 v[148:151], v41 offset:29696
    s_waitcnt lgkmcnt(6)
    v_mfma_f32_32x32x16_bf16 v[96:111], v[152:155], v[164:167], v[96:111]
    ds_read_b128 v[152:155], v41 offset:30720
    v_mfma_f32_32x32x16_bf16 v[112:127], v[156:159], v[164:167], v[112:127]
    ds_read_b128 v[156:159], v41 offset:31744
    s_waitcnt vmcnt(6)
    s_waitcnt lgkmcnt(6)
    v_mfma_f32_32x32x16_bf16 v[64:79], v[128:131], v[168:171], v[64:79]
    ds_read_b128 v[128:131], v41 offset:32768
    buffer_load_dwordx4 v[160:163], v8, s[12:15], s24 offen offset:3072 sc1
    buffer_load_dwordx4 v[164:167], v8, s[12:15], s24 offen offset:3584 sc1
    v_mfma_f32_32x32x16_bf16 v[80:95], v[132:135], v[168:171], v[80:95]
    ds_read_b128 v[132:135], v41 offset:33792
    s_waitcnt lgkmcnt(6)
    v_mfma_f32_32x32x16_bf16 v[96:111], v[136:139], v[168:171], v[96:111]
    ds_read_b128 v[136:139], v41 offset:34816
    v_mfma_f32_32x32x16_bf16 v[112:127], v[140:143], v[168:171], v[112:127]
    ds_read_b128 v[140:143], v41 offset:35840
    s_waitcnt lgkmcnt(6)
    v_mfma_f32_32x32x16_bf16 v[64:79], v[144:147], v[172:175], v[64:79]
    ds_read_b128 v[144:147], v41 offset:36864
    v_mfma_f32_32x32x16_bf16 v[80:95], v[148:151], v[172:175], v[80:95]
    ds_read_b128 v[148:151], v41 offset:37888
    s_waitcnt lgkmcnt(6)
    v_mfma_f32_32x32x16_bf16 v[96:111], v[152:155], v[172:175], v[96:111]
    ds_read_b128 v[152:155], v41 offset:38912
    v_mfma_f32_32x32x16_bf16 v[112:127], v[156:159], v[172:175], v[112:127]
    ds_read_b128 v[156:159], v41 offset:39936
    s_waitcnt vmcnt(6)
    s_waitcnt lgkmcnt(6)
    v_mfma_f32_32x32x16_bf16 v[64:79], v[128:131], v[176:179], v[64:79]
    ds_read_b128 v[128:131], v41 offset:40960
    s_add_u32 s24, s24, 4096
    buffer_load_dwordx4 v[168:171], v8, s[12:15], s24 offen offset:0 sc1
    buffer_load_dwordx4 v[172:175], v8, s[12:15], s24 offen offset:512 sc1
    v_mfma_f32_32x32x16_bf16 v[80:95], v[132:135], v[176:179], v[80:95]
    ds_read_b128 v[132:135], v41 offset:41984
    s_waitcnt lgkmcnt(6)
    v_mfma_f32_32x32x16_bf16 v[96:111], v[136:139], v[176:179], v[96:111]
    ds_read_b128 v[136:139], v41 offset:43008
    v_mfma_f32_32x32x16_bf16 v[112:127], v[140:143], v[176:179], v[112:127]
    ds_read_b128 v[140:143], v41 offset:44032
    s_waitcnt lgkmcnt(6)
    v_mfma_f32_32x32x16_bf16 v[64:79], v[144:147], v[180:183], v[64:79]
    ds_read_b128 v[144:147], v41 offset:45056
    v_mfma_f32_32x32x16_bf16 v[80:95], v[148:151], v[180:183], v[80:95]
    ds_read_b128 v[148:151], v41 offset:46080
    s_waitcnt lgkmcnt(6)
    v_mfma_f32_32x32x16_bf16 v[96:111], v[152:155], v[180:183], v[96:111]
    ds_read_b128 v[152:155], v41 offset:47104
    v_mfma_f32_32x32x16_bf16 v[112:127], v[156:159], v[180:183], v[112:127]
    ds_read_b128 v[156:159], v41 offset:48128
    s_waitcnt vmcnt(6)
    s_waitcnt lgkmcnt(6)
    v_mfma_f32_32x32x16_bf16 v[64:79], v[128:131], v[184:187], v[64:79]
    ds_read_b128 v[128:131], v41 offset:49152
    buffer_load_dwordx4 v[176:179], v8, s[12:15], s24 offen offset:1024 sc1
    buffer_load_dwordx4 v[180:183], v8, s[12:15], s24 offen offset:1536 sc1
    v_mfma_f32_32x32x16_bf16 v[80:95], v[132:135], v[184:187], v[80:95]
    ds_read_b128 v[132:135], v41 offset:50176
    s_waitcnt lgkmcnt(6)
    v_mfma_f32_32x32x16_bf16 v[96:111], v[136:139], v[184:187], v[96:111]
    ds_read_b128 v[136:139], v41 offset:51200
    v_mfma_f32_32x32x16_bf16 v[112:127], v[140:143], v[184:187], v[112:127]
    ds_read_b128 v[140:143], v41 offset:52224
    s_waitcnt lgkmcnt(6)
    v_mfma_f32_32x32x16_bf16 v[64:79], v[144:147], v[188:191], v[64:79]
    ds_read_b128 v[144:147], v41 offset:53248
    v_mfma_f32_32x32x16_bf16 v[80:95], v[148:151], v[188:191], v[80:95]
    ds_read_b128 v[148:151], v41 offset:54272
    s_waitcnt lgkmcnt(6)
    v_mfma_f32_32x32x16_bf16 v[96:111], v[152:155], v[188:191], v[96:111]
    ds_read_b128 v[152:155], v41 offset:55296
    v_mfma_f32_32x32x16_bf16 v[112:127], v[156:159], v[188:191], v[112:127]
    ds_read_b128 v[156:159], v41 offset:56320
    s_waitcnt vmcnt(6)
    s_waitcnt lgkmcnt(6)
    v_mfma_f32_32x32x16_bf16 v[64:79], v[128:131], v[192:195], v[64:79]
    ds_read_b128 v[128:131], v41 offset:57344
    buffer_load_dwordx4 v[184:187], v8, s[12:15], s24 offen offset:2048 sc1
    buffer_load_dwordx4 v[188:191], v8, s[12:15], s24 offen offset:2560 sc1
    v_mfma_f32_32x32x16_bf16 v[80:95], v[132:135], v[192:195], v[80:95]
    ds_read_b128 v[132:135], v41 offset:58368
    s_waitcnt lgkmcnt(6)
    v_mfma_f32_32x32x16_bf16 v[96:111], v[136:139], v[192:195], v[96:111]
    ds_read_b128 v[136:139], v41 offset:59392
    v_mfma_f32_32x32x16_bf16 v[112:127], v[140:143], v[192:195], v[112:127]
    ds_read_b128 v[140:143], v41 offset:60416
    s_waitcnt lgkmcnt(6)
    v_mfma_f32_32x32x16_bf16 v[64:79], v[144:147], v[196:199], v[64:79]
    ds_read_b128 v[144:147], v41 offset:61440
    v_mfma_f32_32x32x16_bf16 v[80:95], v[148:151], v[196:199], v[80:95]
    ds_read_b128 v[148:151], v41 offset:62464
    s_waitcnt lgkmcnt(6)
    v_mfma_f32_32x32x16_bf16 v[96:111], v[152:155], v[196:199], v[96:111]
    ds_read_b128 v[152:155], v41 offset:63488
    v_mfma_f32_32x32x16_bf16 v[112:127], v[156:159], v[196:199], v[112:127]
    ds_read_b128 v[156:159], v41 offset:64512
    s_waitcnt vmcnt(6)
    s_waitcnt lgkmcnt(6)
    v_mfma_f32_32x32x16_bf16 v[64:79], v[128:131], v[160:163], v[64:79]
    ds_read_b128 v[128:131], v42 offset:0
    buffer_load_dwordx4 v[192:195], v8, s[12:15], s24 offen offset:3072 sc1
    buffer_load_dwordx4 v[196:199], v8, s[12:15], s24 offen offset:3584 sc1
    v_mfma_f32_32x32x16_bf16 v[80:95], v[132:135], v[160:163], v[80:95]
    ds_read_b128 v[132:135], v42 offset:4096
    s_waitcnt lgkmcnt(6)
    v_mfma_f32_32x32x16_bf16 v[96:111], v[136:139], v[160:163], v[96:111]
    ds_read_b128 v[136:139], v42 offset:8192
    v_mfma_f32_32x32x16_bf16 v[112:127], v[140:143], v[160:163], v[112:127]
    ds_read_b128 v[140:143], v42 offset:12288
    s_waitcnt lgkmcnt(6)
    v_mfma_f32_32x32x16_bf16 v[64:79], v[144:147], v[164:167], v[64:79]
    ds_read_b128 v[144:147], v42 offset:16384
    v_mfma_f32_32x32x16_bf16 v[80:95], v[148:151], v[164:167], v[80:95]
    ds_read_b128 v[148:151], v42 offset:20480
    s_waitcnt lgkmcnt(6)
    v_mfma_f32_32x32x16_bf16 v[96:111], v[152:155], v[164:167], v[96:111]
    ds_read_b128 v[152:155], v42 offset:24576
    v_mfma_f32_32x32x16_bf16 v[112:127], v[156:159], v[164:167], v[112:127]
    ds_read_b128 v[156:159], v42 offset:28672
    v_mfma_f32_32x32x8_bf16 v[64:79], v[50:51], v[48:49], v[64:79]
    v_mfma_f32_32x32x8_bf16 v[80:95], v[52:53], v[48:49], v[80:95]
    v_mfma_f32_32x32x8_bf16 v[96:111], v[54:55], v[48:49], v[96:111]
    v_mfma_f32_32x32x8_bf16 v[112:127], v[56:57], v[48:49], v[112:127]
    s_barrier
    s_waitcnt vmcnt(6)
    s_waitcnt lgkmcnt(6)
    v_mfma_f32_32x32x16_bf16 v[64:79], v[128:131], v[168:171], v[64:79]
    ds_read_b128 v[128:131], v42 offset:1024
    v_mfma_f32_32x32x16_bf16 v[64:79], v[132:135], v[172:175], v[64:79]
    ds_read_b128 v[132:135], v42 offset:5120
    s_waitcnt vmcnt(4)
    s_waitcnt lgkmcnt(6)
    v_mfma_f32_32x32x16_bf16 v[64:79], v[136:139], v[176:179], v[64:79]
    ds_read_b128 v[136:139], v42 offset:9216
    v_mfma_f32_32x32x16_bf16 v[64:79], v[140:143], v[180:183], v[64:79]
    ds_read_b128 v[140:143], v42 offset:13312
    s_waitcnt vmcnt(2)
    s_waitcnt lgkmcnt(6)
    v_mfma_f32_32x32x16_bf16 v[64:79], v[144:147], v[184:187], v[64:79]
    ds_read_b128 v[144:147], v42 offset:17408
    v_mfma_f32_32x32x16_bf16 v[64:79], v[148:151], v[188:191], v[64:79]
    ds_read_b128 v[148:151], v42 offset:21504
    s_waitcnt vmcnt(0)
    s_waitcnt lgkmcnt(6)
    v_mfma_f32_32x32x16_bf16 v[64:79], v[152:155], v[192:195], v[64:79]
    ds_read_b128 v[152:155], v42 offset:25600
    v_mfma_f32_32x32x16_bf16 v[64:79], v[156:159], v[196:199], v[64:79]
    ds_read_b128 v[156:159], v42 offset:29696
    s_waitcnt lgkmcnt(6)
    v_mfma_f32_32x32x16_bf16 v[80:95], v[128:131], v[168:171], v[80:95]
    ds_read_b128 v[128:131], v42 offset:2048
    v_mfma_f32_32x32x16_bf16 v[80:95], v[132:135], v[172:175], v[80:95]
    ds_read_b128 v[132:135], v42 offset:6144
    s_waitcnt lgkmcnt(6)
    v_mfma_f32_32x32x16_bf16 v[80:95], v[136:139], v[176:179], v[80:95]
    ds_read_b128 v[136:139], v42 offset:10240
    ds_write_b64 v215, v[220:221] offset:40
    ds_write_b64 v215, v[220:221] offset:48
    ds_write_b64 v215, v[220:221] offset:56
    ds_write_b64 v219, v[222:223] offset:288
    v_mfma_f32_32x32x16_bf16 v[80:95], v[140:143], v[180:183], v[80:95]
    ds_read_b128 v[140:143], v42 offset:14336
    v_mul_f32 v64, v64, v45
    v_mul_f32 v65, v65, v45
    v_mul_f32 v66, v66, v45
    v_mul_f32 v67, v67, v45
    s_waitcnt lgkmcnt(10)
    v_mfma_f32_32x32x16_bf16 v[80:95], v[144:147], v[184:187], v[80:95]
    ds_read_b128 v[144:147], v42 offset:18432
    v_cvt_pk_bf16_f32 v64, v64, v65
    v_cvt_pk_bf16_f32 v65, v66, v67
    ds_write_b64 v212, v[64:65] offset:0
    v_mul_f32 v68, v68, v45
    v_mfma_f32_32x32x16_bf16 v[80:95], v[148:151], v[188:191], v[80:95]
    ds_read_b128 v[148:151], v42 offset:22528
    v_mul_f32 v69, v69, v45
    v_mul_f32 v70, v70, v45
    v_mul_f32 v71, v71, v45
    v_cvt_pk_bf16_f32 v68, v68, v69
    s_waitcnt lgkmcnt(11)
    v_mfma_f32_32x32x16_bf16 v[80:95], v[152:155], v[192:195], v[80:95]
    ds_read_b128 v[152:155], v42 offset:26624
    v_cvt_pk_bf16_f32 v69, v70, v71
    ds_write_b64 v212, v[68:69] offset:16
    v_mul_f32 v72, v72, v45
    v_mul_f32 v73, v73, v45
    v_mfma_f32_32x32x16_bf16 v[80:95], v[156:159], v[196:199], v[80:95]
    ds_read_b128 v[156:159], v42 offset:30720
    v_mul_f32 v74, v74, v45
    v_mul_f32 v75, v75, v45
    v_cvt_pk_bf16_f32 v72, v72, v73
    v_cvt_pk_bf16_f32 v73, v74, v75
    ds_write_b64 v213, v[72:73] offset:32
    v_mul_f32 v76, v76, v45
    v_mul_f32 v77, v77, v45
    v_mul_f32 v78, v78, v45
    v_mul_f32 v79, v79, v45
    v_cvt_pk_bf16_f32 v76, v76, v77
    v_cvt_pk_bf16_f32 v77, v78, v79
    ds_write_b64 v212, v[76:77] offset:72
    s_barrier
    s_waitcnt lgkmcnt(14)
    v_mfma_f32_32x32x16_bf16 v[96:111], v[128:131], v[168:171], v[96:111]
    ds_read_b128 v[128:131], v42 offset:3072
    v_mfma_f32_32x32x16_bf16 v[96:111], v[132:135], v[172:175], v[96:111]
    ds_read_b128 v[132:135], v42 offset:7168
    s_waitcnt lgkmcnt(10)
    v_mfma_f32_32x32x16_bf16 v[96:111], v[136:139], v[176:179], v[96:111]
    ds_read_b128 v[136:139], v42 offset:11264
    v_mul_f32 v80, v80, v45
    v_mul_f32 v81, v81, v45
    v_mul_f32 v82, v82, v45
    v_mul_f32 v83, v83, v45
    v_mfma_f32_32x32x16_bf16 v[96:111], v[140:143], v[180:183], v[96:111]
    ds_read_b128 v[140:143], v42 offset:15360
    v_cvt_pk_bf16_f32 v80, v80, v81
    v_cvt_pk_bf16_f32 v81, v82, v83
    ds_write_b64 v212, v[80:81] offset:88
    v_mul_f32 v84, v84, v47
    s_waitcnt lgkmcnt(10)
    v_mfma_f32_32x32x16_bf16 v[96:111], v[144:147], v[184:187], v[96:111]
    ds_read_b128 v[144:147], v42 offset:19456
    v_mul_f32 v85, v85, v47
    v_mul_f32 v86, v86, v47
    v_mul_f32 v87, v87, v47
    v_cvt_pk_bf16_f32 v84, v84, v85
    v_mfma_f32_32x32x16_bf16 v[96:111], v[148:151], v[188:191], v[96:111]
    ds_read_b128 v[148:151], v42 offset:23552
    v_cvt_pk_bf16_f32 v85, v86, v87
    ds_write_b64 v212, v[84:85] offset:128
    v_mul_f32 v88, v88, v47
    v_mul_f32 v89, v89, v47
    s_waitcnt lgkmcnt(10)
    v_mfma_f32_32x32x16_bf16 v[96:111], v[152:155], v[192:195], v[96:111]
    ds_read_b128 v[152:155], v42 offset:27648
    v_mul_f32 v90, v90, v47
    v_mul_f32 v91, v91, v47
    v_cvt_pk_bf16_f32 v88, v88, v89
    v_cvt_pk_bf16_f32 v89, v90, v91
    v_mfma_f32_32x32x16_bf16 v[96:111], v[156:159], v[196:199], v[96:111]
    ds_read_b128 v[156:159], v42 offset:31744
    ds_write_b64 v212, v[88:89] offset:144
    v_mul_f32 v92, v92, v47
    v_mul_f32 v93, v93, v47
    v_mul_f32 v94, v94, v47
    v_mul_f32 v95, v95, v47
    v_cvt_pk_bf16_f32 v92, v92, v93
    v_cvt_pk_bf16_f32 v93, v94, v95
    ds_write_b64 v212, v[92:93] offset:160
    s_waitcnt lgkmcnt(10)
    v_mfma_f32_32x32x16_bf16 v[112:127], v[128:131], v[168:171], v[112:127]
    v_mfma_f32_32x32x16_bf16 v[112:127], v[132:135], v[172:175], v[112:127]
    s_waitcnt lgkmcnt(8)
    v_mfma_f32_32x32x16_bf16 v[112:127], v[136:139], v[176:179], v[112:127]
    v_mul_f32 v96, v96, v47
    v_mul_f32 v97, v97, v47
    v_mul_f32 v98, v98, v47
    v_mul_f32 v99, v99, v47
    v_mfma_f32_32x32x16_bf16 v[112:127], v[140:143], v[180:183], v[112:127]
    v_cvt_pk_bf16_f32 v96, v96, v97
    v_cvt_pk_bf16_f32 v97, v98, v99
    ds_write_b64 v212, v[96:97] offset:176
    v_mul_f32 v100, v100, v47
    s_waitcnt lgkmcnt(6)
    v_mfma_f32_32x32x16_bf16 v[112:127], v[144:147], v[184:187], v[112:127]
    v_mul_f32 v101, v101, v47
    v_mul_f32 v102, v102, v47
    v_mul_f32 v103, v103, v47
    v_cvt_pk_bf16_f32 v100, v100, v101
    v_mfma_f32_32x32x16_bf16 v[112:127], v[148:151], v[188:191], v[112:127]
    v_cvt_pk_bf16_f32 v101, v102, v103
    ds_write_b64 v212, v[100:101] offset:192
    v_mul_f32 v104, v104, v47
    v_mul_f32 v105, v105, v47
    s_waitcnt lgkmcnt(4)
    v_mfma_f32_32x32x16_bf16 v[112:127], v[152:155], v[192:195], v[112:127]
    v_mul_f32 v106, v106, v47
    v_mul_f32 v107, v107, v47
    v_cvt_pk_bf16_f32 v104, v104, v105
    v_cvt_pk_bf16_f32 v105, v106, v107
    v_mfma_f32_32x32x16_bf16 v[112:127], v[156:159], v[196:199], v[112:127]
    ds_write_b64 v212, v[104:105] offset:208
    v_mul_f32 v108, v108, v47
    v_mul_f32 v109, v109, v47
    v_mul_f32 v110, v110, v47
    v_mul_f32 v111, v111, v47
    v_cvt_pk_bf16_f32 v108, v108, v109
    v_cvt_pk_bf16_f32 v109, v110, v111
    ds_write_b64 v212, v[108:109] offset:224
    s_cmp_eq_u32 s18, 0
    s_cbranch_scc0 interleave_layers__softmax_full_mha__sliding_local_dilated__prompt_kernel_ni
    v_mov_b32 v243, 163824
    v_mov_b32 v240, 0
    v_mov_b32 v241, 0
    v_mov_b32 v242, 0
    ds_write_b96 v243, v[240:242]
    ds_write_b32 v243, v240 offset:12
interleave_layers__softmax_full_mha__sliding_local_dilated__prompt_kernel_ni:
    v_mul_f32 v112, v112, v47
    v_mul_f32 v113, v113, v47
    v_mul_f32 v114, v114, v47
    v_mul_f32 v115, v115, v47
    v_cvt_pk_bf16_f32 v112, v112, v113
    v_cvt_pk_bf16_f32 v113, v114, v115
    ds_write_b64 v212, v[112:113] offset:240
    v_mul_f32 v116, v116, v47
    v_mul_f32 v117, v117, v47
    v_mul_f32 v118, v118, v47
    v_mul_f32 v119, v119, v47
    v_cvt_pk_bf16_f32 v116, v116, v117
    v_cvt_pk_bf16_f32 v117, v118, v119
    ds_write_b64 v212, v[116:117] offset:256
    v_mul_f32 v120, v120, v47
    v_mul_f32 v121, v121, v47
    v_mul_f32 v122, v122, v47
    v_mul_f32 v123, v123, v47
    v_cvt_pk_bf16_f32 v120, v120, v121
    v_cvt_pk_bf16_f32 v121, v122, v123
    ds_write_b64 v212, v[120:121] offset:272
    s_waitcnt lgkmcnt(0)
    s_barrier
    ds_read_b64 v[184:185], v216 offset:4736
    ds_read_b64 v[186:187], v216 offset:4744
    ds_read_b64 v[188:189], v216 offset:4800
    ds_read_b64 v[190:191], v216 offset:4808
    ds_read_b64 v[192:193], v216 offset:9472
    ds_read_b64 v[194:195], v216 offset:9480
    ds_read_b64 v[196:197], v216 offset:9536
    ds_read_b64 v[198:199], v216 offset:9544
    ds_read_b64 v[160:161], v216 offset:128
    ds_read_b64 v[162:163], v216 offset:136
    ds_read_b64 v[164:165], v216 offset:168
    ds_read_b64 v[166:167], v216 offset:176
    ds_read_b64 v[168:169], v216 offset:4864
    ds_read_b64 v[170:171], v216 offset:4872
    ds_read_b64 v[172:173], v216 offset:4904
    ds_read_b64 v[174:175], v216 offset:4912
    ds_read_b64 v[176:177], v216 offset:9600
    ds_read_b64 v[178:179], v216 offset:9608
    ds_read_b64 v[180:181], v216 offset:9640
    ds_read_b64 v[182:183], v216 offset:9648
    s_waitcnt lgkmcnt(0)
    ds_read_b64_tr_b16 v[128:129], v217 offset:208
    ds_read_b64_tr_b16 v[136:137], v217 offset:248
    ds_read_b64_tr_b16 v[144:145], v218 offset:0
    ds_read_b64_tr_b16 v[130:131], v217 offset:4944
    ds_read_b64_tr_b16 v[138:139], v217 offset:4984
    ds_read_b64_tr_b16 v[146:147], v218 offset:4736
    ds_read_b64_tr_b16 v[132:133], v217 offset:9680
    ds_read_b64_tr_b16 v[140:141], v217 offset:9720
    ds_read_b64_tr_b16 v[148:149], v218 offset:9472
    v_mfma_f32_16x16x32_bf16 v[64:67], v[160:163], v[184:187], v[208:211]
    v_mfma_f32_16x16x32_bf16 v[68:71], v[168:171], v[184:187], v[200:203]
    v_mfma_f32_16x16x32_bf16 v[72:75], v[164:167], v[188:191], v[208:211]
    v_mfma_f32_16x16x32_bf16 v[76:79], v[172:175], v[188:191], v[200:203]
    v_mfma_f32_16x16x32_bf16 v[80:83], v[168:171], v[192:195], v[204:207]
    v_mfma_f32_16x16x32_bf16 v[84:87], v[176:179], v[192:195], v[200:203]
    v_mfma_f32_16x16x32_bf16 v[88:91], v[172:175], v[196:199], v[204:207]
    v_mfma_f32_16x16x32_bf16 v[92:95], v[180:183], v[196:199], v[200:203]
    s_waitcnt lgkmcnt(0)
    s_barrier
    v_max3_f32 v96, v64, v65, v66
    v_max3_f32 v96, v67, v68, v96
    v_max3_f32 v96, v69, v70, v96
    v_max_f32 v96, v71, v96
    v_max3_f32 v100, v72, v73, v74
    v_max3_f32 v100, v75, v76, v100
    v_max3_f32 v100, v77, v78, v100
    v_max_f32 v100, v79, v100
    v_max3_f32 v104, v80, v81, v82
    v_max3_f32 v104, v83, v84, v104
    v_max3_f32 v104, v85, v86, v104
    v_max_f32 v104, v87, v104
    v_max3_f32 v108, v88, v89, v90
    v_max3_f32 v108, v91, v92, v108
    v_max3_f32 v108, v93, v94, v108
    v_max_f32 v108, v95, v108
    v_mov_b32 v97, v96
    v_mov_b32 v101, v100
    v_mov_b32 v105, v104
    v_mov_b32 v109, v108
    v_permlane16_swap_b32 v96, v97
    v_permlane16_swap_b32 v100, v101
    v_permlane16_swap_b32 v104, v105
    v_permlane16_swap_b32 v108, v109
    v_max_f32 v96, v96, v97
    v_max_f32 v100, v100, v101
    v_max_f32 v104, v104, v105
    v_max_f32 v108, v108, v109
    v_mov_b32 v97, v96
    v_mov_b32 v101, v100
    v_mov_b32 v105, v104
    v_mov_b32 v109, v108
    v_permlane32_swap_b32 v96, v97
    v_permlane32_swap_b32 v100, v101
    v_permlane32_swap_b32 v104, v105
    v_permlane32_swap_b32 v108, v109
    v_max_f32 v96, v96, v97
    v_max_f32 v100, v100, v101
    v_max_f32 v104, v104, v105
    v_max_f32 v108, v108, v109
    v_sub_f32 v64, v64, v96
    v_sub_f32 v65, v65, v96
    v_sub_f32 v66, v66, v96
    v_sub_f32 v67, v67, v96
    v_sub_f32 v68, v68, v96
    v_sub_f32 v69, v69, v96
    v_sub_f32 v70, v70, v96
    v_sub_f32 v71, v71, v96
    v_sub_f32 v72, v72, v100
    v_sub_f32 v73, v73, v100
    v_sub_f32 v74, v74, v100
    v_sub_f32 v75, v75, v100
    v_sub_f32 v76, v76, v100
    v_sub_f32 v77, v77, v100
    v_sub_f32 v78, v78, v100
    v_sub_f32 v79, v79, v100
    v_sub_f32 v80, v80, v104
    v_sub_f32 v81, v81, v104
    v_sub_f32 v82, v82, v104
    v_sub_f32 v83, v83, v104
    v_sub_f32 v84, v84, v104
    v_sub_f32 v85, v85, v104
    v_sub_f32 v86, v86, v104
    v_sub_f32 v87, v87, v104
    v_sub_f32 v88, v88, v108
    v_sub_f32 v89, v89, v108
    v_sub_f32 v90, v90, v108
    v_sub_f32 v91, v91, v108
    v_sub_f32 v92, v92, v108
    v_sub_f32 v93, v93, v108
    v_sub_f32 v94, v94, v108
    v_sub_f32 v95, v95, v108
    v_exp_f32 v64, v64
    v_exp_f32 v65, v65
    v_exp_f32 v66, v66
    v_exp_f32 v67, v67
    v_exp_f32 v68, v68
    v_exp_f32 v69, v69
    v_exp_f32 v70, v70
    v_exp_f32 v71, v71
    v_exp_f32 v72, v72
    v_exp_f32 v73, v73
    v_exp_f32 v74, v74
    v_exp_f32 v75, v75
    v_exp_f32 v76, v76
    v_exp_f32 v77, v77
    v_exp_f32 v78, v78
    v_exp_f32 v79, v79
    v_exp_f32 v80, v80
    v_exp_f32 v81, v81
    v_exp_f32 v82, v82
    v_exp_f32 v83, v83
    v_exp_f32 v84, v84
    v_exp_f32 v85, v85
    v_exp_f32 v86, v86
    v_exp_f32 v87, v87
    v_exp_f32 v88, v88
    v_exp_f32 v89, v89
    v_exp_f32 v90, v90
    v_exp_f32 v91, v91
    v_exp_f32 v92, v92
    v_exp_f32 v93, v93
    v_exp_f32 v94, v94
    v_exp_f32 v95, v95
    v_cvt_pk_bf16_f32 v112, v64, v65
    v_cvt_pk_bf16_f32 v113, v66, v67
    v_cvt_pk_bf16_f32 v114, v68, v69
    v_cvt_pk_bf16_f32 v115, v70, v71
    v_cvt_pk_bf16_f32 v116, v72, v73
    v_cvt_pk_bf16_f32 v117, v74, v75
    v_cvt_pk_bf16_f32 v118, v76, v77
    v_cvt_pk_bf16_f32 v119, v78, v79
    v_cvt_pk_bf16_f32 v120, v80, v81
    v_cvt_pk_bf16_f32 v121, v82, v83
    v_cvt_pk_bf16_f32 v122, v84, v85
    v_cvt_pk_bf16_f32 v123, v86, v87
    v_cvt_pk_bf16_f32 v124, v88, v89
    v_cvt_pk_bf16_f32 v125, v90, v91
    v_cvt_pk_bf16_f32 v126, v92, v93
    v_cvt_pk_bf16_f32 v127, v94, v95
    v_mfma_f32_16x16x32_bf16 v[68:71], v[144:147], v[112:115], 0
    v_mfma_f32_16x16x32_bf16 v[76:79], v[144:147], v[116:119], 0
    v_mfma_f32_16x16x32_bf16 v[84:87], v[146:149], v[120:123], 0
    v_mfma_f32_16x16x32_bf16 v[92:95], v[146:149], v[124:127], 0
    v_mfma_f32_16x16x32_bf16 v[64:67], v[128:131], v[112:115], 0
    v_mfma_f32_16x16x32_bf16 v[72:75], v[136:139], v[116:119], 0
    v_mfma_f32_16x16x32_bf16 v[80:83], v[130:133], v[120:123], 0
    v_mfma_f32_16x16x32_bf16 v[88:91], v[138:141], v[124:127], 0
    s_nop 0
    v_mov_b32 v96, v68
    v_mov_b32 v97, v68
    v_mov_b32 v100, v76
    v_mov_b32 v101, v76
    v_mov_b32 v104, v84
    v_mov_b32 v105, v84
    v_mov_b32 v108, v92
    v_mov_b32 v109, v92
    v_permlane32_swap_b32 v96, v97
    v_permlane32_swap_b32 v100, v101
    v_permlane32_swap_b32 v104, v105
    v_permlane32_swap_b32 v108, v109
    v_rcp_f32 v97, v97
    v_rcp_f32 v101, v101
    v_rcp_f32 v105, v105
    v_rcp_f32 v109, v109
    v_cmp_eq_u32 vcc, 0, v6
    v_mul_f32 v64, v64, v97
    v_mul_f32 v72, v72, v101
    v_mul_f32 v65, v65, v97
    v_mul_f32 v73, v73, v101
    v_mul_f32 v66, v66, v97
    v_mul_f32 v74, v74, v101
    v_mul_f32 v67, v67, v97
    v_mul_f32 v75, v75, v101
    v_cvt_pk_bf16_f32 v40, v64, v65
    v_cvt_pk_bf16_f32 v41, v66, v67
    v_cvt_pk_bf16_f32 v42, v72, v73
    v_cvt_pk_bf16_f32 v43, v74, v75
    buffer_store_dwordx4 v[40:43], v3, s[12:15], s51 offen sc1
    v_cndmask_b32 v97, v101, v97, vcc
    v_cndmask_b32 v68, v76, v68, vcc
    v_cndmask_b32 v69, v77, v69, vcc
    v_cndmask_b32 v70, v78, v70, vcc
    v_cndmask_b32 v71, v79, v71, vcc
    v_mul_f32 v68, v68, v97
    v_mul_f32 v69, v69, v97
    v_mul_f32 v70, v70, v97
    v_mul_f32 v71, v71, v97
    v_cvt_pk_bf16_f32 v44, v68, v69
    v_cvt_pk_bf16_f32 v45, v70, v71
    v_mul_f32 v80, v80, v105
    v_mul_f32 v88, v88, v109
    v_mul_f32 v81, v81, v105
    v_mul_f32 v89, v89, v109
    v_mul_f32 v82, v82, v105
    v_mul_f32 v90, v90, v109
    v_mul_f32 v83, v83, v105
    v_mul_f32 v91, v91, v109
    v_cvt_pk_bf16_f32 v48, v80, v81
    v_cvt_pk_bf16_f32 v49, v82, v83
    v_cvt_pk_bf16_f32 v50, v88, v89
    v_cvt_pk_bf16_f32 v51, v90, v91
    buffer_store_dwordx4 v[48:51], v3, s[12:15], s52 offen sc1
    v_cndmask_b32 v105, v109, v105, vcc
    v_cndmask_b32 v84, v92, v84, vcc
    v_cndmask_b32 v85, v93, v85, vcc
    v_cndmask_b32 v86, v94, v86, vcc
    v_cndmask_b32 v87, v95, v87, vcc
    v_mul_f32 v84, v84, v105
    v_mul_f32 v85, v85, v105
    v_mul_f32 v86, v86, v105
    v_mul_f32 v87, v87, v105
    v_cvt_pk_bf16_f32 v52, v84, v85
    v_cvt_pk_bf16_f32 v53, v86, v87
    s_mov_b32 exec_hi, 0
    buffer_store_dwordx2 v[44:45], v3, s[12:15], s53 offen sc1
    buffer_store_dwordx2 v[52:53], v3, s[12:15], s54 offen sc1
    v_mov_b32 v241, 0
    v_mov_b32 v242, 0
    s_mov_b64 s[56:57], 1
    s_lshl_b32 s48, s16, 8
    s_add_u32 s48, s48, 25088
    v_mov_b32 v243, 163816
    v_mov_b32 v240, 1
    s_mov_b64 exec, 1
    s_waitcnt vmcnt(0)
    ds_add_rtn_u32 v242, v243, v240 offset:8
    s_waitcnt lgkmcnt(0)
    v_readfirstlane_b32 s49, v242
    s_mov_b64 exec, s[56:57]
    s_cmp_eq_u32 s49, 3
    s_cbranch_scc0 interleave_layers__softmax_full_mha__sliding_local_dilated__prompt_kernel_s3_sg
    buffer_atomic_add v240, v241, s[8:11], s48 offen sc1
interleave_layers__softmax_full_mha__sliding_local_dilated__prompt_kernel_s3_sg:
    s_mov_b64 exec, -1
    s_lshl_b32 s22, s20, 2
    s_and_b32 s23, s21, 3
    s_add_u32 s16, s22, s23
    s_lshr_b32 s17, s21, 2
    s_lshl_b32 s19, s16, 2
    s_add_u32 s19, s19, s39
    s_mul_i32 s24, s19, 20480
    s_lshr_b32 s33, s17, 1
    s_mul_i32 s33, s33, 5120
    s_add_u32 s33, s33, s24
    s_and_b32 s34, s17, 1
    s_mul_i32 s35, s34, 3072
    s_add_u32 s35, s35, s33
    s_lshl_b32 s36, s34, 9
    s_add_u32 s36, s36, s33
    s_add_u32 s36, s36, 2048
    s_add_u32 s37, s35, 15990784
    s_add_u32 s38, s36, 15990784
    v_lshrrev_b32 v13, 5, v1
    v_lshlrev_b32 v13, 8, v13
    v_and_b32 v14, 15, v1
    v_lshl_add_u32 v13, v14, 4, v13
    v_bfe_u32 v14, v1, 4, 1
    v_lshl_add_u32 v13, v14, 3, v13
    buffer_load_dwordx4 v[44:47], v3, s[12:15], s37 offen sc1
    buffer_load_dwordx4 v[48:51], v3, s[12:15], s37 offen offset:1024 sc1
    buffer_load_dwordx2 v[52:53], v13, s[12:15], s38 offen sc1
    s_add_u32 s24, s24, 13369344
    s_add_u32 s25, s24, 4096
    s_add_u32 s26, s24, 8192
    s_add_u32 s27, s24, 12288
    s_add_u32 s28, s24, 16384
    v_lshrrev_b32 v9, 4, v1
    v_add_u32 v12, 61440, v3
    v_mov_b32 v243, 163816
    s_mov_b32 s49, 0
    s_cmp_eq_u32 s18, 0
    s_cbranch_scc0 interleave_layers__softmax_full_mha__sliding_local_dilated__prompt_kernel_p4_sp
    v_mov_b32 v241, 0
    v_mov_b32 v242, 16
    s_mov_b64 s[56:57], 1
    s_lshr_b32 s48, s16, 1
    s_lshl_b32 s48, s48, 8
    s_add_u32 s48, s48, 25088
    s_mov_b64 exec, s[56:57]
interleave_layers__softmax_full_mha__sliding_local_dilated__prompt_kernel_p4_pl:
    v_mov_b32 v240, 0
    buffer_atomic_add v240, v241, s[8:11], s48 offen sc0 sc1
    s_add_u32 s49, s49, 1
    s_waitcnt vmcnt(0)
    v_cmp_ge_u32 vcc, v240, v242
    s_cmp_ge_u32 s49, 0x20000
    s_cbranch_scc1 interleave_layers__softmax_full_mha__sliding_local_dilated__prompt_kernel_p4_px
    s_cmp_eq_u64 vcc, exec
    s_cbranch_scc0 interleave_layers__softmax_full_mha__sliding_local_dilated__prompt_kernel_p4_pl
interleave_layers__softmax_full_mha__sliding_local_dilated__prompt_kernel_p4_px:
    s_mov_b64 exec, 1
    v_mov_b32 v240, 1
    ds_write_b32 v243, v240 offset:12
    s_branch interleave_layers__softmax_full_mha__sliding_local_dilated__prompt_kernel_p4_go
interleave_layers__softmax_full_mha__sliding_local_dilated__prompt_kernel_p4_sp:
    s_sleep 1
    ds_read_b32 v240, v243 offset:12
    s_add_u32 s49, s49, 1
    s_waitcnt lgkmcnt(0)
    v_readfirstlane_b32 s44, v240
    s_cmp_ge_u32 s49, 0x400000
    s_cbranch_scc1 interleave_layers__softmax_full_mha__sliding_local_dilated__prompt_kernel_p4_go
    s_cmp_eq_u32 s44, 0
    s_cbranch_scc1 interleave_layers__softmax_full_mha__sliding_local_dilated__prompt_kernel_p4_sp
interleave_layers__softmax_full_mha__sliding_local_dilated__prompt_kernel_p4_go:
    s_mov_b64 exec, -1
    buffer_load_dwordx4 v[76:79], v3, s[12:15], s24 offen offset:0 sc1
    buffer_load_dwordx4 v[80:83], v3, s[12:15], s24 offen offset:1024 sc1
    buffer_load_dwordx4 v[84:87], v3, s[12:15], s24 offen offset:2048 sc1
    buffer_load_dwordx4 v[88:91], v3, s[12:15], s24 offen offset:3072 sc1
    buffer_load_dwordx4 v[92:95], v3, s[12:15], s25 offen offset:0 sc1
    buffer_load_dwordx4 v[96:99], v3, s[12:15], s25 offen offset:1024 sc1
    buffer_load_dwordx4 v[100:103], v3, s[12:15], s25 offen offset:2048 sc1
    buffer_load_dwordx4 v[104:107], v3, s[12:15], s25 offen offset:3072 sc1
    s_waitcnt vmcnt(8)
    v_lshlrev_b32 v24, 16, v44
    v_and_b32 v25, 0xffff0000, v44
    v_lshlrev_b32 v26, 16, v45
    v_and_b32 v27, 0xffff0000, v45
    v_lshlrev_b32 v28, 16, v46
    v_and_b32 v29, 0xffff0000, v46
    v_lshlrev_b32 v30, 16, v47
    v_and_b32 v31, 0xffff0000, v47
    v_lshlrev_b32 v32, 16, v48
    v_and_b32 v33, 0xffff0000, v48
    v_lshlrev_b32 v34, 16, v49
    v_and_b32 v35, 0xffff0000, v49
    v_lshlrev_b32 v36, 16, v50
    v_and_b32 v37, 0xffff0000, v50
    v_lshlrev_b32 v38, 16, v51
    v_and_b32 v39, 0xffff0000, v51
    v_lshlrev_b32 v40, 16, v52
    v_and_b32 v41, 0xffff0000, v52
    v_lshlrev_b32 v42, 16, v53
    v_and_b32 v43, 0xffff0000, v53
    v_and_b32 v54, 15, v1
    v_mul_u32_u24 v54, 1280, v54
    v_lshl_add_u32 v55, v9, 3, v54
    v_lshl_add_u32 v54, v9, 4, v54
    s_mul_i32 s40, s19, 20480
    s_mul_i32 s31, s17, 160
    s_add_u32 s40, s40, s31
    s_lshl_b32 s31, s34, 5
    s_add_u32 s41, s40, s31
    s_xor_b32 s31, s34, 1
    s_lshl_b32 s31, s31, 7
    s_add_u32 s40, s40, s31
    s_add_u32 s37, s35, 131072
    s_add_u32 s38, s36, 131072
    s_lshl_b32 s32, s19, 10
    s_lshl_b32 s33, s17, 7
    s_add_u32 s32, s32, s33
    s_add_u32 s32, s32, 2752512
    v_lshlrev_b32 v16, 3, v1
    v_mov_b32 v18, 0
    v_mov_b32 v19, 0
    v_mov_b32 v20, 0
    v_mov_b32 v21, 0
    s_barrier
    ds_read_b128 v[156:159], v3 offset:0
    ds_read_b128 v[160:163], v3 offset:1024
    ds_read_b128 v[164:167], v3 offset:2048
    ds_read_b128 v[168:171], v3 offset:3072
    ds_read_b128 v[172:175], v3 offset:4096
    ds_read_b128 v[176:179], v3 offset:5120
    ds_read_b128 v[180:183], v3 offset:6144
    ds_read_b128 v[184:187], v3 offset:7168
    ds_read_b128 v[188:191], v3 offset:8192
    ds_read_b128 v[192:195], v3 offset:9216
    s_waitcnt vmcnt(7)
    s_waitcnt lgkmcnt(5)
    v_mfma_f32_16x16x32_bf16 v[24:27], v[156:159], v[76:79], v[24:27]
    ds_read_b128 v[156:159], v3 offset:10240
    buffer_load_dwordx4 v[108:111], v3, s[12:15], s26 offen offset:0 sc1
    v_mfma_f32_16x16x32_bf16 v[28:31], v[160:163], v[76:79], v[28:31]
    ds_read_b128 v[160:163], v3 offset:11264
    v_mfma_f32_16x16x32_bf16 v[32:35], v[164:167], v[76:79], v[32:35]
    ds_read_b128 v[164:167], v3 offset:12288
    v_mfma_f32_16x16x32_bf16 v[36:39], v[168:171], v[76:79], v[36:39]
    ds_read_b128 v[168:171], v3 offset:13312
    v_mfma_f32_16x16x32_bf16 v[40:43], v[172:175], v[76:79], v[40:43]
    ds_read_b128 v[172:175], v3 offset:14336
    s_waitcnt vmcnt(7)
    s_waitcnt lgkmcnt(5)
    v_mfma_f32_16x16x32_bf16 v[24:27], v[176:179], v[80:83], v[24:27]
    ds_read_b128 v[176:179], v3 offset:15360
    buffer_load_dwordx4 v[112:115], v3, s[12:15], s26 offen offset:1024 sc1
    v_mfma_f32_16x16x32_bf16 v[28:31], v[180:183], v[80:83], v[28:31]
    ds_read_b128 v[180:183], v3 offset:16384
    v_mfma_f32_16x16x32_bf16 v[32:35], v[184:187], v[80:83], v[32:35]
    ds_read_b128 v[184:187], v3 offset:17408
    v_mfma_f32_16x16x32_bf16 v[36:39], v[188:191], v[80:83], v[36:39]
    ds_read_b128 v[188:191], v3 offset:18432
    v_mfma_f32_16x16x32_bf16 v[40:43], v[192:195], v[80:83], v[40:43]
    ds_read_b128 v[192:195], v3 offset:19456
    s_waitcnt vmcnt(6)
    s_waitcnt lgkmcnt(5)
    v_mfma_f32_16x16x32_bf16 v[24:27], v[156:159], v[84:87], v[24:27]
    ds_read_b128 v[156:159], v3 offset:20480
    buffer_load_dwordx4 v[116:119], v3, s[12:15], s26 offen offset:2048 sc1
    v_mfma_f32_16x16x32_bf16 v[28:31], v[160:163], v[84:87], v[28:31]
    ds_read_b128 v[160:163], v3 offset:21504
    v_mfma_f32_16x16x32_bf16 v[32:35], v[164:167], v[84:87], v[32:35]
    ds_read_b128 v[164:167], v3 offset:22528
    v_mfma_f32_16x16x32_bf16 v[36:39], v[168:171], v[84:87], v[36:39]
    ds_read_b128 v[168:171], v3 offset:23552
    v_mfma_f32_16x16x32_bf16 v[40:43], v[172:175], v[84:87], v[40:43]
    ds_read_b128 v[172:175], v3 offset:24576
    s_waitcnt lgkmcnt(5)
    v_mfma_f32_16x16x32_bf16 v[24:27], v[176:179], v[88:91], v[24:27]
    ds_read_b128 v[176:179], v3 offset:25600
    buffer_load_dwordx4 v[120:123], v3, s[12:15], s26 offen offset:3072 sc1
    v_mfma_f32_16x16x32_bf16 v[28:31], v[180:183], v[88:91], v[28:31]
    ds_read_b128 v[180:183], v3 offset:26624
    v_mfma_f32_16x16x32_bf16 v[32:35], v[184:187], v[88:91], v[32:35]
    ds_read_b128 v[184:187], v3 offset:27648
    v_mfma_f32_16x16x32_bf16 v[36:39], v[188:191], v[88:91], v[36:39]
    ds_read_b128 v[188:191], v3 offset:28672
    v_mfma_f32_16x16x32_bf16 v[40:43], v[192:195], v[88:91], v[40:43]
    ds_read_b128 v[192:195], v3 offset:29696
    s_waitcnt vmcnt(6)
    s_waitcnt lgkmcnt(5)
    v_mfma_f32_16x16x32_bf16 v[24:27], v[156:159], v[92:95], v[24:27]
    ds_read_b128 v[156:159], v3 offset:30720
    buffer_load_dwordx4 v[124:127], v3, s[12:15], s27 offen offset:0 sc1
    v_mfma_f32_16x16x32_bf16 v[28:31], v[160:163], v[92:95], v[28:31]
    ds_read_b128 v[160:163], v3 offset:31744
    v_mfma_f32_16x16x32_bf16 v[32:35], v[164:167], v[92:95], v[32:35]
    ds_read_b128 v[164:167], v3 offset:32768
    v_mfma_f32_16x16x32_bf16 v[36:39], v[168:171], v[92:95], v[36:39]
    ds_read_b128 v[168:171], v3 offset:33792
    v_mfma_f32_16x16x32_bf16 v[40:43], v[172:175], v[92:95], v[40:43]
    ds_read_b128 v[172:175], v3 offset:34816
    s_waitcnt lgkmcnt(5)
    v_mfma_f32_16x16x32_bf16 v[24:27], v[176:179], v[96:99], v[24:27]
    ds_read_b128 v[176:179], v3 offset:35840
    buffer_load_dwordx4 v[128:131], v3, s[12:15], s27 offen offset:1024 sc1
    v_mfma_f32_16x16x32_bf16 v[28:31], v[180:183], v[96:99], v[28:31]
    ds_read_b128 v[180:183], v3 offset:36864
    v_mfma_f32_16x16x32_bf16 v[32:35], v[184:187], v[96:99], v[32:35]
    ds_read_b128 v[184:187], v3 offset:37888
    v_mfma_f32_16x16x32_bf16 v[36:39], v[188:191], v[96:99], v[36:39]
    ds_read_b128 v[188:191], v3 offset:38912
    v_mfma_f32_16x16x32_bf16 v[40:43], v[192:195], v[96:99], v[40:43]
    ds_read_b128 v[192:195], v3 offset:39936
    s_waitcnt vmcnt(6)
    s_waitcnt lgkmcnt(5)
    v_mfma_f32_16x16x32_bf16 v[24:27], v[156:159], v[100:103], v[24:27]
    ds_read_b128 v[156:159], v3 offset:40960
    buffer_load_dwordx4 v[132:135], v3, s[12:15], s27 offen offset:2048 sc1
    v_mfma_f32_16x16x32_bf16 v[28:31], v[160:163], v[100:103], v[28:31]
    ds_read_b128 v[160:163], v3 offset:41984
    v_mfma_f32_16x16x32_bf16 v[32:35], v[164:167], v[100:103], v[32:35]
    ds_read_b128 v[164:167], v3 offset:43008
    v_mfma_f32_16x16x32_bf16 v[36:39], v[168:171], v[100:103], v[36:39]
    ds_read_b128 v[168:171], v3 offset:44032
    v_mfma_f32_16x16x32_bf16 v[40:43], v[172:175], v[100:103], v[40:43]
    ds_read_b128 v[172:175], v3 offset:45056
    s_waitcnt lgkmcnt(5)
    v_mfma_f32_16x16x32_bf16 v[24:27], v[176:179], v[104:107], v[24:27]
    ds_read_b128 v[176:179], v3 offset:46080
    buffer_load_dwordx4 v[136:139], v3, s[12:15], s27 offen offset:3072 sc1
    v_mfma_f32_16x16x32_bf16 v[28:31], v[180:183], v[104:107], v[28:31]
    ds_read_b128 v[180:183], v3 offset:47104
    v_mfma_f32_16x16x32_bf16 v[32:35], v[184:187], v[104:107], v[32:35]
    ds_read_b128 v[184:187], v3 offset:48128
    v_mfma_f32_16x16x32_bf16 v[36:39], v[188:191], v[104:107], v[36:39]
    ds_read_b128 v[188:191], v3 offset:49152
    v_mfma_f32_16x16x32_bf16 v[40:43], v[192:195], v[104:107], v[40:43]
    ds_read_b128 v[192:195], v3 offset:50176
    s_waitcnt vmcnt(6)
    s_waitcnt lgkmcnt(5)
    v_mfma_f32_16x16x32_bf16 v[24:27], v[156:159], v[108:111], v[24:27]
    ds_read_b128 v[156:159], v3 offset:51200
    buffer_load_dwordx4 v[140:143], v3, s[12:15], s28 offen offset:0 sc1
    v_mfma_f32_16x16x32_bf16 v[28:31], v[160:163], v[108:111], v[28:31]
    ds_read_b128 v[160:163], v3 offset:52224
    v_mfma_f32_16x16x32_bf16 v[32:35], v[164:167], v[108:111], v[32:35]
    ds_read_b128 v[164:167], v3 offset:53248
    v_mfma_f32_16x16x32_bf16 v[36:39], v[168:171], v[108:111], v[36:39]
    ds_read_b128 v[168:171], v3 offset:54272
    v_mfma_f32_16x16x32_bf16 v[40:43], v[172:175], v[108:111], v[40:43]
    ds_read_b128 v[172:175], v3 offset:55296
    s_waitcnt lgkmcnt(5)
    v_mfma_f32_16x16x32_bf16 v[24:27], v[176:179], v[112:115], v[24:27]
    ds_read_b128 v[176:179], v3 offset:56320
    buffer_load_dwordx4 v[144:147], v3, s[12:15], s28 offen offset:1024 sc1
    v_mfma_f32_16x16x32_bf16 v[28:31], v[180:183], v[112:115], v[28:31]
    ds_read_b128 v[180:183], v3 offset:57344
    v_mfma_f32_16x16x32_bf16 v[32:35], v[184:187], v[112:115], v[32:35]
    ds_read_b128 v[184:187], v3 offset:58368
    v_mfma_f32_16x16x32_bf16 v[36:39], v[188:191], v[112:115], v[36:39]
    ds_read_b128 v[188:191], v3 offset:59392
    v_mfma_f32_16x16x32_bf16 v[40:43], v[192:195], v[112:115], v[40:43]
    ds_read_b128 v[192:195], v3 offset:60416
    s_waitcnt vmcnt(6)
    s_waitcnt lgkmcnt(5)
    v_mfma_f32_16x16x32_bf16 v[24:27], v[156:159], v[116:119], v[24:27]
    ds_read_b128 v[156:159], v12 offset:0
    buffer_load_dwordx4 v[148:151], v3, s[12:15], s28 offen offset:2048 sc1
    v_mfma_f32_16x16x32_bf16 v[28:31], v[160:163], v[116:119], v[28:31]
    ds_read_b128 v[160:163], v12 offset:1024
    v_mfma_f32_16x16x32_bf16 v[32:35], v[164:167], v[116:119], v[32:35]
    ds_read_b128 v[164:167], v12 offset:2048
    v_mfma_f32_16x16x32_bf16 v[36:39], v[168:171], v[116:119], v[36:39]
    ds_read_b128 v[168:171], v12 offset:3072
    v_mfma_f32_16x16x32_bf16 v[40:43], v[172:175], v[116:119], v[40:43]
    ds_read_b128 v[172:175], v12 offset:4096
    s_waitcnt lgkmcnt(5)
    v_mfma_f32_16x16x32_bf16 v[24:27], v[176:179], v[120:123], v[24:27]
    ds_read_b128 v[176:179], v12 offset:5120
    buffer_load_dwordx4 v[152:155], v3, s[12:15], s28 offen offset:3072 sc1
    v_mfma_f32_16x16x32_bf16 v[28:31], v[180:183], v[120:123], v[28:31]
    ds_read_b128 v[180:183], v12 offset:6144
    v_mfma_f32_16x16x32_bf16 v[32:35], v[184:187], v[120:123], v[32:35]
    ds_read_b128 v[184:187], v12 offset:7168
    v_mfma_f32_16x16x32_bf16 v[36:39], v[188:191], v[120:123], v[36:39]
    ds_read_b128 v[188:191], v12 offset:8192
    v_mfma_f32_16x16x32_bf16 v[40:43], v[192:195], v[120:123], v[40:43]
    ds_read_b128 v[192:195], v12 offset:9216
    s_waitcnt vmcnt(6)
    s_waitcnt lgkmcnt(5)
    s_barrier
    v_mfma_f32_16x16x32_bf16 v[24:27], v[156:159], v[124:127], v[24:27]
    ds_read_b128 v[156:159], v12 offset:10240
    v_mfma_f32_16x16x32_bf16 v[28:31], v[160:163], v[124:127], v[28:31]
    ds_read_b128 v[160:163], v12 offset:11264
    v_mfma_f32_16x16x32_bf16 v[32:35], v[164:167], v[124:127], v[32:35]
    ds_read_b128 v[164:167], v12 offset:15360
    v_mfma_f32_16x16x32_bf16 v[36:39], v[168:171], v[124:127], v[36:39]
    ds_read_b128 v[168:171], v12 offset:16384
    v_mfma_f32_16x16x32_bf16 v[40:43], v[172:175], v[124:127], v[40:43]
    ds_read_b128 v[172:175], v12 offset:20480
    s_waitcnt lgkmcnt(5)
    v_mfma_f32_16x16x32_bf16 v[24:27], v[176:179], v[128:131], v[24:27]
    ds_read_b128 v[176:179], v12 offset:21504
    v_mfma_f32_16x16x32_bf16 v[28:31], v[180:183], v[128:131], v[28:31]
    ds_read_b128 v[180:183], v12 offset:25600
    v_mfma_f32_16x16x32_bf16 v[32:35], v[184:187], v[128:131], v[32:35]
    ds_read_b128 v[184:187], v12 offset:26624
    v_mfma_f32_16x16x32_bf16 v[36:39], v[188:191], v[128:131], v[36:39]
    ds_read_b128 v[188:191], v12 offset:30720
    v_mfma_f32_16x16x32_bf16 v[40:43], v[192:195], v[128:131], v[40:43]
    ds_read_b128 v[192:195], v12 offset:31744
    s_cmp_eq_u32 s3, 0
    s_cbranch_scc1 interleave_layers__softmax_full_mha__sliding_local_dilated__prompt_kernel_nf
    s_waitcnt vmcnt(5)
    s_waitcnt lgkmcnt(5)
    v_mfma_f32_16x16x32_bf16 v[24:27], v[156:159], v[132:135], v[24:27]
    ds_read_b128 v[156:159], v12 offset:35840
    v_mfma_f32_16x16x32_bf16 v[28:31], v[160:163], v[132:135], v[28:31]
    ds_read_b128 v[160:163], v12 offset:36864
    s_waitcnt vmcnt(4)
    v_mfma_f32_16x16x32_bf16 v[24:27], v[164:167], v[136:139], v[24:27]
    ds_read_b128 v[164:167], v12 offset:12288
    v_mfma_f32_16x16x32_bf16 v[28:31], v[168:171], v[136:139], v[28:31]
    ds_read_b128 v[168:171], v12 offset:13312
    s_waitcnt vmcnt(3)
    v_mfma_f32_16x16x32_bf16 v[24:27], v[172:175], v[140:143], v[24:27]
    ds_read_b128 v[172:175], v12 offset:17408
    s_waitcnt lgkmcnt(5)
    v_mfma_f32_16x16x32_bf16 v[28:31], v[176:179], v[140:143], v[28:31]
    ds_read_b128 v[176:179], v12 offset:18432
    s_waitcnt vmcnt(2)
    v_mfma_f32_16x16x32_bf16 v[24:27], v[180:183], v[144:147], v[24:27]
    ds_read_b128 v[180:183], v12 offset:22528
    v_mfma_f32_16x16x32_bf16 v[28:31], v[184:187], v[144:147], v[28:31]
    ds_read_b128 v[184:187], v12 offset:23552
    s_waitcnt vmcnt(1)
    v_mfma_f32_16x16x32_bf16 v[24:27], v[188:191], v[148:151], v[24:27]
    ds_read_b128 v[188:191], v12 offset:27648
    v_mfma_f32_16x16x32_bf16 v[28:31], v[192:195], v[148:151], v[28:31]
    ds_read_b128 v[192:195], v12 offset:28672
    s_waitcnt vmcnt(0)
    s_waitcnt lgkmcnt(5)
    v_mfma_f32_16x16x32_bf16 v[24:27], v[156:159], v[152:155], v[24:27]
    ds_read_b128 v[156:159], v12 offset:32768
    v_mfma_f32_16x16x32_bf16 v[28:31], v[160:163], v[152:155], v[28:31]
    ds_read_b128 v[160:163], v12 offset:33792
    v_mfma_f32_16x16x32_bf16 v[32:35], v[164:167], v[132:135], v[32:35]
    ds_read_b128 v[164:167], v12 offset:37888
    v_mfma_f32_16x16x32_bf16 v[36:39], v[168:171], v[132:135], v[36:39]
    ds_read_b128 v[168:171], v12 offset:38912
    v_mfma_f32_16x16x32_bf16 v[32:35], v[172:175], v[136:139], v[32:35]
    ds_read_b128 v[172:175], v12 offset:14336
    s_waitcnt lgkmcnt(5)
    v_mfma_f32_16x16x32_bf16 v[36:39], v[176:179], v[136:139], v[36:39]
    ds_read_b128 v[176:179], v12 offset:19456
    v_cvt_pk_bf16_f32 v44, v24, v25
    v_cvt_pk_bf16_f32 v45, v26, v27
    v_mfma_f32_16x16x32_bf16 v[32:35], v[180:183], v[140:143], v[32:35]
    ds_read_b128 v[180:183], v12 offset:24576
    v_cvt_pk_bf16_f32 v46, v28, v29
    v_cvt_pk_bf16_f32 v47, v30, v31
    v_mfma_f32_16x16x32_bf16 v[36:39], v[184:187], v[140:143], v[36:39]
    ds_read_b128 v[184:187], v12 offset:29696
    buffer_store_dwordx4 v[44:47], v54, s[60:63], s41 offen offset:0
    v_mfma_f32_16x16x32_bf16 v[32:35], v[188:191], v[144:147], v[32:35]
    ds_read_b128 v[188:191], v12 offset:34816
    v_mfma_f32_16x16x32_bf16 v[36:39], v[192:195], v[144:147], v[36:39]
    ds_read_b128 v[192:195], v12 offset:39936
    s_waitcnt lgkmcnt(5)
    v_mfma_f32_16x16x32_bf16 v[32:35], v[156:159], v[148:151], v[32:35]
    v_mfma_f32_16x16x32_bf16 v[36:39], v[160:163], v[148:151], v[36:39]
    v_mfma_f32_16x16x32_bf16 v[32:35], v[164:167], v[152:155], v[32:35]
    v_mfma_f32_16x16x32_bf16 v[36:39], v[168:171], v[152:155], v[36:39]
    v_mfma_f32_16x16x32_bf16 v[40:43], v[172:175], v[132:135], v[40:43]
    s_waitcnt lgkmcnt(0)
    v_mfma_f32_16x16x32_bf16 v[40:43], v[176:179], v[136:139], v[40:43]
    v_mfma_f32_16x16x32_bf16 v[40:43], v[180:183], v[140:143], v[40:43]
    v_mfma_f32_16x16x32_bf16 v[40:43], v[184:187], v[144:147], v[40:43]
    s_nop 1
    v_cvt_pk_bf16_f32 v48, v32, v33
    v_cvt_pk_bf16_f32 v49, v34, v35
    v_mfma_f32_16x16x32_bf16 v[40:43], v[188:191], v[148:151], v[40:43]
    v_cvt_pk_bf16_f32 v50, v36, v37
    v_cvt_pk_bf16_f32 v51, v38, v39
    v_mfma_f32_16x16x32_bf16 v[40:43], v[192:195], v[152:155], v[40:43]
    buffer_store_dwordx4 v[48:51], v54, s[60:63], s41 offen offset:64
    s_barrier
    s_nop 5
    v_cvt_pk_bf16_f32 v52, v40, v41
    v_cvt_pk_bf16_f32 v53, v42, v43
    buffer_store_dwordx2 v[52:53], v55, s[60:63], s40 offen
    s_endpgm
interleave_layers__softmax_full_mha__sliding_local_dilated__prompt_kernel_nf:
    s_waitcnt vmcnt(5)
    s_waitcnt lgkmcnt(5)
    v_mfma_f32_16x16x32_bf16 v[24:27], v[156:159], v[132:135], v[24:27]
    ds_read_b128 v[156:159], v12 offset:35840
    v_mfma_f32_16x16x32_bf16 v[28:31], v[160:163], v[132:135], v[28:31]
    ds_read_b128 v[160:163], v12 offset:36864
    s_waitcnt vmcnt(4)
    v_mfma_f32_16x16x32_bf16 v[24:27], v[164:167], v[136:139], v[24:27]
    ds_read_b128 v[164:167], v12 offset:12288
    v_mfma_f32_16x16x32_bf16 v[28:31], v[168:171], v[136:139], v[28:31]
    ds_read_b128 v[168:171], v12 offset:13312
    s_waitcnt vmcnt(3)
    v_mfma_f32_16x16x32_bf16 v[24:27], v[172:175], v[140:143], v[24:27]
    ds_read_b128 v[172:175], v12 offset:17408
    s_waitcnt lgkmcnt(5)
    v_mfma_f32_16x16x32_bf16 v[28:31], v[176:179], v[140:143], v[28:31]
    ds_read_b128 v[176:179], v12 offset:18432
    s_waitcnt vmcnt(2)
    v_mfma_f32_16x16x32_bf16 v[24:27], v[180:183], v[144:147], v[24:27]
    ds_read_b128 v[180:183], v12 offset:22528
    v_mfma_f32_16x16x32_bf16 v[28:31], v[184:187], v[144:147], v[28:31]
    ds_read_b128 v[184:187], v12 offset:23552
    s_waitcnt vmcnt(1)
    v_mfma_f32_16x16x32_bf16 v[24:27], v[188:191], v[148:151], v[24:27]
    ds_read_b128 v[188:191], v12 offset:27648
    v_mfma_f32_16x16x32_bf16 v[28:31], v[192:195], v[148:151], v[28:31]
    ds_read_b128 v[192:195], v12 offset:28672
    s_waitcnt vmcnt(0)
    s_waitcnt lgkmcnt(5)
    v_mfma_f32_16x16x32_bf16 v[24:27], v[156:159], v[152:155], v[24:27]
    ds_read_b128 v[156:159], v12 offset:32768
    v_mfma_f32_16x16x32_bf16 v[28:31], v[160:163], v[152:155], v[28:31]
    ds_read_b128 v[160:163], v12 offset:33792
    v_mfma_f32_16x16x32_bf16 v[32:35], v[164:167], v[132:135], v[32:35]
    ds_read_b128 v[164:167], v12 offset:37888
    v_mfma_f32_16x16x32_bf16 v[36:39], v[168:171], v[132:135], v[36:39]
    ds_read_b128 v[168:171], v12 offset:38912
    v_mfma_f32_16x16x32_bf16 v[32:35], v[172:175], v[136:139], v[32:35]
    ds_read_b128 v[172:175], v12 offset:14336
    s_waitcnt lgkmcnt(5)
    v_mfma_f32_16x16x32_bf16 v[36:39], v[176:179], v[136:139], v[36:39]
    ds_read_b128 v[176:179], v12 offset:19456
    v_cvt_pk_bf16_f32 v44, v24, v25
    v_cvt_pk_bf16_f32 v45, v26, v27
    v_mfma_f32_16x16x32_bf16 v[32:35], v[180:183], v[140:143], v[32:35]
    ds_read_b128 v[180:183], v12 offset:24576
    v_cvt_pk_bf16_f32 v46, v28, v29
    v_cvt_pk_bf16_f32 v47, v30, v31
    v_mfma_f32_16x16x32_bf16 v[36:39], v[184:187], v[140:143], v[36:39]
    ds_read_b128 v[184:187], v12 offset:29696
    buffer_store_dwordx4 v[44:47], v3, s[12:15], s37 offen offset:0 sc1
    v_add_f32 v18, v18, v24
    v_mfma_f32_16x16x32_bf16 v[32:35], v[188:191], v[144:147], v[32:35]
    ds_read_b128 v[188:191], v12 offset:34816
    v_fmac_f32 v19, v24, v24
    v_add_f32 v20, v20, v25
    v_mfma_f32_16x16x32_bf16 v[36:39], v[192:195], v[144:147], v[36:39]
    ds_read_b128 v[192:195], v12 offset:39936
    v_fmac_f32 v21, v25, v25
    v_add_f32 v18, v18, v26
    s_waitcnt lgkmcnt(5)
    v_mfma_f32_16x16x32_bf16 v[32:35], v[156:159], v[148:151], v[32:35]
    v_fmac_f32 v19, v26, v26
    v_add_f32 v20, v20, v27
    v_mfma_f32_16x16x32_bf16 v[36:39], v[160:163], v[148:151], v[36:39]
    v_fmac_f32 v21, v27, v27
    v_add_f32 v18, v18, v28
    v_mfma_f32_16x16x32_bf16 v[32:35], v[164:167], v[152:155], v[32:35]
    v_fmac_f32 v19, v28, v28
    v_add_f32 v20, v20, v29
    v_mfma_f32_16x16x32_bf16 v[36:39], v[168:171], v[152:155], v[36:39]
    v_fmac_f32 v21, v29, v29
    v_add_f32 v18, v18, v30
    v_fmac_f32 v19, v30, v30
    v_add_f32 v20, v20, v31
    v_fmac_f32 v21, v31, v31
    v_mfma_f32_16x16x32_bf16 v[40:43], v[172:175], v[132:135], v[40:43]
    s_waitcnt lgkmcnt(0)
    v_mfma_f32_16x16x32_bf16 v[40:43], v[176:179], v[136:139], v[40:43]
    v_mfma_f32_16x16x32_bf16 v[40:43], v[180:183], v[140:143], v[40:43]
    v_mfma_f32_16x16x32_bf16 v[40:43], v[184:187], v[144:147], v[40:43]
    v_cvt_pk_bf16_f32 v48, v32, v33
    v_cvt_pk_bf16_f32 v49, v34, v35
    v_mfma_f32_16x16x32_bf16 v[40:43], v[188:191], v[148:151], v[40:43]
    v_cvt_pk_bf16_f32 v50, v36, v37
    v_cvt_pk_bf16_f32 v51, v38, v39
    v_mfma_f32_16x16x32_bf16 v[40:43], v[192:195], v[152:155], v[40:43]
    buffer_store_dwordx4 v[48:51], v3, s[12:15], s37 offen offset:1024 sc1
    v_add_f32 v18, v18, v32
    v_fmac_f32 v19, v32, v32
    v_add_f32 v20, v20, v33
    v_fmac_f32 v21, v33, v33
    v_add_f32 v18, v18, v34
    v_fmac_f32 v19, v34, v34
    v_add_f32 v20, v20, v35
    v_fmac_f32 v21, v35, v35
    v_add_f32 v18, v18, v36
    v_fmac_f32 v19, v36, v36
    v_add_f32 v20, v20, v37
    v_fmac_f32 v21, v37, v37
    v_add_f32 v18, v18, v38
    v_fmac_f32 v19, v38, v38
    v_add_f32 v20, v20, v39
    v_fmac_f32 v21, v39, v39
    s_barrier
    v_cvt_pk_bf16_f32 v52, v40, v41
    v_cvt_pk_bf16_f32 v53, v42, v43
    buffer_store_dwordx2 v[52:53], v13, s[12:15], s38 offen sc1
    v_add_f32 v18, v18, v40
    v_fmac_f32 v19, v40, v40
    v_add_f32 v20, v20, v41
    v_fmac_f32 v21, v41, v41
    v_add_f32 v18, v18, v42
    v_fmac_f32 v19, v42, v42
    v_add_f32 v20, v20, v43
    v_fmac_f32 v21, v43, v43
    v_add_f32 v18, v18, v20
    v_add_f32 v19, v19, v21
    v_mov_b32 v20, v18
    v_mov_b32 v21, v19
    s_nop 0
    v_permlane16_swap_b32 v18, v20
    v_permlane16_swap_b32 v19, v21
    s_nop 0
    v_add_f32 v18, v18, v20
    v_add_f32 v19, v19, v21
    v_mov_b32 v20, v18
    v_mov_b32 v21, v19
    s_nop 0
    v_permlane32_swap_b32 v18, v20
    v_permlane32_swap_b32 v19, v21
    s_nop 0
    v_add_f32 v18, v18, v20
    v_add_f32 v19, v19, v21
    s_mov_b64 exec, 0xffff
    buffer_store_dwordx2 v[18:19], v16, s[12:15], s32 offen sc1
    v_mov_b32 v241, 0
    v_mov_b32 v242, 0
    s_mov_b64 s[56:57], 1
    s_lshr_b32 s48, s16, 1
    s_lshl_b32 s48, s48, 8
    s_add_u32 s48, s48, 29184
    v_mov_b32 v243, 163816
    v_mov_b32 v240, 1
    s_mov_b64 exec, 1
    s_waitcnt vmcnt(0)
    ds_add_rtn_u32 v242, v243, v240 offset:16
    s_waitcnt lgkmcnt(0)
    v_readfirstlane_b32 s49, v242
    s_mov_b64 exec, s[56:57]
    s_cmp_eq_u32 s49, 3
    s_cbranch_scc0 interleave_layers__softmax_full_mha__sliding_local_dilated__prompt_kernel_s4_sg
    buffer_atomic_add v240, v241, s[8:11], s48 offen sc1
interleave_layers__softmax_full_mha__sliding_local_dilated__prompt_kernel_s4_sg:
    s_mov_b64 exec, -1
    s_lshl_b32 s22, s20, 1
    s_and_b32 s23, s21, 1
    s_add_u32 s16, s22, s23
    s_lshr_b32 s17, s21, 1
    s_cmp_ge_u32 s17, 15
    s_cbranch_scc1 interleave_layers__softmax_full_mha__sliding_local_dilated__prompt_kernel_idle
    v_and_b32 v10, 31, v1
    v_lshrrev_b32 v4, 5, v1
    v_and_b32 v5, 15, v1
    s_lshl_b32 s19, s16, 2
    s_add_u32 s19, s19, s18
    v_bfe_u32 v7, v1, 4, 1
    v_mul_u32_u24 v8, 20480, v7
    v_lshl_add_u32 v8, v4, 8, v8
    v_lshl_add_u32 v8, v5, 4, v8
    v_lshlrev_b32 v11, 10, v7
    v_lshl_add_u32 v11, v4, 9, v11
    v_lshl_add_u32 v11, v5, 3, v11
    s_lshl_b32 s30, s19, 11
    s_add_u32 s30, s30, 2752512
    s_mul_i32 s24, s19, 40960
    s_add_u32 s24, s24, 131072
    v_add_u32 v41, 65536, v3
    v_add_u32 v42, 131072, v3
    v_subrev_u32 v58, 1, v4
    v_not_b32 v59, v58
    v_lshlrev_b32 v12, 4, v10
    s_lshl_b32 s31, s17, 11
    s_add_u32 s31, s31, 18743296
    buffer_load_dwordx4 v[24:27], v12, s[12:15], s31 offen offset:0
    buffer_load_dwordx4 v[28:31], v12, s[12:15], s31 offen offset:512
    buffer_load_dwordx4 v[32:35], v12, s[12:15], s31 offen offset:1024
    buffer_load_dwordx4 v[36:39], v12, s[12:15], s31 offen offset:1536
    v_mov_b32 v243, 163816
    s_mov_b32 s49, 0
    s_cmp_eq_u32 s18, 0
    s_cbranch_scc0 interleave_layers__softmax_full_mha__sliding_local_dilated__prompt_kernel_p5_sp
    v_mov_b32 v241, 0
    v_mov_b32 v242, 16
    s_mov_b64 s[56:57], 1
    s_lshl_b32 s48, s16, 8
    s_add_u32 s48, s48, 29184
    s_mov_b64 exec, s[56:57]
interleave_layers__softmax_full_mha__sliding_local_dilated__prompt_kernel_p5_pl:
    v_mov_b32 v240, 0
    buffer_atomic_add v240, v241, s[8:11], s48 offen sc0 sc1
    s_add_u32 s49, s49, 1
    s_waitcnt vmcnt(0)
    v_cmp_ge_u32 vcc, v240, v242
    s_cmp_ge_u32 s49, 0x20000
    s_cbranch_scc1 interleave_layers__softmax_full_mha__sliding_local_dilated__prompt_kernel_p5_px
    s_cmp_eq_u64 vcc, exec
    s_cbranch_scc0 interleave_layers__softmax_full_mha__sliding_local_dilated__prompt_kernel_p5_pl
interleave_layers__softmax_full_mha__sliding_local_dilated__prompt_kernel_p5_px:
    s_mov_b64 exec, 1
    v_mov_b32 v240, 1
    ds_write_b32 v243, v240 offset:20
    s_branch interleave_layers__softmax_full_mha__sliding_local_dilated__prompt_kernel_p5_go
interleave_layers__softmax_full_mha__sliding_local_dilated__prompt_kernel_p5_sp:
    s_sleep 1
    ds_read_b32 v240, v243 offset:20
    s_add_u32 s49, s49, 1
    s_waitcnt lgkmcnt(0)
    v_readfirstlane_b32 s44, v240
    s_cmp_ge_u32 s49, 0x400000
    s_cbranch_scc1 interleave_layers__softmax_full_mha__sliding_local_dilated__prompt_kernel_p5_go
    s_cmp_eq_u32 s44, 0
    s_cbranch_scc1 interleave_layers__softmax_full_mha__sliding_local_dilated__prompt_kernel_p5_sp
interleave_layers__softmax_full_mha__sliding_local_dilated__prompt_kernel_p5_go:
    s_mov_b64 exec, -1
    buffer_load_dwordx4 v[160:163], v8, s[12:15], s24 offen offset:0 sc1
    buffer_load_dwordx4 v[164:167], v8, s[12:15], s24 offen offset:512 sc1
    buffer_load_dwordx2 v[16:17], v11, s[12:15], s30 offen offset:0 sc1
    buffer_load_dwordx2 v[18:19], v11, s[12:15], s30 offen offset:128 sc1
    buffer_load_dwordx2 v[20:21], v11, s[12:15], s30 offen offset:256 sc1
    buffer_load_dwordx2 v[22:23], v11, s[12:15], s30 offen offset:384 sc1
    buffer_load_dwordx4 v[168:171], v8, s[12:15], s24 offen offset:1024 sc1
    buffer_load_dwordx4 v[172:175], v8, s[12:15], s24 offen offset:1536 sc1
    buffer_load_dwordx4 v[176:179], v8, s[12:15], s24 offen offset:2048 sc1
    buffer_load_dwordx4 v[180:183], v8, s[12:15], s24 offen offset:2560 sc1
    buffer_load_dwordx4 v[184:187], v8, s[12:15], s24 offen offset:3072 sc1
    buffer_load_dwordx4 v[188:191], v8, s[12:15], s24 offen offset:3584 sc1
    s_cmp_ge_u32 s17, 10
    s_cbranch_scc1 interleave_layers__softmax_full_mha__sliding_local_dilated__prompt_kernel_p5_qv
    s_barrier
    ds_read_b128 v[128:131], v3 offset:0
    ds_read_b128 v[132:135], v3 offset:1024
    ds_read_b128 v[136:139], v3 offset:2048
    ds_read_b128 v[140:143], v3 offset:3072
    ds_read_b128 v[144:147], v3 offset:4096
    ds_read_b128 v[148:151], v3 offset:5120
    ds_read_b128 v[152:155], v3 offset:6144
    ds_read_b128 v[156:159], v3 offset:7168
    s_waitcnt vmcnt(10)
    s_waitcnt lgkmcnt(6)
    v_mfma_f32_32x32x16_bf16 v[64:79], v[128:131], v[160:163], 0
    ds_read_b128 v[128:131], v3 offset:8192
    s_add_u32 s24, s24, 4096
    buffer_load_dwordx4 v[192:195], v8, s[12:15], s24 offen offset:0 sc1
    buffer_load_dwordx4 v[196:199], v8, s[12:15], s24 offen offset:512 sc1
    v_mfma_f32_32x32x16_bf16 v[80:95], v[132:135], v[160:163], 0
    ds_read_b128 v[132:135], v3 offset:9216
    s_waitcnt lgkmcnt(6)
    v_mfma_f32_32x32x16_bf16 v[96:111], v[136:139], v[160:163], 0
    ds_read_b128 v[136:139], v3 offset:10240
    v_mfma_f32_32x32x16_bf16 v[112:127], v[140:143], v[160:163], 0
    ds_read_b128 v[140:143], v3 offset:11264
    s_waitcnt lgkmcnt(6)
    v_mfma_f32_32x32x16_bf16 v[64:79], v[144:147], v[164:167], v[64:79]
    ds_read_b128 v[144:147], v3 offset:12288
    buffer_load_dwordx4 v[200:203], v8, s[12:15], s24 offen offset:1024 sc1
    buffer_load_dwordx4 v[204:207], v8, s[12:15], s24 offen offset:1536 sc1
    v_mfma_f32_32x32x16_bf16 v[80:95], v[148:151], v[164:167], v[80:95]
    ds_read_b128 v[148:151], v3 offset:13312
    s_waitcnt lgkmcnt(6)
    v_mfma_f32_32x32x16_bf16 v[96:111], v[152:155], v[164:167], v[96:111]
    ds_read_b128 v[152:155], v3 offset:14336
    v_mfma_f32_32x32x16_bf16 v[112:127], v[156:159], v[164:167], v[112:127]
    ds_read_b128 v[156:159], v3 offset:15360
    s_waitcnt vmcnt(8)
    s_waitcnt lgkmcnt(6)
    v_mfma_f32_32x32x16_bf16 v[64:79], v[128:131], v[168:171], v[64:79]
    ds_read_b128 v[128:131], v3 offset:16384
    buffer_load_dwordx4 v[208:211], v8, s[12:15], s24 offen offset:2048 sc1
    buffer_load_dwordx4 v[212:215], v8, s[12:15], s24 offen offset:2560 sc1
    v_add_f32 v16, v16, v18
    v_mfma_f32_32x32x16_bf16 v[80:95], v[132:135], v[168:171], v[80:95]
    ds_read_b128 v[132:135], v3 offset:17408
    v_add_f32 v17, v17, v19
    v_add_f32 v20, v20, v22
    s_waitcnt lgkmcnt(6)
    v_mfma_f32_32x32x16_bf16 v[96:111], v[136:139], v[168:171], v[96:111]
    ds_read_b128 v[136:139], v3 offset:18432
    v_add_f32 v21, v21, v23
    v_add_f32 v16, v16, v20
    v_mfma_f32_32x32x16_bf16 v[112:127], v[140:143], v[168:171], v[112:127]
    ds_read_b128 v[140:143], v3 offset:19456
    v_add_f32 v17, v17, v21
    v_mov_b32 v18, v16
    s_waitcnt lgkmcnt(6)
    v_mfma_f32_32x32x16_bf16 v[64:79], v[144:147], v[172:175], v[64:79]
    ds_read_b128 v[144:147], v3 offset:20480
    buffer_load_dwordx4 v[216:219], v8, s[12:15], s24 offen offset:3072 sc1
    buffer_load_dwordx4 v[220:223], v8, s[12:15], s24 offen offset:3584 sc1
    v_permlane32_swap_b32 v16, v18
    v_add_f32 v16, v16, v18
    v_mfma_f32_32x32x16_bf16 v[80:95], v[148:151], v[172:175], v[80:95]
    ds_read_b128 v[148:151], v3 offset:21504
    v_mov_b32 v18, v17
    s_nop 1
    v_permlane32_swap_b32 v17, v18
    s_waitcnt lgkmcnt(6)
    v_mfma_f32_32x32x16_bf16 v[96:111], v[152:155], v[172:175], v[96:111]
    ds_read_b128 v[152:155], v3 offset:22528
    v_add_f32 v17, v17, v18
    v_mul_f32 v46, 0x3acccccd, v16
    v_mfma_f32_32x32x16_bf16 v[112:127], v[156:159], v[172:175], v[112:127]
    ds_read_b128 v[156:159], v3 offset:23552
    v_mul_f32 v18, 0x3acccccd, v17
    v_fma_f32 v18, -v46, v46, v18
    s_waitcnt vmcnt(10)
    s_waitcnt lgkmcnt(6)
    v_mfma_f32_32x32x16_bf16 v[64:79], v[128:131], v[176:179], v[64:79]
    ds_read_b128 v[128:131], v3 offset:24576
    s_add_u32 s24, s24, 4096
    buffer_load_dwordx4 v[160:163], v8, s[12:15], s24 offen offset:0 sc1
    buffer_load_dwordx4 v[164:167], v8, s[12:15], s24 offen offset:512 sc1
    v_max_f32 v18, 0, v18
    v_add_f32 v18, 0x3727c5ac, v18
    v_mfma_f32_32x32x16_bf16 v[80:95], v[132:135], v[176:179], v[80:95]
    ds_read_b128 v[132:135], v3 offset:25600
    v_rsq_f32 v47, v18
    v_xor_b32 v19, 0x80000000, v46
    s_waitcnt lgkmcnt(6)
    v_mfma_f32_32x32x16_bf16 v[96:111], v[136:139], v[176:179], v[96:111]
    ds_read_b128 v[136:139], v3 offset:26624
    v_and_b32 v18, 0xffff0000, v19
    v_sub_f32 v20, v19, v18
    v_mfma_f32_32x32x16_bf16 v[112:127], v[140:143], v[176:179], v[112:127]
    ds_read_b128 v[140:143], v3 offset:27648
    v_cvt_pk_bf16_f32 v48, v18, v18
    v_cvt_pk_bf16_f32 v49, v20, 0
    s_waitcnt lgkmcnt(6)
    v_mfma_f32_32x32x16_bf16 v[64:79], v[144:147], v[180:183], v[64:79]
    ds_read_b128 v[144:147], v3 offset:28672
    buffer_load_dwordx4 v[168:171], v8, s[12:15], s24 offen offset:1024 sc1
    buffer_load_dwordx4 v[172:175], v8, s[12:15], s24 offen offset:1536 sc1
    v_and_b32 v48, v48, v58
    v_and_b32 v49, v49, v58
    v_mfma_f32_32x32x16_bf16 v[80:95], v[148:151], v[180:183], v[80:95]
    ds_read_b128 v[148:151], v3 offset:29696
    v_add_f32 v24, v24, v25
    v_add_f32 v26, v26, v27
    s_waitcnt lgkmcnt(6)
    v_mfma_f32_32x32x16_bf16 v[96:111], v[152:155], v[180:183], v[96:111]
    ds_read_b128 v[152:155], v3 offset:30720
    v_add_f32 v24, v24, v26
    v_and_b32 v18, 0xffff0000, v24
    v_mfma_f32_32x32x16_bf16 v[112:127], v[156:159], v[180:183], v[112:127]
    ds_read_b128 v[156:159], v3 offset:31744
    v_sub_f32 v20, v24, v18
    v_cvt_pk_bf16_f32 v50, v18, v20
    s_waitcnt vmcnt(12)
    s_waitcnt lgkmcnt(6)
    v_mfma_f32_32x32x16_bf16 v[64:79], v[128:131], v[184:187], v[64:79]
    ds_read_b128 v[128:131], v3 offset:32768
    buffer_load_dwordx4 v[176:179], v8, s[12:15], s24 offen offset:2048 sc1
    buffer_load_dwordx4 v[180:183], v8, s[12:15], s24 offen offset:2560 sc1
    v_lshrrev_b32 v51, 16, v18
    v_add_f32 v28, v28, v29
    v_mfma_f32_32x32x16_bf16 v[80:95], v[132:135], v[184:187], v[80:95]
    ds_read_b128 v[132:135], v3 offset:33792
    v_add_f32 v30, v30, v31
    v_add_f32 v28, v28, v30
    s_waitcnt lgkmcnt(6)
    v_mfma_f32_32x32x16_bf16 v[96:111], v[136:139], v[184:187], v[96:111]
    ds_read_b128 v[136:139], v3 offset:34816
    v_and_b32 v18, 0xffff0000, v28
    v_sub_f32 v20, v28, v18
    v_mfma_f32_32x32x16_bf16 v[112:127], v[140:143], v[184:187], v[112:127]
    ds_read_b128 v[140:143], v3 offset:35840
    v_cvt_pk_bf16_f32 v52, v18, v20
    v_lshrrev_b32 v53, 16, v18
    s_waitcnt lgkmcnt(6)
    v_mfma_f32_32x32x16_bf16 v[64:79], v[144:147], v[188:191], v[64:79]
    ds_read_b128 v[144:147], v3 offset:36864
    v_add_f32 v32, v32, v33
    v_add_f32 v34, v34, v35
    v_mfma_f32_32x32x16_bf16 v[80:95], v[148:151], v[188:191], v[80:95]
    ds_read_b128 v[148:151], v3 offset:37888
    v_add_f32 v32, v32, v34
    v_and_b32 v18, 0xffff0000, v32
    s_waitcnt lgkmcnt(6)
    v_mfma_f32_32x32x16_bf16 v[96:111], v[152:155], v[188:191], v[96:111]
    ds_read_b128 v[152:155], v3 offset:38912
    v_sub_f32 v20, v32, v18
    v_cvt_pk_bf16_f32 v54, v18, v20
    v_mfma_f32_32x32x16_bf16 v[112:127], v[156:159], v[188:191], v[112:127]
    ds_read_b128 v[156:159], v3 offset:39936
    v_lshrrev_b32 v55, 16, v18
    v_add_f32 v36, v36, v37
    s_waitcnt vmcnt(12)
    s_waitcnt lgkmcnt(6)
    v_mfma_f32_32x32x16_bf16 v[64:79], v[128:131], v[192:195], v[64:79]
    ds_read_b128 v[128:131], v3 offset:40960
    buffer_load_dwordx4 v[184:187], v8, s[12:15], s24 offen offset:3072 sc1
    buffer_load_dwordx4 v[188:191], v8, s[12:15], s24 offen offset:3584 sc1
    v_add_f32 v38, v38, v39
    v_add_f32 v36, v36, v38
    v_mfma_f32_32x32x16_bf16 v[80:95], v[132:135], v[192:195], v[80:95]
    ds_read_b128 v[132:135], v3 offset:41984
    v_and_b32 v18, 0xffff0000, v36
    v_sub_f32 v20, v36, v18
    s_waitcnt lgkmcnt(6)
    v_mfma_f32_32x32x16_bf16 v[96:111], v[136:139], v[192:195], v[96:111]
    ds_read_b128 v[136:139], v3 offset:43008
    v_cvt_pk_bf16_f32 v56, v18, v20
    v_lshrrev_b32 v57, 16, v18
    v_mfma_f32_32x32x16_bf16 v[112:127], v[140:143], v[192:195], v[112:127]
    ds_read_b128 v[140:143], v3 offset:44032
    s_cmp_ge_u32 s17, 5
    s_cselect_b32 s33, 2621440, 0
    s_cselect_b32 s59, 1.0, 0x3ea52b5c
    s_cselect_b32 s35, 5, 0
    s_cselect_b32 s37, 1, 0
    s_add_u32 s33, s33, 2883584
    s_waitcnt lgkmcnt(6)
    v_mfma_f32_32x32x16_bf16 v[64:79], v[144:147], v[196:199], v[64:79]
    ds_read_b128 v[144:147], v3 offset:45056
    s_sub_u32 s35, s17, s35
    s_and_b32 s36, s19, 31
    v_mfma_f32_32x32x16_bf16 v[80:95], v[148:151], v[196:199], v[80:95]
    ds_read_b128 v[148:151], v3 offset:46080
    s_lshl_b32 s36, s36, 1
    s_lshr_b32 s34, s19, 5
    s_waitcnt lgkmcnt(6)
    v_mfma_f32_32x32x16_bf16 v[96:111], v[152:155], v[196:199], v[96:111]
    ds_read_b128 v[152:155], v3 offset:47104
    s_add_u32 s36, s36, s34
    s_add_u32 s36, s36, 44
    v_mfma_f32_32x32x16_bf16 v[112:127], v[156:159], v[196:199], v[112:127]
    ds_read_b128 v[156:159], v3 offset:48128
    s_and_b32 s36, s36, 63
    s_cmp_eq_u32 s37, 0
    s_cselect_b32 s36, s19, s36
    s_waitcnt vmcnt(12)
    s_waitcnt lgkmcnt(6)
    v_mfma_f32_32x32x16_bf16 v[64:79], v[128:131], v[200:203], v[64:79]
    ds_read_b128 v[128:131], v3 offset:49152
    s_add_u32 s24, s24, 4096
    buffer_load_dwordx4 v[192:195], v8, s[12:15], s24 offen offset:0 sc1
    buffer_load_dwordx4 v[196:199], v8, s[12:15], s24 offen offset:512 sc1
    s_mul_i32 s36, s36, 1280
    s_lshl_b32 s36, s36, s37
    v_mfma_f32_32x32x16_bf16 v[80:95], v[132:135], v[200:203], v[80:95]
    ds_read_b128 v[132:135], v3 offset:50176
    s_add_u32 s33, s33, s36
    s_lshl_b32 s34, 81920, s37
    s_waitcnt lgkmcnt(6)
    v_mfma_f32_32x32x16_bf16 v[96:111], v[136:139], v[200:203], v[96:111]
    ds_read_b128 v[136:139], v3 offset:51200
    v_lshlrev_b32 v16, 4, v10
    v_lshlrev_b32 v17, 3, v10
    v_mfma_f32_32x32x16_bf16 v[112:127], v[140:143], v[200:203], v[112:127]
    ds_read_b128 v[140:143], v3 offset:52224
    v_lshl_add_u32 v18, v4, 9, v16
    s_sub_u32 s36, s34, 512
    s_waitcnt lgkmcnt(6)
    v_mfma_f32_32x32x16_bf16 v[64:79], v[144:147], v[204:207], v[64:79]
    ds_read_b128 v[144:147], v3 offset:53248
    v_and_b32 v19, s36, v59
    v_add_u32 v19, v19, v16
    v_mfma_f32_32x32x16_bf16 v[80:95], v[148:151], v[204:207], v[80:95]
    ds_read_b128 v[148:151], v3 offset:54272
    s_mov_b32 s52, -1
    s_mov_b32 s53, 0
    s_waitcnt lgkmcnt(6)
    v_mfma_f32_32x32x16_bf16 v[96:111], v[152:155], v[204:207], v[96:111]
    ds_read_b128 v[152:155], v3 offset:55296
    s_mov_b32 s54, 0
    s_mov_b32 s55, -1
    v_mfma_f32_32x32x16_bf16 v[112:127], v[156:159], v[204:207], v[112:127]
    ds_read_b128 v[156:159], v3 offset:56320
    v_mul_f32 v47, s59, v47
    s_waitcnt vmcnt(12)
    s_barrier
    s_waitcnt lgkmcnt(6)
    v_mfma_f32_32x32x16_bf16 v[64:79], v[128:131], v[208:211], v[64:79]
    ds_read_b128 v[128:131], v3 offset:57344
    buffer_load_dwordx4 v[200:203], v8, s[12:15], s24 offen offset:1024 sc1
    buffer_load_dwordx4 v[204:207], v8, s[12:15], s24 offen offset:1536 sc1
    v_mfma_f32_32x32x16_bf16 v[80:95], v[132:135], v[208:211], v[80:95]
    ds_read_b128 v[132:135], v3 offset:58368
    s_waitcnt lgkmcnt(6)
    v_mfma_f32_32x32x16_bf16 v[96:111], v[136:139], v[208:211], v[96:111]
    ds_read_b128 v[136:139], v3 offset:59392
    v_mfma_f32_32x32x16_bf16 v[112:127], v[140:143], v[208:211], v[112:127]
    ds_read_b128 v[140:143], v3 offset:60416
    s_waitcnt lgkmcnt(6)
    v_mfma_f32_32x32x16_bf16 v[64:79], v[144:147], v[212:215], v[64:79]
    ds_read_b128 v[144:147], v3 offset:61440
    v_mfma_f32_32x32x16_bf16 v[80:95], v[148:151], v[212:215], v[80:95]
    ds_read_b128 v[148:151], v3 offset:62464
    s_waitcnt lgkmcnt(6)
    v_mfma_f32_32x32x16_bf16 v[96:111], v[152:155], v[212:215], v[96:111]
    ds_read_b128 v[152:155], v3 offset:63488
    v_mfma_f32_32x32x16_bf16 v[112:127], v[156:159], v[212:215], v[112:127]
    ds_read_b128 v[156:159], v3 offset:64512
    s_waitcnt vmcnt(12)
    s_waitcnt lgkmcnt(6)
    v_mfma_f32_32x32x16_bf16 v[64:79], v[128:131], v[216:219], v[64:79]
    ds_read_b128 v[128:131], v41 offset:0
    buffer_load_dwordx4 v[208:211], v8, s[12:15], s24 offen offset:2048 sc1
    buffer_load_dwordx4 v[212:215], v8, s[12:15], s24 offen offset:2560 sc1
    v_mfma_f32_32x32x16_bf16 v[80:95], v[132:135], v[216:219], v[80:95]
    ds_read_b128 v[132:135], v41 offset:1024
    s_waitcnt lgkmcnt(6)
    v_mfma_f32_32x32x16_bf16 v[96:111], v[136:139], v[216:219], v[96:111]
    ds_read_b128 v[136:139], v41 offset:2048
    v_mfma_f32_32x32x16_bf16 v[112:127], v[140:143], v[216:219], v[112:127]
    ds_read_b128 v[140:143], v41 offset:3072
    s_waitcnt lgkmcnt(6)
    v_mfma_f32_32x32x16_bf16 v[64:79], v[144:147], v[220:223], v[64:79]
    ds_read_b128 v[144:147], v41 offset:4096
    v_mfma_f32_32x32x16_bf16 v[80:95], v[148:151], v[220:223], v[80:95]
    ds_read_b128 v[148:151], v41 offset:5120
    s_waitcnt lgkmcnt(6)
    v_mfma_f32_32x32x16_bf16 v[96:111], v[152:155], v[220:223], v[96:111]
    ds_read_b128 v[152:155], v41 offset:6144
    v_mfma_f32_32x32x16_bf16 v[112:127], v[156:159], v[220:223], v[112:127]
    ds_read_b128 v[156:159], v41 offset:7168
    s_waitcnt vmcnt(12)
    s_waitcnt lgkmcnt(6)
    v_mfma_f32_32x32x16_bf16 v[64:79], v[128:131], v[160:163], v[64:79]
    ds_read_b128 v[128:131], v41 offset:8192
    buffer_load_dwordx4 v[216:219], v8, s[12:15], s24 offen offset:3072 sc1
    buffer_load_dwordx4 v[220:223], v8, s[12:15], s24 offen offset:3584 sc1
    v_mfma_f32_32x32x16_bf16 v[80:95], v[132:135], v[160:163], v[80:95]
    ds_read_b128 v[132:135], v41 offset:9216
    s_waitcnt lgkmcnt(6)
    v_mfma_f32_32x32x16_bf16 v[96:111], v[136:139], v[160:163], v[96:111]
    ds_read_b128 v[136:139], v41 offset:10240
    v_mfma_f32_32x32x16_bf16 v[112:127], v[140:143], v[160:163], v[112:127]
    ds_read_b128 v[140:143], v41 offset:11264
    s_waitcnt lgkmcnt(6)
    v_mfma_f32_32x32x16_bf16 v[64:79], v[144:147], v[164:167], v[64:79]
    ds_read_b128 v[144:147], v41 offset:12288
    v_mfma_f32_32x32x16_bf16 v[80:95], v[148:151], v[164:167], v[80:95]
    ds_read_b128 v[148:151], v41 offset:13312
    s_waitcnt lgkmcnt(6)
    v_mfma_f32_32x32x16_bf16 v[96:111], v[152:155], v[164:167], v[96:111]
    ds_read_b128 v[152:155], v41 offset:14336
    v_mfma_f32_32x32x16_bf16 v[112:127], v[156:159], v[164:167], v[112:127]
    ds_read_b128 v[156:159], v41 offset:15360
    s_waitcnt vmcnt(12)
    s_waitcnt lgkmcnt(6)
    v_mfma_f32_32x32x16_bf16 v[64:79], v[128:131], v[168:171], v[64:79]
    ds_read_b128 v[128:131], v41 offset:16384
    s_add_u32 s24, s24, 4096
    buffer_load_dwordx4 v[160:163], v8, s[12:15], s24 offen offset:0 sc1
    buffer_load_dwordx4 v[164:167], v8, s[12:15], s24 offen offset:512 sc1
    v_mfma_f32_32x32x16_bf16 v[80:95], v[132:135], v[168:171], v[80:95]
    ds_read_b128 v[132:135], v41 offset:17408
    s_waitcnt lgkmcnt(6)
    v_mfma_f32_32x32x16_bf16 v[96:111], v[136:139], v[168:171], v[96:111]
    ds_read_b128 v[136:139], v41 offset:18432
    v_mfma_f32_32x32x16_bf16 v[112:127], v[140:143], v[168:171], v[112:127]
    ds_read_b128 v[140:143], v41 offset:19456
    s_waitcnt lgkmcnt(6)
    v_mfma_f32_32x32x16_bf16 v[64:79], v[144:147], v[172:175], v[64:79]
    ds_read_b128 v[144:147], v41 offset:20480
    v_mfma_f32_32x32x16_bf16 v[80:95], v[148:151], v[172:175], v[80:95]
    ds_read_b128 v[148:151], v41 offset:21504
    s_waitcnt lgkmcnt(6)
    v_mfma_f32_32x32x16_bf16 v[96:111], v[152:155], v[172:175], v[96:111]
    ds_read_b128 v[152:155], v41 offset:22528
    v_mfma_f32_32x32x16_bf16 v[112:127], v[156:159], v[172:175], v[112:127]
    ds_read_b128 v[156:159], v41 offset:23552
    s_waitcnt vmcnt(12)
    s_waitcnt lgkmcnt(6)
    v_mfma_f32_32x32x16_bf16 v[64:79], v[128:131], v[176:179], v[64:79]
    ds_read_b128 v[128:131], v41 offset:24576
    buffer_load_dwordx4 v[168:171], v8, s[12:15], s24 offen offset:1024 sc1
    buffer_load_dwordx4 v[172:175], v8, s[12:15], s24 offen offset:1536 sc1
    v_mfma_f32_32x32x16_bf16 v[80:95], v[132:135], v[176:179], v[80:95]
    ds_read_b128 v[132:135], v41 offset:25600
    s_waitcnt lgkmcnt(6)
    v_mfma_f32_32x32x16_bf16 v[96:111], v[136:139], v[176:179], v[96:111]
    ds_read_b128 v[136:139], v41 offset:26624
    v_mfma_f32_32x32x16_bf16 v[112:127], v[140:143], v[176:179], v[112:127]
    ds_read_b128 v[140:143], v41 offset:27648
    s_waitcnt lgkmcnt(6)
    v_mfma_f32_32x32x16_bf16 v[64:79], v[144:147], v[180:183], v[64:79]
    ds_read_b128 v[144:147], v41 offset:28672
    v_mfma_f32_32x32x16_bf16 v[80:95], v[148:151], v[180:183], v[80:95]
    ds_read_b128 v[148:151], v41 offset:29696
    s_waitcnt lgkmcnt(6)
    v_mfma_f32_32x32x16_bf16 v[96:111], v[152:155], v[180:183], v[96:111]
    ds_read_b128 v[152:155], v41 offset:30720
    v_mfma_f32_32x32x16_bf16 v[112:127], v[156:159], v[180:183], v[112:127]
    ds_read_b128 v[156:159], v41 offset:31744
    s_waitcnt vmcnt(12)
    s_waitcnt lgkmcnt(6)
    v_mfma_f32_32x32x16_bf16 v[64:79], v[128:131], v[184:187], v[64:79]
    ds_read_b128 v[128:131], v41 offset:32768
    buffer_load_dwordx4 v[176:179], v8, s[12:15], s24 offen offset:2048 sc1
    buffer_load_dwordx4 v[180:183], v8, s[12:15], s24 offen offset:2560 sc1
    v_mfma_f32_32x32x16_bf16 v[80:95], v[132:135], v[184:187], v[80:95]
    ds_read_b128 v[132:135], v41 offset:33792
    s_waitcnt lgkmcnt(6)
    v_mfma_f32_32x32x16_bf16 v[96:111], v[136:139], v[184:187], v[96:111]
    ds_read_b128 v[136:139], v41 offset:34816
    v_mfma_f32_32x32x16_bf16 v[112:127], v[140:143], v[184:187], v[112:127]
    ds_read_b128 v[140:143], v41 offset:35840
    s_waitcnt lgkmcnt(6)
    v_mfma_f32_32x32x16_bf16 v[64:79], v[144:147], v[188:191], v[64:79]
    ds_read_b128 v[144:147], v41 offset:36864
    v_mfma_f32_32x32x16_bf16 v[80:95], v[148:151], v[188:191], v[80:95]
    ds_read_b128 v[148:151], v41 offset:37888
    s_waitcnt lgkmcnt(6)
    v_mfma_f32_32x32x16_bf16 v[96:111], v[152:155], v[188:191], v[96:111]
    ds_read_b128 v[152:155], v41 offset:38912
    v_mfma_f32_32x32x16_bf16 v[112:127], v[156:159], v[188:191], v[112:127]
    ds_read_b128 v[156:159], v41 offset:39936
    s_waitcnt vmcnt(12)
    s_waitcnt lgkmcnt(6)
    v_mfma_f32_32x32x16_bf16 v[64:79], v[128:131], v[192:195], v[64:79]
    ds_read_b128 v[128:131], v41 offset:40960
    buffer_load_dwordx4 v[184:187], v8, s[12:15], s24 offen offset:3072 sc1
    buffer_load_dwordx4 v[188:191], v8, s[12:15], s24 offen offset:3584 sc1
    v_mfma_f32_32x32x16_bf16 v[80:95], v[132:135], v[192:195], v[80:95]
    ds_read_b128 v[132:135], v41 offset:45056
    s_waitcnt lgkmcnt(6)
    v_mfma_f32_32x32x16_bf16 v[96:111], v[136:139], v[192:195], v[96:111]
    ds_read_b128 v[136:139], v41 offset:49152
    v_mfma_f32_32x32x16_bf16 v[112:127], v[140:143], v[192:195], v[112:127]
    ds_read_b128 v[140:143], v41 offset:53248
    s_waitcnt lgkmcnt(6)
    v_mfma_f32_32x32x16_bf16 v[64:79], v[144:147], v[196:199], v[64:79]
    ds_read_b128 v[144:147], v41 offset:57344
    v_mfma_f32_32x32x16_bf16 v[80:95], v[148:151], v[196:199], v[80:95]
    ds_read_b128 v[148:151], v41 offset:61440
    s_waitcnt lgkmcnt(6)
    v_mfma_f32_32x32x16_bf16 v[96:111], v[152:155], v[196:199], v[96:111]
    ds_read_b128 v[152:155], v42 offset:0
    v_mfma_f32_32x32x16_bf16 v[112:127], v[156:159], v[196:199], v[112:127]
    ds_read_b128 v[156:159], v42 offset:4096
    v_mfma_f32_32x32x8_bf16 v[64:79], v[50:51], v[48:49], v[64:79]
    v_mfma_f32_32x32x8_bf16 v[80:95], v[52:53], v[48:49], v[80:95]
    v_mfma_f32_32x32x8_bf16 v[96:111], v[54:55], v[48:49], v[96:111]
    v_mfma_f32_32x32x8_bf16 v[112:127], v[56:57], v[48:49], v[112:127]
    s_cmp_eq_u32 s35, 1
    s_cbranch_scc1 interleave_layers__softmax_full_mha__sliding_local_dilated__prompt_kernel_p5_e1
    s_cmp_eq_u32 s35, 2
    s_cbranch_scc1 interleave_layers__softmax_full_mha__sliding_local_dilated__prompt_kernel_p5_e2
    s_cmp_eq_u32 s35, 3
    s_cbranch_scc1 interleave_layers__softmax_full_mha__sliding_local_dilated__prompt_kernel_p5_e3
    s_cmp_eq_u32 s35, 4
    s_cbranch_scc1 interleave_layers__softmax_full_mha__sliding_local_dilated__prompt_kernel_p5_e4
    s_waitcnt vmcnt(12)
    s_waitcnt lgkmcnt(6)
    v_mfma_f32_32x32x16_bf16 v[64:79], v[128:131], v[200:203], v[64:79]
    ds_read_b128 v[128:131], v42 offset:8192
    v_mfma_f32_32x32x16_bf16 v[64:79], v[132:135], v[204:207], v[64:79]
    ds_read_b128 v[132:135], v42 offset:12288
    s_waitcnt vmcnt(10)
    s_waitcnt lgkmcnt(6)
    v_mfma_f32_32x32x16_bf16 v[64:79], v[136:139], v[208:211], v[64:79]
    ds_read_b128 v[136:139], v42 offset:16384
    v_mfma_f32_32x32x16_bf16 v[64:79], v[140:143], v[212:215], v[64:79]
    ds_read_b128 v[140:143], v42 offset:20480
    s_waitcnt vmcnt(8)
    s_waitcnt lgkmcnt(6)
    v_mfma_f32_32x32x16_bf16 v[64:79], v[144:147], v[216:219], v[64:79]
    ds_read_b128 v[144:147], v42 offset:24576
    v_mfma_f32_32x32x16_bf16 v[64:79], v[148:151], v[220:223], v[64:79]
    ds_read_b128 v[148:151], v42 offset:28672
    s_waitcnt vmcnt(6)
    s_waitcnt lgkmcnt(6)
    v_mfma_f32_32x32x16_bf16 v[64:79], v[152:155], v[160:163], v[64:79]
    ds_read_b128 v[152:155], v41 offset:41984
    v_mfma_f32_32x32x16_bf16 v[64:79], v[156:159], v[164:167], v[64:79]
    ds_read_b128 v[156:159], v41 offset:46080
    s_waitcnt vmcnt(4)
    s_waitcnt lgkmcnt(6)
    v_mfma_f32_32x32x16_bf16 v[64:79], v[128:131], v[168:171], v[64:79]
    ds_read_b128 v[128:131], v41 offset:50176
    v_mfma_f32_32x32x16_bf16 v[64:79], v[132:135], v[172:175], v[64:79]
    ds_read_b128 v[132:135], v41 offset:54272
    s_waitcnt vmcnt(2)
    s_waitcnt lgkmcnt(6)
    v_mfma_f32_32x32x16_bf16 v[64:79], v[136:139], v[176:179], v[64:79]
    ds_read_b128 v[136:139], v41 offset:58368
    v_mfma_f32_32x32x16_bf16 v[64:79], v[140:143], v[180:183], v[64:79]
    ds_read_b128 v[140:143], v41 offset:62464
    s_waitcnt vmcnt(0)
    s_waitcnt lgkmcnt(6)
    v_mfma_f32_32x32x16_bf16 v[64:79], v[144:147], v[184:187], v[64:79]
    ds_read_b128 v[144:147], v42 offset:1024
    v_mfma_f32_32x32x16_bf16 v[64:79], v[148:151], v[188:191], v[64:79]
    ds_read_b128 v[148:151], v42 offset:5120
    s_waitcnt lgkmcnt(6)
    v_mfma_f32_32x32x16_bf16 v[80:95], v[152:155], v[200:203], v[80:95]
    ds_read_b128 v[152:155], v42 offset:9216
    v_mfma_f32_32x32x16_bf16 v[80:95], v[156:159], v[204:207], v[80:95]
    ds_read_b128 v[156:159], v42 offset:13312
    s_waitcnt lgkmcnt(6)
    v_mfma_f32_32x32x16_bf16 v[80:95], v[128:131], v[208:211], v[80:95]
    ds_read_b128 v[128:131], v42 offset:17408
    s_nop 2
    v_mul_f32 v64, v64, v47
    v_mul_f32 v65, v65, v47
    v_mul_f32 v66, v66, v47
    v_mul_f32 v67, v67, v47
    v_mfma_f32_32x32x16_bf16 v[80:95], v[132:135], v[212:215], v[80:95]
    ds_read_b128 v[132:135], v42 offset:21504
    v_mul_f32 v68, v68, v47
    v_mul_f32 v69, v69, v47
    v_mul_f32 v70, v70, v47
    v_mul_f32 v71, v71, v47
    s_waitcnt lgkmcnt(6)
    v_mfma_f32_32x32x16_bf16 v[80:95], v[136:139], v[216:219], v[80:95]
    ds_read_b128 v[136:139], v42 offset:25600
    v_mul_f32 v72, v72, v47
    v_mul_f32 v73, v73, v47
    v_mul_f32 v74, v74, v47
    v_mul_f32 v75, v75, v47
    v_mfma_f32_32x32x16_bf16 v[80:95], v[140:143], v[220:223], v[80:95]
    ds_read_b128 v[140:143], v42 offset:29696
    v_mul_f32 v76, v76, v47
    v_mul_f32 v77, v77, v47
    v_mul_f32 v78, v78, v47
    v_mul_f32 v79, v79, v47
    s_waitcnt lgkmcnt(6)
    v_mfma_f32_32x32x16_bf16 v[80:95], v[144:147], v[160:163], v[80:95]
    ds_read_b128 v[144:147], v41 offset:43008
    v_cvt_pk_bf16_f32 v64, v64, v65
    v_cvt_pk_bf16_f32 v65, v66, v67
    v_cvt_pk_bf16_f32 v66, v68, v69
    v_cvt_pk_bf16_f32 v67, v70, v71
    v_mfma_f32_32x32x16_bf16 v[80:95], v[148:151], v[164:167], v[80:95]
    ds_read_b128 v[148:151], v41 offset:47104
    v_cvt_pk_bf16_f32 v68, v72, v73
    v_cvt_pk_bf16_f32 v69, v74, v75
    v_cvt_pk_bf16_f32 v70, v76, v77
    v_cvt_pk_bf16_f32 v71, v78, v79
    s_waitcnt lgkmcnt(6)
    v_mfma_f32_32x32x16_bf16 v[80:95], v[152:155], v[168:171], v[80:95]
    ds_read_b128 v[152:155], v41 offset:51200
    v_permlane32_swap_b32 v64, v66
    v_permlane32_swap_b32 v65, v67
    v_permlane32_swap_b32 v68, v70
    v_permlane32_swap_b32 v69, v71
    v_mfma_f32_32x32x16_bf16 v[80:95], v[156:159], v[172:175], v[80:95]
    ds_read_b128 v[156:159], v41 offset:55296
    buffer_store_dwordx4 v[64:67], v18, s[12:15], s33 offen offset:0 sc1
    s_mul_i32 s36, s34, 1
    s_add_u32 s36, s36, s33
    s_add_u32 s38, s33, s34
    s_waitcnt lgkmcnt(6)
    v_mfma_f32_32x32x16_bf16 v[80:95], v[128:131], v[176:179], v[80:95]
    ds_read_b128 v[128:131], v41 offset:59392
    s_mov_b64 exec, s[54:55]
    buffer_store_dwordx4 v[68:71], v16, s[12:15], s36 offen offset:0 sc1
    s_mov_b64 exec, s[52:53]
    buffer_store_dwordx2 v[68:69], v17, s[12:15], s33 offen offset:1024 sc1
    buffer_store_dwordx2 v[70:71], v17, s[12:15], s38 offen offset:1024 sc1
    s_mov_b64 exec, -1
    v_mfma_f32_32x32x16_bf16 v[80:95], v[132:135], v[180:183], v[80:95]
    ds_read_b128 v[132:135], v41 offset:63488
    s_waitcnt lgkmcnt(6)
    v_mfma_f32_32x32x16_bf16 v[80:95], v[136:139], v[184:187], v[80:95]
    ds_read_b128 v[136:139], v42 offset:2048
    v_mfma_f32_32x32x16_bf16 v[80:95], v[140:143], v[188:191], v[80:95]
    ds_read_b128 v[140:143], v42 offset:6144
    s_waitcnt lgkmcnt(6)
    v_mfma_f32_32x32x16_bf16 v[96:111], v[144:147], v[200:203], v[96:111]
    ds_read_b128 v[144:147], v42 offset:10240
    v_mfma_f32_32x32x16_bf16 v[96:111], v[148:151], v[204:207], v[96:111]
    ds_read_b128 v[148:151], v42 offset:14336
    s_waitcnt lgkmcnt(6)
    v_mfma_f32_32x32x16_bf16 v[96:111], v[152:155], v[208:211], v[96:111]
    ds_read_b128 v[152:155], v42 offset:18432
    s_nop 2
    v_mul_f32 v80, v80, v47
    v_mul_f32 v81, v81, v47
    v_mul_f32 v82, v82, v47
    v_mul_f32 v83, v83, v47
    v_mfma_f32_32x32x16_bf16 v[96:111], v[156:159], v[212:215], v[96:111]
    ds_read_b128 v[156:159], v42 offset:22528
    v_mul_f32 v84, v84, v47
    v_mul_f32 v85, v85, v47
    v_mul_f32 v86, v86, v47
    v_mul_f32 v87, v87, v47
    s_waitcnt lgkmcnt(6)
    v_mfma_f32_32x32x16_bf16 v[96:111], v[128:131], v[216:219], v[96:111]
    ds_read_b128 v[128:131], v42 offset:26624
    v_mul_f32 v88, v88, v47
    v_mul_f32 v89, v89, v47
    v_mul_f32 v90, v90, v47
    v_mul_f32 v91, v91, v47
    v_mfma_f32_32x32x16_bf16 v[96:111], v[132:135], v[220:223], v[96:111]
    ds_read_b128 v[132:135], v42 offset:30720
    v_mul_f32 v92, v92, v47
    v_mul_f32 v93, v93, v47
    v_mul_f32 v94, v94, v47
    v_mul_f32 v95, v95, v47
    s_waitcnt lgkmcnt(6)
    v_mfma_f32_32x32x16_bf16 v[96:111], v[136:139], v[160:163], v[96:111]
    ds_read_b128 v[136:139], v41 offset:44032
    v_cvt_pk_bf16_f32 v80, v80, v81
    v_cvt_pk_bf16_f32 v81, v82, v83
    v_cvt_pk_bf16_f32 v82, v84, v85
    v_cvt_pk_bf16_f32 v83, v86, v87
    v_mfma_f32_32x32x16_bf16 v[96:111], v[140:143], v[164:167], v[96:111]
    ds_read_b128 v[140:143], v41 offset:48128
    v_cvt_pk_bf16_f32 v84, v88, v89
    v_cvt_pk_bf16_f32 v85, v90, v91
    v_cvt_pk_bf16_f32 v86, v92, v93
    v_cvt_pk_bf16_f32 v87, v94, v95
    s_waitcnt lgkmcnt(6)
    v_mfma_f32_32x32x16_bf16 v[96:111], v[144:147], v[168:171], v[96:111]
    ds_read_b128 v[144:147], v41 offset:52224
    v_permlane32_swap_b32 v80, v82
    v_permlane32_swap_b32 v81, v83
    v_permlane32_swap_b32 v84, v86
    v_permlane32_swap_b32 v85, v87
    v_mfma_f32_32x32x16_bf16 v[96:111], v[148:151], v[172:175], v[96:111]
    ds_read_b128 v[148:151], v41 offset:56320
    s_mul_i32 s36, s34, 1
    s_add_u32 s36, s36, s33
    buffer_store_dwordx4 v[80:83], v19, s[12:15], s36 offen offset:512 sc1
    s_mul_i32 s36, s34, 2
    s_waitcnt lgkmcnt(6)
    v_mfma_f32_32x32x16_bf16 v[96:111], v[152:155], v[176:179], v[96:111]
    ds_read_b128 v[152:155], v41 offset:60416
    s_add_u32 s36, s36, s33
    s_mul_i32 s37, s34, 2
    s_add_u32 s37, s37, s33
    s_add_u32 s38, s37, s34
    v_mfma_f32_32x32x16_bf16 v[96:111], v[156:159], v[180:183], v[96:111]
    ds_read_b128 v[156:159], v41 offset:64512
    s_mov_b64 exec, s[52:53]
    buffer_store_dwordx4 v[84:87], v16, s[12:15], s36 offen offset:512 sc1
    s_mov_b64 exec, s[54:55]
    buffer_store_dwordx2 v[84:85], v17, s[12:15], s37 offen offset:1024 sc1
    buffer_store_dwordx2 v[86:87], v17, s[12:15], s38 offen offset:1024 sc1
    s_mov_b64 exec, -1
    s_waitcnt lgkmcnt(6)
    v_mfma_f32_32x32x16_bf16 v[96:111], v[128:131], v[184:187], v[96:111]
    ds_read_b128 v[128:131], v42 offset:3072
    v_mfma_f32_32x32x16_bf16 v[96:111], v[132:135], v[188:191], v[96:111]
    ds_read_b128 v[132:135], v42 offset:7168
    s_waitcnt lgkmcnt(6)
    v_mfma_f32_32x32x16_bf16 v[112:127], v[136:139], v[200:203], v[112:127]
    ds_read_b128 v[136:139], v42 offset:11264
    v_mfma_f32_32x32x16_bf16 v[112:127], v[140:143], v[204:207], v[112:127]
    ds_read_b128 v[140:143], v42 offset:15360
    s_waitcnt lgkmcnt(6)
    v_mfma_f32_32x32x16_bf16 v[112:127], v[144:147], v[208:211], v[112:127]
    ds_read_b128 v[144:147], v42 offset:19456
    s_nop 2
    v_mul_f32 v96, v96, v47
    v_mul_f32 v97, v97, v47
    v_mul_f32 v98, v98, v47
    v_mul_f32 v99, v99, v47
    v_mfma_f32_32x32x16_bf16 v[112:127], v[148:151], v[212:215], v[112:127]
    ds_read_b128 v[148:151], v42 offset:23552
    v_mul_f32 v100, v100, v47
    v_mul_f32 v101, v101, v47
    v_mul_f32 v102, v102, v47
    v_mul_f32 v103, v103, v47
    s_waitcnt lgkmcnt(6)
    v_mfma_f32_32x32x16_bf16 v[112:127], v[152:155], v[216:219], v[112:127]
    ds_read_b128 v[152:155], v42 offset:27648
    v_mul_f32 v104, v104, v47
    v_mul_f32 v105, v105, v47
    v_mul_f32 v106, v106, v47
    v_mul_f32 v107, v107, v47
    v_mfma_f32_32x32x16_bf16 v[112:127], v[156:159], v[220:223], v[112:127]
    ds_read_b128 v[156:159], v42 offset:31744
    v_mul_f32 v108, v108, v47
    v_mul_f32 v109, v109, v47
    v_mul_f32 v110, v110, v47
    v_mul_f32 v111, v111, v47
    s_waitcnt lgkmcnt(6)
    v_mfma_f32_32x32x16_bf16 v[112:127], v[128:131], v[160:163], v[112:127]
    v_cvt_pk_bf16_f32 v96, v96, v97
    v_cvt_pk_bf16_f32 v97, v98, v99
    v_cvt_pk_bf16_f32 v98, v100, v101
    v_cvt_pk_bf16_f32 v99, v102, v103
    v_mfma_f32_32x32x16_bf16 v[112:127], v[132:135], v[164:167], v[112:127]
    v_cvt_pk_bf16_f32 v100, v104, v105
    v_cvt_pk_bf16_f32 v101, v106, v107
    v_cvt_pk_bf16_f32 v102, v108, v109
    v_cvt_pk_bf16_f32 v103, v110, v111
    s_waitcnt lgkmcnt(4)
    v_mfma_f32_32x32x16_bf16 v[112:127], v[136:139], v[168:171], v[112:127]
    v_permlane32_swap_b32 v96, v98
    v_permlane32_swap_b32 v97, v99
    v_permlane32_swap_b32 v100, v102
    v_permlane32_swap_b32 v101, v103
    v_mfma_f32_32x32x16_bf16 v[112:127], v[140:143], v[172:175], v[112:127]
    s_mul_i32 s36, s34, 3
    s_add_u32 s36, s36, s33
    buffer_store_dwordx4 v[96:99], v18, s[12:15], s36 offen offset:0 sc1
    s_mul_i32 s36, s34, 4
    s_waitcnt lgkmcnt(2)
    v_mfma_f32_32x32x16_bf16 v[112:127], v[144:147], v[176:179], v[112:127]
    s_add_u32 s36, s36, s33
    buffer_store_dwordx4 v[100:103], v18, s[12:15], s36 offen offset:0 sc1
    v_mfma_f32_32x32x16_bf16 v[112:127], v[148:151], v[180:183], v[112:127]
    s_waitcnt lgkmcnt(0)
    v_mfma_f32_32x32x16_bf16 v[112:127], v[152:155], v[184:187], v[112:127]
    v_mfma_f32_32x32x16_bf16 v[112:127], v[156:159], v[188:191], v[112:127]
    s_barrier
    s_nop 10
    v_mul_f32 v112, v112, v47
    v_mul_f32 v113, v113, v47
    v_mul_f32 v114, v114, v47
    v_mul_f32 v115, v115, v47
    v_mul_f32 v116, v116, v47
    v_mul_f32 v117, v117, v47
    v_mul_f32 v118, v118, v47
    v_mul_f32 v119, v119, v47
    v_mul_f32 v120, v120, v47
    v_mul_f32 v121, v121, v47
    v_mul_f32 v122, v122, v47
    v_mul_f32 v123, v123, v47
    v_mul_f32 v124, v124, v47
    v_mul_f32 v125, v125, v47
    v_mul_f32 v126, v126, v47
    v_mul_f32 v127, v127, v47
    v_cvt_pk_bf16_f32 v112, v112, v113
    v_cvt_pk_bf16_f32 v113, v114, v115
    v_cvt_pk_bf16_f32 v114, v116, v117
    v_cvt_pk_bf16_f32 v115, v118, v119
    v_cvt_pk_bf16_f32 v116, v120, v121
    v_cvt_pk_bf16_f32 v117, v122, v123
    v_cvt_pk_bf16_f32 v118, v124, v125
    v_cvt_pk_bf16_f32 v119, v126, v127
    v_permlane32_swap_b32 v112, v114
    v_permlane32_swap_b32 v113, v115
    v_permlane32_swap_b32 v116, v118
    v_permlane32_swap_b32 v117, v119
    s_mul_i32 s36, s34, 5
    s_add_u32 s36, s36, s33
    s_mul_i32 s37, s34, 4
    s_add_u32 s37, s37, s33
    s_add_u32 s38, s37, s34
    s_mov_b64 exec, s[54:55]
    buffer_store_dwordx4 v[112:115], v16, s[12:15], s36 offen offset:0 sc1
    s_mov_b64 exec, s[52:53]
    buffer_store_dwordx2 v[112:113], v17, s[12:15], s37 offen offset:1024 sc1
    buffer_store_dwordx2 v[114:115], v17, s[12:15], s38 offen offset:1024 sc1
    s_mov_b64 exec, -1
    s_mul_i32 s36, s34, 5
    s_add_u32 s36, s36, s33
    buffer_store_dwordx4 v[116:119], v19, s[12:15], s36 offen offset:512 sc1
    s_branch interleave_layers__softmax_full_mha__sliding_local_dilated__prompt_kernel_p5_fin5
interleave_layers__softmax_full_mha__sliding_local_dilated__prompt_kernel_p5_e1:
    s_waitcnt vmcnt(12)
    s_waitcnt lgkmcnt(6)
    v_mfma_f32_32x32x16_bf16 v[64:79], v[128:131], v[200:203], v[64:79]
    ds_read_b128 v[128:131], v42 offset:8192
    v_mfma_f32_32x32x16_bf16 v[64:79], v[132:135], v[204:207], v[64:79]
    ds_read_b128 v[132:135], v42 offset:12288
    s_waitcnt vmcnt(10)
    s_waitcnt lgkmcnt(6)
    v_mfma_f32_32x32x16_bf16 v[64:79], v[136:139], v[208:211], v[64:79]
    ds_read_b128 v[136:139], v42 offset:16384
    v_mfma_f32_32x32x16_bf16 v[64:79], v[140:143], v[212:215], v[64:79]
    ds_read_b128 v[140:143], v42 offset:20480
    s_waitcnt vmcnt(8)
    s_waitcnt lgkmcnt(6)
    v_mfma_f32_32x32x16_bf16 v[64:79], v[144:147], v[216:219], v[64:79]
    ds_read_b128 v[144:147], v42 offset:24576
    v_mfma_f32_32x32x16_bf16 v[64:79], v[148:151], v[220:223], v[64:79]
    ds_read_b128 v[148:151], v42 offset:28672
    s_waitcnt vmcnt(6)
    s_waitcnt lgkmcnt(6)
    v_mfma_f32_32x32x16_bf16 v[64:79], v[152:155], v[160:163], v[64:79]
    ds_read_b128 v[152:155], v41 offset:41984
    v_mfma_f32_32x32x16_bf16 v[64:79], v[156:159], v[164:167], v[64:79]
    ds_read_b128 v[156:159], v41 offset:46080
    s_waitcnt vmcnt(4)
    s_waitcnt lgkmcnt(6)
    v_mfma_f32_32x32x16_bf16 v[64:79], v[128:131], v[168:171], v[64:79]
    ds_read_b128 v[128:131], v41 offset:50176
    v_mfma_f32_32x32x16_bf16 v[64:79], v[132:135], v[172:175], v[64:79]
    ds_read_b128 v[132:135], v41 offset:54272
    s_waitcnt vmcnt(2)
    s_waitcnt lgkmcnt(6)
    v_mfma_f32_32x32x16_bf16 v[64:79], v[136:139], v[176:179], v[64:79]
    ds_read_b128 v[136:139], v41 offset:58368
    v_mfma_f32_32x32x16_bf16 v[64:79], v[140:143], v[180:183], v[64:79]
    ds_read_b128 v[140:143], v41 offset:62464
    s_waitcnt vmcnt(0)
    s_waitcnt lgkmcnt(6)
    v_mfma_f32_32x32x16_bf16 v[64:79], v[144:147], v[184:187], v[64:79]
    ds_read_b128 v[144:147], v42 offset:1024
    v_mfma_f32_32x32x16_bf16 v[64:79], v[148:151], v[188:191], v[64:79]
    ds_read_b128 v[148:151], v42 offset:5120
    s_waitcnt lgkmcnt(6)
    v_mfma_f32_32x32x16_bf16 v[80:95], v[152:155], v[200:203], v[80:95]
    ds_read_b128 v[152:155], v42 offset:9216
    v_mfma_f32_32x32x16_bf16 v[80:95], v[156:159], v[204:207], v[80:95]
    ds_read_b128 v[156:159], v42 offset:13312
    s_waitcnt lgkmcnt(6)
    v_mfma_f32_32x32x16_bf16 v[80:95], v[128:131], v[208:211], v[80:95]
    ds_read_b128 v[128:131], v42 offset:17408
    s_nop 2
    v_mul_f32 v64, v64, v47
    v_mul_f32 v65, v65, v47
    v_mul_f32 v66, v66, v47
    v_mul_f32 v67, v67, v47
    v_mfma_f32_32x32x16_bf16 v[80:95], v[132:135], v[212:215], v[80:95]
    ds_read_b128 v[132:135], v42 offset:21504
    v_mul_f32 v68, v68, v47
    v_mul_f32 v69, v69, v47
    v_mul_f32 v70, v70, v47
    v_mul_f32 v71, v71, v47
    s_waitcnt lgkmcnt(6)
    v_mfma_f32_32x32x16_bf16 v[80:95], v[136:139], v[216:219], v[80:95]
    ds_read_b128 v[136:139], v42 offset:25600
    v_mul_f32 v72, v72, v47
    v_mul_f32 v73, v73, v47
    v_mul_f32 v74, v74, v47
    v_mul_f32 v75, v75, v47
    v_mfma_f32_32x32x16_bf16 v[80:95], v[140:143], v[220:223], v[80:95]
    ds_read_b128 v[140:143], v42 offset:29696
    v_mul_f32 v76, v76, v47
    v_mul_f32 v77, v77, v47
    v_mul_f32 v78, v78, v47
    v_mul_f32 v79, v79, v47
    s_waitcnt lgkmcnt(6)
    v_mfma_f32_32x32x16_bf16 v[80:95], v[144:147], v[160:163], v[80:95]
    ds_read_b128 v[144:147], v41 offset:43008
    v_cvt_pk_bf16_f32 v64, v64, v65
    v_cvt_pk_bf16_f32 v65, v66, v67
    v_cvt_pk_bf16_f32 v66, v68, v69
    v_cvt_pk_bf16_f32 v67, v70, v71
    v_mfma_f32_32x32x16_bf16 v[80:95], v[148:151], v[164:167], v[80:95]
    ds_read_b128 v[148:151], v41 offset:47104
    v_cvt_pk_bf16_f32 v68, v72, v73
    v_cvt_pk_bf16_f32 v69, v74, v75
    v_cvt_pk_bf16_f32 v70, v76, v77
    v_cvt_pk_bf16_f32 v71, v78, v79
    s_waitcnt lgkmcnt(6)
    v_mfma_f32_32x32x16_bf16 v[80:95], v[152:155], v[168:171], v[80:95]
    ds_read_b128 v[152:155], v41 offset:51200
    v_permlane32_swap_b32 v64, v66
    v_permlane32_swap_b32 v65, v67
    v_permlane32_swap_b32 v68, v70
    v_permlane32_swap_b32 v69, v71
    v_mfma_f32_32x32x16_bf16 v[80:95], v[156:159], v[172:175], v[80:95]
    ds_read_b128 v[156:159], v41 offset:55296
    s_mul_i32 s36, s34, 6
    s_add_u32 s36, s36, s33
    s_mul_i32 s37, s34, 6
    s_add_u32 s37, s37, s33
    s_waitcnt lgkmcnt(6)
    v_mfma_f32_32x32x16_bf16 v[80:95], v[128:131], v[176:179], v[80:95]
    ds_read_b128 v[128:131], v41 offset:59392
    s_add_u32 s38, s37, s34
    s_mov_b64 exec, s[52:53]
    buffer_store_dwordx4 v[64:67], v16, s[12:15], s36 offen offset:512 sc1
    s_mov_b64 exec, s[54:55]
    buffer_store_dwordx2 v[64:65], v17, s[12:15], s37 offen offset:1024 sc1
    buffer_store_dwordx2 v[66:67], v17, s[12:15], s38 offen offset:1024 sc1
    s_mov_b64 exec, -1
    s_mul_i32 s36, s34, 7
    s_add_u32 s36, s36, s33
    v_mfma_f32_32x32x16_bf16 v[80:95], v[132:135], v[180:183], v[80:95]
    ds_read_b128 v[132:135], v41 offset:63488
    buffer_store_dwordx4 v[68:71], v18, s[12:15], s36 offen offset:0 sc1
    s_waitcnt lgkmcnt(6)
    v_mfma_f32_32x32x16_bf16 v[80:95], v[136:139], v[184:187], v[80:95]
    ds_read_b128 v[136:139], v42 offset:2048
    v_mfma_f32_32x32x16_bf16 v[80:95], v[140:143], v[188:191], v[80:95]
    ds_read_b128 v[140:143], v42 offset:6144
    s_waitcnt lgkmcnt(6)
    v_mfma_f32_32x32x16_bf16 v[96:111], v[144:147], v[200:203], v[96:111]
    ds_read_b128 v[144:147], v42 offset:10240
    v_mfma_f32_32x32x16_bf16 v[96:111], v[148:151], v[204:207], v[96:111]
    ds_read_b128 v[148:151], v42 offset:14336
    s_waitcnt lgkmcnt(6)
    v_mfma_f32_32x32x16_bf16 v[96:111], v[152:155], v[208:211], v[96:111]
    ds_read_b128 v[152:155], v42 offset:18432
    s_nop 2
    v_mul_f32 v80, v80, v47
    v_mul_f32 v81, v81, v47
    v_mul_f32 v82, v82, v47
    v_mul_f32 v83, v83, v47
    v_mfma_f32_32x32x16_bf16 v[96:111], v[156:159], v[212:215], v[96:111]
    ds_read_b128 v[156:159], v42 offset:22528
    v_mul_f32 v84, v84, v47
    v_mul_f32 v85, v85, v47
    v_mul_f32 v86, v86, v47
    v_mul_f32 v87, v87, v47
    s_waitcnt lgkmcnt(6)
    v_mfma_f32_32x32x16_bf16 v[96:111], v[128:131], v[216:219], v[96:111]
    ds_read_b128 v[128:131], v42 offset:26624
    v_mul_f32 v88, v88, v47
    v_mul_f32 v89, v89, v47
    v_mul_f32 v90, v90, v47
    v_mul_f32 v91, v91, v47
    v_mfma_f32_32x32x16_bf16 v[96:111], v[132:135], v[220:223], v[96:111]
    ds_read_b128 v[132:135], v42 offset:30720
    v_mul_f32 v92, v92, v47
    v_mul_f32 v93, v93, v47
    v_mul_f32 v94, v94, v47
    v_mul_f32 v95, v95, v47
    s_waitcnt lgkmcnt(6)
    v_mfma_f32_32x32x16_bf16 v[96:111], v[136:139], v[160:163], v[96:111]
    ds_read_b128 v[136:139], v41 offset:44032
    v_cvt_pk_bf16_f32 v80, v80, v81
    v_cvt_pk_bf16_f32 v81, v82, v83
    v_cvt_pk_bf16_f32 v82, v84, v85
    v_cvt_pk_bf16_f32 v83, v86, v87
    v_mfma_f32_32x32x16_bf16 v[96:111], v[140:143], v[164:167], v[96:111]
    ds_read_b128 v[140:143], v41 offset:48128
    v_cvt_pk_bf16_f32 v84, v88, v89
    v_cvt_pk_bf16_f32 v85, v90, v91
    v_cvt_pk_bf16_f32 v86, v92, v93
    v_cvt_pk_bf16_f32 v87, v94, v95
    s_waitcnt lgkmcnt(6)
    v_mfma_f32_32x32x16_bf16 v[96:111], v[144:147], v[168:171], v[96:111]
    ds_read_b128 v[144:147], v41 offset:52224
    v_permlane32_swap_b32 v80, v82
    v_permlane32_swap_b32 v81, v83
    v_permlane32_swap_b32 v84, v86
    v_permlane32_swap_b32 v85, v87
    v_mfma_f32_32x32x16_bf16 v[96:111], v[148:151], v[172:175], v[96:111]
    ds_read_b128 v[148:151], v41 offset:56320
    s_mul_i32 s36, s34, 8
    s_add_u32 s36, s36, s33
    buffer_store_dwordx4 v[80:83], v18, s[12:15], s36 offen offset:0 sc1
    s_mul_i32 s36, s34, 9
    s_waitcnt lgkmcnt(6)
    v_mfma_f32_32x32x16_bf16 v[96:111], v[152:155], v[176:179], v[96:111]
    ds_read_b128 v[152:155], v41 offset:60416
    s_add_u32 s36, s36, s33
    s_mul_i32 s37, s34, 8
    s_add_u32 s37, s37, s33
    s_add_u32 s38, s37, s34
    v_mfma_f32_32x32x16_bf16 v[96:111], v[156:159], v[180:183], v[96:111]
    ds_read_b128 v[156:159], v41 offset:64512
    s_mov_b64 exec, s[54:55]
    buffer_store_dwordx4 v[84:87], v16, s[12:15], s36 offen offset:0 sc1
    s_mov_b64 exec, s[52:53]
    buffer_store_dwordx2 v[84:85], v17, s[12:15], s37 offen offset:1024 sc1
    buffer_store_dwordx2 v[86:87], v17, s[12:15], s38 offen offset:1024 sc1
    s_mov_b64 exec, -1
    s_waitcnt lgkmcnt(6)
    v_mfma_f32_32x32x16_bf16 v[96:111], v[128:131], v[184:187], v[96:111]
    ds_read_b128 v[128:131], v42 offset:3072
    v_mfma_f32_32x32x16_bf16 v[96:111], v[132:135], v[188:191], v[96:111]
    ds_read_b128 v[132:135], v42 offset:7168
    s_waitcnt lgkmcnt(6)
    v_mfma_f32_32x32x16_bf16 v[112:127], v[136:139], v[200:203], v[112:127]
    ds_read_b128 v[136:139], v42 offset:11264
    v_mfma_f32_32x32x16_bf16 v[112:127], v[140:143], v[204:207], v[112:127]
    ds_read_b128 v[140:143], v42 offset:15360
    s_waitcnt lgkmcnt(6)
    v_mfma_f32_32x32x16_bf16 v[112:127], v[144:147], v[208:211], v[112:127]
    ds_read_b128 v[144:147], v42 offset:19456
    s_nop 2
    v_mul_f32 v96, v96, v47
    v_mul_f32 v97, v97, v47
    v_mul_f32 v98, v98, v47
    v_mul_f32 v99, v99, v47
    v_mfma_f32_32x32x16_bf16 v[112:127], v[148:151], v[212:215], v[112:127]
    ds_read_b128 v[148:151], v42 offset:23552
    v_mul_f32 v100, v100, v47
    v_mul_f32 v101, v101, v47
    v_mul_f32 v102, v102, v47
    v_mul_f32 v103, v103, v47
    s_waitcnt lgkmcnt(6)
    v_mfma_f32_32x32x16_bf16 v[112:127], v[152:155], v[216:219], v[112:127]
    ds_read_b128 v[152:155], v42 offset:27648
    v_mul_f32 v104, v104, v47
    v_mul_f32 v105, v105, v47
    v_mul_f32 v106, v106, v47
    v_mul_f32 v107, v107, v47
    v_mfma_f32_32x32x16_bf16 v[112:127], v[156:159], v[220:223], v[112:127]
    ds_read_b128 v[156:159], v42 offset:31744
    v_mul_f32 v108, v108, v47
    v_mul_f32 v109, v109, v47
    v_mul_f32 v110, v110, v47
    v_mul_f32 v111, v111, v47
    s_waitcnt lgkmcnt(6)
    v_mfma_f32_32x32x16_bf16 v[112:127], v[128:131], v[160:163], v[112:127]
    v_cvt_pk_bf16_f32 v96, v96, v97
    v_cvt_pk_bf16_f32 v97, v98, v99
    v_cvt_pk_bf16_f32 v98, v100, v101
    v_cvt_pk_bf16_f32 v99, v102, v103
    v_mfma_f32_32x32x16_bf16 v[112:127], v[132:135], v[164:167], v[112:127]
    v_cvt_pk_bf16_f32 v100, v104, v105
    v_cvt_pk_bf16_f32 v101, v106, v107
    v_cvt_pk_bf16_f32 v102, v108, v109
    v_cvt_pk_bf16_f32 v103, v110, v111
    s_waitcnt lgkmcnt(4)
    v_mfma_f32_32x32x16_bf16 v[112:127], v[136:139], v[168:171], v[112:127]
    v_permlane32_swap_b32 v96, v98
    v_permlane32_swap_b32 v97, v99
    v_permlane32_swap_b32 v100, v102
    v_permlane32_swap_b32 v101, v103
    v_mfma_f32_32x32x16_bf16 v[112:127], v[140:143], v[172:175], v[112:127]
    s_mul_i32 s36, s34, 9
    s_add_u32 s36, s36, s33
    buffer_store_dwordx4 v[96:99], v19, s[12:15], s36 offen offset:512 sc1
    s_mul_i32 s36, s34, 10
    s_waitcnt lgkmcnt(2)
    v_mfma_f32_32x32x16_bf16 v[112:127], v[144:147], v[176:179], v[112:127]
    s_add_u32 s36, s36, s33
    s_mul_i32 s37, s34, 10
    s_add_u32 s37, s37, s33
    s_add_u32 s38, s37, s34
    v_mfma_f32_32x32x16_bf16 v[112:127], v[148:151], v[180:183], v[112:127]
    s_mov_b64 exec, s[52:53]
    buffer_store_dwordx4 v[100:103], v16, s[12:15], s36 offen offset:512 sc1
    s_mov_b64 exec, s[54:55]
    buffer_store_dwordx2 v[100:101], v17, s[12:15], s37 offen offset:1024 sc1
    buffer_store_dwordx2 v[102:103], v17, s[12:15], s38 offen offset:1024 sc1
    s_mov_b64 exec, -1
    s_waitcnt lgkmcnt(0)
    v_mfma_f32_32x32x16_bf16 v[112:127], v[152:155], v[184:187], v[112:127]
    v_mfma_f32_32x32x16_bf16 v[112:127], v[156:159], v[188:191], v[112:127]
    s_barrier
    s_nop 10
    v_mul_f32 v112, v112, v47
    v_mul_f32 v113, v113, v47
    v_mul_f32 v114, v114, v47
    v_mul_f32 v115, v115, v47
    v_mul_f32 v116, v116, v47
    v_mul_f32 v117, v117, v47
    v_mul_f32 v118, v118, v47
    v_mul_f32 v119, v119, v47
    v_mul_f32 v120, v120, v47
    v_mul_f32 v121, v121, v47
    v_mul_f32 v122, v122, v47
    v_mul_f32 v123, v123, v47
    v_mul_f32 v124, v124, v47
    v_mul_f32 v125, v125, v47
    v_mul_f32 v126, v126, v47
    v_mul_f32 v127, v127, v47
    v_cvt_pk_bf16_f32 v112, v112, v113
    v_cvt_pk_bf16_f32 v113, v114, v115
    v_cvt_pk_bf16_f32 v114, v116, v117
    v_cvt_pk_bf16_f32 v115, v118, v119
    v_cvt_pk_bf16_f32 v116, v120, v121
    v_cvt_pk_bf16_f32 v117, v122, v123
    v_cvt_pk_bf16_f32 v118, v124, v125
    v_cvt_pk_bf16_f32 v119, v126, v127
    v_permlane32_swap_b32 v112, v114
    v_permlane32_swap_b32 v113, v115
    v_permlane32_swap_b32 v116, v118
    v_permlane32_swap_b32 v117, v119
    s_mul_i32 s36, s34, 11
    s_add_u32 s36, s36, s33
    buffer_store_dwordx4 v[112:115], v18, s[12:15], s36 offen offset:0 sc1
    s_mul_i32 s36, s34, 12
    s_add_u32 s36, s36, s33
    buffer_store_dwordx4 v[116:119], v18, s[12:15], s36 offen offset:0 sc1
    s_branch interleave_layers__softmax_full_mha__sliding_local_dilated__prompt_kernel_p5_fin5
interleave_layers__softmax_full_mha__sliding_local_dilated__prompt_kernel_p5_e2:
    s_waitcnt vmcnt(12)
    s_waitcnt lgkmcnt(6)
    v_mfma_f32_32x32x16_bf16 v[64:79], v[128:131], v[200:203], v[64:79]
    ds_read_b128 v[128:131], v42 offset:8192
    v_mfma_f32_32x32x16_bf16 v[64:79], v[132:135], v[204:207], v[64:79]
    ds_read_b128 v[132:135], v42 offset:12288
    s_waitcnt vmcnt(10)
    s_waitcnt lgkmcnt(6)
    v_mfma_f32_32x32x16_bf16 v[64:79], v[136:139], v[208:211], v[64:79]
    ds_read_b128 v[136:139], v42 offset:16384
    v_mfma_f32_32x32x16_bf16 v[64:79], v[140:143], v[212:215], v[64:79]
    ds_read_b128 v[140:143], v42 offset:20480
    s_waitcnt vmcnt(8)
    s_waitcnt lgkmcnt(6)
    v_mfma_f32_32x32x16_bf16 v[64:79], v[144:147], v[216:219], v[64:79]
    ds_read_b128 v[144:147], v42 offset:24576
    v_mfma_f32_32x32x16_bf16 v[64:79], v[148:151], v[220:223], v[64:79]
    ds_read_b128 v[148:151], v42 offset:28672
    s_waitcnt vmcnt(6)
    s_waitcnt lgkmcnt(6)
    v_mfma_f32_32x32x16_bf16 v[64:79], v[152:155], v[160:163], v[64:79]
    ds_read_b128 v[152:155], v41 offset:41984
    v_mfma_f32_32x32x16_bf16 v[64:79], v[156:159], v[164:167], v[64:79]
    ds_read_b128 v[156:159], v41 offset:46080
    s_waitcnt vmcnt(4)
    s_waitcnt lgkmcnt(6)
    v_mfma_f32_32x32x16_bf16 v[64:79], v[128:131], v[168:171], v[64:79]
    ds_read_b128 v[128:131], v41 offset:50176
    v_mfma_f32_32x32x16_bf16 v[64:79], v[132:135], v[172:175], v[64:79]
    ds_read_b128 v[132:135], v41 offset:54272
    s_waitcnt vmcnt(2)
    s_waitcnt lgkmcnt(6)
    v_mfma_f32_32x32x16_bf16 v[64:79], v[136:139], v[176:179], v[64:79]
    ds_read_b128 v[136:139], v41 offset:58368
    v_mfma_f32_32x32x16_bf16 v[64:79], v[140:143], v[180:183], v[64:79]
    ds_read_b128 v[140:143], v41 offset:62464
    s_waitcnt vmcnt(0)
    s_waitcnt lgkmcnt(6)
    v_mfma_f32_32x32x16_bf16 v[64:79], v[144:147], v[184:187], v[64:79]
    ds_read_b128 v[144:147], v42 offset:1024
    v_mfma_f32_32x32x16_bf16 v[64:79], v[148:151], v[188:191], v[64:79]
    ds_read_b128 v[148:151], v42 offset:5120
    s_waitcnt lgkmcnt(6)
    v_mfma_f32_32x32x16_bf16 v[80:95], v[152:155], v[200:203], v[80:95]
    ds_read_b128 v[152:155], v42 offset:9216
    v_mfma_f32_32x32x16_bf16 v[80:95], v[156:159], v[204:207], v[80:95]
    ds_read_b128 v[156:159], v42 offset:13312
    s_waitcnt lgkmcnt(6)
    v_mfma_f32_32x32x16_bf16 v[80:95], v[128:131], v[208:211], v[80:95]
    ds_read_b128 v[128:131], v42 offset:17408
    s_nop 2
    v_mul_f32 v64, v64, v47
    v_mul_f32 v65, v65, v47
    v_mul_f32 v66, v66, v47
    v_mul_f32 v67, v67, v47
    v_mfma_f32_32x32x16_bf16 v[80:95], v[132:135], v[212:215], v[80:95]
    ds_read_b128 v[132:135], v42 offset:21504
    v_mul_f32 v68, v68, v47
    v_mul_f32 v69, v69, v47
    v_mul_f32 v70, v70, v47
    v_mul_f32 v71, v71, v47
    s_waitcnt lgkmcnt(6)
    v_mfma_f32_32x32x16_bf16 v[80:95], v[136:139], v[216:219], v[80:95]
    ds_read_b128 v[136:139], v42 offset:25600
    v_mul_f32 v72, v72, v47
    v_mul_f32 v73, v73, v47
    v_mul_f32 v74, v74, v47
    v_mul_f32 v75, v75, v47
    v_mfma_f32_32x32x16_bf16 v[80:95], v[140:143], v[220:223], v[80:95]
    ds_read_b128 v[140:143], v42 offset:29696
    v_mul_f32 v76, v76, v47
    v_mul_f32 v77, v77, v47
    v_mul_f32 v78, v78, v47
    v_mul_f32 v79, v79, v47
    s_waitcnt lgkmcnt(6)
    v_mfma_f32_32x32x16_bf16 v[80:95], v[144:147], v[160:163], v[80:95]
    ds_read_b128 v[144:147], v41 offset:43008
    v_cvt_pk_bf16_f32 v64, v64, v65
    v_cvt_pk_bf16_f32 v65, v66, v67
    v_cvt_pk_bf16_f32 v66, v68, v69
    v_cvt_pk_bf16_f32 v67, v70, v71
    v_mfma_f32_32x32x16_bf16 v[80:95], v[148:151], v[164:167], v[80:95]
    ds_read_b128 v[148:151], v41 offset:47104
    v_cvt_pk_bf16_f32 v68, v72, v73
    v_cvt_pk_bf16_f32 v69, v74, v75
    v_cvt_pk_bf16_f32 v70, v76, v77
    v_cvt_pk_bf16_f32 v71, v78, v79
    s_waitcnt lgkmcnt(6)
    v_mfma_f32_32x32x16_bf16 v[80:95], v[152:155], v[168:171], v[80:95]
    ds_read_b128 v[152:155], v41 offset:51200
    v_permlane32_swap_b32 v64, v66
    v_permlane32_swap_b32 v65, v67
    v_permlane32_swap_b32 v68, v70
    v_permlane32_swap_b32 v69, v71
    v_mfma_f32_32x32x16_bf16 v[80:95], v[156:159], v[172:175], v[80:95]
    ds_read_b128 v[156:159], v41 offset:55296
    s_mul_i32 s36, s34, 13
    s_add_u32 s36, s36, s33
    s_mul_i32 s37, s34, 12
    s_add_u32 s37, s37, s33
    s_waitcnt lgkmcnt(6)
    v_mfma_f32_32x32x16_bf16 v[80:95], v[128:131], v[176:179], v[80:95]
    ds_read_b128 v[128:131], v41 offset:59392
    s_add_u32 s38, s37, s34
    s_mov_b64 exec, s[54:55]
    buffer_store_dwordx4 v[64:67], v16, s[12:15], s36 offen offset:0 sc1
    s_mov_b64 exec, s[52:53]
    buffer_store_dwordx2 v[64:65], v17, s[12:15], s37 offen offset:1024 sc1
    buffer_store_dwordx2 v[66:67], v17, s[12:15], s38 offen offset:1024 sc1
    s_mov_b64 exec, -1
    s_mul_i32 s36, s34, 13
    s_add_u32 s36, s36, s33
    v_mfma_f32_32x32x16_bf16 v[80:95], v[132:135], v[180:183], v[80:95]
    ds_read_b128 v[132:135], v41 offset:63488
    buffer_store_dwordx4 v[68:71], v19, s[12:15], s36 offen offset:512 sc1
    s_waitcnt lgkmcnt(6)
    v_mfma_f32_32x32x16_bf16 v[80:95], v[136:139], v[184:187], v[80:95]
    ds_read_b128 v[136:139], v42 offset:2048
    v_mfma_f32_32x32x16_bf16 v[80:95], v[140:143], v[188:191], v[80:95]
    ds_read_b128 v[140:143], v42 offset:6144
    s_waitcnt lgkmcnt(6)
    v_mfma_f32_32x32x16_bf16 v[96:111], v[144:147], v[200:203], v[96:111]
    ds_read_b128 v[144:147], v42 offset:10240
    v_mfma_f32_32x32x16_bf16 v[96:111], v[148:151], v[204:207], v[96:111]
    ds_read_b128 v[148:151], v42 offset:14336
    s_waitcnt lgkmcnt(6)
    v_mfma_f32_32x32x16_bf16 v[96:111], v[152:155], v[208:211], v[96:111]
    ds_read_b128 v[152:155], v42 offset:18432
    s_nop 2
    v_mul_f32 v80, v80, v47
    v_mul_f32 v81, v81, v47
    v_mul_f32 v82, v82, v47
    v_mul_f32 v83, v83, v47
    v_mfma_f32_32x32x16_bf16 v[96:111], v[156:159], v[212:215], v[96:111]
    ds_read_b128 v[156:159], v42 offset:22528
    v_mul_f32 v84, v84, v47
    v_mul_f32 v85, v85, v47
    v_mul_f32 v86, v86, v47
    v_mul_f32 v87, v87, v47
    s_waitcnt lgkmcnt(6)
    v_mfma_f32_32x32x16_bf16 v[96:111], v[128:131], v[216:219], v[96:111]
    ds_read_b128 v[128:131], v42 offset:26624
    v_mul_f32 v88, v88, v47
    v_mul_f32 v89, v89, v47
    v_mul_f32 v90, v90, v47
    v_mul_f32 v91, v91, v47
    v_mfma_f32_32x32x16_bf16 v[96:111], v[132:135], v[220:223], v[96:111]
    ds_read_b128 v[132:135], v42 offset:30720
    v_mul_f32 v92, v92, v47
    v_mul_f32 v93, v93, v47
    v_mul_f32 v94, v94, v47
    v_mul_f32 v95, v95, v47
    s_waitcnt lgkmcnt(6)
    v_mfma_f32_32x32x16_bf16 v[96:111], v[136:139], v[160:163], v[96:111]
    ds_read_b128 v[136:139], v41 offset:44032
    v_cvt_pk_bf16_f32 v80, v80, v81
    v_cvt_pk_bf16_f32 v81, v82, v83
    v_cvt_pk_bf16_f32 v82, v84, v85
    v_cvt_pk_bf16_f32 v83, v86, v87
    v_mfma_f32_32x32x16_bf16 v[96:111], v[140:143], v[164:167], v[96:111]
    ds_read_b128 v[140:143], v41 offset:48128
    v_cvt_pk_bf16_f32 v84, v88, v89
    v_cvt_pk_bf16_f32 v85, v90, v91
    v_cvt_pk_bf16_f32 v86, v92, v93
    v_cvt_pk_bf16_f32 v87, v94, v95
    s_waitcnt lgkmcnt(6)
    v_mfma_f32_32x32x16_bf16 v[96:111], v[144:147], v[168:171], v[96:111]
    ds_read_b128 v[144:147], v41 offset:52224
    v_permlane32_swap_b32 v80, v82
    v_permlane32_swap_b32 v81, v83
    v_permlane32_swap_b32 v84, v86
    v_permlane32_swap_b32 v85, v87
    v_mfma_f32_32x32x16_bf16 v[96:111], v[148:151], v[172:175], v[96:111]
    ds_read_b128 v[148:151], v41 offset:56320
    s_mul_i32 s36, s34, 14
    s_add_u32 s36, s36, s33
    s_mul_i32 s37, s34, 14
    s_add_u32 s37, s37, s33
    s_waitcnt lgkmcnt(6)
    v_mfma_f32_32x32x16_bf16 v[96:111], v[152:155], v[176:179], v[96:111]
    ds_read_b128 v[152:155], v41 offset:60416
    s_add_u32 s38, s37, s34
    s_mov_b64 exec, s[52:53]
    buffer_store_dwordx4 v[80:83], v16, s[12:15], s36 offen offset:512 sc1
    s_mov_b64 exec, s[54:55]
    buffer_store_dwordx2 v[80:81], v17, s[12:15], s37 offen offset:1024 sc1
    buffer_store_dwordx2 v[82:83], v17, s[12:15], s38 offen offset:1024 sc1
    s_mov_b64 exec, -1
    s_mul_i32 s36, s34, 15
    s_add_u32 s36, s36, s33
    v_mfma_f32_32x32x16_bf16 v[96:111], v[156:159], v[180:183], v[96:111]
    ds_read_b128 v[156:159], v41 offset:64512
    buffer_store_dwordx4 v[84:87], v18, s[12:15], s36 offen offset:0 sc1
    s_waitcnt lgkmcnt(6)
    v_mfma_f32_32x32x16_bf16 v[96:111], v[128:131], v[184:187], v[96:111]
    ds_read_b128 v[128:131], v42 offset:3072
    v_mfma_f32_32x32x16_bf16 v[96:111], v[132:135], v[188:191], v[96:111]
    ds_read_b128 v[132:135], v42 offset:7168
    s_waitcnt lgkmcnt(6)
    v_mfma_f32_32x32x16_bf16 v[112:127], v[136:139], v[200:203], v[112:127]
    ds_read_b128 v[136:139], v42 offset:11264
    v_mfma_f32_32x32x16_bf16 v[112:127], v[140:143], v[204:207], v[112:127]
    ds_read_b128 v[140:143], v42 offset:15360
    s_waitcnt lgkmcnt(6)
    v_mfma_f32_32x32x16_bf16 v[112:127], v[144:147], v[208:211], v[112:127]
    ds_read_b128 v[144:147], v42 offset:19456
    s_nop 2
    v_mul_f32 v96, v96, v47
    v_mul_f32 v97, v97, v47
    v_mul_f32 v98, v98, v47
    v_mul_f32 v99, v99, v47
    v_mfma_f32_32x32x16_bf16 v[112:127], v[148:151], v[212:215], v[112:127]
    ds_read_b128 v[148:151], v42 offset:23552
    v_mul_f32 v100, v100, v47
    v_mul_f32 v101, v101, v47
    v_mul_f32 v102, v102, v47
    v_mul_f32 v103, v103, v47
    s_waitcnt lgkmcnt(6)
    v_mfma_f32_32x32x16_bf16 v[112:127], v[152:155], v[216:219], v[112:127]
    ds_read_b128 v[152:155], v42 offset:27648
    v_mul_f32 v104, v104, v47
    v_mul_f32 v105, v105, v47
    v_mul_f32 v106, v106, v47
    v_mul_f32 v107, v107, v47
    v_mfma_f32_32x32x16_bf16 v[112:127], v[156:159], v[220:223], v[112:127]
    ds_read_b128 v[156:159], v42 offset:31744
    v_mul_f32 v108, v108, v47
    v_mul_f32 v109, v109, v47
    v_mul_f32 v110, v110, v47
    v_mul_f32 v111, v111, v47
    s_waitcnt lgkmcnt(6)
    v_mfma_f32_32x32x16_bf16 v[112:127], v[128:131], v[160:163], v[112:127]
    v_cvt_pk_bf16_f32 v96, v96, v97
    v_cvt_pk_bf16_f32 v97, v98, v99
    v_cvt_pk_bf16_f32 v98, v100, v101
    v_cvt_pk_bf16_f32 v99, v102, v103
    v_mfma_f32_32x32x16_bf16 v[112:127], v[132:135], v[164:167], v[112:127]
    v_cvt_pk_bf16_f32 v100, v104, v105
    v_cvt_pk_bf16_f32 v101, v106, v107
    v_cvt_pk_bf16_f32 v102, v108, v109
    v_cvt_pk_bf16_f32 v103, v110, v111
    s_waitcnt lgkmcnt(4)
    v_mfma_f32_32x32x16_bf16 v[112:127], v[136:139], v[168:171], v[112:127]
    v_permlane32_swap_b32 v96, v98
    v_permlane32_swap_b32 v97, v99
    v_permlane32_swap_b32 v100, v102
    v_permlane32_swap_b32 v101, v103
    v_mfma_f32_32x32x16_bf16 v[112:127], v[140:143], v[172:175], v[112:127]
    s_mul_i32 s36, s34, 16
    s_add_u32 s36, s36, s33
    buffer_store_dwordx4 v[96:99], v18, s[12:15], s36 offen offset:0 sc1
    s_mul_i32 s36, s34, 17
    s_waitcnt lgkmcnt(2)
    v_mfma_f32_32x32x16_bf16 v[112:127], v[144:147], v[176:179], v[112:127]
    s_add_u32 s36, s36, s33
    s_mul_i32 s37, s34, 16
    s_add_u32 s37, s37, s33
    s_add_u32 s38, s37, s34
    v_mfma_f32_32x32x16_bf16 v[112:127], v[148:151], v[180:183], v[112:127]
    s_mov_b64 exec, s[54:55]
    buffer_store_dwordx4 v[100:103], v16, s[12:15], s36 offen offset:0 sc1
    s_mov_b64 exec, s[52:53]
    buffer_store_dwordx2 v[100:101], v17, s[12:15], s37 offen offset:1024 sc1
    buffer_store_dwordx2 v[102:103], v17, s[12:15], s38 offen offset:1024 sc1
    s_mov_b64 exec, -1
    s_waitcnt lgkmcnt(0)
    v_mfma_f32_32x32x16_bf16 v[112:127], v[152:155], v[184:187], v[112:127]
    v_mfma_f32_32x32x16_bf16 v[112:127], v[156:159], v[188:191], v[112:127]
    s_barrier
    s_nop 10
    v_mul_f32 v112, v112, v47
    v_mul_f32 v113, v113, v47
    v_mul_f32 v114, v114, v47
    v_mul_f32 v115, v115, v47
    v_mul_f32 v116, v116, v47
    v_mul_f32 v117, v117, v47
    v_mul_f32 v118, v118, v47
    v_mul_f32 v119, v119, v47
    v_mul_f32 v120, v120, v47
    v_mul_f32 v121, v121, v47
    v_mul_f32 v122, v122, v47
    v_mul_f32 v123, v123, v47
    v_mul_f32 v124, v124, v47
    v_mul_f32 v125, v125, v47
    v_mul_f32 v126, v126, v47
    v_mul_f32 v127, v127, v47
    v_cvt_pk_bf16_f32 v112, v112, v113
    v_cvt_pk_bf16_f32 v113, v114, v115
    v_cvt_pk_bf16_f32 v114, v116, v117
    v_cvt_pk_bf16_f32 v115, v118, v119
    v_cvt_pk_bf16_f32 v116, v120, v121
    v_cvt_pk_bf16_f32 v117, v122, v123
    v_cvt_pk_bf16_f32 v118, v124, v125
    v_cvt_pk_bf16_f32 v119, v126, v127
    v_permlane32_swap_b32 v112, v114
    v_permlane32_swap_b32 v113, v115
    v_permlane32_swap_b32 v116, v118
    v_permlane32_swap_b32 v117, v119
    s_mul_i32 s36, s34, 17
    s_add_u32 s36, s36, s33
    buffer_store_dwordx4 v[112:115], v19, s[12:15], s36 offen offset:512 sc1
    s_mul_i32 s36, s34, 18
    s_add_u32 s36, s36, s33
    s_mul_i32 s37, s34, 18
    s_add_u32 s37, s37, s33
    s_add_u32 s38, s37, s34
    s_mov_b64 exec, s[52:53]
    buffer_store_dwordx4 v[116:119], v16, s[12:15], s36 offen offset:512 sc1
    s_mov_b64 exec, s[54:55]
    buffer_store_dwordx2 v[116:117], v17, s[12:15], s37 offen offset:1024 sc1
    buffer_store_dwordx2 v[118:119], v17, s[12:15], s38 offen offset:1024 sc1
    s_mov_b64 exec, -1
    s_branch interleave_layers__softmax_full_mha__sliding_local_dilated__prompt_kernel_p5_fin5
interleave_layers__softmax_full_mha__sliding_local_dilated__prompt_kernel_p5_e3:
    s_waitcnt vmcnt(12)
    s_waitcnt lgkmcnt(6)
    v_mfma_f32_32x32x16_bf16 v[64:79], v[128:131], v[200:203], v[64:79]
    ds_read_b128 v[128:131], v42 offset:8192
    v_mfma_f32_32x32x16_bf16 v[64:79], v[132:135], v[204:207], v[64:79]
    ds_read_b128 v[132:135], v42 offset:12288
    s_waitcnt vmcnt(10)
    s_waitcnt lgkmcnt(6)
    v_mfma_f32_32x32x16_bf16 v[64:79], v[136:139], v[208:211], v[64:79]
    ds_read_b128 v[136:139], v42 offset:16384
    v_mfma_f32_32x32x16_bf16 v[64:79], v[140:143], v[212:215], v[64:79]
    ds_read_b128 v[140:143], v42 offset:20480
    s_waitcnt vmcnt(8)
    s_waitcnt lgkmcnt(6)
    v_mfma_f32_32x32x16_bf16 v[64:79], v[144:147], v[216:219], v[64:79]
    ds_read_b128 v[144:147], v42 offset:24576
    v_mfma_f32_32x32x16_bf16 v[64:79], v[148:151], v[220:223], v[64:79]
    ds_read_b128 v[148:151], v42 offset:28672
    s_waitcnt vmcnt(6)
    s_waitcnt lgkmcnt(6)
    v_mfma_f32_32x32x16_bf16 v[64:79], v[152:155], v[160:163], v[64:79]
    ds_read_b128 v[152:155], v41 offset:41984
    v_mfma_f32_32x32x16_bf16 v[64:79], v[156:159], v[164:167], v[64:79]
    ds_read_b128 v[156:159], v41 offset:46080
    s_waitcnt vmcnt(4)
    s_waitcnt lgkmcnt(6)
    v_mfma_f32_32x32x16_bf16 v[64:79], v[128:131], v[168:171], v[64:79]
    ds_read_b128 v[128:131], v41 offset:50176
    v_mfma_f32_32x32x16_bf16 v[64:79], v[132:135], v[172:175], v[64:79]
    ds_read_b128 v[132:135], v41 offset:54272
    s_waitcnt vmcnt(2)
    s_waitcnt lgkmcnt(6)
    v_mfma_f32_32x32x16_bf16 v[64:79], v[136:139], v[176:179], v[64:79]
    ds_read_b128 v[136:139], v41 offset:58368
    v_mfma_f32_32x32x16_bf16 v[64:79], v[140:143], v[180:183], v[64:79]
    ds_read_b128 v[140:143], v41 offset:62464
    s_waitcnt vmcnt(0)
    s_waitcnt lgkmcnt(6)
    v_mfma_f32_32x32x16_bf16 v[64:79], v[144:147], v[184:187], v[64:79]
    ds_read_b128 v[144:147], v42 offset:1024
    v_mfma_f32_32x32x16_bf16 v[64:79], v[148:151], v[188:191], v[64:79]
    ds_read_b128 v[148:151], v42 offset:5120
    s_waitcnt lgkmcnt(6)
    v_mfma_f32_32x32x16_bf16 v[80:95], v[152:155], v[200:203], v[80:95]
    ds_read_b128 v[152:155], v42 offset:9216
    v_mfma_f32_32x32x16_bf16 v[80:95], v[156:159], v[204:207], v[80:95]
    ds_read_b128 v[156:159], v42 offset:13312
    s_waitcnt lgkmcnt(6)
    v_mfma_f32_32x32x16_bf16 v[80:95], v[128:131], v[208:211], v[80:95]
    ds_read_b128 v[128:131], v42 offset:17408
    s_nop 2
    v_mul_f32 v64, v64, v47
    v_mul_f32 v65, v65, v47
    v_mul_f32 v66, v66, v47
    v_mul_f32 v67, v67, v47
    v_mfma_f32_32x32x16_bf16 v[80:95], v[132:135], v[212:215], v[80:95]
    ds_read_b128 v[132:135], v42 offset:21504
    v_mul_f32 v68, v68, v47
    v_mul_f32 v69, v69, v47
    v_mul_f32 v70, v70, v47
    v_mul_f32 v71, v71, v47
    s_waitcnt lgkmcnt(6)
    v_mfma_f32_32x32x16_bf16 v[80:95], v[136:139], v[216:219], v[80:95]
    ds_read_b128 v[136:139], v42 offset:25600
    v_mul_f32 v72, v72, v47
    v_mul_f32 v73, v73, v47
    v_mul_f32 v74, v74, v47
    v_mul_f32 v75, v75, v47
    v_mfma_f32_32x32x16_bf16 v[80:95], v[140:143], v[220:223], v[80:95]
    ds_read_b128 v[140:143], v42 offset:29696
    v_mul_f32 v76, v76, v47
    v_mul_f32 v77, v77, v47
    v_mul_f32 v78, v78, v47
    v_mul_f32 v79, v79, v47
    s_waitcnt lgkmcnt(6)
    v_mfma_f32_32x32x16_bf16 v[80:95], v[144:147], v[160:163], v[80:95]
    ds_read_b128 v[144:147], v41 offset:43008
    v_cvt_pk_bf16_f32 v64, v64, v65
    v_cvt_pk_bf16_f32 v65, v66, v67
    v_cvt_pk_bf16_f32 v66, v68, v69
    v_cvt_pk_bf16_f32 v67, v70, v71
    v_mfma_f32_32x32x16_bf16 v[80:95], v[148:151], v[164:167], v[80:95]
    ds_read_b128 v[148:151], v41 offset:47104
    v_cvt_pk_bf16_f32 v68, v72, v73
    v_cvt_pk_bf16_f32 v69, v74, v75
    v_cvt_pk_bf16_f32 v70, v76, v77
    v_cvt_pk_bf16_f32 v71, v78, v79
    s_waitcnt lgkmcnt(6)
    v_mfma_f32_32x32x16_bf16 v[80:95], v[152:155], v[168:171], v[80:95]
    ds_read_b128 v[152:155], v41 offset:51200
    v_permlane32_swap_b32 v64, v66
    v_permlane32_swap_b32 v65, v67
    v_permlane32_swap_b32 v68, v70
    v_permlane32_swap_b32 v69, v71
    v_mfma_f32_32x32x16_bf16 v[80:95], v[156:159], v[172:175], v[80:95]
    ds_read_b128 v[156:159], v41 offset:55296
    s_mul_i32 s36, s34, 19
    s_add_u32 s36, s36, s33
    buffer_store_dwordx4 v[64:67], v18, s[12:15], s36 offen offset:0 sc1
    s_mul_i32 s36, s34, 20
    s_waitcnt lgkmcnt(6)
    v_mfma_f32_32x32x16_bf16 v[80:95], v[128:131], v[176:179], v[80:95]
    ds_read_b128 v[128:131], v41 offset:59392
    s_add_u32 s36, s36, s33
    buffer_store_dwordx4 v[68:71], v18, s[12:15], s36 offen offset:0 sc1
    v_mfma_f32_32x32x16_bf16 v[80:95], v[132:135], v[180:183], v[80:95]
    ds_read_b128 v[132:135], v41 offset:63488
    s_waitcnt lgkmcnt(6)
    v_mfma_f32_32x32x16_bf16 v[80:95], v[136:139], v[184:187], v[80:95]
    ds_read_b128 v[136:139], v42 offset:2048
    v_mfma_f32_32x32x16_bf16 v[80:95], v[140:143], v[188:191], v[80:95]
    ds_read_b128 v[140:143], v42 offset:6144
    s_waitcnt lgkmcnt(6)
    v_mfma_f32_32x32x16_bf16 v[96:111], v[144:147], v[200:203], v[96:111]
    ds_read_b128 v[144:147], v42 offset:10240
    v_mfma_f32_32x32x16_bf16 v[96:111], v[148:151], v[204:207], v[96:111]
    ds_read_b128 v[148:151], v42 offset:14336
    s_waitcnt lgkmcnt(6)
    v_mfma_f32_32x32x16_bf16 v[96:111], v[152:155], v[208:211], v[96:111]
    ds_read_b128 v[152:155], v42 offset:18432
    s_nop 2
    v_mul_f32 v80, v80, v47
    v_mul_f32 v81, v81, v47
    v_mul_f32 v82, v82, v47
    v_mul_f32 v83, v83, v47
    v_mfma_f32_32x32x16_bf16 v[96:111], v[156:159], v[212:215], v[96:111]
    ds_read_b128 v[156:159], v42 offset:22528
    v_mul_f32 v84, v84, v47
    v_mul_f32 v85, v85, v47
    v_mul_f32 v86, v86, v47
    v_mul_f32 v87, v87, v47
    s_waitcnt lgkmcnt(6)
    v_mfma_f32_32x32x16_bf16 v[96:111], v[128:131], v[216:219], v[96:111]
    ds_read_b128 v[128:131], v42 offset:26624
    v_mul_f32 v88, v88, v47
    v_mul_f32 v89, v89, v47
    v_mul_f32 v90, v90, v47
    v_mul_f32 v91, v91, v47
    v_mfma_f32_32x32x16_bf16 v[96:111], v[132:135], v[220:223], v[96:111]
    ds_read_b128 v[132:135], v42 offset:30720
    v_mul_f32 v92, v92, v47
    v_mul_f32 v93, v93, v47
    v_mul_f32 v94, v94, v47
    v_mul_f32 v95, v95, v47
    s_waitcnt lgkmcnt(6)
    v_mfma_f32_32x32x16_bf16 v[96:111], v[136:139], v[160:163], v[96:111]
    ds_read_b128 v[136:139], v41 offset:44032
    v_cvt_pk_bf16_f32 v80, v80, v81
    v_cvt_pk_bf16_f32 v81, v82, v83
    v_cvt_pk_bf16_f32 v82, v84, v85
    v_cvt_pk_bf16_f32 v83, v86, v87
    v_mfma_f32_32x32x16_bf16 v[96:111], v[140:143], v[164:167], v[96:111]
    ds_read_b128 v[140:143], v41 offset:48128
    v_cvt_pk_bf16_f32 v84, v88, v89
    v_cvt_pk_bf16_f32 v85, v90, v91
    v_cvt_pk_bf16_f32 v86, v92, v93
    v_cvt_pk_bf16_f32 v87, v94, v95
    s_waitcnt lgkmcnt(6)
    v_mfma_f32_32x32x16_bf16 v[96:111], v[144:147], v[168:171], v[96:111]
    ds_read_b128 v[144:147], v41 offset:52224
    v_permlane32_swap_b32 v80, v82
    v_permlane32_swap_b32 v81, v83
    v_permlane32_swap_b32 v84, v86
    v_permlane32_swap_b32 v85, v87
    v_mfma_f32_32x32x16_bf16 v[96:111], v[148:151], v[172:175], v[96:111]
    ds_read_b128 v[148:151], v41 offset:56320
    s_mul_i32 s36, s34, 21
    s_add_u32 s36, s36, s33
    s_mul_i32 s37, s34, 20
    s_add_u32 s37, s37, s33
    s_waitcnt lgkmcnt(6)
    v_mfma_f32_32x32x16_bf16 v[96:111], v[152:155], v[176:179], v[96:111]
    ds_read_b128 v[152:155], v41 offset:60416
    s_add_u32 s38, s37, s34
    s_mov_b64 exec, s[54:55]
    buffer_store_dwordx4 v[80:83], v16, s[12:15], s36 offen offset:0 sc1
    s_mov_b64 exec, s[52:53]
    buffer_store_dwordx2 v[80:81], v17, s[12:15], s37 offen offset:1024 sc1
    buffer_store_dwordx2 v[82:83], v17, s[12:15], s38 offen offset:1024 sc1
    s_mov_b64 exec, -1
    s_mul_i32 s36, s34, 21
    s_add_u32 s36, s36, s33
    v_mfma_f32_32x32x16_bf16 v[96:111], v[156:159], v[180:183], v[96:111]
    ds_read_b128 v[156:159], v41 offset:64512
    buffer_store_dwordx4 v[84:87], v19, s[12:15], s36 offen offset:512 sc1
    s_waitcnt lgkmcnt(6)
    v_mfma_f32_32x32x16_bf16 v[96:111], v[128:131], v[184:187], v[96:111]
    ds_read_b128 v[128:131], v42 offset:3072
    v_mfma_f32_32x32x16_bf16 v[96:111], v[132:135], v[188:191], v[96:111]
    ds_read_b128 v[132:135], v42 offset:7168
    s_waitcnt lgkmcnt(6)
    v_mfma_f32_32x32x16_bf16 v[112:127], v[136:139], v[200:203], v[112:127]
    ds_read_b128 v[136:139], v42 offset:11264
    v_mfma_f32_32x32x16_bf16 v[112:127], v[140:143], v[204:207], v[112:127]
    ds_read_b128 v[140:143], v42 offset:15360
    s_waitcnt lgkmcnt(6)
    v_mfma_f32_32x32x16_bf16 v[112:127], v[144:147], v[208:211], v[112:127]
    ds_read_b128 v[144:147], v42 offset:19456
    s_nop 2
    v_mul_f32 v96, v96, v47
    v_mul_f32 v97, v97, v47
    v_mul_f32 v98, v98, v47
    v_mul_f32 v99, v99, v47
    v_mfma_f32_32x32x16_bf16 v[112:127], v[148:151], v[212:215], v[112:127]
    ds_read_b128 v[148:151], v42 offset:23552
    v_mul_f32 v100, v100, v47
    v_mul_f32 v101, v101, v47
    v_mul_f32 v102, v102, v47
    v_mul_f32 v103, v103, v47
    s_waitcnt lgkmcnt(6)
    v_mfma_f32_32x32x16_bf16 v[112:127], v[152:155], v[216:219], v[112:127]
    ds_read_b128 v[152:155], v42 offset:27648
    v_mul_f32 v104, v104, v47
    v_mul_f32 v105, v105, v47
    v_mul_f32 v106, v106, v47
    v_mul_f32 v107, v107, v47
    v_mfma_f32_32x32x16_bf16 v[112:127], v[156:159], v[220:223], v[112:127]
    ds_read_b128 v[156:159], v42 offset:31744
    v_mul_f32 v108, v108, v47
    v_mul_f32 v109, v109, v47
    v_mul_f32 v110, v110, v47
    v_mul_f32 v111, v111, v47
    s_waitcnt lgkmcnt(6)
    v_mfma_f32_32x32x16_bf16 v[112:127], v[128:131], v[160:163], v[112:127]
    v_cvt_pk_bf16_f32 v96, v96, v97
    v_cvt_pk_bf16_f32 v97, v98, v99
    v_cvt_pk_bf16_f32 v98, v100, v101
    v_cvt_pk_bf16_f32 v99, v102, v103
    v_mfma_f32_32x32x16_bf16 v[112:127], v[132:135], v[164:167], v[112:127]
    v_cvt_pk_bf16_f32 v100, v104, v105
    v_cvt_pk_bf16_f32 v101, v106, v107
    v_cvt_pk_bf16_f32 v102, v108, v109
    v_cvt_pk_bf16_f32 v103, v110, v111
    s_waitcnt lgkmcnt(4)
    v_mfma_f32_32x32x16_bf16 v[112:127], v[136:139], v[168:171], v[112:127]
    v_permlane32_swap_b32 v96, v98
    v_permlane32_swap_b32 v97, v99
    v_permlane32_swap_b32 v100, v102
    v_permlane32_swap_b32 v101, v103
    v_mfma_f32_32x32x16_bf16 v[112:127], v[140:143], v[172:175], v[112:127]
    s_mul_i32 s36, s34, 22
    s_add_u32 s36, s36, s33
    s_mul_i32 s37, s34, 22
    s_add_u32 s37, s37, s33
    s_waitcnt lgkmcnt(2)
    v_mfma_f32_32x32x16_bf16 v[112:127], v[144:147], v[176:179], v[112:127]
    s_add_u32 s38, s37, s34
    s_mov_b64 exec, s[52:53]
    buffer_store_dwordx4 v[96:99], v16, s[12:15], s36 offen offset:512 sc1
    s_mov_b64 exec, s[54:55]
    buffer_store_dwordx2 v[96:97], v17, s[12:15], s37 offen offset:1024 sc1
    buffer_store_dwordx2 v[98:99], v17, s[12:15], s38 offen offset:1024 sc1
    s_mov_b64 exec, -1
    s_mul_i32 s36, s34, 23
    s_add_u32 s36, s36, s33
    v_mfma_f32_32x32x16_bf16 v[112:127], v[148:151], v[180:183], v[112:127]
    buffer_store_dwordx4 v[100:103], v18, s[12:15], s36 offen offset:0 sc1
    s_waitcnt lgkmcnt(0)
    v_mfma_f32_32x32x16_bf16 v[112:127], v[152:155], v[184:187], v[112:127]
    v_mfma_f32_32x32x16_bf16 v[112:127], v[156:159], v[188:191], v[112:127]
    s_barrier
    s_nop 10
    v_mul_f32 v112, v112, v47
    v_mul_f32 v113, v113, v47
    v_mul_f32 v114, v114, v47
    v_mul_f32 v115, v115, v47
    v_mul_f32 v116, v116, v47
    v_mul_f32 v117, v117, v47
    v_mul_f32 v118, v118, v47
    v_mul_f32 v119, v119, v47
    v_mul_f32 v120, v120, v47
    v_mul_f32 v121, v121, v47
    v_mul_f32 v122, v122, v47
    v_mul_f32 v123, v123, v47
    v_mul_f32 v124, v124, v47
    v_mul_f32 v125, v125, v47
    v_mul_f32 v126, v126, v47
    v_mul_f32 v127, v127, v47
    v_cvt_pk_bf16_f32 v112, v112, v113
    v_cvt_pk_bf16_f32 v113, v114, v115
    v_cvt_pk_bf16_f32 v114, v116, v117
    v_cvt_pk_bf16_f32 v115, v118, v119
    v_cvt_pk_bf16_f32 v116, v120, v121
    v_cvt_pk_bf16_f32 v117, v122, v123
    v_cvt_pk_bf16_f32 v118, v124, v125
    v_cvt_pk_bf16_f32 v119, v126, v127
    v_permlane32_swap_b32 v112, v114
    v_permlane32_swap_b32 v113, v115
    v_permlane32_swap_b32 v116, v118
    v_permlane32_swap_b32 v117, v119
    s_mul_i32 s36, s34, 24
    s_add_u32 s36, s36, s33
    buffer_store_dwordx4 v[112:115], v18, s[12:15], s36 offen offset:0 sc1
    s_mul_i32 s36, s34, 25
    s_add_u32 s36, s36, s33
    s_mul_i32 s37, s34, 24
    s_add_u32 s37, s37, s33
    s_add_u32 s38, s37, s34
    s_mov_b64 exec, s[54:55]
    buffer_store_dwordx4 v[116:119], v16, s[12:15], s36 offen offset:0 sc1
    s_mov_b64 exec, s[52:53]
    buffer_store_dwordx2 v[116:117], v17, s[12:15], s37 offen offset:1024 sc1
    buffer_store_dwordx2 v[118:119], v17, s[12:15], s38 offen offset:1024 sc1
    s_mov_b64 exec, -1
    s_branch interleave_layers__softmax_full_mha__sliding_local_dilated__prompt_kernel_p5_fin5
interleave_layers__softmax_full_mha__sliding_local_dilated__prompt_kernel_p5_e4:
    s_waitcnt vmcnt(12)
    s_waitcnt lgkmcnt(6)
    v_mfma_f32_32x32x16_bf16 v[64:79], v[128:131], v[200:203], v[64:79]
    ds_read_b128 v[128:131], v42 offset:8192
    v_mfma_f32_32x32x16_bf16 v[64:79], v[132:135], v[204:207], v[64:79]
    ds_read_b128 v[132:135], v42 offset:12288
    s_waitcnt vmcnt(10)
    s_waitcnt lgkmcnt(6)
    v_mfma_f32_32x32x16_bf16 v[64:79], v[136:139], v[208:211], v[64:79]
    ds_read_b128 v[136:139], v42 offset:16384
    v_mfma_f32_32x32x16_bf16 v[64:79], v[140:143], v[212:215], v[64:79]
    ds_read_b128 v[140:143], v42 offset:20480
    s_waitcnt vmcnt(8)
    s_waitcnt lgkmcnt(6)
    v_mfma_f32_32x32x16_bf16 v[64:79], v[144:147], v[216:219], v[64:79]
    ds_read_b128 v[144:147], v42 offset:24576
    v_mfma_f32_32x32x16_bf16 v[64:79], v[148:151], v[220:223], v[64:79]
    ds_read_b128 v[148:151], v42 offset:28672
    s_waitcnt vmcnt(6)
    s_waitcnt lgkmcnt(6)
    v_mfma_f32_32x32x16_bf16 v[64:79], v[152:155], v[160:163], v[64:79]
    ds_read_b128 v[152:155], v41 offset:41984
    v_mfma_f32_32x32x16_bf16 v[64:79], v[156:159], v[164:167], v[64:79]
    ds_read_b128 v[156:159], v41 offset:46080
    s_waitcnt vmcnt(4)
    s_waitcnt lgkmcnt(6)
    v_mfma_f32_32x32x16_bf16 v[64:79], v[128:131], v[168:171], v[64:79]
    ds_read_b128 v[128:131], v41 offset:50176
    v_mfma_f32_32x32x16_bf16 v[64:79], v[132:135], v[172:175], v[64:79]
    ds_read_b128 v[132:135], v41 offset:54272
    s_waitcnt vmcnt(2)
    s_waitcnt lgkmcnt(6)
    v_mfma_f32_32x32x16_bf16 v[64:79], v[136:139], v[176:179], v[64:79]
    ds_read_b128 v[136:139], v41 offset:58368
    v_mfma_f32_32x32x16_bf16 v[64:79], v[140:143], v[180:183], v[64:79]
    ds_read_b128 v[140:143], v41 offset:62464
    s_waitcnt vmcnt(0)
    s_waitcnt lgkmcnt(6)
    v_mfma_f32_32x32x16_bf16 v[64:79], v[144:147], v[184:187], v[64:79]
    ds_read_b128 v[144:147], v42 offset:1024
    v_mfma_f32_32x32x16_bf16 v[64:79], v[148:151], v[188:191], v[64:79]
    ds_read_b128 v[148:151], v42 offset:5120
    s_waitcnt lgkmcnt(6)
    v_mfma_f32_32x32x16_bf16 v[80:95], v[152:155], v[200:203], v[80:95]
    ds_read_b128 v[152:155], v42 offset:9216
    v_mfma_f32_32x32x16_bf16 v[80:95], v[156:159], v[204:207], v[80:95]
    ds_read_b128 v[156:159], v42 offset:13312
    s_waitcnt lgkmcnt(6)
    v_mfma_f32_32x32x16_bf16 v[80:95], v[128:131], v[208:211], v[80:95]
    ds_read_b128 v[128:131], v42 offset:17408
    s_nop 2
    v_mul_f32 v64, v64, v47
    v_mul_f32 v65, v65, v47
    v_mul_f32 v66, v66, v47
    v_mul_f32 v67, v67, v47
    v_mfma_f32_32x32x16_bf16 v[80:95], v[132:135], v[212:215], v[80:95]
    ds_read_b128 v[132:135], v42 offset:21504
    v_mul_f32 v68, v68, v47
    v_mul_f32 v69, v69, v47
    v_mul_f32 v70, v70, v47
    v_mul_f32 v71, v71, v47
    s_waitcnt lgkmcnt(6)
    v_mfma_f32_32x32x16_bf16 v[80:95], v[136:139], v[216:219], v[80:95]
    ds_read_b128 v[136:139], v42 offset:25600
    v_mul_f32 v72, v72, v47
    v_mul_f32 v73, v73, v47
    v_mul_f32 v74, v74, v47
    v_mul_f32 v75, v75, v47
    v_mfma_f32_32x32x16_bf16 v[80:95], v[140:143], v[220:223], v[80:95]
    ds_read_b128 v[140:143], v42 offset:29696
    v_mul_f32 v76, v76, v47
    v_mul_f32 v77, v77, v47
    v_mul_f32 v78, v78, v47
    v_mul_f32 v79, v79, v47
    s_waitcnt lgkmcnt(6)
    v_mfma_f32_32x32x16_bf16 v[80:95], v[144:147], v[160:163], v[80:95]
    ds_read_b128 v[144:147], v41 offset:43008
    v_cvt_pk_bf16_f32 v64, v64, v65
    v_cvt_pk_bf16_f32 v65, v66, v67
    v_cvt_pk_bf16_f32 v66, v68, v69
    v_cvt_pk_bf16_f32 v67, v70, v71
    v_mfma_f32_32x32x16_bf16 v[80:95], v[148:151], v[164:167], v[80:95]
    ds_read_b128 v[148:151], v41 offset:47104
    v_cvt_pk_bf16_f32 v68, v72, v73
    v_cvt_pk_bf16_f32 v69, v74, v75
    v_cvt_pk_bf16_f32 v70, v76, v77
    v_cvt_pk_bf16_f32 v71, v78, v79
    s_waitcnt lgkmcnt(6)
    v_mfma_f32_32x32x16_bf16 v[80:95], v[152:155], v[168:171], v[80:95]
    ds_read_b128 v[152:155], v41 offset:51200
    v_permlane32_swap_b32 v64, v66
    v_permlane32_swap_b32 v65, v67
    v_permlane32_swap_b32 v68, v70
    v_permlane32_swap_b32 v69, v71
    v_mfma_f32_32x32x16_bf16 v[80:95], v[156:159], v[172:175], v[80:95]
    ds_read_b128 v[156:159], v41 offset:55296
    s_mul_i32 s36, s34, 25
    s_add_u32 s36, s36, s33
    buffer_store_dwordx4 v[64:67], v19, s[12:15], s36 offen offset:512 sc1
    s_mul_i32 s36, s34, 26
    s_waitcnt lgkmcnt(6)
    v_mfma_f32_32x32x16_bf16 v[80:95], v[128:131], v[176:179], v[80:95]
    ds_read_b128 v[128:131], v41 offset:59392
    s_add_u32 s36, s36, s33
    s_mul_i32 s37, s34, 26
    s_add_u32 s37, s37, s33
    s_add_u32 s38, s37, s34
    v_mfma_f32_32x32x16_bf16 v[80:95], v[132:135], v[180:183], v[80:95]
    ds_read_b128 v[132:135], v41 offset:63488
    s_mov_b64 exec, s[52:53]
    buffer_store_dwordx4 v[68:71], v16, s[12:15], s36 offen offset:512 sc1
    s_mov_b64 exec, s[54:55]
    buffer_store_dwordx2 v[68:69], v17, s[12:15], s37 offen offset:1024 sc1
    buffer_store_dwordx2 v[70:71], v17, s[12:15], s38 offen offset:1024 sc1
    s_mov_b64 exec, -1
    s_waitcnt lgkmcnt(6)
    v_mfma_f32_32x32x16_bf16 v[80:95], v[136:139], v[184:187], v[80:95]
    ds_read_b128 v[136:139], v42 offset:2048
    v_mfma_f32_32x32x16_bf16 v[80:95], v[140:143], v[188:191], v[80:95]
    ds_read_b128 v[140:143], v42 offset:6144
    s_waitcnt lgkmcnt(6)
    v_mfma_f32_32x32x16_bf16 v[96:111], v[144:147], v[200:203], v[96:111]
    ds_read_b128 v[144:147], v42 offset:10240
    v_mfma_f32_32x32x16_bf16 v[96:111], v[148:151], v[204:207], v[96:111]
    ds_read_b128 v[148:151], v42 offset:14336
    s_waitcnt lgkmcnt(6)
    v_mfma_f32_32x32x16_bf16 v[96:111], v[152:155], v[208:211], v[96:111]
    ds_read_b128 v[152:155], v42 offset:18432
    s_nop 2
    v_mul_f32 v80, v80, v47
    v_mul_f32 v81, v81, v47
    v_mul_f32 v82, v82, v47
    v_mul_f32 v83, v83, v47
    v_mfma_f32_32x32x16_bf16 v[96:111], v[156:159], v[212:215], v[96:111]
    ds_read_b128 v[156:159], v42 offset:22528
    v_mul_f32 v84, v84, v47
    v_mul_f32 v85, v85, v47
    v_mul_f32 v86, v86, v47
    v_mul_f32 v87, v87, v47
    s_waitcnt lgkmcnt(6)
    v_mfma_f32_32x32x16_bf16 v[96:111], v[128:131], v[216:219], v[96:111]
    ds_read_b128 v[128:131], v42 offset:26624
    v_mul_f32 v88, v88, v47
    v_mul_f32 v89, v89, v47
    v_mul_f32 v90, v90, v47
    v_mul_f32 v91, v91, v47
    v_mfma_f32_32x32x16_bf16 v[96:111], v[132:135], v[220:223], v[96:111]
    ds_read_b128 v[132:135], v42 offset:30720
    v_mul_f32 v92, v92, v47
    v_mul_f32 v93, v93, v47
    v_mul_f32 v94, v94, v47
    v_mul_f32 v95, v95, v47
    s_waitcnt lgkmcnt(6)
    v_mfma_f32_32x32x16_bf16 v[96:111], v[136:139], v[160:163], v[96:111]
    ds_read_b128 v[136:139], v41 offset:44032
    v_cvt_pk_bf16_f32 v80, v80, v81
    v_cvt_pk_bf16_f32 v81, v82, v83
    v_cvt_pk_bf16_f32 v82, v84, v85
    v_cvt_pk_bf16_f32 v83, v86, v87
    v_mfma_f32_32x32x16_bf16 v[96:111], v[140:143], v[164:167], v[96:111]
    ds_read_b128 v[140:143], v41 offset:48128
    v_cvt_pk_bf16_f32 v84, v88, v89
    v_cvt_pk_bf16_f32 v85, v90, v91
    v_cvt_pk_bf16_f32 v86, v92, v93
    v_cvt_pk_bf16_f32 v87, v94, v95
    s_waitcnt lgkmcnt(6)
    v_mfma_f32_32x32x16_bf16 v[96:111], v[144:147], v[168:171], v[96:111]
    ds_read_b128 v[144:147], v41 offset:52224
    v_permlane32_swap_b32 v80, v82
    v_permlane32_swap_b32 v81, v83
    v_permlane32_swap_b32 v84, v86
    v_permlane32_swap_b32 v85, v87
    v_mfma_f32_32x32x16_bf16 v[96:111], v[148:151], v[172:175], v[96:111]
    ds_read_b128 v[148:151], v41 offset:56320
    s_mul_i32 s36, s34, 27
    s_add_u32 s36, s36, s33
    buffer_store_dwordx4 v[80:83], v18, s[12:15], s36 offen offset:0 sc1
    s_mul_i32 s36, s34, 28
    s_waitcnt lgkmcnt(6)
    v_mfma_f32_32x32x16_bf16 v[96:111], v[152:155], v[176:179], v[96:111]
    ds_read_b128 v[152:155], v41 offset:60416
    s_add_u32 s36, s36, s33
    buffer_store_dwordx4 v[84:87], v18, s[12:15], s36 offen offset:0 sc1
    v_mfma_f32_32x32x16_bf16 v[96:111], v[156:159], v[180:183], v[96:111]
    ds_read_b128 v[156:159], v41 offset:64512
    s_waitcnt lgkmcnt(6)
    v_mfma_f32_32x32x16_bf16 v[96:111], v[128:131], v[184:187], v[96:111]
    ds_read_b128 v[128:131], v42 offset:3072
    v_mfma_f32_32x32x16_bf16 v[96:111], v[132:135], v[188:191], v[96:111]
    ds_read_b128 v[132:135], v42 offset:7168
    s_waitcnt lgkmcnt(6)
    v_mfma_f32_32x32x16_bf16 v[112:127], v[136:139], v[200:203], v[112:127]
    ds_read_b128 v[136:139], v42 offset:11264
    v_mfma_f32_32x32x16_bf16 v[112:127], v[140:143], v[204:207], v[112:127]
    ds_read_b128 v[140:143], v42 offset:15360
    s_waitcnt lgkmcnt(6)
    v_mfma_f32_32x32x16_bf16 v[112:127], v[144:147], v[208:211], v[112:127]
    ds_read_b128 v[144:147], v42 offset:19456
    s_nop 2
    v_mul_f32 v96, v96, v47
    v_mul_f32 v97, v97, v47
    v_mul_f32 v98, v98, v47
    v_mul_f32 v99, v99, v47
    v_mfma_f32_32x32x16_bf16 v[112:127], v[148:151], v[212:215], v[112:127]
    ds_read_b128 v[148:151], v42 offset:23552
    v_mul_f32 v100, v100, v47
    v_mul_f32 v101, v101, v47
    v_mul_f32 v102, v102, v47
    v_mul_f32 v103, v103, v47
    s_waitcnt lgkmcnt(6)
    v_mfma_f32_32x32x16_bf16 v[112:127], v[152:155], v[216:219], v[112:127]
    ds_read_b128 v[152:155], v42 offset:27648
    v_mul_f32 v104, v104, v47
    v_mul_f32 v105, v105, v47
    v_mul_f32 v106, v106, v47
    v_mul_f32 v107, v107, v47
    v_mfma_f32_32x32x16_bf16 v[112:127], v[156:159], v[220:223], v[112:127]
    ds_read_b128 v[156:159], v42 offset:31744
    v_mul_f32 v108, v108, v47
    v_mul_f32 v109, v109, v47
    v_mul_f32 v110, v110, v47
    v_mul_f32 v111, v111, v47
    s_waitcnt lgkmcnt(6)
    v_mfma_f32_32x32x16_bf16 v[112:127], v[128:131], v[160:163], v[112:127]
    v_cvt_pk_bf16_f32 v96, v96, v97
    v_cvt_pk_bf16_f32 v97, v98, v99
    v_cvt_pk_bf16_f32 v98, v100, v101
    v_cvt_pk_bf16_f32 v99, v102, v103
    v_mfma_f32_32x32x16_bf16 v[112:127], v[132:135], v[164:167], v[112:127]
    v_cvt_pk_bf16_f32 v100, v104, v105
    v_cvt_pk_bf16_f32 v101, v106, v107
    v_cvt_pk_bf16_f32 v102, v108, v109
    v_cvt_pk_bf16_f32 v103, v110, v111
    s_waitcnt lgkmcnt(4)
    v_mfma_f32_32x32x16_bf16 v[112:127], v[136:139], v[168:171], v[112:127]
    v_permlane32_swap_b32 v96, v98
    v_permlane32_swap_b32 v97, v99
    v_permlane32_swap_b32 v100, v102
    v_permlane32_swap_b32 v101, v103
    v_mfma_f32_32x32x16_bf16 v[112:127], v[140:143], v[172:175], v[112:127]
    s_mul_i32 s36, s34, 29
    s_add_u32 s36, s36, s33
    s_mul_i32 s37, s34, 28
    s_add_u32 s37, s37, s33
    s_waitcnt lgkmcnt(2)
    v_mfma_f32_32x32x16_bf16 v[112:127], v[144:147], v[176:179], v[112:127]
    s_add_u32 s38, s37, s34
    s_mov_b64 exec, s[54:55]
    buffer_store_dwordx4 v[96:99], v16, s[12:15], s36 offen offset:0 sc1
    s_mov_b64 exec, s[52:53]
    buffer_store_dwordx2 v[96:97], v17, s[12:15], s37 offen offset:1024 sc1
    buffer_store_dwordx2 v[98:99], v17, s[12:15], s38 offen offset:1024 sc1
    s_mov_b64 exec, -1
    s_mul_i32 s36, s34, 29
    s_add_u32 s36, s36, s33
    v_mfma_f32_32x32x16_bf16 v[112:127], v[148:151], v[180:183], v[112:127]
    buffer_store_dwordx4 v[100:103], v19, s[12:15], s36 offen offset:512 sc1
    s_waitcnt lgkmcnt(0)
    v_mfma_f32_32x32x16_bf16 v[112:127], v[152:155], v[184:187], v[112:127]
    v_mfma_f32_32x32x16_bf16 v[112:127], v[156:159], v[188:191], v[112:127]
    s_barrier
    s_nop 10
    v_mul_f32 v112, v112, v47
    v_mul_f32 v113, v113, v47
    v_mul_f32 v114, v114, v47
    v_mul_f32 v115, v115, v47
    v_mul_f32 v116, v116, v47
    v_mul_f32 v117, v117, v47
    v_mul_f32 v118, v118, v47
    v_mul_f32 v119, v119, v47
    v_mul_f32 v120, v120, v47
    v_mul_f32 v121, v121, v47
    v_mul_f32 v122, v122, v47
    v_mul_f32 v123, v123, v47
    v_mul_f32 v124, v124, v47
    v_mul_f32 v125, v125, v47
    v_mul_f32 v126, v126, v47
    v_mul_f32 v127, v127, v47
    v_cvt_pk_bf16_f32 v112, v112, v113
    v_cvt_pk_bf16_f32 v113, v114, v115
    v_cvt_pk_bf16_f32 v114, v116, v117
    v_cvt_pk_bf16_f32 v115, v118, v119
    v_cvt_pk_bf16_f32 v116, v120, v121
    v_cvt_pk_bf16_f32 v117, v122, v123
    v_cvt_pk_bf16_f32 v118, v124, v125
    v_cvt_pk_bf16_f32 v119, v126, v127
    v_permlane32_swap_b32 v112, v114
    v_permlane32_swap_b32 v113, v115
    v_permlane32_swap_b32 v116, v118
    v_permlane32_swap_b32 v117, v119
    s_mul_i32 s36, s34, 30
    s_add_u32 s36, s36, s33
    s_mul_i32 s37, s34, 30
    s_add_u32 s37, s37, s33
    s_add_u32 s38, s37, s34
    s_mov_b64 exec, s[52:53]
    buffer_store_dwordx4 v[112:115], v16, s[12:15], s36 offen offset:512 sc1
    s_mov_b64 exec, s[54:55]
    buffer_store_dwordx2 v[112:113], v17, s[12:15], s37 offen offset:1024 sc1
    buffer_store_dwordx2 v[114:115], v17, s[12:15], s38 offen offset:1024 sc1
    s_mov_b64 exec, -1
    s_mul_i32 s36, s34, 31
    s_add_u32 s36, s36, s33
    buffer_store_dwordx4 v[116:119], v18, s[12:15], s36 offen offset:0 sc1
    s_branch interleave_layers__softmax_full_mha__sliding_local_dilated__prompt_kernel_p5_fin5
interleave_layers__softmax_full_mha__sliding_local_dilated__prompt_kernel_p5_qv:
    s_barrier
    ds_read_b128 v[128:131], v3 offset:0
    ds_read_b128 v[132:135], v3 offset:1024
    ds_read_b128 v[136:139], v3 offset:2048
    ds_read_b128 v[140:143], v3 offset:3072
    ds_read_b128 v[144:147], v3 offset:4096
    ds_read_b128 v[148:151], v3 offset:5120
    ds_read_b128 v[152:155], v3 offset:6144
    ds_read_b128 v[156:159], v3 offset:7168
    s_waitcnt vmcnt(10)
    s_waitcnt lgkmcnt(6)
    v_mfma_f32_32x32x16_bf16 v[64:79], v[160:163], v[128:131], 0
    ds_read_b128 v[128:131], v3 offset:8192
    s_add_u32 s24, s24, 4096
    buffer_load_dwordx4 v[192:195], v8, s[12:15], s24 offen offset:0 sc1
    buffer_load_dwordx4 v[196:199], v8, s[12:15], s24 offen offset:512 sc1
    v_mfma_f32_32x32x16_bf16 v[80:95], v[160:163], v[132:135], 0
    ds_read_b128 v[132:135], v3 offset:9216
    s_waitcnt lgkmcnt(6)
    v_mfma_f32_32x32x16_bf16 v[96:111], v[160:163], v[136:139], 0
    ds_read_b128 v[136:139], v3 offset:10240
    v_mfma_f32_32x32x16_bf16 v[112:127], v[160:163], v[140:143], 0
    ds_read_b128 v[140:143], v3 offset:11264
    s_waitcnt lgkmcnt(6)
    v_mfma_f32_32x32x16_bf16 v[64:79], v[164:167], v[144:147], v[64:79]
    ds_read_b128 v[144:147], v3 offset:12288
    buffer_load_dwordx4 v[200:203], v8, s[12:15], s24 offen offset:1024 sc1
    buffer_load_dwordx4 v[204:207], v8, s[12:15], s24 offen offset:1536 sc1
    v_mfma_f32_32x32x16_bf16 v[80:95], v[164:167], v[148:151], v[80:95]
    ds_read_b128 v[148:151], v3 offset:13312
    s_waitcnt lgkmcnt(6)
    v_mfma_f32_32x32x16_bf16 v[96:111], v[164:167], v[152:155], v[96:111]
    ds_read_b128 v[152:155], v3 offset:14336
    v_mfma_f32_32x32x16_bf16 v[112:127], v[164:167], v[156:159], v[112:127]
    ds_read_b128 v[156:159], v3 offset:15360
    s_waitcnt vmcnt(8)
    s_waitcnt lgkmcnt(6)
    v_mfma_f32_32x32x16_bf16 v[64:79], v[168:171], v[128:131], v[64:79]
    ds_read_b128 v[128:131], v3 offset:16384
    buffer_load_dwordx4 v[208:211], v8, s[12:15], s24 offen offset:2048 sc1
    buffer_load_dwordx4 v[212:215], v8, s[12:15], s24 offen offset:2560 sc1
    v_add_f32 v16, v16, v18
    v_mfma_f32_32x32x16_bf16 v[80:95], v[168:171], v[132:135], v[80:95]
    ds_read_b128 v[132:135], v3 offset:17408
    v_add_f32 v17, v17, v19
    v_add_f32 v20, v20, v22
    s_waitcnt lgkmcnt(6)
    v_mfma_f32_32x32x16_bf16 v[96:111], v[168:171], v[136:139], v[96:111]
    ds_read_b128 v[136:139], v3 offset:18432
    v_add_f32 v21, v21, v23
    v_add_f32 v16, v16, v20
    v_mfma_f32_32x32x16_bf16 v[112:127], v[168:171], v[140:143], v[112:127]
    ds_read_b128 v[140:143], v3 offset:19456
    v_add_f32 v17, v17, v21
    v_mov_b32 v18, v16
    s_waitcnt lgkmcnt(6)
    v_mfma_f32_32x32x16_bf16 v[64:79], v[172:175], v[144:147], v[64:79]
    ds_read_b128 v[144:147], v3 offset:20480
    buffer_load_dwordx4 v[216:219], v8, s[12:15], s24 offen offset:3072 sc1
    buffer_load_dwordx4 v[220:223], v8, s[12:15], s24 offen offset:3584 sc1
    v_permlane32_swap_b32 v16, v18
    v_add_f32 v16, v16, v18
    v_mfma_f32_32x32x16_bf16 v[80:95], v[172:175], v[148:151], v[80:95]
    ds_read_b128 v[148:151], v3 offset:21504
    v_mov_b32 v18, v17
    s_nop 1
    v_permlane32_swap_b32 v17, v18
    s_waitcnt lgkmcnt(6)
    v_mfma_f32_32x32x16_bf16 v[96:111], v[172:175], v[152:155], v[96:111]
    ds_read_b128 v[152:155], v3 offset:22528
    v_add_f32 v17, v17, v18
    v_mul_f32 v46, 0x3acccccd, v16
    v_mfma_f32_32x32x16_bf16 v[112:127], v[172:175], v[156:159], v[112:127]
    ds_read_b128 v[156:159], v3 offset:23552
    v_mul_f32 v18, 0x3acccccd, v17
    v_fma_f32 v18, -v46, v46, v18
    s_waitcnt vmcnt(10)
    s_waitcnt lgkmcnt(6)
    v_mfma_f32_32x32x16_bf16 v[64:79], v[176:179], v[128:131], v[64:79]
    ds_read_b128 v[128:131], v3 offset:24576
    s_add_u32 s24, s24, 4096
    buffer_load_dwordx4 v[160:163], v8, s[12:15], s24 offen offset:0 sc1
    buffer_load_dwordx4 v[164:167], v8, s[12:15], s24 offen offset:512 sc1
    v_max_f32 v18, 0, v18
    v_add_f32 v18, 0x3727c5ac, v18
    v_mfma_f32_32x32x16_bf16 v[80:95], v[176:179], v[132:135], v[80:95]
    ds_read_b128 v[132:135], v3 offset:25600
    v_rsq_f32 v47, v18
    v_xor_b32 v19, 0x80000000, v46
    s_waitcnt lgkmcnt(6)
    v_mfma_f32_32x32x16_bf16 v[96:111], v[176:179], v[136:139], v[96:111]
    ds_read_b128 v[136:139], v3 offset:26624
    v_and_b32 v18, 0xffff0000, v19
    v_sub_f32 v20, v19, v18
    v_mfma_f32_32x32x16_bf16 v[112:127], v[176:179], v[140:143], v[112:127]
    ds_read_b128 v[140:143], v3 offset:27648
    v_cvt_pk_bf16_f32 v48, v18, v18
    v_cvt_pk_bf16_f32 v49, v20, 0
    s_waitcnt lgkmcnt(6)
    v_mfma_f32_32x32x16_bf16 v[64:79], v[180:183], v[144:147], v[64:79]
    ds_read_b128 v[144:147], v3 offset:28672
    buffer_load_dwordx4 v[168:171], v8, s[12:15], s24 offen offset:1024 sc1
    buffer_load_dwordx4 v[172:175], v8, s[12:15], s24 offen offset:1536 sc1
    v_and_b32 v48, v48, v58
    v_and_b32 v49, v49, v58
    v_mfma_f32_32x32x16_bf16 v[80:95], v[180:183], v[148:151], v[80:95]
    ds_read_b128 v[148:151], v3 offset:29696
    v_add_f32 v24, v24, v25
    v_add_f32 v26, v26, v27
    s_waitcnt lgkmcnt(6)
    v_mfma_f32_32x32x16_bf16 v[96:111], v[180:183], v[152:155], v[96:111]
    ds_read_b128 v[152:155], v3 offset:30720
    v_add_f32 v24, v24, v26
    v_and_b32 v18, 0xffff0000, v24
    v_mfma_f32_32x32x16_bf16 v[112:127], v[180:183], v[156:159], v[112:127]
    ds_read_b128 v[156:159], v3 offset:31744
    v_sub_f32 v20, v24, v18
    v_cvt_pk_bf16_f32 v50, v18, v20
    s_waitcnt vmcnt(12)
    s_waitcnt lgkmcnt(6)
    v_mfma_f32_32x32x16_bf16 v[64:79], v[184:187], v[128:131], v[64:79]
    ds_read_b128 v[128:131], v3 offset:32768
    buffer_load_dwordx4 v[176:179], v8, s[12:15], s24 offen offset:2048 sc1
    buffer_load_dwordx4 v[180:183], v8, s[12:15], s24 offen offset:2560 sc1
    v_lshrrev_b32 v51, 16, v18
    v_add_f32 v28, v28, v29
    v_mfma_f32_32x32x16_bf16 v[80:95], v[184:187], v[132:135], v[80:95]
    ds_read_b128 v[132:135], v3 offset:33792
    v_add_f32 v30, v30, v31
    v_add_f32 v28, v28, v30
    s_waitcnt lgkmcnt(6)
    v_mfma_f32_32x32x16_bf16 v[96:111], v[184:187], v[136:139], v[96:111]
    ds_read_b128 v[136:139], v3 offset:34816
    v_and_b32 v18, 0xffff0000, v28
    v_sub_f32 v20, v28, v18
    v_mfma_f32_32x32x16_bf16 v[112:127], v[184:187], v[140:143], v[112:127]
    ds_read_b128 v[140:143], v3 offset:35840
    v_cvt_pk_bf16_f32 v52, v18, v20
    v_lshrrev_b32 v53, 16, v18
    s_waitcnt lgkmcnt(6)
    v_mfma_f32_32x32x16_bf16 v[64:79], v[188:191], v[144:147], v[64:79]
    ds_read_b128 v[144:147], v3 offset:36864
    v_add_f32 v32, v32, v33
    v_add_f32 v34, v34, v35
    v_mfma_f32_32x32x16_bf16 v[80:95], v[188:191], v[148:151], v[80:95]
    ds_read_b128 v[148:151], v3 offset:37888
    v_add_f32 v32, v32, v34
    v_and_b32 v18, 0xffff0000, v32
    s_waitcnt lgkmcnt(6)
    v_mfma_f32_32x32x16_bf16 v[96:111], v[188:191], v[152:155], v[96:111]
    ds_read_b128 v[152:155], v3 offset:38912
    v_sub_f32 v20, v32, v18
    v_cvt_pk_bf16_f32 v54, v18, v20
    v_mfma_f32_32x32x16_bf16 v[112:127], v[188:191], v[156:159], v[112:127]
    ds_read_b128 v[156:159], v3 offset:39936
    v_lshrrev_b32 v55, 16, v18
    v_add_f32 v36, v36, v37
    s_waitcnt vmcnt(12)
    s_waitcnt lgkmcnt(6)
    v_mfma_f32_32x32x16_bf16 v[64:79], v[192:195], v[128:131], v[64:79]
    ds_read_b128 v[128:131], v3 offset:40960
    buffer_load_dwordx4 v[184:187], v8, s[12:15], s24 offen offset:3072 sc1
    buffer_load_dwordx4 v[188:191], v8, s[12:15], s24 offen offset:3584 sc1
    v_add_f32 v38, v38, v39
    v_add_f32 v36, v36, v38
    v_mfma_f32_32x32x16_bf16 v[80:95], v[192:195], v[132:135], v[80:95]
    ds_read_b128 v[132:135], v3 offset:41984
    v_and_b32 v18, 0xffff0000, v36
    v_sub_f32 v20, v36, v18
    s_waitcnt lgkmcnt(6)
    v_mfma_f32_32x32x16_bf16 v[96:111], v[192:195], v[136:139], v[96:111]
    ds_read_b128 v[136:139], v3 offset:43008
    v_cvt_pk_bf16_f32 v56, v18, v20
    v_lshrrev_b32 v57, 16, v18
    v_mfma_f32_32x32x16_bf16 v[112:127], v[192:195], v[140:143], v[112:127]
    ds_read_b128 v[140:143], v3 offset:44032
    v_lshlrev_b32 v16, 4, v4
    v_add_u32 v17, 0, v16
    s_waitcnt lgkmcnt(6)
    v_mfma_f32_32x32x16_bf16 v[64:79], v[196:199], v[144:147], v[64:79]
    ds_read_b128 v[144:147], v3 offset:45056
    ds_bpermute_b32 v224, v17, v47
    v_add_u32 v17, 4, v16
    v_mfma_f32_32x32x16_bf16 v[80:95], v[196:199], v[148:151], v[80:95]
    ds_read_b128 v[148:151], v3 offset:46080
    ds_bpermute_b32 v225, v17, v47
    v_add_u32 v17, 8, v16
    s_waitcnt lgkmcnt(8)
    v_mfma_f32_32x32x16_bf16 v[96:111], v[196:199], v[152:155], v[96:111]
    ds_read_b128 v[152:155], v3 offset:47104
    ds_bpermute_b32 v226, v17, v47
    v_add_u32 v17, 12, v16
    v_mfma_f32_32x32x16_bf16 v[112:127], v[196:199], v[156:159], v[112:127]
    ds_read_b128 v[156:159], v3 offset:48128
    ds_bpermute_b32 v227, v17, v47
    v_add_u32 v17, 32, v16
    s_waitcnt vmcnt(12)
    s_waitcnt lgkmcnt(10)
    v_mfma_f32_32x32x16_bf16 v[64:79], v[200:203], v[128:131], v[64:79]
    ds_read_b128 v[128:131], v3 offset:49152
    s_add_u32 s24, s24, 4096
    buffer_load_dwordx4 v[192:195], v8, s[12:15], s24 offen offset:0 sc1
    buffer_load_dwordx4 v[196:199], v8, s[12:15], s24 offen offset:512 sc1
    ds_bpermute_b32 v228, v17, v47
    v_add_u32 v17, 36, v16
    v_mfma_f32_32x32x16_bf16 v[80:95], v[200:203], v[132:135], v[80:95]
    ds_read_b128 v[132:135], v3 offset:50176
    ds_bpermute_b32 v229, v17, v47
    v_add_u32 v17, 40, v16
    s_waitcnt lgkmcnt(12)
    v_mfma_f32_32x32x16_bf16 v[96:111], v[200:203], v[136:139], v[96:111]
    ds_read_b128 v[136:139], v3 offset:51200
    ds_bpermute_b32 v230, v17, v47
    v_add_u32 v17, 44, v16
    v_mfma_f32_32x32x16_bf16 v[112:127], v[200:203], v[140:143], v[112:127]
    ds_read_b128 v[140:143], v3 offset:52224
    ds_bpermute_b32 v231, v17, v47
    v_add_u32 v17, 64, v16
    s_waitcnt lgkmcnt(13)
    v_mfma_f32_32x32x16_bf16 v[64:79], v[204:207], v[144:147], v[64:79]
    ds_read_b128 v[144:147], v3 offset:53248
    ds_bpermute_b32 v232, v17, v47
    v_add_u32 v17, 68, v16
    v_mfma_f32_32x32x16_bf16 v[80:95], v[204:207], v[148:151], v[80:95]
    ds_read_b128 v[148:151], v3 offset:54272
    ds_bpermute_b32 v233, v17, v47
    v_add_u32 v17, 72, v16
    s_waitcnt lgkmcnt(13)
    v_mfma_f32_32x32x16_bf16 v[96:111], v[204:207], v[152:155], v[96:111]
    ds_read_b128 v[152:155], v3 offset:55296
    ds_bpermute_b32 v234, v17, v47
    v_add_u32 v17, 76, v16
    v_mfma_f32_32x32x16_bf16 v[112:127], v[204:207], v[156:159], v[112:127]
    ds_read_b128 v[156:159], v3 offset:56320
    ds_bpermute_b32 v235, v17, v47
    v_add_u32 v17, 96, v16
    s_waitcnt vmcnt(12)
    s_barrier
    s_waitcnt lgkmcnt(13)
    v_mfma_f32_32x32x16_bf16 v[64:79], v[208:211], v[128:131], v[64:79]
    ds_read_b128 v[128:131], v3 offset:57344
    buffer_load_dwordx4 v[200:203], v8, s[12:15], s24 offen offset:1024 sc1
    buffer_load_dwordx4 v[204:207], v8, s[12:15], s24 offen offset:1536 sc1
    ds_bpermute_b32 v236, v17, v47
    v_add_u32 v17, 100, v16
    v_mfma_f32_32x32x16_bf16 v[80:95], v[208:211], v[132:135], v[80:95]
    ds_read_b128 v[132:135], v3 offset:58368
    ds_bpermute_b32 v237, v17, v47
    v_add_u32 v17, 104, v16
    s_waitcnt lgkmcnt(13)
    v_mfma_f32_32x32x16_bf16 v[96:111], v[208:211], v[136:139], v[96:111]
    ds_read_b128 v[136:139], v3 offset:59392
    ds_bpermute_b32 v238, v17, v47
    v_add_u32 v17, 108, v16
    v_mfma_f32_32x32x16_bf16 v[112:127], v[208:211], v[140:143], v[112:127]
    ds_read_b128 v[140:143], v3 offset:60416
    ds_bpermute_b32 v239, v17, v47
    s_sub_u32 s35, s17, 10
    s_waitcnt lgkmcnt(13)
    v_mfma_f32_32x32x16_bf16 v[64:79], v[212:215], v[144:147], v[64:79]
    ds_read_b128 v[144:147], v3 offset:61440
    s_lshl_b32 s35, s35, 7
    s_and_b32 s36, s19, 31
    v_mfma_f32_32x32x16_bf16 v[80:95], v[212:215], v[148:151], v[80:95]
    ds_read_b128 v[148:151], v3 offset:62464
    s_lshl_b32 s36, s36, 1
    s_lshr_b32 s34, s19, 5
    s_waitcnt lgkmcnt(11)
    v_mfma_f32_32x32x16_bf16 v[96:111], v[212:215], v[152:155], v[96:111]
    ds_read_b128 v[152:155], v3 offset:63488
    s_add_u32 s36, s36, s34
    s_add_u32 s36, s36, 44
    v_mfma_f32_32x32x16_bf16 v[112:127], v[212:215], v[156:159], v[112:127]
    ds_read_b128 v[156:159], v3 offset:64512
    s_and_b32 s36, s36, 63
    s_mul_i32 s36, s36, 2560
    s_waitcnt vmcnt(12)
    s_waitcnt lgkmcnt(9)
    v_mfma_f32_32x32x16_bf16 v[64:79], v[216:219], v[128:131], v[64:79]
    ds_read_b128 v[128:131], v41 offset:0
    buffer_load_dwordx4 v[208:211], v8, s[12:15], s24 offen offset:2048 sc1
    buffer_load_dwordx4 v[212:215], v8, s[12:15], s24 offen offset:2560 sc1
    s_add_u32 s33, s36, 5506304
    v_mul_u32_u24 v20, 320, v4
    v_mfma_f32_32x32x16_bf16 v[80:95], v[216:219], v[132:135], v[80:95]
    ds_read_b128 v[132:135], v41 offset:1024
    v_add_u32 v16, s35, v10
    v_mul_u32_u24 v17, 52429, v16
    s_waitcnt lgkmcnt(7)
    v_mfma_f32_32x32x16_bf16 v[96:111], v[216:219], v[136:139], v[96:111]
    ds_read_b128 v[136:139], v41 offset:2048
    v_lshrrev_b32 v17, 20, v17
    v_mul_u32_u24 v18, 20, v17
    v_mfma_f32_32x32x16_bf16 v[112:127], v[216:219], v[140:143], v[112:127]
    ds_read_b128 v[140:143], v41 offset:3072
    v_sub_u32 v18, v16, v18
    v_mul_u32_u24 v17, 163840, v17
    s_waitcnt lgkmcnt(6)
    v_mfma_f32_32x32x16_bf16 v[64:79], v[220:223], v[144:147], v[64:79]
    ds_read_b128 v[144:147], v41 offset:4096
    v_lshl_add_u32 v17, v18, 4, v17
    v_add_u32 v24, v17, v20
    v_mfma_f32_32x32x16_bf16 v[80:95], v[220:223], v[148:151], v[80:95]
    ds_read_b128 v[148:151], v41 offset:5120
    v_add_u32 v16, s35, v10
    v_add_u32 v16, 32, v16
    s_waitcnt lgkmcnt(6)
    v_mfma_f32_32x32x16_bf16 v[96:111], v[220:223], v[152:155], v[96:111]
    ds_read_b128 v[152:155], v41 offset:6144
    v_mul_u32_u24 v17, 52429, v16
    v_lshrrev_b32 v17, 20, v17
    v_mfma_f32_32x32x16_bf16 v[112:127], v[220:223], v[156:159], v[112:127]
    ds_read_b128 v[156:159], v41 offset:7168
    v_mul_u32_u24 v18, 20, v17
    v_sub_u32 v18, v16, v18
    s_waitcnt vmcnt(12)
    s_waitcnt lgkmcnt(6)
    v_mfma_f32_32x32x16_bf16 v[64:79], v[160:163], v[128:131], v[64:79]
    ds_read_b128 v[128:131], v41 offset:8192
    buffer_load_dwordx4 v[216:219], v8, s[12:15], s24 offen offset:3072 sc1
    buffer_load_dwordx4 v[220:223], v8, s[12:15], s24 offen offset:3584 sc1
    v_mul_u32_u24 v17, 163840, v17
    v_lshl_add_u32 v17, v18, 4, v17
    v_mfma_f32_32x32x16_bf16 v[80:95], v[160:163], v[132:135], v[80:95]
    ds_read_b128 v[132:135], v41 offset:9216
    v_add_u32 v25, v17, v20
    v_add_u32 v16, s35, v10
    s_waitcnt lgkmcnt(6)
    v_mfma_f32_32x32x16_bf16 v[96:111], v[160:163], v[136:139], v[96:111]
    ds_read_b128 v[136:139], v41 offset:10240
    v_add_u32 v16, 64, v16
    v_mul_u32_u24 v17, 52429, v16
    v_mfma_f32_32x32x16_bf16 v[112:127], v[160:163], v[140:143], v[112:127]
    ds_read_b128 v[140:143], v41 offset:11264
    v_lshrrev_b32 v17, 20, v17
    v_mul_u32_u24 v18, 20, v17
    s_waitcnt lgkmcnt(6)
    v_mfma_f32_32x32x16_bf16 v[64:79], v[164:167], v[144:147], v[64:79]
    ds_read_b128 v[144:147], v41 offset:12288
    v_sub_u32 v18, v16, v18
    v_mul_u32_u24 v17, 163840, v17
    v_mfma_f32_32x32x16_bf16 v[80:95], v[164:167], v[148:151], v[80:95]
    ds_read_b128 v[148:151], v41 offset:13312
    v_lshl_add_u32 v17, v18, 4, v17
    v_add_u32 v26, v17, v20
    s_waitcnt lgkmcnt(6)
    v_mfma_f32_32x32x16_bf16 v[96:111], v[164:167], v[152:155], v[96:111]
    ds_read_b128 v[152:155], v41 offset:14336
    v_add_u32 v16, s35, v10
    v_add_u32 v16, 96, v16
    v_mfma_f32_32x32x16_bf16 v[112:127], v[164:167], v[156:159], v[112:127]
    ds_read_b128 v[156:159], v41 offset:15360
    v_mul_u32_u24 v17, 52429, v16
    v_lshrrev_b32 v17, 20, v17
    s_waitcnt vmcnt(12)
    s_waitcnt lgkmcnt(6)
    v_mfma_f32_32x32x16_bf16 v[64:79], v[168:171], v[128:131], v[64:79]
    ds_read_b128 v[128:131], v41 offset:16384
    s_add_u32 s24, s24, 4096
    buffer_load_dwordx4 v[160:163], v8, s[12:15], s24 offen offset:0 sc1
    buffer_load_dwordx4 v[164:167], v8, s[12:15], s24 offen offset:512 sc1
    v_mul_u32_u24 v18, 20, v17
    v_sub_u32 v18, v16, v18
    v_mfma_f32_32x32x16_bf16 v[80:95], v[168:171], v[132:135], v[80:95]
    ds_read_b128 v[132:135], v41 offset:17408
    v_mul_u32_u24 v17, 163840, v17
    v_lshl_add_u32 v17, v18, 4, v17
    s_waitcnt lgkmcnt(6)
    v_mfma_f32_32x32x16_bf16 v[96:111], v[168:171], v[136:139], v[96:111]
    ds_read_b128 v[136:139], v41 offset:18432
    v_add_u32 v27, v17, v20
    v_mfma_f32_32x32x16_bf16 v[112:127], v[168:171], v[140:143], v[112:127]
    ds_read_b128 v[140:143], v41 offset:19456
    s_waitcnt lgkmcnt(6)
    v_mfma_f32_32x32x16_bf16 v[64:79], v[172:175], v[144:147], v[64:79]
    ds_read_b128 v[144:147], v41 offset:20480
    v_mfma_f32_32x32x16_bf16 v[80:95], v[172:175], v[148:151], v[80:95]
    ds_read_b128 v[148:151], v41 offset:21504
    s_waitcnt lgkmcnt(6)
    v_mfma_f32_32x32x16_bf16 v[96:111], v[172:175], v[152:155], v[96:111]
    ds_read_b128 v[152:155], v41 offset:22528
    v_mfma_f32_32x32x16_bf16 v[112:127], v[172:175], v[156:159], v[112:127]
    ds_read_b128 v[156:159], v41 offset:23552
    s_waitcnt vmcnt(12)
    s_waitcnt lgkmcnt(6)
    v_mfma_f32_32x32x16_bf16 v[64:79], v[176:179], v[128:131], v[64:79]
    ds_read_b128 v[128:131], v41 offset:24576
    buffer_load_dwordx4 v[168:171], v8, s[12:15], s24 offen offset:1024 sc1
    buffer_load_dwordx4 v[172:175], v8, s[12:15], s24 offen offset:1536 sc1
    v_mfma_f32_32x32x16_bf16 v[80:95], v[176:179], v[132:135], v[80:95]
    ds_read_b128 v[132:135], v41 offset:25600
    s_waitcnt lgkmcnt(6)
    v_mfma_f32_32x32x16_bf16 v[96:111], v[176:179], v[136:139], v[96:111]
    ds_read_b128 v[136:139], v41 offset:26624
    v_mfma_f32_32x32x16_bf16 v[112:127], v[176:179], v[140:143], v[112:127]
    ds_read_b128 v[140:143], v41 offset:27648
    s_waitcnt lgkmcnt(6)
    v_mfma_f32_32x32x16_bf16 v[64:79], v[180:183], v[144:147], v[64:79]
    ds_read_b128 v[144:147], v41 offset:28672
    v_mfma_f32_32x32x16_bf16 v[80:95], v[180:183], v[148:151], v[80:95]
    ds_read_b128 v[148:151], v41 offset:29696
    s_waitcnt lgkmcnt(6)
    v_mfma_f32_32x32x16_bf16 v[96:111], v[180:183], v[152:155], v[96:111]
    ds_read_b128 v[152:155], v41 offset:30720
    v_mfma_f32_32x32x16_bf16 v[112:127], v[180:183], v[156:159], v[112:127]
    ds_read_b128 v[156:159], v41 offset:31744
    s_waitcnt vmcnt(12)
    s_waitcnt lgkmcnt(6)
    v_mfma_f32_32x32x16_bf16 v[64:79], v[184:187], v[128:131], v[64:79]
    ds_read_b128 v[128:131], v41 offset:32768
    buffer_load_dwordx4 v[176:179], v8, s[12:15], s24 offen offset:2048 sc1
    buffer_load_dwordx4 v[180:183], v8, s[12:15], s24 offen offset:2560 sc1
    v_mfma_f32_32x32x16_bf16 v[80:95], v[184:187], v[132:135], v[80:95]
    ds_read_b128 v[132:135], v41 offset:33792
    s_waitcnt lgkmcnt(6)
    v_mfma_f32_32x32x16_bf16 v[96:111], v[184:187], v[136:139], v[96:111]
    ds_read_b128 v[136:139], v41 offset:34816
    v_mfma_f32_32x32x16_bf16 v[112:127], v[184:187], v[140:143], v[112:127]
    ds_read_b128 v[140:143], v41 offset:35840
    s_waitcnt lgkmcnt(6)
    v_mfma_f32_32x32x16_bf16 v[64:79], v[188:191], v[144:147], v[64:79]
    ds_read_b128 v[144:147], v41 offset:36864
    v_mfma_f32_32x32x16_bf16 v[80:95], v[188:191], v[148:151], v[80:95]
    ds_read_b128 v[148:151], v41 offset:37888
    s_waitcnt lgkmcnt(6)
    v_mfma_f32_32x32x16_bf16 v[96:111], v[188:191], v[152:155], v[96:111]
    ds_read_b128 v[152:155], v41 offset:38912
    v_mfma_f32_32x32x16_bf16 v[112:127], v[188:191], v[156:159], v[112:127]
    ds_read_b128 v[156:159], v41 offset:39936
    s_waitcnt vmcnt(12)
    s_waitcnt lgkmcnt(6)
    v_mfma_f32_32x32x16_bf16 v[64:79], v[192:195], v[128:131], v[64:79]
    ds_read_b128 v[128:131], v41 offset:40960
    buffer_load_dwordx4 v[184:187], v8, s[12:15], s24 offen offset:3072 sc1
    buffer_load_dwordx4 v[188:191], v8, s[12:15], s24 offen offset:3584 sc1
    v_mfma_f32_32x32x16_bf16 v[80:95], v[192:195], v[132:135], v[80:95]
    ds_read_b128 v[132:135], v41 offset:45056
    s_waitcnt lgkmcnt(6)
    v_mfma_f32_32x32x16_bf16 v[96:111], v[192:195], v[136:139], v[96:111]
    ds_read_b128 v[136:139], v41 offset:49152
    v_mfma_f32_32x32x16_bf16 v[112:127], v[192:195], v[140:143], v[112:127]
    ds_read_b128 v[140:143], v41 offset:53248
    s_waitcnt lgkmcnt(6)
    v_mfma_f32_32x32x16_bf16 v[64:79], v[196:199], v[144:147], v[64:79]
    ds_read_b128 v[144:147], v41 offset:57344
    v_mfma_f32_32x32x16_bf16 v[80:95], v[196:199], v[148:151], v[80:95]
    ds_read_b128 v[148:151], v41 offset:61440
    s_waitcnt lgkmcnt(6)
    v_mfma_f32_32x32x16_bf16 v[96:111], v[196:199], v[152:155], v[96:111]
    ds_read_b128 v[152:155], v42 offset:0
    v_mfma_f32_32x32x16_bf16 v[112:127], v[196:199], v[156:159], v[112:127]
    ds_read_b128 v[156:159], v42 offset:4096
    v_mfma_f32_32x32x8_bf16 v[64:79], v[48:49], v[50:51], v[64:79]
    v_mfma_f32_32x32x8_bf16 v[80:95], v[48:49], v[52:53], v[80:95]
    v_mfma_f32_32x32x8_bf16 v[96:111], v[48:49], v[54:55], v[96:111]
    v_mfma_f32_32x32x8_bf16 v[112:127], v[48:49], v[56:57], v[112:127]
    s_waitcnt vmcnt(12)
    s_waitcnt lgkmcnt(6)
    v_mfma_f32_32x32x16_bf16 v[64:79], v[200:203], v[128:131], v[64:79]
    ds_read_b128 v[128:131], v42 offset:8192
    v_mfma_f32_32x32x16_bf16 v[64:79], v[204:207], v[132:135], v[64:79]
    ds_read_b128 v[132:135], v42 offset:12288
    s_waitcnt vmcnt(10)
    s_waitcnt lgkmcnt(6)
    v_mfma_f32_32x32x16_bf16 v[64:79], v[208:211], v[136:139], v[64:79]
    ds_read_b128 v[136:139], v42 offset:16384
    v_mfma_f32_32x32x16_bf16 v[64:79], v[212:215], v[140:143], v[64:79]
    ds_read_b128 v[140:143], v42 offset:20480
    s_waitcnt vmcnt(8)
    s_waitcnt lgkmcnt(6)
    v_mfma_f32_32x32x16_bf16 v[64:79], v[216:219], v[144:147], v[64:79]
    ds_read_b128 v[144:147], v42 offset:24576
    v_mfma_f32_32x32x16_bf16 v[64:79], v[220:223], v[148:151], v[64:79]
    ds_read_b128 v[148:151], v42 offset:28672
    s_waitcnt vmcnt(6)
    s_waitcnt lgkmcnt(6)
    v_mfma_f32_32x32x16_bf16 v[64:79], v[160:163], v[152:155], v[64:79]
    ds_read_b128 v[152:155], v41 offset:41984
    v_mfma_f32_32x32x16_bf16 v[64:79], v[164:167], v[156:159], v[64:79]
    ds_read_b128 v[156:159], v41 offset:46080
    s_waitcnt vmcnt(4)
    s_waitcnt lgkmcnt(6)
    v_mfma_f32_32x32x16_bf16 v[64:79], v[168:171], v[128:131], v[64:79]
    ds_read_b128 v[128:131], v41 offset:50176
    v_mfma_f32_32x32x16_bf16 v[64:79], v[172:175], v[132:135], v[64:79]
    ds_read_b128 v[132:135], v41 offset:54272
    s_waitcnt vmcnt(2)
    s_waitcnt lgkmcnt(6)
    v_mfma_f32_32x32x16_bf16 v[64:79], v[176:179], v[136:139], v[64:79]
    ds_read_b128 v[136:139], v41 offset:58368
    v_mfma_f32_32x32x16_bf16 v[64:79], v[180:183], v[140:143], v[64:79]
    ds_read_b128 v[140:143], v41 offset:62464
    s_waitcnt vmcnt(0)
    s_waitcnt lgkmcnt(6)
    v_mfma_f32_32x32x16_bf16 v[64:79], v[184:187], v[144:147], v[64:79]
    ds_read_b128 v[144:147], v42 offset:1024
    v_mfma_f32_32x32x16_bf16 v[64:79], v[188:191], v[148:151], v[64:79]
    ds_read_b128 v[148:151], v42 offset:5120
    s_waitcnt lgkmcnt(6)
    v_mfma_f32_32x32x16_bf16 v[80:95], v[200:203], v[152:155], v[80:95]
    ds_read_b128 v[152:155], v42 offset:9216
    v_mfma_f32_32x32x16_bf16 v[80:95], v[204:207], v[156:159], v[80:95]
    ds_read_b128 v[156:159], v42 offset:13312
    s_waitcnt lgkmcnt(6)
    v_mfma_f32_32x32x16_bf16 v[80:95], v[208:211], v[128:131], v[80:95]
    ds_read_b128 v[128:131], v42 offset:17408
    s_nop 2
    v_mul_f32 v64, v64, v224
    v_mul_f32 v65, v65, v225
    v_mul_f32 v66, v66, v226
    v_mul_f32 v67, v67, v227
    v_mfma_f32_32x32x16_bf16 v[80:95], v[212:215], v[132:135], v[80:95]
    ds_read_b128 v[132:135], v42 offset:21504
    v_mul_f32 v68, v68, v228
    v_mul_f32 v69, v69, v229
    v_mul_f32 v70, v70, v230
    v_mul_f32 v71, v71, v231
    s_waitcnt lgkmcnt(6)
    v_mfma_f32_32x32x16_bf16 v[80:95], v[216:219], v[136:139], v[80:95]
    ds_read_b128 v[136:139], v42 offset:25600
    v_mul_f32 v72, v72, v232
    v_mul_f32 v73, v73, v233
    v_mul_f32 v74, v74, v234
    v_mul_f32 v75, v75, v235
    v_mfma_f32_32x32x16_bf16 v[80:95], v[220:223], v[140:143], v[80:95]
    ds_read_b128 v[140:143], v42 offset:29696
    v_mul_f32 v76, v76, v236
    v_mul_f32 v77, v77, v237
    v_mul_f32 v78, v78, v238
    v_mul_f32 v79, v79, v239
    s_waitcnt lgkmcnt(6)
    v_mfma_f32_32x32x16_bf16 v[80:95], v[160:163], v[144:147], v[80:95]
    ds_read_b128 v[144:147], v41 offset:43008
    v_cvt_pk_bf16_f32 v64, v64, v65
    v_cvt_pk_bf16_f32 v65, v66, v67
    v_cvt_pk_bf16_f32 v66, v68, v69
    v_cvt_pk_bf16_f32 v67, v70, v71
    v_mfma_f32_32x32x16_bf16 v[80:95], v[164:167], v[148:151], v[80:95]
    ds_read_b128 v[148:151], v41 offset:47104
    v_cvt_pk_bf16_f32 v68, v72, v73
    v_cvt_pk_bf16_f32 v69, v74, v75
    v_cvt_pk_bf16_f32 v70, v76, v77
    v_cvt_pk_bf16_f32 v71, v78, v79
    s_waitcnt lgkmcnt(6)
    v_mfma_f32_32x32x16_bf16 v[80:95], v[168:171], v[152:155], v[80:95]
    ds_read_b128 v[152:155], v41 offset:51200
    buffer_store_dwordx4 v[64:67], v24, s[12:15], s33 offen offset:0 sc1
    buffer_store_dwordx4 v[68:71], v24, s[12:15], s33 offen offset:640 sc1
    v_mfma_f32_32x32x16_bf16 v[80:95], v[172:175], v[156:159], v[80:95]
    ds_read_b128 v[156:159], v41 offset:55296
    s_waitcnt lgkmcnt(6)
    v_mfma_f32_32x32x16_bf16 v[80:95], v[176:179], v[128:131], v[80:95]
    ds_read_b128 v[128:131], v41 offset:59392
    v_mfma_f32_32x32x16_bf16 v[80:95], v[180:183], v[132:135], v[80:95]
    ds_read_b128 v[132:135], v41 offset:63488
    s_waitcnt lgkmcnt(6)
    v_mfma_f32_32x32x16_bf16 v[80:95], v[184:187], v[136:139], v[80:95]
    ds_read_b128 v[136:139], v42 offset:2048
    v_mfma_f32_32x32x16_bf16 v[80:95], v[188:191], v[140:143], v[80:95]
    ds_read_b128 v[140:143], v42 offset:6144
    s_waitcnt lgkmcnt(6)
    v_mfma_f32_32x32x16_bf16 v[96:111], v[200:203], v[144:147], v[96:111]
    ds_read_b128 v[144:147], v42 offset:10240
    v_mfma_f32_32x32x16_bf16 v[96:111], v[204:207], v[148:151], v[96:111]
    ds_read_b128 v[148:151], v42 offset:14336
    s_waitcnt lgkmcnt(6)
    v_mfma_f32_32x32x16_bf16 v[96:111], v[208:211], v[152:155], v[96:111]
    ds_read_b128 v[152:155], v42 offset:18432
    s_nop 2
    v_mul_f32 v80, v80, v224
    v_mul_f32 v81, v81, v225
    v_mul_f32 v82, v82, v226
    v_mul_f32 v83, v83, v227
    v_mfma_f32_32x32x16_bf16 v[96:111], v[212:215], v[156:159], v[96:111]
    ds_read_b128 v[156:159], v42 offset:22528
    v_mul_f32 v84, v84, v228
    v_mul_f32 v85, v85, v229
    v_mul_f32 v86, v86, v230
    v_mul_f32 v87, v87, v231
    s_waitcnt lgkmcnt(6)
    v_mfma_f32_32x32x16_bf16 v[96:111], v[216:219], v[128:131], v[96:111]
    ds_read_b128 v[128:131], v42 offset:26624
    v_mul_f32 v88, v88, v232
    v_mul_f32 v89, v89, v233
    v_mul_f32 v90, v90, v234
    v_mul_f32 v91, v91, v235
    v_mfma_f32_32x32x16_bf16 v[96:111], v[220:223], v[132:135], v[96:111]
    ds_read_b128 v[132:135], v42 offset:30720
    v_mul_f32 v92, v92, v236
    v_mul_f32 v93, v93, v237
    v_mul_f32 v94, v94, v238
    v_mul_f32 v95, v95, v239
    s_waitcnt lgkmcnt(6)
    v_mfma_f32_32x32x16_bf16 v[96:111], v[160:163], v[136:139], v[96:111]
    ds_read_b128 v[136:139], v41 offset:44032
    v_cvt_pk_bf16_f32 v80, v80, v81
    v_cvt_pk_bf16_f32 v81, v82, v83
    v_cvt_pk_bf16_f32 v82, v84, v85
    v_cvt_pk_bf16_f32 v83, v86, v87
    v_mfma_f32_32x32x16_bf16 v[96:111], v[164:167], v[140:143], v[96:111]
    ds_read_b128 v[140:143], v41 offset:48128
    v_cvt_pk_bf16_f32 v84, v88, v89
    v_cvt_pk_bf16_f32 v85, v90, v91
    v_cvt_pk_bf16_f32 v86, v92, v93
    v_cvt_pk_bf16_f32 v87, v94, v95
    s_waitcnt lgkmcnt(6)
    v_mfma_f32_32x32x16_bf16 v[96:111], v[168:171], v[144:147], v[96:111]
    ds_read_b128 v[144:147], v41 offset:52224
    buffer_store_dwordx4 v[80:83], v25, s[12:15], s33 offen offset:0 sc1
    buffer_store_dwordx4 v[84:87], v25, s[12:15], s33 offen offset:640 sc1
    v_mfma_f32_32x32x16_bf16 v[96:111], v[172:175], v[148:151], v[96:111]
    ds_read_b128 v[148:151], v41 offset:56320
    s_waitcnt lgkmcnt(6)
    v_mfma_f32_32x32x16_bf16 v[96:111], v[176:179], v[152:155], v[96:111]
    ds_read_b128 v[152:155], v41 offset:60416
    v_mfma_f32_32x32x16_bf16 v[96:111], v[180:183], v[156:159], v[96:111]
    ds_read_b128 v[156:159], v41 offset:64512
    s_waitcnt lgkmcnt(6)
    v_mfma_f32_32x32x16_bf16 v[96:111], v[184:187], v[128:131], v[96:111]
    ds_read_b128 v[128:131], v42 offset:3072
    v_mfma_f32_32x32x16_bf16 v[96:111], v[188:191], v[132:135], v[96:111]
    ds_read_b128 v[132:135], v42 offset:7168
    s_waitcnt lgkmcnt(6)
    v_mfma_f32_32x32x16_bf16 v[112:127], v[200:203], v[136:139], v[112:127]
    ds_read_b128 v[136:139], v42 offset:11264
    v_mfma_f32_32x32x16_bf16 v[112:127], v[204:207], v[140:143], v[112:127]
    ds_read_b128 v[140:143], v42 offset:15360
    s_waitcnt lgkmcnt(6)
    v_mfma_f32_32x32x16_bf16 v[112:127], v[208:211], v[144:147], v[112:127]
    ds_read_b128 v[144:147], v42 offset:19456
    s_nop 2
    v_mul_f32 v96, v96, v224
    v_mul_f32 v97, v97, v225
    v_mul_f32 v98, v98, v226
    v_mul_f32 v99, v99, v227
    v_mfma_f32_32x32x16_bf16 v[112:127], v[212:215], v[148:151], v[112:127]
    ds_read_b128 v[148:151], v42 offset:23552
    v_mul_f32 v100, v100, v228
    v_mul_f32 v101, v101, v229
    v_mul_f32 v102, v102, v230
    v_mul_f32 v103, v103, v231
    s_waitcnt lgkmcnt(6)
    v_mfma_f32_32x32x16_bf16 v[112:127], v[216:219], v[152:155], v[112:127]
    ds_read_b128 v[152:155], v42 offset:27648
    v_mul_f32 v104, v104, v232
    v_mul_f32 v105, v105, v233
    v_mul_f32 v106, v106, v234
    v_mul_f32 v107, v107, v235
    v_mfma_f32_32x32x16_bf16 v[112:127], v[220:223], v[156:159], v[112:127]
    ds_read_b128 v[156:159], v42 offset:31744
    v_mul_f32 v108, v108, v236
    v_mul_f32 v109, v109, v237
    v_mul_f32 v110, v110, v238
    v_mul_f32 v111, v111, v239
    s_waitcnt lgkmcnt(6)
    v_mfma_f32_32x32x16_bf16 v[112:127], v[160:163], v[128:131], v[112:127]
    v_cvt_pk_bf16_f32 v96, v96, v97
    v_cvt_pk_bf16_f32 v97, v98, v99
    v_cvt_pk_bf16_f32 v98, v100, v101
    v_cvt_pk_bf16_f32 v99, v102, v103
    v_mfma_f32_32x32x16_bf16 v[112:127], v[164:167], v[132:135], v[112:127]
    v_cvt_pk_bf16_f32 v100, v104, v105
    v_cvt_pk_bf16_f32 v101, v106, v107
    v_cvt_pk_bf16_f32 v102, v108, v109
    v_cvt_pk_bf16_f32 v103, v110, v111
    s_waitcnt lgkmcnt(4)
    v_mfma_f32_32x32x16_bf16 v[112:127], v[168:171], v[136:139], v[112:127]
    buffer_store_dwordx4 v[96:99], v26, s[12:15], s33 offen offset:0 sc1
    buffer_store_dwordx4 v[100:103], v26, s[12:15], s33 offen offset:640 sc1
    v_mfma_f32_32x32x16_bf16 v[112:127], v[172:175], v[140:143], v[112:127]
    s_waitcnt lgkmcnt(2)
    v_mfma_f32_32x32x16_bf16 v[112:127], v[176:179], v[144:147], v[112:127]
    v_mfma_f32_32x32x16_bf16 v[112:127], v[180:183], v[148:151], v[112:127]
    s_waitcnt lgkmcnt(0)
    v_mfma_f32_32x32x16_bf16 v[112:127], v[184:187], v[152:155], v[112:127]
    v_mfma_f32_32x32x16_bf16 v[112:127], v[188:191], v[156:159], v[112:127]
    s_barrier
    s_nop 10
    v_mul_f32 v112, v112, v224
    v_mul_f32 v113, v113, v225
    v_mul_f32 v114, v114, v226
    v_mul_f32 v115, v115, v227
    v_mul_f32 v116, v116, v228
    v_mul_f32 v117, v117, v229
    v_mul_f32 v118, v118, v230
    v_mul_f32 v119, v119, v231
    v_mul_f32 v120, v120, v232
    v_mul_f32 v121, v121, v233
    v_mul_f32 v122, v122, v234
    v_mul_f32 v123, v123, v235
    v_mul_f32 v124, v124, v236
    v_mul_f32 v125, v125, v237
    v_mul_f32 v126, v126, v238
    v_mul_f32 v127, v127, v239
    v_cvt_pk_bf16_f32 v112, v112, v113
    v_cvt_pk_bf16_f32 v113, v114, v115
    v_cvt_pk_bf16_f32 v114, v116, v117
    v_cvt_pk_bf16_f32 v115, v118, v119
    v_cvt_pk_bf16_f32 v116, v120, v121
    v_cvt_pk_bf16_f32 v117, v122, v123
    v_cvt_pk_bf16_f32 v118, v124, v125
    v_cvt_pk_bf16_f32 v119, v126, v127
    buffer_store_dwordx4 v[112:115], v27, s[12:15], s33 offen offset:0 sc1
    buffer_store_dwordx4 v[116:119], v27, s[12:15], s33 offen offset:640 sc1
interleave_layers__softmax_full_mha__sliding_local_dilated__prompt_kernel_p5_fin5:
    s_barrier
    s_lshl_b32 s48, s17, 11
    s_add_u32 s48, s48, 98816
    v_lshlrev_b32 v241, 8, v1
    s_mov_b64 s[56:57], 0xff
    v_mov_b32 v243, 163816
    v_mov_b32 v240, 1
    s_mov_b64 exec, 1
    s_waitcnt vmcnt(0)
    ds_add_rtn_u32 v242, v243, v240 offset:0
    s_waitcnt lgkmcnt(0)
    v_readfirstlane_b32 s49, v242
    s_mov_b64 exec, s[56:57]
    s_cmp_eq_u32 s49, 3
    s_cbranch_scc0 interleave_layers__softmax_full_mha__sliding_local_dilated__prompt_kernel_s5_sg
    buffer_atomic_add v240, v241, s[8:11], s48 offen sc1
interleave_layers__softmax_full_mha__sliding_local_dilated__prompt_kernel_s5_sg:
    s_mov_b64 exec, -1
interleave_layers__softmax_full_mha__sliding_local_dilated__prompt_kernel_t1:
    s_mov_b32 s3, 1
    s_add_u32 s8, s8, 65536
    s_addc_u32 s9, s9, 0
    s_mov_b32 s10, 65536
    s_branch interleave_layers__softmax_full_mha__sliding_local_dilated__prompt_kernel_top
interleave_layers__softmax_full_mha__sliding_local_dilated__prompt_kernel_idle:
    s_barrier
    s_barrier
    s_barrier
    s_barrier
    s_branch interleave_layers__softmax_full_mha__sliding_local_dilated__prompt_kernel_t1
interleave_layers__softmax_full_mha__sliding_local_dilated__prompt_kernel_ld:
    s_setprio 2
    s_lshl_b32 s22, s20, 1
    s_and_b32 s23, s21, 1
    s_add_u32 s16, s22, s23
    s_lshr_b32 s17, s21, 1
    s_nop 0
    s_mul_i32 s58, s17, 163840
    s_add_u32 s58, s58, s45
    s_add_u32 s58, s58, 22216704
    s_lshl_b32 s22, s20, 2
    s_and_b32 s23, s21, 3
    s_add_u32 s16, s22, s23
    s_lshr_b32 s17, s21, 2
    s_mul_i32 s50, s17, 102400
    s_add_u32 s50, s50, s45
    s_add_u32 s50, s50, 21397504
    s_mul_i32 s51, s16, 81920
    s_lshl_b32 s52, s17, 2
    s_add_u32 s52, s52, s39
    s_mul_i32 s52, s52, 2560
    s_add_u32 s51, s51, s52
    s_add_u32 s51, s51, 10747904
    v_min_u32 v21, 39, v1
    v_lshlrev_b32 v21, 6, v21
    s_lshl_b32 s48, s17, 3
    s_and_b32 s49, s16, 1
    s_add_u32 s48, s48, s49
    s_lshl_b32 s48, s48, 8
    s_add_u32 s48, s48, 0
    v_lshlrev_b32 v241, 9, v1
    s_mov_b64 s[56:57], 15
    v_mov_b32 v243, 163816
    v_mov_b32 v240, 1
    s_mov_b64 exec, 1
    s_waitcnt vmcnt(0)
    ds_add_rtn_u32 v242, v243, v240 offset:8
    s_waitcnt lgkmcnt(0)
    v_readfirstlane_b32 s49, v242
    s_mov_b64 exec, s[56:57]
    s_cmp_eq_u32 s49, 7
    s_cbranch_scc0 interleave_layers__softmax_full_mha__sliding_local_dilated__prompt_kernel_s1l_sg
    buffer_atomic_add v240, v241, s[8:11], s48 offen sc1
interleave_layers__softmax_full_mha__sliding_local_dilated__prompt_kernel_s1l_sg:
    s_mov_b64 exec, -1
    v_lshrrev_b32 v6, 5, v1
    v_and_b32 v5, 31, v1
    s_lshr_b32 s30, s21, 1
    v_mul_u32_u24 v12, 5120, v6
    v_lshl_add_u32 v12, v5, 2, v12
    s_mul_i32 s30, s30, 10240
    s_lshl_b32 s31, s39, 7
    s_add_u32 s30, s30, s31
    s_add_u32 s30, s30, 18776064
    s_add_u32 s31, s30, 2560
    buffer_load_dword v64, v12, s[12:15], s30 offen offset:0
    buffer_load_dword v65, v12, s[12:15], s30 offen offset:512
    buffer_load_dword v66, v12, s[12:15], s30 offen offset:1024
    buffer_load_dword v67, v12, s[12:15], s30 offen offset:1536
    buffer_load_dword v68, v12, s[12:15], s30 offen offset:2048
    buffer_load_dword v69, v12, s[12:15], s31 offen offset:0
    buffer_load_dword v70, v12, s[12:15], s31 offen offset:512
    buffer_load_dword v71, v12, s[12:15], s31 offen offset:1024
    buffer_load_dword v72, v12, s[12:15], s31 offen offset:1536
    buffer_load_dword v73, v12, s[12:15], s31 offen offset:2048
    v_bfe_u32 v6, v1, 4, 1
    v_lshlrev_b32 v46, 9, v6
    v_and_b32 v5, 15, v1
    v_lshl_add_u32 v46, v5, 3, v46
    s_lshl_b32 s30, s39, 12
    v_add_u32 v46, s30, v46
    s_add_u32 m0, s45, 24576
    s_add_u32 s32, s50, 24576
    buffer_load_dwordx4 v3, s[12:15], s32 offen sc1 lds
    s_add_u32 m0, s45, 28672
    s_add_u32 s32, s50, 28672
    buffer_load_dwordx4 v3, s[12:15], s32 offen sc1 lds
    s_add_u32 m0, s45, 32768
    s_add_u32 s32, s50, 32768
    buffer_load_dwordx4 v3, s[12:15], s32 offen sc1 lds
    s_add_u32 m0, s45, 36864
    s_add_u32 s32, s50, 36864
    buffer_load_dwordx4 v3, s[12:15], s32 offen sc1 lds
    s_add_u32 m0, s45, 40960
    s_add_u32 s32, s50, 40960
    buffer_load_dwordx4 v3, s[12:15], s32 offen sc1 lds
    s_add_u32 m0, s45, 45056
    s_add_u32 s32, s50, 45056
    buffer_load_dwordx4 v3, s[12:15], s32 offen sc1 lds
    s_add_u32 m0, s45, 49152
    s_add_u32 s32, s50, 49152
    buffer_load_dwordx4 v3, s[12:15], s32 offen sc1 lds
    s_add_u32 m0, s45, 53248
    s_add_u32 s32, s50, 53248
    buffer_load_dwordx4 v3, s[12:15], s32 offen sc1 lds
    s_add_u32 m0, s45, 57344
    s_add_u32 s32, s50, 57344
    buffer_load_dwordx4 v3, s[12:15], s32 offen sc1 lds
    s_add_u32 m0, s45, 61440
    s_add_u32 s32, s50, 61440
    buffer_load_dwordx4 v3, s[12:15], s32 offen sc1 lds
    s_add_u32 m0, s45, 65536
    s_add_u32 s32, s50, 65536
    buffer_load_dwordx4 v3, s[12:15], s32 offen sc1 lds
    s_add_u32 m0, s45, 69632
    s_add_u32 s32, s50, 69632
    buffer_load_dwordx4 v3, s[12:15], s32 offen sc1 lds
    s_add_u32 m0, s45, 73728
    s_add_u32 s32, s50, 73728
    buffer_load_dwordx4 v3, s[12:15], s32 offen sc1 lds
    s_add_u32 m0, s45, 77824
    s_add_u32 s32, s50, 77824
    buffer_load_dwordx4 v3, s[12:15], s32 offen sc1 lds
    s_add_u32 m0, s45, 81920
    s_add_u32 s32, s50, 81920
    buffer_load_dwordx4 v3, s[12:15], s32 offen sc1 lds
    s_add_u32 m0, s45, 86016
    s_add_u32 s32, s50, 86016
    buffer_load_dwordx4 v3, s[12:15], s32 offen sc1 lds
    s_add_u32 m0, s45, 90112
    s_add_u32 s32, s50, 90112
    buffer_load_dwordx4 v3, s[12:15], s32 offen sc1 lds
    s_add_u32 m0, s45, 94208
    s_add_u32 s32, s50, 94208
    buffer_load_dwordx4 v3, s[12:15], s32 offen sc1 lds
    s_add_u32 m0, s45, 98304
    s_add_u32 s32, s50, 98304
    buffer_load_dwordx4 v3, s[12:15], s32 offen sc1 lds
    s_add_u32 m0, s45, 102400
    s_add_u32 s32, s58, 102400
    buffer_load_dwordx4 v3, s[12:15], s32 offen sc1 lds
    s_add_u32 m0, s45, 106496
    s_add_u32 s32, s58, 106496
    buffer_load_dwordx4 v3, s[12:15], s32 offen sc1 lds
    s_add_u32 m0, s45, 110592
    s_add_u32 s32, s58, 110592
    buffer_load_dwordx4 v3, s[12:15], s32 offen sc1 lds
    s_add_u32 m0, s45, 114688
    s_add_u32 s32, s58, 114688
    buffer_load_dwordx4 v3, s[12:15], s32 offen sc1 lds
    s_add_u32 m0, s45, 118784
    s_add_u32 s32, s58, 118784
    buffer_load_dwordx4 v3, s[12:15], s32 offen sc1 lds
    s_add_u32 m0, s45, 122880
    s_add_u32 s32, s58, 122880
    buffer_load_dwordx4 v3, s[12:15], s32 offen sc1 lds
    s_add_u32 m0, s45, 126976
    s_add_u32 s32, s58, 126976
    buffer_load_dwordx4 v3, s[12:15], s32 offen sc1 lds
    s_add_u32 m0, s45, 131072
    s_add_u32 s32, s58, 131072
    buffer_load_dwordx4 v3, s[12:15], s32 offen sc1 lds
    v_mov_b32 v243, 163824
    s_mov_b32 s49, 0
interleave_layers__softmax_full_mha__sliding_local_dilated__prompt_kernel_a8:
    ds_read_b32 v240, v243
    s_add_u32 s49, s49, 1
    s_waitcnt lgkmcnt(0)
    v_readfirstlane_b32 s44, v240
    s_cmp_ge_u32 s49, 0x400000
    s_cselect_b32 s44, 8, s44
    s_cmp_lt_u32 s44, 8
    s_cbranch_scc1 interleave_layers__softmax_full_mha__sliding_local_dilated__prompt_kernel_a8
    s_add_u32 m0, s45, 135168
    s_add_u32 s32, s58, 135168
    buffer_load_dwordx4 v3, s[12:15], s32 offen sc1 lds
    s_add_u32 m0, s45, 139264
    s_add_u32 s32, s58, 139264
    buffer_load_dwordx4 v3, s[12:15], s32 offen sc1 lds
    s_add_u32 m0, s45, 143360
    s_add_u32 s32, s58, 143360
    buffer_load_dwordx4 v3, s[12:15], s32 offen sc1 lds
    s_add_u32 m0, s45, 147456
    s_add_u32 s32, s58, 147456
    buffer_load_dwordx4 v3, s[12:15], s32 offen sc1 lds
    s_add_u32 m0, s45, 151552
    s_add_u32 s32, s58, 151552
    buffer_load_dwordx4 v3, s[12:15], s32 offen sc1 lds
    s_add_u32 m0, s45, 155648
    s_add_u32 s32, s58, 155648
    buffer_load_dwordx4 v3, s[12:15], s32 offen sc1 lds
    s_waitcnt vmcnt(33)
    v_add_f32 v64, v64, v69
    v_add_f32 v65, v65, v70
    v_add_f32 v66, v66, v71
    v_add_f32 v67, v67, v72
    v_add_f32 v68, v68, v73
    v_add_f32 v64, v64, v65
    v_add_f32 v66, v66, v67
    v_add_f32 v64, v64, v68
    v_add_f32 v64, v64, v66
    v_mov_b32 v65, v64
    s_nop 1
    v_permlane32_swap_b32 v64, v65
    s_nop 1
    v_add_f32 v64, v64, v65
    v_and_b32 v17, 0xffff0000, v64
    v_sub_f32 v19, v64, v17
    v_cvt_pk_bf16_f32 v28, v17, v19
    v_lshrrev_b32 v29, 16, v17
    s_waitcnt vmcnt(14)
    s_barrier
    s_barrier
    s_add_u32 m0, s45, 0
    s_add_u32 s32, s58, 0
    buffer_load_dwordx4 v3, s[12:15], s32 offen sc1 lds
    s_add_u32 m0, s45, 4096
    s_add_u32 s32, s58, 4096
    buffer_load_dwordx4 v3, s[12:15], s32 offen sc1 lds
    s_add_u32 m0, s45, 8192
    s_add_u32 s32, s58, 8192
    buffer_load_dwordx4 v3, s[12:15], s32 offen sc1 lds
    s_add_u32 m0, s45, 12288
    s_add_u32 s32, s58, 12288
    buffer_load_dwordx4 v3, s[12:15], s32 offen sc1 lds
    s_add_u32 m0, s45, 16384
    s_add_u32 s32, s58, 16384
    buffer_load_dwordx4 v3, s[12:15], s32 offen sc1 lds
    s_add_u32 m0, s45, 20480
    s_add_u32 s32, s58, 20480
    buffer_load_dwordx4 v3, s[12:15], s32 offen sc1 lds
    s_add_u32 m0, s45, 24576
    s_add_u32 s32, s58, 24576
    buffer_load_dwordx4 v3, s[12:15], s32 offen sc1 lds
    s_add_u32 m0, s45, 28672
    s_add_u32 s32, s58, 28672
    buffer_load_dwordx4 v3, s[12:15], s32 offen sc1 lds
    s_add_u32 m0, s45, 32768
    s_add_u32 s32, s58, 32768
    buffer_load_dwordx4 v3, s[12:15], s32 offen sc1 lds
    s_add_u32 m0, s45, 36864
    s_add_u32 s32, s58, 36864
    buffer_load_dwordx4 v3, s[12:15], s32 offen sc1 lds
    s_add_u32 m0, s45, 40960
    s_add_u32 s32, s58, 40960
    buffer_load_dwordx4 v3, s[12:15], s32 offen sc1 lds
    s_add_u32 m0, s45, 45056
    s_add_u32 s32, s58, 45056
    buffer_load_dwordx4 v3, s[12:15], s32 offen sc1 lds
    s_add_u32 m0, s45, 49152
    s_add_u32 s32, s58, 49152
    buffer_load_dwordx4 v3, s[12:15], s32 offen sc1 lds
    s_add_u32 m0, s45, 53248
    s_add_u32 s32, s58, 53248
    buffer_load_dwordx4 v3, s[12:15], s32 offen sc1 lds
    s_add_u32 m0, s45, 57344
    s_add_u32 s32, s58, 57344
    buffer_load_dwordx4 v3, s[12:15], s32 offen sc1 lds
    s_barrier
    s_waitcnt vmcnt(0)
    s_add_u32 m0, s45, 61440
    s_add_u32 s32, s58, 61440
    buffer_load_dwordx4 v3, s[12:15], s32 offen sc1 lds
    s_add_u32 m0, s45, 65536
    s_add_u32 s32, s58, 65536
    buffer_load_dwordx4 v3, s[12:15], s32 offen sc1 lds
    s_add_u32 m0, s45, 69632
    s_add_u32 s32, s58, 69632
    buffer_load_dwordx4 v3, s[12:15], s32 offen sc1 lds
    s_waitcnt vmcnt(2)
    s_add_u32 m0, s45, 73728
    s_add_u32 s32, s58, 73728
    buffer_load_dwordx4 v3, s[12:15], s32 offen sc1 lds
    s_waitcnt vmcnt(2)
    s_add_u32 m0, s45, 77824
    s_add_u32 s32, s58, 77824
    buffer_load_dwordx4 v3, s[12:15], s32 offen sc1 lds
    s_waitcnt vmcnt(2)
    s_add_u32 m0, s45, 81920
    s_add_u32 s32, s58, 81920
    buffer_load_dwordx4 v3, s[12:15], s32 offen sc1 lds
    s_waitcnt vmcnt(2)
    s_add_u32 m0, s45, 86016
    s_add_u32 s32, s58, 86016
    buffer_load_dwordx4 v3, s[12:15], s32 offen sc1 lds
    s_waitcnt vmcnt(2)
    s_add_u32 m0, s45, 90112
    s_add_u32 s32, s58, 90112
    buffer_load_dwordx4 v3, s[12:15], s32 offen sc1 lds
    s_waitcnt vmcnt(2)
    s_add_u32 m0, s45, 94208
    s_add_u32 s32, s58, 94208
    buffer_load_dwordx4 v3, s[12:15], s32 offen sc1 lds
    s_waitcnt vmcnt(2)
    s_add_u32 m0, s45, 98304
    s_add_u32 s32, s58, 98304
    buffer_load_dwordx4 v3, s[12:15], s32 offen sc1 lds
    s_waitcnt vmcnt(2)
    s_lshl_b32 s22, s20, 1
    s_and_b32 s23, s21, 1
    s_add_u32 s16, s22, s23
    s_lshr_b32 s17, s21, 1
    v_and_b32 v5, 15, v1
    v_lshrrev_b32 v6, 4, v1
    v_lshlrev_b32 v11, 3, v5
    v_lshl_add_u32 v11, v6, 8, v11
    v_cmp_eq_u32 vcc, 0, v6
    s_lshl_b32 s22, s16, 3
    s_max_u32 s22, s22, 1
    v_cndmask_b32 v4, 0, -1, vcc
    s_sub_u32 s22, s22, 1
    s_mul_i32 s24, s22, 20480
    s_add_u32 s24, s24, 15990784
    s_add_u32 s24, s24, s45
    s_lshl_b32 s27, s22, 10
    s_add_u32 s27, s27, 18612224
    v_lshrrev_b32 v12, 1, v6
    v_lshlrev_b32 v40, 12, v12
    v_and_b32 v12, 1, v6
    v_lshl_add_u32 v40, v12, 9, v40
    v_lshl_add_u32 v40, v5, 4, v40
    s_lshl_b32 s32, s39, 13
    v_add_u32 v40, s32, v40
    v_add_u32 v41, 65536, v40
    v_add_u32 v42, 131072, v40
    s_mul_i32 s33, s39, 6144
    s_add_u32 s33, s33, 49152
    v_add_u32 v43, s33, v3
    s_min_u32 s40, s39, 2
    s_lshl_b32 s41, s40, 11
    s_add_u32 s41, s41, 49152
    v_add_u32 v44, s41, v3
    s_lshl_b32 s41, s40, 12
    v_lshlrev_b32 v45, 3, v5
    v_add_u32 v45, s41, v45
    v_mul_u32_u24 v12, 296, v5
    v_add_u32 v12, 88448, v12
    s_lshl_b32 s41, s40, 3
    s_sub_u32 s41, s41, 2
    v_add_u32 v13, s41, v6
    v_add_u32 v14, 16, v13
    v_cmp_gt_u32 vcc, 20, v13
    s_nop 1
    v_cndmask_b32 v14, 0, v14, vcc
    v_lshl_add_u32 v50, v14, 3, v12
    v_add_u32 v13, s41, v6
    v_add_u32 v13, 4, v13
    v_add_u32 v14, 16, v13
    v_cmp_gt_u32 vcc, 20, v13
    s_nop 1
    v_cndmask_b32 v14, 0, v14, vcc
    v_lshl_add_u32 v51, v14, 3, v12
    v_mov_b32 v47, v12
    v_mov_b32 v56, 0x3f803f80
    v_mov_b32 v57, 0x3f803f80
    s_mul_i32 s51, s16, 163840
    s_lshl_b32 s52, s17, 2
    s_add_u32 s52, s52, s39
    s_mul_i32 s52, s52, 2560
    s_add_u32 s51, s51, s52
    s_add_u32 s51, s51, 15990784
    v_min_u32 v21, 39, v1
    v_lshlrev_b32 v21, 6, v21
    s_setprio 0
    s_barrier
    s_add_u32 m0, s45, 159744
    s_add_u32 s32, s58, 159744
    buffer_load_dwordx4 v3, s[12:15], s32 offen sc1 lds
    ds_write_b64 v46, v[28:29] offset:3456
    buffer_load_dwordx2 v[24:25], v11, s[12:15], s27 offen offset:0 sc1
    buffer_load_dwordx2 v[26:27], v11, s[12:15], s27 offen offset:128 sc1
    buffer_load_dwordx4 v[128:131], v3, s[12:15], s24 offen sc1
    s_add_u32 s24, s24, 4096
    buffer_load_dwordx4 v[132:135], v3, s[12:15], s24 offen sc1
    s_add_u32 s24, s24, 4096
    buffer_load_dwordx4 v[136:139], v3, s[12:15], s24 offen sc1
    s_add_u32 s24, s24, 4096
    buffer_load_dwordx4 v[140:143], v3, s[12:15], s24 offen sc1
    s_add_u32 s24, s24, 4096
    buffer_load_dwordx4 v[144:147], v3, s[12:15], s24 offen sc1
    s_waitcnt vmcnt(5)
    v_add_f32 v24, v24, v26
    v_add_f32 v25, v25, v27
    v_mov_b32 v26, v24
    s_nop 1
    v_permlane16_swap_b32 v24, v26
    s_nop 1
    v_add_f32 v24, v24, v26
    v_mov_b32 v27, v25
    s_nop 1
    v_permlane16_swap_b32 v25, v27
    s_nop 1
    v_add_f32 v25, v25, v27
    v_mov_b32 v26, v24
    s_nop 1
    v_permlane32_swap_b32 v24, v26
    s_nop 1
    v_add_f32 v24, v24, v26
    v_mov_b32 v27, v25
    s_nop 1
    v_permlane32_swap_b32 v25, v27
    s_nop 1
    v_add_f32 v25, v25, v27
    v_mul_f32 v26, 0x3acccccd, v24
    v_mul_f32 v27, 0x3acccccd, v25
    v_fma_f32 v27, -v26, v26, v27
    v_max_f32 v27, 0, v27
    v_add_f32 v27, 0x3727c5ac, v27
    v_rsq_f32 v48, v27
    s_nop 0
    v_xor_b32 v18, 0x80000000, v26
    v_and_b32 v17, 0xffff0000, v18
    v_sub_f32 v19, v18, v17
    v_cvt_pk_bf16_f32 v52, v17, v17
    v_cvt_pk_bf16_f32 v53, v19, 0
    v_and_b32 v52, v52, v4
    v_and_b32 v53, v53, v4
    s_waitcnt lgkmcnt(0)
    s_barrier
    ds_read_b128 v[96:99], v40 offset:1024
    ds_read_b128 v[100:103], v40 offset:1280
    ds_read_b128 v[104:107], v40 offset:2048
    ds_read_b128 v[108:111], v40 offset:2304
    ds_read_b128 v[112:115], v40 offset:3072
    ds_read_b128 v[116:119], v40 offset:3328
    ds_read_b64 v[20:21], v45 offset:7552
    ds_read_b64 v[22:23], v45 offset:8064
    s_waitcnt vmcnt(4)
    s_waitcnt lgkmcnt(7)
    v_mfma_f32_16x16x32_bf16 v[148:151], v[96:99], v[128:131], 0
    ds_read_b128 v[96:99], v40 offset:33792
    s_waitcnt lgkmcnt(7)
    v_mfma_f32_16x16x32_bf16 v[152:155], v[100:103], v[128:131], 0
    ds_read_b128 v[100:103], v40 offset:34048
    s_waitcnt lgkmcnt(7)
    v_mfma_f32_16x16x32_bf16 v[156:159], v[104:107], v[128:131], 0
    ds_read_b128 v[104:107], v40 offset:34816
    s_waitcnt lgkmcnt(7)
    v_mfma_f32_16x16x32_bf16 v[160:163], v[108:111], v[128:131], 0
    ds_read_b128 v[108:111], v40 offset:35072
    s_waitcnt lgkmcnt(7)
    v_mfma_f32_16x16x32_bf16 v[164:167], v[112:115], v[128:131], 0
    ds_read_b128 v[112:115], v40 offset:35840
    s_waitcnt lgkmcnt(7)
    v_mfma_f32_16x16x32_bf16 v[168:171], v[116:119], v[128:131], 0
    ds_read_b128 v[116:119], v40 offset:36096
    s_waitcnt vmcnt(3)
    s_waitcnt lgkmcnt(5)
    v_mfma_f32_16x16x32_bf16 v[148:151], v[96:99], v[132:135], v[148:151]
    ds_read_b128 v[96:99], v41 offset:1024
    s_waitcnt lgkmcnt(5)
    v_mfma_f32_16x16x32_bf16 v[152:155], v[100:103], v[132:135], v[152:155]
    ds_read_b128 v[100:103], v41 offset:1280
    s_waitcnt lgkmcnt(5)
    v_mfma_f32_16x16x32_bf16 v[156:159], v[104:107], v[132:135], v[156:159]
    ds_read_b128 v[104:107], v41 offset:2048
    s_waitcnt lgkmcnt(5)
    v_mfma_f32_16x16x32_bf16 v[160:163], v[108:111], v[132:135], v[160:163]
    ds_read_b128 v[108:111], v41 offset:2304
    s_waitcnt lgkmcnt(5)
    v_mfma_f32_16x16x32_bf16 v[164:167], v[112:115], v[132:135], v[164:167]
    ds_read_b128 v[112:115], v41 offset:3072
    s_waitcnt lgkmcnt(5)
    v_mfma_f32_16x16x32_bf16 v[168:171], v[116:119], v[132:135], v[168:171]
    ds_read_b128 v[116:119], v41 offset:3328
    s_waitcnt vmcnt(2)
    s_waitcnt lgkmcnt(5)
    v_mfma_f32_16x16x32_bf16 v[148:151], v[96:99], v[136:139], v[148:151]
    ds_read_b128 v[96:99], v41 offset:33792
    s_waitcnt lgkmcnt(5)
    v_mfma_f32_16x16x32_bf16 v[152:155], v[100:103], v[136:139], v[152:155]
    ds_read_b128 v[100:103], v41 offset:34048
    s_waitcnt lgkmcnt(5)
    v_mfma_f32_16x16x32_bf16 v[156:159], v[104:107], v[136:139], v[156:159]
    ds_read_b128 v[104:107], v41 offset:34816
    s_waitcnt lgkmcnt(5)
    v_mfma_f32_16x16x32_bf16 v[160:163], v[108:111], v[136:139], v[160:163]
    ds_read_b128 v[108:111], v41 offset:35072
    s_waitcnt lgkmcnt(5)
    v_mfma_f32_16x16x32_bf16 v[164:167], v[112:115], v[136:139], v[164:167]
    ds_read_b128 v[112:115], v41 offset:35840
    s_waitcnt lgkmcnt(5)
    v_mfma_f32_16x16x32_bf16 v[168:171], v[116:119], v[136:139], v[168:171]
    ds_read_b128 v[116:119], v41 offset:36096
    s_waitcnt vmcnt(1)
    s_waitcnt lgkmcnt(5)
    v_mfma_f32_16x16x32_bf16 v[148:151], v[96:99], v[140:143], v[148:151]
    ds_read_b128 v[96:99], v42 offset:1024
    s_waitcnt lgkmcnt(5)
    v_mfma_f32_16x16x32_bf16 v[152:155], v[100:103], v[140:143], v[152:155]
    ds_read_b128 v[100:103], v42 offset:1280
    s_waitcnt lgkmcnt(5)
    v_mfma_f32_16x16x32_bf16 v[156:159], v[104:107], v[140:143], v[156:159]
    ds_read_b128 v[104:107], v42 offset:2048
    s_waitcnt lgkmcnt(5)
    v_mfma_f32_16x16x32_bf16 v[160:163], v[108:111], v[140:143], v[160:163]
    ds_read_b128 v[108:111], v42 offset:2304
    s_waitcnt lgkmcnt(5)
    v_mfma_f32_16x16x32_bf16 v[164:167], v[112:115], v[140:143], v[164:167]
    ds_read_b128 v[112:115], v42 offset:3072
    s_waitcnt lgkmcnt(5)
    v_mfma_f32_16x16x32_bf16 v[168:171], v[116:119], v[140:143], v[168:171]
    ds_read_b128 v[116:119], v42 offset:3328
    s_waitcnt vmcnt(0)
    s_waitcnt lgkmcnt(5)
    v_mfma_f32_16x16x32_bf16 v[148:151], v[96:99], v[144:147], v[148:151]
    s_waitcnt lgkmcnt(4)
    v_mfma_f32_16x16x32_bf16 v[152:155], v[100:103], v[144:147], v[152:155]
    s_waitcnt lgkmcnt(3)
    v_mfma_f32_16x16x32_bf16 v[156:159], v[104:107], v[144:147], v[156:159]
    s_waitcnt lgkmcnt(2)
    v_mfma_f32_16x16x32_bf16 v[160:163], v[108:111], v[144:147], v[160:163]
    s_waitcnt lgkmcnt(1)
    v_mfma_f32_16x16x32_bf16 v[164:167], v[112:115], v[144:147], v[164:167]
    s_waitcnt lgkmcnt(0)
    v_mfma_f32_16x16x32_bf16 v[168:171], v[116:119], v[144:147], v[168:171]
    s_barrier
    ds_write_b128 v43, v[148:151] offset:0
    ds_write_b128 v43, v[152:155] offset:1024
    ds_write_b128 v43, v[156:159] offset:2048
    ds_write_b128 v43, v[160:163] offset:3072
    s_nop 0
    ds_write_b128 v43, v[164:167] offset:4096
    s_nop 0
    ds_write_b128 v43, v[168:171] offset:5120
    s_waitcnt lgkmcnt(0)
    s_barrier
    ds_read_b128 v[96:99], v44 offset:0
    ds_read_b128 v[100:103], v44 offset:1024
    ds_read_b128 v[104:107], v44 offset:6144
    ds_read_b128 v[108:111], v44 offset:7168
    ds_read_b128 v[112:115], v44 offset:12288
    ds_read_b128 v[116:119], v44 offset:13312
    ds_read_b128 v[120:123], v44 offset:18432
    ds_read_b128 v[124:127], v44 offset:19456
    s_waitcnt lgkmcnt(0)
    v_add_f32 v96, v96, v104
    v_add_f32 v112, v112, v120
    v_add_f32 v80, v96, v112
    v_add_f32 v97, v97, v105
    v_add_f32 v113, v113, v121
    v_add_f32 v81, v97, v113
    v_add_f32 v98, v98, v106
    v_add_f32 v114, v114, v122
    v_add_f32 v82, v98, v114
    v_add_f32 v99, v99, v107
    v_add_f32 v115, v115, v123
    v_add_f32 v83, v99, v115
    v_add_f32 v100, v100, v108
    v_add_f32 v116, v116, v124
    v_add_f32 v84, v100, v116
    v_add_f32 v101, v101, v109
    v_add_f32 v117, v117, v125
    v_add_f32 v85, v101, v117
    v_add_f32 v102, v102, v110
    v_add_f32 v118, v118, v126
    v_add_f32 v86, v102, v118
    v_add_f32 v103, v103, v111
    v_add_f32 v119, v119, v127
    v_add_f32 v87, v103, v119
    v_mfma_f32_16x16x16_bf16 v[80:83], v[20:21], v[52:53], v[80:83]
    s_nop 0
    v_mfma_f32_16x16x16_bf16 v[84:87], v[22:23], v[52:53], v[84:87]
    s_nop 5
    v_mul_f32 v80, v80, v48
    v_mul_f32 v81, v81, v48
    v_mul_f32 v82, v82, v48
    v_mul_f32 v83, v83, v48
    v_cvt_pk_bf16_f32 v88, v80, v81
    v_cvt_pk_bf16_f32 v89, v82, v83
    v_mul_f32 v84, v84, v48
    v_mul_f32 v85, v85, v48
    v_mul_f32 v86, v86, v48
    v_mul_f32 v87, v87, v48
    v_cvt_pk_bf16_f32 v90, v84, v85
    v_cvt_pk_bf16_f32 v91, v86, v87
    ds_write_b64 v50, v[88:89]
    ds_write_b64 v51, v[90:91]
    ds_write_b64 v47, v[56:57] offset:288
    s_setprio 2
    s_waitcnt lgkmcnt(0)
    s_barrier
    s_lshl_b32 s22, s20, 1
    s_and_b32 s23, s21, 1
    s_add_u32 s16, s22, s23
    s_lshr_b32 s17, s21, 1
    s_min_u32 s17, s17, 14
    s_mul_i32 s58, s17, 163840
    s_add_u32 s58, s58, s45
    s_add_u32 s58, s58, 18939904
    s_lshl_b32 s22, s20, 2
    s_and_b32 s23, s21, 3
    s_add_u32 s16, s22, s23
    s_lshr_b32 s17, s21, 2
    s_mul_i32 s50, s17, 102400
    s_add_u32 s50, s50, s45
    s_add_u32 s50, s50, 24838144
    s_mul_i32 s51, s16, 81920
    s_lshl_b32 s52, s17, 2
    s_add_u32 s52, s52, s39
    s_mul_i32 s52, s52, 2560
    s_add_u32 s51, s51, s52
    s_add_u32 s51, s51, 13369344
    v_min_u32 v21, 39, v1
    v_lshlrev_b32 v21, 6, v21
    s_add_u32 m0, s45, 0
    s_add_u32 s32, s50, 0
    buffer_load_dwordx4 v3, s[12:15], s32 offen sc1 lds
    s_add_u32 m0, s45, 4096
    s_add_u32 s32, s50, 4096
    buffer_load_dwordx4 v3, s[12:15], s32 offen sc1 lds
    s_add_u32 m0, s45, 8192
    s_add_u32 s32, s50, 8192
    buffer_load_dwordx4 v3, s[12:15], s32 offen sc1 lds
    s_add_u32 m0, s45, 12288
    s_add_u32 s32, s50, 12288
    buffer_load_dwordx4 v3, s[12:15], s32 offen sc1 lds
    s_add_u32 m0, s45, 16384
    s_add_u32 s32, s50, 16384
    buffer_load_dwordx4 v3, s[12:15], s32 offen sc1 lds
    s_add_u32 m0, s45, 20480
    s_add_u32 s32, s50, 20480
    buffer_load_dwordx4 v3, s[12:15], s32 offen sc1 lds
    s_barrier
    s_add_u32 m0, s45, 24576
    s_add_u32 s32, s50, 24576
    buffer_load_dwordx4 v3, s[12:15], s32 offen sc1 lds
    s_waitcnt vmcnt(4)
    s_add_u32 m0, s45, 28672
    s_add_u32 s32, s50, 28672
    buffer_load_dwordx4 v3, s[12:15], s32 offen sc1 lds
    s_waitcnt vmcnt(4)
    s_add_u32 m0, s45, 32768
    s_add_u32 s32, s50, 32768
    buffer_load_dwordx4 v3, s[12:15], s32 offen sc1 lds
    s_waitcnt vmcnt(4)
    s_add_u32 m0, s45, 36864
    s_add_u32 s32, s50, 36864
    buffer_load_dwordx4 v3, s[12:15], s32 offen sc1 lds
    s_waitcnt vmcnt(4)
    s_add_u32 m0, s45, 40960
    s_add_u32 s32, s50, 40960
    buffer_load_dwordx4 v3, s[12:15], s32 offen sc1 lds
    s_waitcnt vmcnt(4)
    s_add_u32 m0, s45, 45056
    s_add_u32 s32, s50, 45056
    buffer_load_dwordx4 v3, s[12:15], s32 offen sc1 lds
    s_waitcnt vmcnt(4)
    s_add_u32 m0, s45, 49152
    s_add_u32 s32, s50, 49152
    buffer_load_dwordx4 v3, s[12:15], s32 offen sc1 lds
    s_waitcnt vmcnt(4)
    s_add_u32 m0, s45, 53248
    s_add_u32 s32, s50, 53248
    buffer_load_dwordx4 v3, s[12:15], s32 offen sc1 lds
    s_waitcnt vmcnt(4)
    s_add_u32 m0, s45, 57344
    s_add_u32 s32, s50, 57344
    buffer_load_dwordx4 v3, s[12:15], s32 offen sc1 lds
    s_waitcnt vmcnt(4)
    s_add_u32 m0, s45, 61440
    s_add_u32 s32, s50, 61440
    buffer_load_dwordx4 v3, s[12:15], s32 offen sc1 lds
    s_waitcnt vmcnt(4)
    s_add_u32 m0, s45, 65536
    s_add_u32 s32, s50, 65536
    buffer_load_dwordx4 v3, s[12:15], s32 offen sc1 lds
    s_waitcnt vmcnt(4)
    s_add_u32 m0, s45, 69632
    s_add_u32 s32, s50, 69632
    buffer_load_dwordx4 v3, s[12:15], s32 offen sc1 lds
    s_waitcnt vmcnt(4)
    s_add_u32 m0, s45, 73728
    s_add_u32 s32, s50, 73728
    buffer_load_dwordx4 v3, s[12:15], s32 offen sc1 lds
    s_waitcnt vmcnt(4)
    s_add_u32 m0, s45, 77824
    s_add_u32 s32, s50, 77824
    buffer_load_dwordx4 v3, s[12:15], s32 offen sc1 lds
    s_waitcnt vmcnt(4)
    s_add_u32 m0, s45, 81920
    s_add_u32 s32, s50, 81920
    buffer_load_dwordx4 v3, s[12:15], s32 offen sc1 lds
    s_waitcnt vmcnt(4)
    s_add_u32 m0, s45, 86016
    s_add_u32 s32, s50, 86016
    buffer_load_dwordx4 v3, s[12:15], s32 offen sc1 lds
    s_waitcnt vmcnt(4)
    s_add_u32 m0, s45, 90112
    s_add_u32 s32, s50, 90112
    buffer_load_dwordx4 v3, s[12:15], s32 offen sc1 lds
    s_waitcnt vmcnt(4)
    s_add_u32 m0, s45, 94208
    s_add_u32 s32, s50, 94208
    buffer_load_dwordx4 v3, s[12:15], s32 offen sc1 lds
    s_waitcnt vmcnt(4)
    s_add_u32 m0, s45, 98304
    s_add_u32 s32, s50, 98304
    buffer_load_dwordx4 v3, s[12:15], s32 offen sc1 lds
    s_waitcnt vmcnt(4)
    s_cmp_eq_u32 s3, 0
    s_cbranch_scc1 interleave_layers__softmax_full_mha__sliding_local_dilated__prompt_kernel_nl
    s_waitcnt vmcnt(0)
    s_barrier
    buffer_load_dword v20, v21, s[12:15], s51 offen
    s_endpgm
interleave_layers__softmax_full_mha__sliding_local_dilated__prompt_kernel_nl:
    s_add_u32 m0, s45, 131072
    s_add_u32 s32, s58, 131072
    buffer_load_dwordx4 v3, s[12:15], s32 offen sc1 lds
    s_waitcnt vmcnt(4)
    s_add_u32 m0, s45, 135168
    s_add_u32 s32, s58, 135168
    buffer_load_dwordx4 v3, s[12:15], s32 offen sc1 lds
    s_waitcnt vmcnt(4)
    s_add_u32 m0, s45, 139264
    s_add_u32 s32, s58, 139264
    buffer_load_dwordx4 v3, s[12:15], s32 offen sc1 lds
    s_waitcnt vmcnt(4)
    s_add_u32 m0, s45, 143360
    s_add_u32 s32, s58, 143360
    buffer_load_dwordx4 v3, s[12:15], s32 offen sc1 lds
    s_waitcnt vmcnt(4)
    s_add_u32 m0, s45, 147456
    s_add_u32 s32, s58, 147456
    buffer_load_dwordx4 v3, s[12:15], s32 offen sc1 lds
    s_waitcnt vmcnt(4)
    s_add_u32 m0, s45, 151552
    s_add_u32 s32, s58, 151552
    buffer_load_dwordx4 v3, s[12:15], s32 offen sc1 lds
    s_waitcnt vmcnt(4)
    s_add_u32 m0, s45, 155648
    s_add_u32 s32, s58, 155648
    buffer_load_dwordx4 v3, s[12:15], s32 offen sc1 lds
    s_waitcnt vmcnt(4)
    s_barrier
    s_add_u32 m0, s45, 102400
    s_add_u32 s32, s58, 102400
    buffer_load_dwordx4 v3, s[12:15], s32 offen sc1 lds
    s_add_u32 m0, s45, 106496
    s_add_u32 s32, s58, 106496
    buffer_load_dwordx4 v3, s[12:15], s32 offen sc1 lds
    s_add_u32 m0, s45, 110592
    s_add_u32 s32, s58, 110592
    buffer_load_dwordx4 v3, s[12:15], s32 offen sc1 lds
    s_add_u32 m0, s45, 114688
    s_add_u32 s32, s58, 114688
    buffer_load_dwordx4 v3, s[12:15], s32 offen sc1 lds
    s_add_u32 m0, s45, 118784
    s_add_u32 s32, s58, 118784
    buffer_load_dwordx4 v3, s[12:15], s32 offen sc1 lds
    s_add_u32 m0, s45, 122880
    s_add_u32 s32, s58, 122880
    buffer_load_dwordx4 v3, s[12:15], s32 offen sc1 lds
    s_add_u32 m0, s45, 126976
    s_add_u32 s32, s58, 126976
    buffer_load_dwordx4 v3, s[12:15], s32 offen sc1 lds
    s_barrier
    s_add_u32 m0, s45, 0
    s_add_u32 s32, s58, 0
    buffer_load_dwordx4 v3, s[12:15], s32 offen sc1 lds
    s_add_u32 m0, s45, 4096
    s_add_u32 s32, s58, 4096
    buffer_load_dwordx4 v3, s[12:15], s32 offen sc1 lds
    s_add_u32 m0, s45, 8192
    s_add_u32 s32, s58, 8192
    buffer_load_dwordx4 v3, s[12:15], s32 offen sc1 lds
    s_add_u32 m0, s45, 12288
    s_add_u32 s32, s58, 12288
    buffer_load_dwordx4 v3, s[12:15], s32 offen sc1 lds
    s_add_u32 m0, s45, 16384
    s_add_u32 s32, s58, 16384
    buffer_load_dwordx4 v3, s[12:15], s32 offen sc1 lds
    s_add_u32 m0, s45, 20480
    s_add_u32 s32, s58, 20480
    buffer_load_dwordx4 v3, s[12:15], s32 offen sc1 lds
    s_add_u32 m0, s45, 24576
    s_add_u32 s32, s58, 24576
    buffer_load_dwordx4 v3, s[12:15], s32 offen sc1 lds
    s_add_u32 m0, s45, 28672
    s_add_u32 s32, s58, 28672
    buffer_load_dwordx4 v3, s[12:15], s32 offen sc1 lds
    s_add_u32 m0, s45, 32768
    s_add_u32 s32, s58, 32768
    buffer_load_dwordx4 v3, s[12:15], s32 offen sc1 lds
    s_add_u32 m0, s45, 36864
    s_add_u32 s32, s58, 36864
    buffer_load_dwordx4 v3, s[12:15], s32 offen sc1 lds
    s_add_u32 m0, s45, 40960
    s_add_u32 s32, s58, 40960
    buffer_load_dwordx4 v3, s[12:15], s32 offen sc1 lds
    s_add_u32 m0, s45, 45056
    s_add_u32 s32, s58, 45056
    buffer_load_dwordx4 v3, s[12:15], s32 offen sc1 lds
    s_add_u32 m0, s45, 49152
    s_add_u32 s32, s58, 49152
    buffer_load_dwordx4 v3, s[12:15], s32 offen sc1 lds
    s_add_u32 m0, s45, 53248
    s_add_u32 s32, s58, 53248
    buffer_load_dwordx4 v3, s[12:15], s32 offen sc1 lds
    s_add_u32 m0, s45, 57344
    s_add_u32 s32, s58, 57344
    buffer_load_dwordx4 v3, s[12:15], s32 offen sc1 lds
    s_barrier
    s_waitcnt vmcnt(0)
    s_add_u32 m0, s45, 61440
    s_add_u32 s32, s58, 61440
    buffer_load_dwordx4 v3, s[12:15], s32 offen sc1 lds
    s_add_u32 m0, s45, 65536
    s_add_u32 s32, s58, 65536
    buffer_load_dwordx4 v3, s[12:15], s32 offen sc1 lds
    s_add_u32 m0, s45, 69632
    s_add_u32 s32, s58, 69632
    buffer_load_dwordx4 v3, s[12:15], s32 offen sc1 lds
    s_waitcnt vmcnt(2)
    s_add_u32 m0, s45, 73728
    s_add_u32 s32, s58, 73728
    buffer_load_dwordx4 v3, s[12:15], s32 offen sc1 lds
    s_waitcnt vmcnt(2)
    s_add_u32 m0, s45, 77824
    s_add_u32 s32, s58, 77824
    buffer_load_dwordx4 v3, s[12:15], s32 offen sc1 lds
    s_waitcnt vmcnt(2)
    s_add_u32 m0, s45, 81920
    s_add_u32 s32, s58, 81920
    buffer_load_dwordx4 v3, s[12:15], s32 offen sc1 lds
    s_waitcnt vmcnt(2)
    s_add_u32 m0, s45, 86016
    s_add_u32 s32, s58, 86016
    buffer_load_dwordx4 v3, s[12:15], s32 offen sc1 lds
    s_waitcnt vmcnt(2)
    s_add_u32 m0, s45, 90112
    s_add_u32 s32, s58, 90112
    buffer_load_dwordx4 v3, s[12:15], s32 offen sc1 lds
    s_waitcnt vmcnt(2)
    s_add_u32 m0, s45, 94208
    s_add_u32 s32, s58, 94208
    buffer_load_dwordx4 v3, s[12:15], s32 offen sc1 lds
    s_waitcnt vmcnt(2)
    s_add_u32 m0, s45, 98304
    s_add_u32 s32, s58, 98304
    buffer_load_dwordx4 v3, s[12:15], s32 offen sc1 lds
    s_waitcnt vmcnt(2)
    s_lshl_b32 s22, s20, 1
    s_and_b32 s23, s21, 1
    s_add_u32 s16, s22, s23
    s_lshr_b32 s17, s21, 1
    s_mul_i32 s51, s16, 163840
    s_lshl_b32 s52, s17, 2
    s_add_u32 s52, s52, s39
    s_mul_i32 s52, s52, 2560
    s_add_u32 s51, s51, s52
    s_add_u32 s51, s51, 131072
    v_min_u32 v21, 39, v1
    v_lshlrev_b32 v21, 6, v21
    s_barrier
    s_add_u32 m0, s45, 159744
    s_add_u32 s32, s58, 159744
    buffer_load_dwordx4 v3, s[12:15], s32 offen sc1 lds
    s_waitcnt vmcnt(0)
    s_barrier
    s_barrier
    v_mov_b32 v243, 163816
    v_mov_b32 v240, 0
    v_mov_b32 v241, 0
    ds_write_b64 v243, v[240:241]
    s_waitcnt lgkmcnt(0)
    s_barrier
    s_branch interleave_layers__softmax_full_mha__sliding_local_dilated__prompt_kernel_t1
interleave_layers__softmax_full_mha__sliding_local_dilated__prompt_kernel_end:
    s_endpgm
interleave_layers__softmax_full_mha__sliding_local_dilated__prompt_kernel_late:
    s_mov_b32 s49, 0
interleave_layers__softmax_full_mha__sliding_local_dilated__prompt_kernel_late1:
    s_sleep 8
    s_mov_b32 exec_lo, 0xffff7fff
    s_mov_b32 exec_hi, 0
    buffer_load_dword v135, v134, s[12:15], 0 offen sc1
    s_mov_b64 exec, -1
    s_add_u32 s49, s49, 1
    s_waitcnt vmcnt(0)
    v_cmp_gt_u32 vcc, v131, v135
    s_cmp_ge_u32 s49, 0x20000
    s_cbranch_scc1 interleave_layers__softmax_full_mha__sliding_local_dilated__prompt_kernel_lok
    s_cbranch_vccnz interleave_layers__softmax_full_mha__sliding_local_dilated__prompt_kernel_late1
    s_branch interleave_layers__softmax_full_mha__sliding_local_dilated__prompt_kernel_lok
interleave_layers__softmax_full_mha__sliding_local_dilated__prompt_kernel_slow:
    s_cmp_eq_u32 s30, 0
    s_cbranch_scc0 interleave_layers__softmax_full_mha__sliding_local_dilated__prompt_kernel_fin
    s_mov_b32 s30, 1
    s_waitcnt vmcnt(0)
    v_mov_b32 v32, 0xff800000
    s_add_u32 s27, s19, 5505024
    s_mov_b32 s31, 0
interleave_layers__softmax_full_mha__sliding_local_dilated__prompt_kernel_mx:
    buffer_load_dwordx4 v[24:27], v22, s[12:15], s27 offen sc1
    buffer_load_dwordx2 v[28:29], v23, s[12:15], s27 offen offset:1024 sc1
    s_waitcnt vmcnt(0)
    v_mfma_f32_32x32x16_bf16 v[56:71], v[24:27], v[8:11], 0
    s_nop 10
    v_mfma_f32_32x32x8_bf16 v[56:71], v[28:29], v[12:13], v[56:71]
    s_nop 12
    v_max3_f32 v32, v56, v57, v32
    v_max3_f32 v32, v58, v59, v32
    v_max3_f32 v32, v60, v61, v32
    v_max3_f32 v32, v62, v63, v32
    v_max3_f32 v32, v64, v65, v32
    v_max3_f32 v32, v66, v67, v32
    v_max3_f32 v32, v68, v69, v32
    v_max3_f32 v32, v70, v71, v32
    s_add_u32 s27, s27, 2560
    s_add_u32 s31, s31, 1
    s_cmp_lt_u32 s31, 64
    s_cbranch_scc1 interleave_layers__softmax_full_mha__sliding_local_dilated__prompt_kernel_mx
    v_mov_b32 v33, v32
    s_nop 1
    v_permlane32_swap_b32 v32, v33
    s_nop 1
    v_max_f32 v32, v32, v33
    v_xor_b32 v32, 0x80000000, v32
    v_mov_b32 v112, v32
    v_mov_b32 v113, v32
    v_mov_b32 v114, v32
    v_mov_b32 v115, v32
    v_mov_b32 v116, v32
    v_mov_b32 v117, v32
    v_mov_b32 v118, v32
    v_mov_b32 v119, v32
    v_mov_b32 v120, v32
    v_mov_b32 v121, v32
    v_mov_b32 v122, v32
    v_mov_b32 v123, v32
    v_mov_b32 v124, v32
    v_mov_b32 v125, v32
    v_mov_b32 v126, v32
    v_mov_b32 v127, v32
    v_mov_b32 v96, 0
    v_mov_b32 v97, 0
    v_mov_b32 v98, 0
    v_mov_b32 v99, 0
    v_mov_b32 v100, 0
    v_mov_b32 v101, 0
    v_mov_b32 v102, 0
    v_mov_b32 v103, 0
    v_mov_b32 v104, 0
    v_mov_b32 v105, 0
    v_mov_b32 v106, 0
    v_mov_b32 v107, 0
    v_mov_b32 v108, 0
    v_mov_b32 v109, 0
    v_mov_b32 v110, 0
    v_mov_b32 v111, 0
    v_mov_b32 v40, v20
    v_mov_b32 v41, v20
    v_mov_b32 v42, v20
    v_mov_b32 v43, v20
    v_mov_b32 v44, v20
    v_mov_b32 v45, v20
    v_mov_b32 v46, v20
    v_mov_b32 v47, v20
    s_add_u32 s27, s19, 5505024
    s_mov_b32 s31, 0
interleave_layers__softmax_full_mha__sliding_local_dilated__prompt_kernel_sl:
    s_mov_b64 exec, s[28:29]
    buffer_load_dwordx4 v[40:43], v21, s[12:15], s27 offen sc1
    buffer_load_dwordx4 v[44:47], v21, s[12:15], s27 offen offset:640 sc1
    s_mov_b64 exec, -1
    buffer_load_dwordx4 v[24:27], v22, s[12:15], s27 offen sc1
    buffer_load_dwordx2 v[28:29], v23, s[12:15], s27 offen offset:1024 sc1
    s_waitcnt vmcnt(0)
    v_mfma_f32_32x32x16_bf16 v[56:71], v[24:27], v[8:11], v[112:127]
    s_nop 10
    v_mfma_f32_32x32x8_bf16 v[56:71], v[28:29], v[12:13], v[56:71]
    s_nop 12
    v_exp_f32 v56, v56
    v_exp_f32 v57, v57
    v_exp_f32 v58, v58
    v_exp_f32 v59, v59
    v_exp_f32 v60, v60
    v_exp_f32 v61, v61
    v_exp_f32 v62, v62
    v_exp_f32 v63, v63
    v_exp_f32 v64, v64
    v_exp_f32 v65, v65
    v_exp_f32 v66, v66
    v_exp_f32 v67, v67
    v_exp_f32 v68, v68
    v_exp_f32 v69, v69
    v_exp_f32 v70, v70
    v_exp_f32 v71, v71
    s_nop 0
    v_cvt_pk_bf16_f32 v88, v56, v57
    v_cvt_pk_bf16_f32 v89, v58, v59
    v_cvt_pk_bf16_f32 v90, v60, v61
    v_cvt_pk_bf16_f32 v91, v62, v63
    v_cvt_pk_bf16_f32 v92, v64, v65
    v_cvt_pk_bf16_f32 v93, v66, v67
    v_cvt_pk_bf16_f32 v94, v68, v69
    v_cvt_pk_bf16_f32 v95, v70, v71
    s_nop 1
    v_mfma_f32_32x32x16_bf16 v[96:111], v[40:43], v[88:91], v[96:111]
    v_mfma_f32_32x32x16_bf16 v[96:111], v[44:47], v[92:95], v[96:111]
    s_add_u32 s27, s27, 2560
    s_add_u32 s31, s31, 1
    s_cmp_lt_u32 s31, 64
    s_cbranch_scc1 interleave_layers__softmax_full_mha__sliding_local_dilated__prompt_kernel_sl
    s_nop 12
    s_branch interleave_layers__softmax_full_mha__sliding_local_dilated__prompt_kernel_chk
.section .rodata,"a"
.p2align 6
.amdhsa_kernel interleave_layers__softmax_full_mha__sliding_local_dilated__prompt_kernel
  .amdhsa_next_free_vgpr 244
  .amdhsa_next_free_sgpr 102
  .amdhsa_accum_offset 244
  .amdhsa_group_segment_fixed_size 0
  .amdhsa_kernarg_size 72
  .amdhsa_user_sgpr_count 2
  .amdhsa_user_sgpr_kernarg_segment_ptr 1
  .amdhsa_system_sgpr_workgroup_id_x 1
.end_amdhsa_kernel
.text
code_end:
```
